```python
import torch

def _softmax(x, axis=-1):
    return torch.softmax(x, dim=axis)
def _gelu(x):
    return torch.nn.functional.gelu(x, approximate="tanh")
def _silu(x):
    return torch.nn.functional.silu(x)
def _sigmoid(x):
    return torch.sigmoid(x)
def _layernorm(x, axis=-1, eps=1e-5):
    m = x.mean(dim=axis, keepdim=True)
    v = x.var(dim=axis, keepdim=True, unbiased=False)
    return (x - m) / torch.sqrt(v + eps)
def _scatter_add(tgt, idx, src, axis=0):
    return tgt.clone().index_add_(axis, idx, src)
def _segment_sum(src, seg, n):
    out = torch.zeros((n,) + src.shape[1:], dtype=src.dtype)
    return out.index_add_(0, seg, src)
def _pad(x, pw):
    flat = tuple(v for pair in reversed(pw) for v in pair)
    return torch.nn.functional.pad(x, flat)

kernel_name = 'interleave_layers__spectral_gfnet__mixer_channel_mlp__prompt'

def setup_inputs():

    _w = (lambda a: (lambda t: t.to(torch.bfloat16) if t.is_floating_point() else t)(torch.as_tensor(a)))
    def _A_setup():
        B, S, D = 1, 2048, 640
        Df = D // 2 + 1
        return {
            "x": _w((lambda *s: torch.randn(*s, dtype=torch.bfloat16) * 0.05)(B, S, D)),
            "w_r": _w((lambda *s: torch.randn(*s, dtype=torch.bfloat16) * 0.8)(S, Df) * 0.02),
            "w_i": _w((lambda *s: torch.randn(*s, dtype=torch.bfloat16) * 0.8)(S, Df) * 0.02),
        }
    _A_in = _A_setup()

    def _B_setup():
        B, S, D, F = 1, 2048, 640, 1728
        return {
            "x": _w((lambda *s: torch.randn(*s, dtype=torch.bfloat16) * 0.05)(B, S, D)),
            "w1": _w((lambda *s: torch.randn(*s, dtype=torch.bfloat16) * 0.8)(D, F) * (D ** -0.5)),
            "b1": _w((lambda *s: torch.randn(*s, dtype=torch.bfloat16) * 0.4)(F)),
            "w2": _w((lambda *s: torch.randn(*s, dtype=torch.bfloat16) * 0.05)(F, D) * (F ** -0.5)),
            "b2": _w((lambda *s: torch.randn(*s, dtype=torch.bfloat16) * 0.05)(D)),
        }
    _B_in = _B_setup()

    return {
        "A_x": _A_in["x"],
        "A_w_r": _A_in["w_r"],
        "A_w_i": _A_in["w_i"],
        "B_x": _B_in["x"],
        "B_w1": _B_in["w1"],
        "B_b1": _B_in["b1"],
        "B_w2": _B_in["w2"],
        "B_b2": _B_in["b2"],
    }

def reference(A_x, A_w_r, A_w_i, B_x, B_w1, B_b1, B_w2, B_b2):
    def _A_ref(x, w_r, w_i):
        B, S, D = x.shape
        X = (lambda x, axes=(-2,-1): torch.fft.rfft2(x.float(), dim=axes))(x, axes=(-2, -1))
        W = w_r + 1j * w_i
        X = X * W
        y = (lambda x, s, axes=(-2,-1): torch.fft.irfft2(x, s=s, dim=axes).to(torch.bfloat16))(X, (S, D), axes=(-2, -1))
        return y

    def _B_ref(x, w1, b1, w2, b2):
        y = _layernorm(x, axis=-1)
        h = _gelu(torch.einsum("bsd,df->bsf", y, w1) + b1)
        return torch.einsum("bsf,fd->bsd", h, w2) + b2

    x = A_x
    x = x + _A_ref(_layernorm(x, axis=-1), A_w_r, A_w_i)
    x = x + _B_ref(_layernorm(x, axis=-1), B_w1, B_b1, B_w2, B_b2)
    x = x + _A_ref(_layernorm(x, axis=-1), A_w_r, A_w_i)
    x = x + _B_ref(_layernorm(x, axis=-1), B_w1, B_b1, B_w2, B_b2)
    return x
```

```asm
; @launch kernel=mk_kernel grid=(256,1,1) block=(256,1,1) lds=163840
.amdgcn_target "amdgcn-amd-amdhsa--gfx950"
.text
.globl mk_kernel
.p2align 8
.type mk_kernel,@function
mk_kernel:
mk_kernel_code:
    s_load_dwordx16 s[8:23], s[0:1], 0
    s_load_dwordx4 s[24:27], s[0:1], 64
    s_load_dwordx2 s[28:29], s[0:1], 80
    v_lshrrev_b32 v3, 6, v0
    v_and_b32 v1, 15, v0
    v_readfirstlane_b32 s56, v3
    v_bfe_u32 v2, v0, 4, 2
    v_and_b32 v3, 63, v0
    s_cmp_ge_u32 s2, 256
    s_nop 2
    s_cbranch_scc1 mk_kernel_r1
    s_sub_u32 s57, s2, 0
    s_cmp_ge_u32 s2, 8
    s_cbranch_scc1 f_npf
    s_getpc_b64 s[52:53]
    s_add_u32 s52, s52, mk_kernel_code@rel32@lo+4
    s_addc_u32 s53, s53, mk_kernel_code@rel32@hi+12
    s_and_b32 s53, s53, 0xffff
    s_mov_b32 s54, mk_kernel_cend-mk_kernel_code
    s_mov_b32 s55, 0x20000
    v_lshlrev_b32 v4, 7, v0
    s_mov_b32 s64, 0
    buffer_load_dword a253, v4, s[52:55], s64 offen
    s_mov_b32 s64, 32768
    buffer_load_dword a253, v4, s[52:55], s64 offen
    s_mov_b32 s64, 65536
    buffer_load_dword a253, v4, s[52:55], s64 offen
    s_add_u32 s57, s2, 160
f_npf:
    s_sub_u32 s57, s57, 8
    s_cmp_ge_u32 s2, 160
    s_cselect_b32 s3, s2, s57
    s_lshl_b32 s62, s56, 10
    s_cmp_ge_u32 s3, 128
    s_cbranch_scc1 f_pb
    s_and_b32 s58, s3, 7
    s_lshr_b32 s57, s3, 3
    s_lshl4_add_u32 s57, s58, s57
    s_mov_b32 s3, s57
    s_and_b32 s60, s57, 1
    s_lshl_b32 s60, s60, 3
    s_lshr_b32 s58, s57, 5
    s_lshl4_add_u32 s60, s58, s60
    s_bfe_u32 s58, s57, 0x20001
    s_lshl_b32 s58, s58, 8
    s_add_u32 s60, s60, s58
    s_and_b32 s58, s57, 8
    s_lshl4_add_u32 s60, s58, s60
    s_and_b32 s58, s57, 16
    s_lshl_b32 s58, s58, 6
    s_add_u32 s60, s60, s58
    s_lshl1_add_u32 s60, s56, s60
    v_and_b32 v4, 1, v2
    v_lshlrev_b32 v4, 6, v4
    v_lshrrev_b32 v6, 1, v2
    v_add3_u32 v4, v4, v6, s60
    s_and_b32 s58, s56, 1
    s_lshl_b32 s58, s58, 1
    s_xor_b32 s58, s58, s56
    s_lshl_b32 s58, s58, 2
    v_or_b32 v5, s58, v2
    v_xor_b32 v5, v5, v1
    v_mul_u32_u24 v4, 1280, v4
    v_lshl_add_u32 v4, v5, 4, v4
    s_waitcnt lgkmcnt(0)
    s_mov_b32 s32, s8
    s_and_b32 s33, s9, 0xffff
    s_mov_b32 s34, 2621440
    s_mov_b32 s35, 0x20000
    s_add_u32 m0, s62, 0
    s_nop 0
    buffer_load_dwordx4 v4, s[32:35], 0 offen offset:0 nt lds
    s_add_u32 m0, s62, 3840
    s_nop 0
    buffer_load_dwordx4 v4, s[32:35], 0 offen offset:256 nt lds
    s_add_u32 m0, s62, 7680
    s_nop 0
    buffer_load_dwordx4 v4, s[32:35], 0 offen offset:512 nt lds
    s_add_u32 m0, s62, 11520
    s_nop 0
    buffer_load_dwordx4 v4, s[32:35], 0 offen offset:768 nt lds
    s_add_u32 m0, s62, 15360
    s_nop 0
    buffer_load_dwordx4 v4, s[32:35], 0 offen offset:1024 nt lds
    s_bfe_u32 s58, s3, 0x20001
    s_lshl_b32 s60, s58, 7
    s_lshr_b32 s58, s3, 5
    s_lshl_b32 s58, s58, 9
    s_add_u32 s60, s60, s58
    s_and_b32 s58, s3, 8
    s_lshl3_add_u32 s60, s58, s60
    s_and_b32 s58, s3, 16
    s_add_u32 s60, s60, s58
    s_and_b32 s58, s3, 1
    s_lshl3_add_u32 s60, s58, s60
    s_and_b32 s58, s56, 2
    s_lshl4_add_u32 s60, s58, s60
    s_mul_i32 s60, s60, 642
    s_add_u32 s61, s60, 4096
    s_mul_i32 s63, s56, 5248
    s_mov_b32 s34, 1314816
    s_add_u32 m0, s63, 24576
    s_bitcmp1_b32 s56, 0
    s_cselect_b32 s32, s12, s10
    s_cselect_b32 s33, s13, s11
    s_and_b32 s33, s33, 0xffff
    v_lshlrev_b32 v4, 4, v3
    buffer_load_dwordx4 v4, s[32:35], s60 offen offset:0 nt lds
    buffer_load_dwordx4 v4, s[32:35], s60 offen offset:1024 nt lds
    buffer_load_dwordx4 v4, s[32:35], s60 offen offset:2048 nt lds
    s_add_u32 s36, s28, 6979584
    s_addc_u32 s37, s29, 0
    s_and_b32 s37, s37, 0xffff
    s_mov_b32 s38, 2662400
    s_mov_b32 s39, 0x20000
    s_mov_b32 s96, 0
    s_branch f_gen
f_pb:
    s_sub_u32 s57, 255, s3
    s_and_b32 s58, s57, 7
    s_lshr_b32 s59, s57, 5
    s_lshl3_add_u32 s58, s59, s58
    s_bfe_u32 s59, s57, 0x20003
    s_lshl2_add_u32 s67, s58, s59
    s_and_b32 s58, s3, 7
    s_bfe_u32 s59, s3, 0x10003
    s_lshl1_add_u32 s58, s58, s59
    s_add_u32 s58, s58, 92
    s_cmp_lt_u32 s67, 92
    s_cselect_b32 s67, s67, 108
    s_cmp_lt_u32 s3, 144
    s_cselect_b32 s67, s58, s67
    s_sub_u32 s57, 252, s3
    s_min_u32 s57, s57, 112
    s_cmp_ge_u32 s67, 108
    s_cbranch_scc1 f_p2
    s_and_b32 s58, s56, 1
    s_lshl_b32 s58, s58, 2
    v_lshrrev_b32 v4, 1, v3
    v_xor_b32 v4, s58, v4
    v_mul_u32_u24 v4, 3456, v4
    v_and_b32 v5, 1, v3
    v_lshl_add_u32 v4, v5, 4, v4
    s_mul_i32 s58, s56, 110592
    s_lshl_b32 s59, s67, 5
    s_add_u32 s58, s58, s59
    v_add_u32 v4, s58, v4
    v_and_b32 v144, 31, v3
    v_bfe_u32 v145, v3, 5, 1
    v_lshl_add_u32 v144, v145, 7, v144
    v_lshl_add_u32 v144, s56, 5, v144
    v_lshlrev_b32 v144, 7, v144
    v_add_u32 v144, 311296, v144
    s_lshl_b32 s58, s3, 2
    v_and_or_b32 v147, v0, 3, s58
    v_bfe_u32 v145, v0, 2, 1
    v_mad_u32_u24 v146, v145, 3, 4
    v_lshlrev_b32 v147, v146, v147
    v_lshl_add_u32 v147, v145, 14, v147
    v_lshrrev_b32 v145, 3, v0
    v_lshl_add_u32 v147, v145, 20, v147
    v_mov_b32 v148, 0
    v_mov_b32 v149, 0
    v_mov_b32 v150, 0
    v_mov_b32 v151, 0
    s_lshl_b32 s58, s3, 7
    s_add_u32 s65, s58, 311296
    s_add_u32 s58, s58, -114688
    v_lshl_add_u32 v145, v0, 15, s58
    v_subrev_u32 v146, 8, v0
    v_cmp_gt_u32 s[68:69], 5, v146
    s_nop 1
    v_cndmask_b32_e64 v147, v147, v145, s[68:69]
    s_waitcnt lgkmcnt(0)
    s_add_u32 s44, s28, 12271616
    s_addc_u32 s45, s29, 0
    s_and_b32 s45, s45, 0xffff
    s_mov_b32 s46, 344064
    s_mov_b32 s47, 0x20000
    buffer_load_dword a254, v144, s[44:47], 0 offen
    buffer_load_dword a255, off, s[44:47], s65
    buffer_store_dwordx4 v[148:151], v147, s[44:47], 0 offen sc1
    s_mov_b32 s32, s16
    s_and_b32 s33, s17, 0xffff
    s_mov_b32 s34, 2211840
    s_mov_b32 s35, 0x20000
    s_and_b32 s60, s67, 3
    s_lshl_b32 s58, s60, 12
    s_add_u32 m0, s62, s58
    s_mul_i32 s64, s60, 442368
    buffer_load_dwordx4 v4, s[32:35], s64 offen lds
    s_add_u32 s60, s60, 1
    s_cmp_eq_u32 s60, 5
    s_cselect_b32 s60, 0, s60
    s_lshl_b32 s58, s60, 12
    s_add_u32 m0, s62, s58
    s_mul_i32 s64, s60, 442368
    buffer_load_dwordx4 v4, s[32:35], s64 offen lds
    s_add_u32 s60, s60, 1
    s_cmp_eq_u32 s60, 5
    s_cselect_b32 s60, 0, s60
    s_lshl_b32 s58, s60, 12
    s_add_u32 m0, s62, s58
    s_mul_i32 s64, s60, 442368
    buffer_load_dwordx4 v4, s[32:35], s64 offen lds
    s_add_u32 s60, s60, 1
    s_cmp_eq_u32 s60, 5
    s_cselect_b32 s60, 0, s60
    s_lshl_b32 s58, s60, 12
    s_add_u32 m0, s62, s58
    s_mul_i32 s64, s60, 442368
    buffer_load_dwordx4 v4, s[32:35], s64 offen lds
    s_add_u32 s60, s60, 1
    s_cmp_eq_u32 s60, 5
    s_cselect_b32 s60, 0, s60
    s_lshl_b32 s58, s60, 12
    s_add_u32 m0, s62, s58
    s_mul_i32 s64, s60, 442368
    buffer_load_dwordx4 v4, s[32:35], s64 offen lds
    s_mov_b32 s40, s18
    s_and_b32 s41, s19, 0xffff
    s_mov_b32 s42, 3456
    s_mov_b32 s43, 0x20000
    v_lshl_add_u32 v4, v1, 1, s59
    buffer_load_ushort a251, v4, s[40:43], 0 offen
    s_add_u32 s36, s28, 32768
    s_addc_u32 s37, s29, 0
    s_and_b32 s37, s37, 0xffff
    s_mov_b32 s38, 2211840
    s_mov_b32 s39, 0x20000
    s_mov_b32 s96, 1
    s_branch f_gen
f_p2:
    s_lshl_b32 s60, s57, 4
    s_cmp_eq_u32 s57, 108
    s_cselect_b32 s60, 0, s60
    s_lshl2_add_u32 s60, s56, s60
    v_add_u32 v4, s60, v2
    s_and_b32 s58, s56, 1
    s_lshl_b32 s58, s58, 1
    s_xor_b32 s58, s58, s56
    s_lshl_b32 s58, s58, 2
    v_or_b32 v5, s58, v2
    v_xor_b32 v5, v5, v1
    v_mul_u32_u24 v4, 1280, v4
    v_lshl_add_u32 v4, v5, 4, v4
    s_waitcnt lgkmcnt(0)
    s_cmp_eq_u32 s57, 108
    s_mov_b32 s34, 2211840
    s_mov_b32 s35, 0x20000
    s_cselect_b32 s34, 1280, s34
    s_cselect_b32 s32, s22, s20
    s_cselect_b32 s33, s23, s21
    s_and_b32 s33, s33, 0xffff
    s_add_u32 m0, s62, 24576
    s_nop 0
    buffer_load_dwordx4 v4, s[32:35], 0 offen offset:0 nt lds
    s_add_u32 m0, s62, 28416
    s_nop 0
    buffer_load_dwordx4 v4, s[32:35], 0 offen offset:256 nt lds
    s_add_u32 m0, s62, 32256
    s_nop 0
    buffer_load_dwordx4 v4, s[32:35], 0 offen offset:512 nt lds
    s_add_u32 m0, s62, 36096
    s_nop 0
    buffer_load_dwordx4 v4, s[32:35], 0 offen offset:768 nt lds
    s_add_u32 m0, s62, 39936
    s_nop 0
    buffer_load_dwordx4 v4, s[32:35], 0 offen offset:1024 nt lds
    v_and_b32 v144, 31, v3
    v_bfe_u32 v145, v3, 5, 1
    v_lshl_add_u32 v144, v145, 7, v144
    v_lshl_add_u32 v144, s56, 5, v144
    v_lshlrev_b32 v144, 7, v144
    v_add_u32 v144, 311296, v144
    s_lshl_b32 s58, s3, 2
    v_and_or_b32 v147, v0, 3, s58
    v_bfe_u32 v145, v0, 2, 1
    v_mad_u32_u24 v146, v145, 3, 4
    v_lshlrev_b32 v147, v146, v147
    v_lshl_add_u32 v147, v145, 14, v147
    v_lshrrev_b32 v145, 3, v0
    v_lshl_add_u32 v147, v145, 20, v147
    v_mov_b32 v148, 0
    v_mov_b32 v149, 0
    v_mov_b32 v150, 0
    v_mov_b32 v151, 0
    s_lshl_b32 s58, s3, 7
    s_add_u32 s65, s58, 311296
    s_add_u32 s58, s58, -114688
    v_lshl_add_u32 v145, v0, 15, s58
    v_subrev_u32 v146, 8, v0
    v_cmp_gt_u32 s[68:69], 5, v146
    s_nop 1
    v_cndmask_b32_e64 v147, v147, v145, s[68:69]
    s_add_u32 s44, s28, 12271616
    s_addc_u32 s45, s29, 0
    s_and_b32 s45, s45, 0xffff
    s_mov_b32 s46, 344064
    s_mov_b32 s47, 0x20000
    buffer_load_dword a254, v144, s[44:47], 0 offen
    buffer_load_dword a255, off, s[44:47], s65
    buffer_store_dwordx4 v[148:151], v147, s[44:47], 0 offen sc1
    s_mov_b32 s96, 2
f_gen:
    s_mov_b32 s97, 0x3d64f92e
    s_cmp_eq_u32 s96, 0
    s_cselect_b32 s97, 0xce4f92e, s97
    v_bfe_u32 v144, v1, 1, 1
    v_lshlrev_b32 v144, 4, v144
    v_mov_b32 v145, 0xffff
    v_lshlrev_b32 v144, v144, v145
    v_lshrrev_b32 v145, 2, v1
    v_cmp_eq_u32 vcc, 0, v145
    s_nop 1
    v_cndmask_b32 v10, 0, v144, vcc
    v_cmp_eq_u32 vcc, 1, v145
    s_nop 1
    v_cndmask_b32 v11, 0, v144, vcc
    v_cmp_eq_u32 vcc, 2, v145
    s_nop 1
    v_cndmask_b32 v12, 0, v144, vcc
    v_cmp_eq_u32 vcc, 3, v145
    s_nop 1
    v_cndmask_b32 v13, 0, v144, vcc
    v_and_b32 v15, 1, v1
    v_cvt_f32_u32 v17, v15
    v_mul_f32 v17, 0.5, v17
    v_lshrrev_b32 v18, 1, v1
    v_cvt_f32_u32 v18, v18
    v_mul_f32 v18, 0x3d000000, v18
    v_cvt_f32_u32 v35, v2
    s_cmp_eq_u32 s56, 3
    s_nop 2
    s_cbranch_scc1 f_sp
    s_mul_i32 s66, s56, 3
    s_add_u32 s66, s66, 1
    v_mul_f32 v17, 0.5, v17
    v_cvt_f32_u32 v19, s66
    v_fmamk_f32 v18, v19, 0x3acccccd, v18
    v_mul_f32 v19, 0x3d4ccccd, v19
    v_mul_u32_u24 v15, 0x8000, v15
    v_lshl_or_b32 v15, v15, 16, v15
    v_xor_b32 v16, 0x80008000, v15
    v_and_b32 v14, 1, v2
    v_mul_u32_u24 v14, 0x8000, v14
    v_lshl_or_b32 v14, v14, 16, v14
    v_fma_f32 v144, v35, v19, v17
    v_fmamk_f32 v145, v19, 0x40800000, v144
    v_fmamk_f32 v146, v19, 0x41000000, v144
    v_fmamk_f32 v147, v19, 0x41400000, v144
    v_fmamk_f32 v148, v19, 0x41800000, v144
    v_cos_f32 v144, v144
    v_cos_f32 v145, v145
    v_cos_f32 v146, v146
    v_cos_f32 v147, v147
    v_cos_f32 v148, v148
    v_mul_f32 v144, s97, v144
    v_mul_f32 v145, s97, v145
    v_mul_f32 v146, s97, v146
    v_mul_f32 v147, s97, v147
    v_mul_f32 v148, s97, v148
    v_cvt_pk_bf16_f32 v144, v144, v144
    v_cvt_pk_bf16_f32 v145, v145, v145
    v_cvt_pk_bf16_f32 v146, v146, v146
    v_cvt_pk_bf16_f32 v147, v147, v147
    v_cvt_pk_bf16_f32 v148, v148, v148
    v_and_b32 v36, v10, v144
    v_and_b32 v37, v11, v144
    v_and_b32 v38, v12, v144
    v_and_b32 v39, v13, v144
    v_and_b32 v40, v10, v145
    v_and_b32 v41, v11, v145
    v_and_b32 v42, v12, v145
    v_and_b32 v43, v13, v145
    v_and_b32 v44, v10, v146
    v_and_b32 v45, v11, v146
    v_and_b32 v46, v12, v146
    v_and_b32 v47, v13, v146
    v_and_b32 v48, v10, v147
    v_and_b32 v49, v11, v147
    v_and_b32 v50, v12, v147
    v_and_b32 v51, v13, v147
    v_and_b32 v52, v10, v148
    v_and_b32 v53, v11, v148
    v_and_b32 v54, v12, v148
    v_and_b32 v55, v13, v148
    v_mul_f32 v152, v35, v18
    v_fma_f32 v144, v152, 2.0, v17
    v_fmamk_f32 v145, v18, 0x3f800000, v144
    v_fmamk_f32 v146, v18, 0x41000000, v144
    v_fmamk_f32 v147, v18, 0x41100000, v144
    v_fmamk_f32 v148, v18, 0x41800000, v144
    v_fmamk_f32 v149, v18, 0x41880000, v144
    v_fmamk_f32 v150, v18, 0x41c00000, v144
    v_fmamk_f32 v151, v18, 0x41c80000, v144
    v_sin_f32 v152, v144
    v_cos_f32 v144, v144
    v_sin_f32 v153, v145
    v_cos_f32 v145, v145
    v_sin_f32 v154, v146
    v_cos_f32 v146, v146
    v_sin_f32 v155, v147
    v_cos_f32 v147, v147
    v_sin_f32 v156, v148
    v_cos_f32 v148, v148
    v_sin_f32 v157, v149
    v_cos_f32 v149, v149
    v_sin_f32 v158, v150
    v_cos_f32 v150, v150
    v_sin_f32 v159, v151
    v_cos_f32 v151, v151
    v_cvt_pk_bf16_f32 v96, v144, v152
    v_cvt_pk_bf16_f32 v97, v145, v153
    v_cvt_pk_bf16_f32 v105, -v153, v145
    v_cvt_pk_bf16_f32 v98, v146, v154
    v_cvt_pk_bf16_f32 v99, v147, v155
    v_cvt_pk_bf16_f32 v107, -v155, v147
    v_cvt_pk_bf16_f32 v100, v148, v156
    v_cvt_pk_bf16_f32 v101, v149, v157
    v_cvt_pk_bf16_f32 v109, -v157, v149
    v_cvt_pk_bf16_f32 v102, v150, v158
    v_cvt_pk_bf16_f32 v103, v151, v159
    v_cvt_pk_bf16_f32 v111, -v159, v151
    v_xor_b32 v104, v14, v96
    v_xor_b32 v105, v14, v105
    v_xor_b32 v106, v14, v98
    v_xor_b32 v107, v14, v107
    v_xor_b32 v108, v14, v100
    v_xor_b32 v109, v14, v109
    v_xor_b32 v110, v14, v102
    v_xor_b32 v111, v14, v111
    v_add_f32 v18, 0x3acccccd, v18
    v_add_f32 v19, 0x3d4ccccd, v19
    v_fma_f32 v144, v35, v19, v17
    v_fmamk_f32 v145, v19, 0x40800000, v144
    v_fmamk_f32 v146, v19, 0x41000000, v144
    v_fmamk_f32 v147, v19, 0x41400000, v144
    v_fmamk_f32 v148, v19, 0x41800000, v144
    v_cos_f32 v144, v144
    v_cos_f32 v145, v145
    v_cos_f32 v146, v146
    v_cos_f32 v147, v147
    v_cos_f32 v148, v148
    v_mul_f32 v144, s97, v144
    v_mul_f32 v145, s97, v145
    v_mul_f32 v146, s97, v146
    v_mul_f32 v147, s97, v147
    v_mul_f32 v148, s97, v148
    v_cvt_pk_bf16_f32 v144, v144, v144
    v_cvt_pk_bf16_f32 v145, v145, v145
    v_cvt_pk_bf16_f32 v146, v146, v146
    v_cvt_pk_bf16_f32 v147, v147, v147
    v_cvt_pk_bf16_f32 v148, v148, v148
    v_and_b32 v56, v10, v144
    v_and_b32 v57, v11, v144
    v_and_b32 v58, v12, v144
    v_and_b32 v59, v13, v144
    v_and_b32 v60, v10, v145
    v_and_b32 v61, v11, v145
    v_and_b32 v62, v12, v145
    v_and_b32 v63, v13, v145
    v_and_b32 v64, v10, v146
    v_and_b32 v65, v11, v146
    v_and_b32 v66, v12, v146
    v_and_b32 v67, v13, v146
    v_and_b32 v68, v10, v147
    v_and_b32 v69, v11, v147
    v_and_b32 v70, v12, v147
    v_and_b32 v71, v13, v147
    v_and_b32 v72, v10, v148
    v_and_b32 v73, v11, v148
    v_and_b32 v74, v12, v148
    v_and_b32 v75, v13, v148
    v_mul_f32 v152, v35, v18
    v_fma_f32 v144, v152, 2.0, v17
    v_fmamk_f32 v145, v18, 0x3f800000, v144
    v_fmamk_f32 v146, v18, 0x41000000, v144
    v_fmamk_f32 v147, v18, 0x41100000, v144
    v_fmamk_f32 v148, v18, 0x41800000, v144
    v_fmamk_f32 v149, v18, 0x41880000, v144
    v_fmamk_f32 v150, v18, 0x41c00000, v144
    v_fmamk_f32 v151, v18, 0x41c80000, v144
    v_sin_f32 v152, v144
    v_cos_f32 v144, v144
    v_sin_f32 v153, v145
    v_cos_f32 v145, v145
    v_sin_f32 v154, v146
    v_cos_f32 v146, v146
    v_sin_f32 v155, v147
    v_cos_f32 v147, v147
    v_sin_f32 v156, v148
    v_cos_f32 v148, v148
    v_sin_f32 v157, v149
    v_cos_f32 v149, v149
    v_sin_f32 v158, v150
    v_cos_f32 v150, v150
    v_sin_f32 v159, v151
    v_cos_f32 v151, v151
    v_cvt_pk_bf16_f32 v112, v144, v152
    v_cvt_pk_bf16_f32 v113, v145, v153
    v_cvt_pk_bf16_f32 v121, -v153, v145
    v_cvt_pk_bf16_f32 v114, v146, v154
    v_cvt_pk_bf16_f32 v115, v147, v155
    v_cvt_pk_bf16_f32 v123, -v155, v147
    v_cvt_pk_bf16_f32 v116, v148, v156
    v_cvt_pk_bf16_f32 v117, v149, v157
    v_cvt_pk_bf16_f32 v125, -v157, v149
    v_cvt_pk_bf16_f32 v118, v150, v158
    v_cvt_pk_bf16_f32 v119, v151, v159
    v_cvt_pk_bf16_f32 v127, -v159, v151
    v_xor_b32 v120, v14, v112
    v_xor_b32 v121, v14, v121
    v_xor_b32 v122, v14, v114
    v_xor_b32 v123, v14, v123
    v_xor_b32 v124, v14, v116
    v_xor_b32 v125, v14, v125
    v_xor_b32 v126, v14, v118
    v_xor_b32 v127, v14, v127
    v_add_f32 v18, 0x3acccccd, v18
    v_add_f32 v19, 0x3d4ccccd, v19
    v_fma_f32 v144, v35, v19, v17
    v_fmamk_f32 v145, v19, 0x40800000, v144
    v_fmamk_f32 v146, v19, 0x41000000, v144
    v_fmamk_f32 v147, v19, 0x41400000, v144
    v_fmamk_f32 v148, v19, 0x41800000, v144
    v_cos_f32 v144, v144
    v_cos_f32 v145, v145
    v_cos_f32 v146, v146
    v_cos_f32 v147, v147
    v_cos_f32 v148, v148
    v_mul_f32 v144, s97, v144
    v_mul_f32 v145, s97, v145
    v_mul_f32 v146, s97, v146
    v_mul_f32 v147, s97, v147
    v_mul_f32 v148, s97, v148
    v_cvt_pk_bf16_f32 v144, v144, v144
    v_cvt_pk_bf16_f32 v145, v145, v145
    v_cvt_pk_bf16_f32 v146, v146, v146
    v_cvt_pk_bf16_f32 v147, v147, v147
    v_cvt_pk_bf16_f32 v148, v148, v148
    v_and_b32 v76, v10, v144
    v_and_b32 v77, v11, v144
    v_and_b32 v78, v12, v144
    v_and_b32 v79, v13, v144
    v_and_b32 v80, v10, v145
    v_and_b32 v81, v11, v145
    v_and_b32 v82, v12, v145
    v_and_b32 v83, v13, v145
    v_and_b32 v84, v10, v146
    v_and_b32 v85, v11, v146
    v_and_b32 v86, v12, v146
    v_and_b32 v87, v13, v146
    v_and_b32 v88, v10, v147
    v_and_b32 v89, v11, v147
    v_and_b32 v90, v12, v147
    v_and_b32 v91, v13, v147
    v_and_b32 v92, v10, v148
    v_and_b32 v93, v11, v148
    v_and_b32 v94, v12, v148
    v_and_b32 v95, v13, v148
    v_mul_f32 v152, v35, v18
    v_fma_f32 v144, v152, 2.0, v17
    v_fmamk_f32 v145, v18, 0x3f800000, v144
    v_fmamk_f32 v146, v18, 0x41000000, v144
    v_fmamk_f32 v147, v18, 0x41100000, v144
    v_fmamk_f32 v148, v18, 0x41800000, v144
    v_fmamk_f32 v149, v18, 0x41880000, v144
    v_fmamk_f32 v150, v18, 0x41c00000, v144
    v_fmamk_f32 v151, v18, 0x41c80000, v144
    v_sin_f32 v152, v144
    v_cos_f32 v144, v144
    v_sin_f32 v153, v145
    v_cos_f32 v145, v145
    v_sin_f32 v154, v146
    v_cos_f32 v146, v146
    v_sin_f32 v155, v147
    v_cos_f32 v147, v147
    v_sin_f32 v156, v148
    v_cos_f32 v148, v148
    v_sin_f32 v157, v149
    v_cos_f32 v149, v149
    v_sin_f32 v158, v150
    v_cos_f32 v150, v150
    v_sin_f32 v159, v151
    v_cos_f32 v151, v151
    v_cvt_pk_bf16_f32 v128, v144, v152
    v_cvt_pk_bf16_f32 v129, v145, v153
    v_cvt_pk_bf16_f32 v137, -v153, v145
    v_cvt_pk_bf16_f32 v130, v146, v154
    v_cvt_pk_bf16_f32 v131, v147, v155
    v_cvt_pk_bf16_f32 v139, -v155, v147
    v_cvt_pk_bf16_f32 v132, v148, v156
    v_cvt_pk_bf16_f32 v133, v149, v157
    v_cvt_pk_bf16_f32 v141, -v157, v149
    v_cvt_pk_bf16_f32 v134, v150, v158
    v_cvt_pk_bf16_f32 v135, v151, v159
    v_cvt_pk_bf16_f32 v143, -v159, v151
    v_xor_b32 v136, v14, v128
    v_xor_b32 v137, v14, v137
    v_xor_b32 v138, v14, v130
    v_xor_b32 v139, v14, v139
    v_xor_b32 v140, v14, v132
    v_xor_b32 v141, v14, v141
    v_xor_b32 v142, v14, v134
    v_xor_b32 v143, v14, v143
    s_cmp_eq_u32 s96, 1
    s_nop 2
    s_cbranch_scc1 f_t_w1
    s_cmp_eq_u32 s96, 2
    s_cbranch_scc1 f_t_w2
    v_lshlrev_b32 v4, 4, v3
    buffer_load_dwordx4 v4, s[32:35], s60 offen offset:3072 nt lds
    s_add_u32 m0, s63, 28672
    s_nop 0
    buffer_load_dwordx4 v4, s[32:35], s61 offen offset:0 nt lds
    s_mov_b64 exec, 1
    buffer_load_dwordx4 v4, s[32:35], s61 offen offset:1024 nt lds
    s_mov_b64 exec, -1
    s_add_u32 s48, s28, 9641984
    s_addc_u32 s49, s29, 0
    s_and_b32 s49, s49, 0xffff
    s_mov_b32 s50, 2621440
    s_mov_b32 s51, 0x20000
    v_bfe_u32 v17, v3, 3, 1
    v_lshlrev_b32 v17, 2, v17
    v_add_u32 v17, v17, v2
    s_cmp_lt_u32 s56, 2
    s_cselect_b32 s98, 1, -1
    s_mul_i32 s58, s98, 80
    s_mul_i32 s59, s98, 40
    v_mul_i32_i24 v10, s58, v17
    v_and_b32 v17, 7, v3
    v_mul_u32_u24 v11, 642, v17
    v_add_u32 v10, v10, v11
    s_mul_i32 s99, s56, 5
    s_sub_u32 s100, 325, s99
    s_cmp_lt_u32 s56, 2
    s_cselect_b32 s100, s99, s100
    s_lshl_b32 s100, s100, 1
    v_add_u32 v10, s100, v10
    v_add_u32 v11, s59, v10
    v_cmp_gt_u32 vcc, 8, v0
    v_add_u32 v12, 640, v10
    s_nop 0
    v_cndmask_b32 v12, v10, v12, vcc
    v_lshrrev_b32 v13, 3, v3
    v_lshlrev_b32 v13, 14, v13
    v_lshl_add_u32 v13, v17, 4, v13
    s_lshl_b32 s58, s3, 7
    s_lshr_b32 s59, s56, 1
    s_lshl_b32 s59, s59, 17
    s_add_u32 s58, s58, s59
    v_add_u32 v13, s58, v13
    s_sub_u32 s100, s99, 5
    s_cmp_lt_u32 s56, 2
    s_cselect_b32 s99, s99, s100
    v_and_b32 v5, 4, v1
    v_lshlrev_b32 v5, 1, v5
    v_xor_b32 v5, v5, v1
    v_lshlrev_b32 v6, 2, v2
    v_xor_b32 v5, v5, v6
    v_lshlrev_b32 v5, 4, v5
    v_lshl_add_u32 v5, v1, 8, v5
    v_xor_b32 v6, 16, v5
    v_xor_b32 v7, 32, v5
    v_xor_b32 v8, 48, v5
    v_and_b32 v4, 1, v1
    v_lshl_add_u32 v9, v2, 1, v4
    v_mul_u32_u24 v9, 16640, v9
    v_and_b32 v4, 14, v1
    v_lshl_add_u32 v9, v4, 3, v9
    s_mul_i32 s58, s66, 266240
    s_lshl_b32 s59, s57, 7
    s_mov_b32 vcc_lo, 0x55555555
    s_mov_b32 vcc_hi, 0x55555555
    s_add_u32 s58, s58, s59
    v_add_u32 v9, s58, v9
    v_and_b32 v144, 31, v3
    v_bfe_u32 v145, v3, 5, 1
    v_lshl_add_u32 v144, v145, 7, v144
    v_lshl_add_u32 v144, s56, 5, v144
    v_lshlrev_b32 v144, 7, v144
    v_add_u32 v144, 311296, v144
    s_lshl_b32 s58, s3, 2
    v_and_or_b32 v147, v0, 3, s58
    v_bfe_u32 v145, v0, 2, 1
    v_mad_u32_u24 v146, v145, 3, 4
    v_lshlrev_b32 v147, v146, v147
    v_lshl_add_u32 v147, v145, 14, v147
    v_lshrrev_b32 v145, 3, v0
    v_lshl_add_u32 v147, v145, 20, v147
    v_mov_b32 v148, 0
    v_mov_b32 v149, 0
    v_mov_b32 v150, 0
    v_mov_b32 v151, 0
    s_lshl_b32 s58, s3, 7
    s_add_u32 s65, s58, 311296
    s_add_u32 s58, s58, -114688
    v_lshl_add_u32 v145, v0, 15, s58
    v_subrev_u32 v146, 8, v0
    v_cmp_gt_u32 s[68:69], 5, v146
    s_nop 1
    v_cndmask_b32_e64 v147, v147, v145, s[68:69]
    s_add_u32 s44, s28, 12271616
    s_addc_u32 s45, s29, 0
    s_and_b32 s45, s45, 0xffff
    s_mov_b32 s46, 344064
    s_mov_b32 s47, 0x20000
    buffer_load_dword a254, v144, s[44:47], 0 offen
    buffer_load_dword a255, off, s[44:47], s65
    buffer_store_dwordx4 v[148:151], v147, s[44:47], 0 offen sc1
    s_waitcnt vmcnt(9)
    s_barrier
    ds_read_b128 v[176:179], v5 offset:0
    ds_read_b128 v[180:183], v5 offset:4096
    ds_read_b128 v[184:187], v5 offset:8192
    ds_read_b128 v[188:191], v5 offset:12288
    ds_read_b128 v[192:195], v5 offset:16384
    ds_read_b128 v[196:199], v6 offset:0
    ds_read_b128 v[200:203], v6 offset:4096
    ds_read_b128 v[204:207], v6 offset:8192
    ds_read_b128 v[208:211], v6 offset:12288
    ds_read_b128 v[212:215], v6 offset:16384
    ds_read_b128 v[216:219], v7 offset:0
    ds_read_b128 v[220:223], v7 offset:4096
    ds_read_b128 v[224:227], v7 offset:8192
    ds_read_b128 v[228:231], v7 offset:12288
    ds_read_b128 v[232:235], v7 offset:16384
    ds_read_b128 v[236:239], v8 offset:0
    ds_read_b128 v[240:243], v8 offset:4096
    ds_read_b128 v[244:247], v8 offset:8192
    ds_read_b128 v[248:251], v8 offset:12288
    ds_read_b128 v[252:255], v8 offset:16384
    s_waitcnt lgkmcnt(15)
    v_mfma_f32_16x16x32_bf16 v[20:23], v[36:39], v[176:179], 0
    v_mfma_f32_16x16x32_bf16 v[20:23], v[40:43], v[180:183], v[20:23]
    v_mfma_f32_16x16x32_bf16 v[20:23], v[44:47], v[184:187], v[20:23]
    v_mfma_f32_16x16x32_bf16 v[20:23], v[48:51], v[188:191], v[20:23]
    v_mfma_f32_16x16x32_bf16 v[20:23], v[52:55], v[192:195], v[20:23]
    s_waitcnt lgkmcnt(14)
    v_mfma_f32_16x16x32_bf16 v[24:27], v[36:39], v[196:199], 0
    s_waitcnt lgkmcnt(13)
    v_mfma_f32_16x16x32_bf16 v[24:27], v[40:43], v[200:203], v[24:27]
    s_waitcnt lgkmcnt(12)
    v_mfma_f32_16x16x32_bf16 v[24:27], v[44:47], v[204:207], v[24:27]
    s_waitcnt lgkmcnt(11)
    v_mfma_f32_16x16x32_bf16 v[24:27], v[48:51], v[208:211], v[24:27]
    s_waitcnt lgkmcnt(10)
    v_mfma_f32_16x16x32_bf16 v[24:27], v[52:55], v[212:215], v[24:27]
    s_waitcnt lgkmcnt(9)
    v_mfma_f32_16x16x32_bf16 v[28:31], v[36:39], v[216:219], 0
    v_cvt_pk_bf16_f32 v144, v20, v21
    v_cvt_pk_bf16_f32 v145, v22, v23
    s_waitcnt lgkmcnt(8)
    v_mfma_f32_16x16x32_bf16 v[28:31], v[40:43], v[220:223], v[28:31]
    s_waitcnt lgkmcnt(7)
    v_mfma_f32_16x16x32_bf16 v[28:31], v[44:47], v[224:227], v[28:31]
    s_waitcnt lgkmcnt(6)
    v_mfma_f32_16x16x32_bf16 v[28:31], v[48:51], v[228:231], v[28:31]
    s_waitcnt lgkmcnt(5)
    v_mfma_f32_16x16x32_bf16 v[28:31], v[52:55], v[232:235], v[28:31]
    s_waitcnt lgkmcnt(4)
    v_mfma_f32_16x16x32_bf16 v[32:35], v[36:39], v[236:239], 0
    v_cvt_pk_bf16_f32 v146, v24, v25
    v_cvt_pk_bf16_f32 v147, v26, v27
    s_waitcnt lgkmcnt(3)
    v_mfma_f32_16x16x32_bf16 v[32:35], v[40:43], v[240:243], v[32:35]
    s_waitcnt lgkmcnt(2)
    v_mfma_f32_16x16x32_bf16 v[32:35], v[44:47], v[244:247], v[32:35]
    s_waitcnt lgkmcnt(1)
    v_mfma_f32_16x16x32_bf16 v[32:35], v[48:51], v[248:251], v[32:35]
    s_waitcnt lgkmcnt(0)
    v_mfma_f32_16x16x32_bf16 v[32:35], v[52:55], v[252:255], v[32:35]
    v_mfma_f32_16x16x32_bf16 v[20:23], v[56:59], v[176:179], 0
    v_cvt_pk_bf16_f32 v148, v28, v29
    v_cvt_pk_bf16_f32 v149, v30, v31
    v_mfma_f32_16x16x32_bf16 v[20:23], v[60:63], v[180:183], v[20:23]
    v_mfma_f32_16x16x32_bf16 v[20:23], v[64:67], v[184:187], v[20:23]
    v_mfma_f32_16x16x32_bf16 v[20:23], v[68:71], v[188:191], v[20:23]
    v_mfma_f32_16x16x32_bf16 v[20:23], v[72:75], v[192:195], v[20:23]
    v_mfma_f32_16x16x32_bf16 v[24:27], v[56:59], v[196:199], 0
    v_cvt_pk_bf16_f32 v150, v32, v33
    v_cvt_pk_bf16_f32 v151, v34, v35
    v_mfma_f32_16x16x32_bf16 v[24:27], v[60:63], v[200:203], v[24:27]
    v_xor_b32 v36, v15, v96
    v_xor_b32 v37, v16, v97
    v_mfma_f32_16x16x32_bf16 v[24:27], v[64:67], v[204:207], v[24:27]
    v_xor_b32 v38, v15, v98
    v_xor_b32 v39, v16, v99
    v_mfma_f32_16x16x32_bf16 v[24:27], v[68:71], v[208:211], v[24:27]
    v_xor_b32 v40, v15, v100
    v_xor_b32 v41, v16, v101
    v_mfma_f32_16x16x32_bf16 v[24:27], v[72:75], v[212:215], v[24:27]
    v_xor_b32 v42, v15, v102
    v_xor_b32 v43, v16, v103
    v_mfma_f32_16x16x32_bf16 v[28:31], v[56:59], v[216:219], 0
    v_xor_b32 v44, v15, v104
    v_xor_b32 v45, v16, v105
    v_mfma_f32_16x16x32_bf16 v[28:31], v[60:63], v[220:223], v[28:31]
    v_xor_b32 v46, v15, v106
    v_xor_b32 v47, v16, v107
    v_mfma_f32_16x16x32_bf16 v[28:31], v[64:67], v[224:227], v[28:31]
    v_xor_b32 v48, v15, v108
    v_xor_b32 v49, v16, v109
    v_mfma_f32_16x16x32_bf16 v[28:31], v[68:71], v[228:231], v[28:31]
    v_xor_b32 v50, v15, v110
    v_xor_b32 v51, v16, v111
    v_mfma_f32_16x16x32_bf16 v[28:31], v[72:75], v[232:235], v[28:31]
    v_cvt_pk_bf16_f32 v152, v20, v21
    v_cvt_pk_bf16_f32 v153, v22, v23
    v_mfma_f32_16x16x32_bf16 v[32:35], v[56:59], v[236:239], 0
    v_cvt_pk_bf16_f32 v154, v24, v25
    v_cvt_pk_bf16_f32 v155, v26, v27
    v_mfma_f32_16x16x32_bf16 v[32:35], v[60:63], v[240:243], v[32:35]
    v_mfma_f32_16x16x32_bf16 v[32:35], v[64:67], v[244:247], v[32:35]
    v_mfma_f32_16x16x32_bf16 v[32:35], v[68:71], v[248:251], v[32:35]
    v_mfma_f32_16x16x32_bf16 v[32:35], v[72:75], v[252:255], v[32:35]
    v_mfma_f32_16x16x32_bf16 v[20:23], v[76:79], v[176:179], 0
    v_cvt_pk_bf16_f32 v156, v28, v29
    v_cvt_pk_bf16_f32 v157, v30, v31
    v_mfma_f32_16x16x32_bf16 v[20:23], v[80:83], v[180:183], v[20:23]
    v_mfma_f32_16x16x32_bf16 v[20:23], v[84:87], v[184:187], v[20:23]
    v_mfma_f32_16x16x32_bf16 v[20:23], v[88:91], v[188:191], v[20:23]
    v_mfma_f32_16x16x32_bf16 v[20:23], v[92:95], v[192:195], v[20:23]
    v_mfma_f32_16x16x32_bf16 v[24:27], v[76:79], v[196:199], 0
    v_cvt_pk_bf16_f32 v158, v32, v33
    v_cvt_pk_bf16_f32 v159, v34, v35
    v_mfma_f32_16x16x32_bf16 v[24:27], v[80:83], v[200:203], v[24:27]
    v_xor_b32 v56, v15, v112
    v_xor_b32 v57, v16, v113
    v_mfma_f32_16x16x32_bf16 v[24:27], v[84:87], v[204:207], v[24:27]
    v_xor_b32 v58, v15, v114
    v_xor_b32 v59, v16, v115
    v_mfma_f32_16x16x32_bf16 v[24:27], v[88:91], v[208:211], v[24:27]
    v_xor_b32 v60, v15, v116
    v_xor_b32 v61, v16, v117
    v_mfma_f32_16x16x32_bf16 v[24:27], v[92:95], v[212:215], v[24:27]
    v_xor_b32 v62, v15, v118
    v_xor_b32 v63, v16, v119
    v_mfma_f32_16x16x32_bf16 v[28:31], v[76:79], v[216:219], 0
    v_xor_b32 v64, v15, v120
    v_xor_b32 v65, v16, v121
    v_mfma_f32_16x16x32_bf16 v[28:31], v[80:83], v[220:223], v[28:31]
    v_xor_b32 v66, v15, v122
    v_xor_b32 v67, v16, v123
    v_mfma_f32_16x16x32_bf16 v[28:31], v[84:87], v[224:227], v[28:31]
    v_xor_b32 v68, v15, v124
    v_xor_b32 v69, v16, v125
    v_mfma_f32_16x16x32_bf16 v[28:31], v[88:91], v[228:231], v[28:31]
    v_xor_b32 v70, v15, v126
    v_xor_b32 v71, v16, v127
    v_mfma_f32_16x16x32_bf16 v[28:31], v[92:95], v[232:235], v[28:31]
    v_cvt_pk_bf16_f32 v160, v20, v21
    v_cvt_pk_bf16_f32 v161, v22, v23
    v_mfma_f32_16x16x32_bf16 v[32:35], v[76:79], v[236:239], 0
    v_cvt_pk_bf16_f32 v162, v24, v25
    v_cvt_pk_bf16_f32 v163, v26, v27
    v_mfma_f32_16x16x32_bf16 v[32:35], v[80:83], v[240:243], v[32:35]
    v_mfma_f32_16x16x32_bf16 v[32:35], v[84:87], v[244:247], v[32:35]
    v_mfma_f32_16x16x32_bf16 v[32:35], v[88:91], v[248:251], v[32:35]
    v_mfma_f32_16x16x32_bf16 v[32:35], v[92:95], v[252:255], v[32:35]
    v_mfma_f32_16x16x32_bf16 v[168:171], v[96:99], v[144:147], 0
    v_cvt_pk_bf16_f32 v164, v28, v29
    v_cvt_pk_bf16_f32 v165, v30, v31
    v_mfma_f32_16x16x32_bf16 v[168:171], v[100:103], v[148:151], v[168:171]
    v_mfma_f32_16x16x32_bf16 v[172:175], v[104:107], v[144:147], 0
    v_mfma_f32_16x16x32_bf16 v[172:175], v[108:111], v[148:151], v[172:175]
    v_mfma_f32_16x16x32_bf16 v[20:23], v[36:39], v[144:147], 0
    v_mfma_f32_16x16x32_bf16 v[20:23], v[40:43], v[148:151], v[20:23]
    v_cvt_pk_bf16_f32 v166, v32, v33
    v_cvt_pk_bf16_f32 v167, v34, v35
    v_mfma_f32_16x16x32_bf16 v[24:27], v[44:47], v[144:147], 0
    v_xor_b32 v76, v15, v128
    v_xor_b32 v77, v16, v129
    v_mfma_f32_16x16x32_bf16 v[24:27], v[48:51], v[148:151], v[24:27]
    v_xor_b32 v78, v15, v130
    v_xor_b32 v79, v16, v131
    v_mfma_f32_16x16x32_bf16 v[28:31], v[112:115], v[152:155], 0
    v_xor_b32 v80, v15, v132
    v_xor_b32 v81, v16, v133
    v_mfma_f32_16x16x32_bf16 v[28:31], v[116:119], v[156:159], v[28:31]
    v_xor_b32 v82, v15, v134
    v_xor_b32 v83, v16, v135
    v_mfma_f32_16x16x32_bf16 v[32:35], v[120:123], v[152:155], 0
    v_xor_b32 v84, v15, v136
    v_xor_b32 v85, v16, v137
    v_mfma_f32_16x16x32_bf16 v[32:35], v[124:127], v[156:159], v[32:35]
    v_xor_b32 v86, v15, v138
    v_xor_b32 v87, v16, v139
    v_xor_b32 v88, v15, v140
    v_xor_b32 v89, v16, v141
    v_xor_b32 v90, v15, v142
    v_xor_b32 v91, v16, v143
    v_cvt_pk_bf16_f32 v168, v168, v169
    v_cvt_pk_bf16_f32 v169, v170, v171
    v_cvt_pk_bf16_f32 v170, v172, v173
    v_cvt_pk_bf16_f32 v171, v174, v175
    s_nop 0
    v_cndmask_b32_dpp v172, v170, v168, vcc quad_perm:[1,0,3,2] row_mask:0xf bank_mask:0xf
    v_cndmask_b32_dpp v173, v171, v169, vcc quad_perm:[1,0,3,2] row_mask:0xf bank_mask:0xf
    s_not_b64 vcc, vcc
    v_cndmask_b32_dpp v174, v168, v170, vcc quad_perm:[1,0,3,2] row_mask:0xf bank_mask:0xf
    v_cndmask_b32_dpp v175, v169, v171, vcc quad_perm:[1,0,3,2] row_mask:0xf bank_mask:0xf
    s_mov_b32 s64, 0
    buffer_store_dwordx4 v[172:175], v9, s[36:39], s64 offen sc1
    v_mfma_f32_16x16x32_bf16 v[168:171], v[56:59], v[152:155], 0
    v_cvt_pk_bf16_f32 v20, v20, v21
    v_cvt_pk_bf16_f32 v21, v22, v23
    v_mfma_f32_16x16x32_bf16 v[168:171], v[60:63], v[156:159], v[168:171]
    v_cvt_pk_bf16_f32 v22, v24, v25
    v_cvt_pk_bf16_f32 v23, v26, v27
    v_mfma_f32_16x16x32_bf16 v[172:175], v[64:67], v[152:155], 0
    v_cndmask_b32_dpp v26, v20, v22, vcc quad_perm:[1,0,3,2] row_mask:0xf bank_mask:0xf
    v_cndmask_b32_dpp v27, v21, v23, vcc quad_perm:[1,0,3,2] row_mask:0xf bank_mask:0xf
    v_mfma_f32_16x16x32_bf16 v[172:175], v[68:71], v[156:159], v[172:175]
    s_not_b64 vcc, vcc
    v_cndmask_b32_dpp v24, v22, v20, vcc quad_perm:[1,0,3,2] row_mask:0xf bank_mask:0xf
    v_cndmask_b32_dpp v25, v23, v21, vcc quad_perm:[1,0,3,2] row_mask:0xf bank_mask:0xf
    s_mov_b32 s64, 133120
    buffer_store_dwordx4 v[24:27], v9, s[36:39], s64 offen sc1
    v_mfma_f32_16x16x32_bf16 v[20:23], v[128:131], v[160:163], 0
    v_cvt_pk_bf16_f32 v28, v28, v29
    v_cvt_pk_bf16_f32 v29, v30, v31
    v_mfma_f32_16x16x32_bf16 v[20:23], v[132:135], v[164:167], v[20:23]
    v_cvt_pk_bf16_f32 v30, v32, v33
    v_cvt_pk_bf16_f32 v31, v34, v35
    v_mfma_f32_16x16x32_bf16 v[24:27], v[136:139], v[160:163], 0
    v_cndmask_b32_dpp v32, v30, v28, vcc quad_perm:[1,0,3,2] row_mask:0xf bank_mask:0xf
    v_cndmask_b32_dpp v33, v31, v29, vcc quad_perm:[1,0,3,2] row_mask:0xf bank_mask:0xf
    v_mfma_f32_16x16x32_bf16 v[24:27], v[140:143], v[164:167], v[24:27]
    s_not_b64 vcc, vcc
    v_cndmask_b32_dpp v34, v28, v30, vcc quad_perm:[1,0,3,2] row_mask:0xf bank_mask:0xf
    v_cndmask_b32_dpp v35, v29, v31, vcc quad_perm:[1,0,3,2] row_mask:0xf bank_mask:0xf
    s_mov_b32 s64, 266240
    buffer_store_dwordx4 v[32:35], v9, s[36:39], s64 offen sc1
    v_mfma_f32_16x16x32_bf16 v[28:31], v[76:79], v[160:163], 0
    v_cvt_pk_bf16_f32 v168, v168, v169
    v_cvt_pk_bf16_f32 v169, v170, v171
    v_mfma_f32_16x16x32_bf16 v[28:31], v[80:83], v[164:167], v[28:31]
    v_cvt_pk_bf16_f32 v170, v172, v173
    v_cvt_pk_bf16_f32 v171, v174, v175
    v_mfma_f32_16x16x32_bf16 v[32:35], v[84:87], v[160:163], 0
    v_cndmask_b32_dpp v174, v168, v170, vcc quad_perm:[1,0,3,2] row_mask:0xf bank_mask:0xf
    v_cndmask_b32_dpp v175, v169, v171, vcc quad_perm:[1,0,3,2] row_mask:0xf bank_mask:0xf
    v_mfma_f32_16x16x32_bf16 v[32:35], v[88:91], v[164:167], v[32:35]
    s_not_b64 vcc, vcc
    v_cndmask_b32_dpp v172, v170, v168, vcc quad_perm:[1,0,3,2] row_mask:0xf bank_mask:0xf
    v_cndmask_b32_dpp v173, v171, v169, vcc quad_perm:[1,0,3,2] row_mask:0xf bank_mask:0xf
    s_mov_b32 s64, 399360
    buffer_store_dwordx4 v[172:175], v9, s[36:39], s64 offen sc1
    v_cvt_pk_bf16_f32 v20, v20, v21
    v_cvt_pk_bf16_f32 v21, v22, v23
    v_cvt_pk_bf16_f32 v22, v24, v25
    v_cvt_pk_bf16_f32 v23, v26, v27
    s_nop 0
    v_cndmask_b32_dpp v24, v22, v20, vcc quad_perm:[1,0,3,2] row_mask:0xf bank_mask:0xf
    v_cndmask_b32_dpp v25, v23, v21, vcc quad_perm:[1,0,3,2] row_mask:0xf bank_mask:0xf
    s_not_b64 vcc, vcc
    v_cndmask_b32_dpp v26, v20, v22, vcc quad_perm:[1,0,3,2] row_mask:0xf bank_mask:0xf
    v_cndmask_b32_dpp v27, v21, v23, vcc quad_perm:[1,0,3,2] row_mask:0xf bank_mask:0xf
    s_mov_b32 s64, 532480
    buffer_store_dwordx4 v[24:27], v9, s[36:39], s64 offen sc1
    v_cvt_pk_bf16_f32 v28, v28, v29
    v_cvt_pk_bf16_f32 v29, v30, v31
    v_cvt_pk_bf16_f32 v30, v32, v33
    v_cvt_pk_bf16_f32 v31, v34, v35
    s_nop 0
    v_cndmask_b32_dpp v34, v28, v30, vcc quad_perm:[1,0,3,2] row_mask:0xf bank_mask:0xf
    v_cndmask_b32_dpp v35, v29, v31, vcc quad_perm:[1,0,3,2] row_mask:0xf bank_mask:0xf
    s_not_b64 vcc, vcc
    v_cndmask_b32_dpp v32, v30, v28, vcc quad_perm:[1,0,3,2] row_mask:0xf bank_mask:0xf
    v_cndmask_b32_dpp v33, v31, v29, vcc quad_perm:[1,0,3,2] row_mask:0xf bank_mask:0xf
    s_mov_b32 s64, 665600
    buffer_store_dwordx4 v[32:35], v9, s[36:39], s64 offen sc1
    s_waitcnt vmcnt(9)
    s_nop 0
    s_branch f_xend
f_t_w1:
    v_and_b32 v5, 1, v2
    v_lshlrev_b32 v5, 7, v5
    v_lshl_add_u32 v5, v2, 10, v5
    v_lshl_add_u32 v5, v1, 3, v5
    v_xor_b32 v6, 128, v5
    v_lshlrev_b32 v9, 4, v3
    s_lshl_b32 s58, s66, 11
    s_mul_i32 s59, s67, 20480
    s_add_u32 s58, s58, s59
    v_add_u32 v9, s58, v9
    s_lshl_b32 s60, s57, 4
    s_cmp_eq_u32 s57, 108
    s_cselect_b32 s60, 0, s60
    s_lshl2_add_u32 s60, s56, s60
    v_add_u32 v19, s60, v2
    s_and_b32 s58, s56, 1
    s_lshl_b32 s58, s58, 1
    s_xor_b32 s58, s58, s56
    s_lshl_b32 s58, s58, 2
    v_or_b32 v169, s58, v2
    v_xor_b32 v169, v169, v1
    v_mul_u32_u24 v19, 1280, v19
    v_lshl_add_u32 v19, v169, 4, v19
    s_waitcnt lgkmcnt(0)
    s_cmp_eq_u32 s57, 108
    s_mov_b32 s34, 2211840
    s_mov_b32 s35, 0x20000
    s_cselect_b32 s34, 1280, s34
    s_cselect_b32 s32, s22, s20
    s_cselect_b32 s33, s23, s21
    s_and_b32 s33, s33, 0xffff
    s_add_u32 m0, s62, 24576
    s_nop 0
    buffer_load_dwordx4 v19, s[32:35], 0 offen offset:0 nt lds
    s_add_u32 m0, s62, 28416
    s_nop 0
    buffer_load_dwordx4 v19, s[32:35], 0 offen offset:256 nt lds
    s_add_u32 m0, s62, 32256
    s_nop 0
    buffer_load_dwordx4 v19, s[32:35], 0 offen offset:512 nt lds
    s_add_u32 m0, s62, 36096
    s_nop 0
    buffer_load_dwordx4 v19, s[32:35], 0 offen offset:768 nt lds
    s_add_u32 m0, s62, 39936
    s_nop 0
    buffer_load_dwordx4 v19, s[32:35], 0 offen offset:1024 nt lds
    s_waitcnt vmcnt(5)
    s_barrier
    ds_read_b64_tr_b16 v[176:177], v5 offset:0
    ds_read_b64_tr_b16 v[178:179], v6 offset:0
    ds_read_b64_tr_b16 v[180:181], v5 offset:4096
    ds_read_b64_tr_b16 v[182:183], v6 offset:4096
    ds_read_b64_tr_b16 v[184:185], v5 offset:8192
    ds_read_b64_tr_b16 v[186:187], v6 offset:8192
    ds_read_b64_tr_b16 v[188:189], v5 offset:12288
    ds_read_b64_tr_b16 v[190:191], v6 offset:12288
    ds_read_b64_tr_b16 v[192:193], v5 offset:16384
    ds_read_b64_tr_b16 v[194:195], v6 offset:16384
    ds_read_b64_tr_b16 v[196:197], v5 offset:256
    ds_read_b64_tr_b16 v[198:199], v6 offset:256
    ds_read_b64_tr_b16 v[200:201], v5 offset:4352
    ds_read_b64_tr_b16 v[202:203], v6 offset:4352
    ds_read_b64_tr_b16 v[204:205], v5 offset:8448
    ds_read_b64_tr_b16 v[206:207], v6 offset:8448
    ds_read_b64_tr_b16 v[208:209], v5 offset:12544
    ds_read_b64_tr_b16 v[210:211], v6 offset:12544
    ds_read_b64_tr_b16 v[212:213], v5 offset:16640
    ds_read_b64_tr_b16 v[214:215], v6 offset:16640
    ds_read_b64_tr_b16 v[216:217], v5 offset:512
    ds_read_b64_tr_b16 v[218:219], v6 offset:512
    ds_read_b64_tr_b16 v[220:221], v5 offset:4608
    ds_read_b64_tr_b16 v[222:223], v6 offset:4608
    ds_read_b64_tr_b16 v[224:225], v5 offset:8704
    ds_read_b64_tr_b16 v[226:227], v6 offset:8704
    ds_read_b64_tr_b16 v[228:229], v5 offset:12800
    ds_read_b64_tr_b16 v[230:231], v6 offset:12800
    ds_read_b64_tr_b16 v[232:233], v5 offset:16896
    ds_read_b64_tr_b16 v[234:235], v6 offset:16896
    ds_read_b64_tr_b16 v[236:237], v5 offset:768
    ds_read_b64_tr_b16 v[238:239], v6 offset:768
    ds_read_b64_tr_b16 v[240:241], v5 offset:4864
    ds_read_b64_tr_b16 v[242:243], v6 offset:4864
    ds_read_b64_tr_b16 v[244:245], v5 offset:8960
    ds_read_b64_tr_b16 v[246:247], v6 offset:8960
    ds_read_b64_tr_b16 v[248:249], v5 offset:13056
    ds_read_b64_tr_b16 v[250:251], v6 offset:13056
    ds_read_b64_tr_b16 v[252:253], v5 offset:17152
    ds_read_b64_tr_b16 v[254:255], v6 offset:17152
    s_waitcnt lgkmcnt(15)
    v_mfma_f32_16x16x32_bf16 v[20:23], v[36:39], v[176:179], 0
    v_mfma_f32_16x16x32_bf16 v[20:23], v[40:43], v[180:183], v[20:23]
    v_mfma_f32_16x16x32_bf16 v[20:23], v[44:47], v[184:187], v[20:23]
    v_mfma_f32_16x16x32_bf16 v[20:23], v[48:51], v[188:191], v[20:23]
    v_mfma_f32_16x16x32_bf16 v[20:23], v[52:55], v[192:195], v[20:23]
    v_mfma_f32_16x16x32_bf16 v[24:27], v[36:39], v[196:199], 0
    v_xor_b32 v10, v15, v96
    v_xor_b32 v11, v16, v97
    v_mfma_f32_16x16x32_bf16 v[24:27], v[40:43], v[200:203], v[24:27]
    v_xor_b32 v12, v15, v98
    v_xor_b32 v13, v16, v99
    v_mfma_f32_16x16x32_bf16 v[24:27], v[44:47], v[204:207], v[24:27]
    v_accvgpr_write_b32 a0, v10
    v_accvgpr_write_b32 a1, v11
    v_mfma_f32_16x16x32_bf16 v[24:27], v[48:51], v[208:211], v[24:27]
    v_accvgpr_write_b32 a2, v12
    v_accvgpr_write_b32 a3, v13
    v_mfma_f32_16x16x32_bf16 v[24:27], v[52:55], v[212:215], v[24:27]
    v_mfma_f32_16x16x32_bf16 v[28:31], v[36:39], v[216:219], 0
    v_cvt_pk_bf16_f32 v144, v20, v21
    v_cvt_pk_bf16_f32 v145, v22, v23
    v_mfma_f32_16x16x32_bf16 v[28:31], v[40:43], v[220:223], v[28:31]
    v_xor_b32 v10, v15, v100
    v_xor_b32 v11, v16, v101
    s_waitcnt lgkmcnt(14)
    v_mfma_f32_16x16x32_bf16 v[28:31], v[44:47], v[224:227], v[28:31]
    v_xor_b32 v12, v15, v102
    v_xor_b32 v13, v16, v103
    s_waitcnt lgkmcnt(12)
    v_mfma_f32_16x16x32_bf16 v[28:31], v[48:51], v[228:231], v[28:31]
    v_accvgpr_write_b32 a4, v10
    v_accvgpr_write_b32 a5, v11
    s_waitcnt lgkmcnt(10)
    v_mfma_f32_16x16x32_bf16 v[28:31], v[52:55], v[232:235], v[28:31]
    v_accvgpr_write_b32 a6, v12
    v_accvgpr_write_b32 a7, v13
    s_waitcnt lgkmcnt(8)
    v_mfma_f32_16x16x32_bf16 v[32:35], v[36:39], v[236:239], 0
    v_cvt_pk_bf16_f32 v146, v24, v25
    v_cvt_pk_bf16_f32 v147, v26, v27
    s_waitcnt lgkmcnt(6)
    v_mfma_f32_16x16x32_bf16 v[32:35], v[40:43], v[240:243], v[32:35]
    v_xor_b32 v10, v15, v104
    v_xor_b32 v11, v16, v105
    s_waitcnt lgkmcnt(4)
    v_mfma_f32_16x16x32_bf16 v[32:35], v[44:47], v[244:247], v[32:35]
    v_xor_b32 v12, v15, v106
    v_xor_b32 v13, v16, v107
    s_waitcnt lgkmcnt(2)
    v_mfma_f32_16x16x32_bf16 v[32:35], v[48:51], v[248:251], v[32:35]
    v_accvgpr_write_b32 a8, v10
    v_accvgpr_write_b32 a9, v11
    s_waitcnt lgkmcnt(0)
    v_mfma_f32_16x16x32_bf16 v[32:35], v[52:55], v[252:255], v[32:35]
    v_accvgpr_write_b32 a10, v12
    v_accvgpr_write_b32 a11, v13
    v_mfma_f32_16x16x32_bf16 v[20:23], v[56:59], v[176:179], 0
    v_cvt_pk_bf16_f32 v148, v28, v29
    v_cvt_pk_bf16_f32 v149, v30, v31
    v_mfma_f32_16x16x32_bf16 v[20:23], v[60:63], v[180:183], v[20:23]
    v_xor_b32 v10, v15, v108
    v_xor_b32 v11, v16, v109
    v_mfma_f32_16x16x32_bf16 v[20:23], v[64:67], v[184:187], v[20:23]
    v_xor_b32 v12, v15, v110
    v_xor_b32 v13, v16, v111
    v_mfma_f32_16x16x32_bf16 v[20:23], v[68:71], v[188:191], v[20:23]
    v_accvgpr_write_b32 a12, v10
    v_accvgpr_write_b32 a13, v11
    v_mfma_f32_16x16x32_bf16 v[20:23], v[72:75], v[192:195], v[20:23]
    v_accvgpr_write_b32 a14, v12
    v_accvgpr_write_b32 a15, v13
    v_mfma_f32_16x16x32_bf16 v[24:27], v[56:59], v[196:199], 0
    v_cvt_pk_bf16_f32 v150, v32, v33
    v_cvt_pk_bf16_f32 v151, v34, v35
    v_mfma_f32_16x16x32_bf16 v[24:27], v[60:63], v[200:203], v[24:27]
    v_xor_b32 v10, v15, v112
    v_xor_b32 v11, v16, v113
    v_mfma_f32_16x16x32_bf16 v[24:27], v[64:67], v[204:207], v[24:27]
    v_xor_b32 v12, v15, v114
    v_xor_b32 v13, v16, v115
    v_mfma_f32_16x16x32_bf16 v[24:27], v[68:71], v[208:211], v[24:27]
    v_accvgpr_write_b32 a16, v10
    v_accvgpr_write_b32 a17, v11
    v_mfma_f32_16x16x32_bf16 v[24:27], v[72:75], v[212:215], v[24:27]
    v_accvgpr_write_b32 a18, v12
    v_accvgpr_write_b32 a19, v13
    v_mfma_f32_16x16x32_bf16 v[28:31], v[56:59], v[216:219], 0
    v_cvt_pk_bf16_f32 v152, v20, v21
    v_cvt_pk_bf16_f32 v153, v22, v23
    v_mfma_f32_16x16x32_bf16 v[28:31], v[60:63], v[220:223], v[28:31]
    v_xor_b32 v10, v15, v116
    v_xor_b32 v11, v16, v117
    v_mfma_f32_16x16x32_bf16 v[28:31], v[64:67], v[224:227], v[28:31]
    v_xor_b32 v12, v15, v118
    v_xor_b32 v13, v16, v119
    v_mfma_f32_16x16x32_bf16 v[28:31], v[68:71], v[228:231], v[28:31]
    v_accvgpr_write_b32 a20, v10
    v_accvgpr_write_b32 a21, v11
    v_mfma_f32_16x16x32_bf16 v[28:31], v[72:75], v[232:235], v[28:31]
    v_accvgpr_write_b32 a22, v12
    v_accvgpr_write_b32 a23, v13
    v_mfma_f32_16x16x32_bf16 v[32:35], v[56:59], v[236:239], 0
    v_cvt_pk_bf16_f32 v154, v24, v25
    v_cvt_pk_bf16_f32 v155, v26, v27
    v_mfma_f32_16x16x32_bf16 v[32:35], v[60:63], v[240:243], v[32:35]
    v_xor_b32 v10, v15, v120
    v_xor_b32 v11, v16, v121
    v_mfma_f32_16x16x32_bf16 v[32:35], v[64:67], v[244:247], v[32:35]
    v_xor_b32 v12, v15, v122
    v_xor_b32 v13, v16, v123
    v_mfma_f32_16x16x32_bf16 v[32:35], v[68:71], v[248:251], v[32:35]
    v_accvgpr_write_b32 a24, v10
    v_accvgpr_write_b32 a25, v11
    v_mfma_f32_16x16x32_bf16 v[32:35], v[72:75], v[252:255], v[32:35]
    v_accvgpr_write_b32 a26, v12
    v_accvgpr_write_b32 a27, v13
    v_mfma_f32_16x16x32_bf16 v[20:23], v[76:79], v[176:179], 0
    v_cvt_pk_bf16_f32 v156, v28, v29
    v_cvt_pk_bf16_f32 v157, v30, v31
    v_mfma_f32_16x16x32_bf16 v[20:23], v[80:83], v[180:183], v[20:23]
    v_xor_b32 v10, v15, v124
    v_xor_b32 v11, v16, v125
    v_mfma_f32_16x16x32_bf16 v[20:23], v[84:87], v[184:187], v[20:23]
    v_xor_b32 v12, v15, v126
    v_xor_b32 v13, v16, v127
    v_mfma_f32_16x16x32_bf16 v[20:23], v[88:91], v[188:191], v[20:23]
    v_accvgpr_write_b32 a28, v10
    v_accvgpr_write_b32 a29, v11
    v_mfma_f32_16x16x32_bf16 v[20:23], v[92:95], v[192:195], v[20:23]
    v_accvgpr_write_b32 a30, v12
    v_accvgpr_write_b32 a31, v13
    v_mfma_f32_16x16x32_bf16 v[24:27], v[76:79], v[196:199], 0
    v_cvt_pk_bf16_f32 v158, v32, v33
    v_cvt_pk_bf16_f32 v159, v34, v35
    v_mfma_f32_16x16x32_bf16 v[24:27], v[80:83], v[200:203], v[24:27]
    v_xor_b32 v10, v15, v128
    v_xor_b32 v11, v16, v129
    v_mfma_f32_16x16x32_bf16 v[24:27], v[84:87], v[204:207], v[24:27]
    v_xor_b32 v12, v15, v130
    v_xor_b32 v13, v16, v131
    v_mfma_f32_16x16x32_bf16 v[24:27], v[88:91], v[208:211], v[24:27]
    v_accvgpr_write_b32 a32, v10
    v_accvgpr_write_b32 a33, v11
    v_mfma_f32_16x16x32_bf16 v[24:27], v[92:95], v[212:215], v[24:27]
    v_accvgpr_write_b32 a34, v12
    v_accvgpr_write_b32 a35, v13
    v_mfma_f32_16x16x32_bf16 v[28:31], v[76:79], v[216:219], 0
    v_cvt_pk_bf16_f32 v160, v20, v21
    v_cvt_pk_bf16_f32 v161, v22, v23
    v_mfma_f32_16x16x32_bf16 v[28:31], v[80:83], v[220:223], v[28:31]
    v_xor_b32 v10, v15, v132
    v_xor_b32 v11, v16, v133
    v_mfma_f32_16x16x32_bf16 v[28:31], v[84:87], v[224:227], v[28:31]
    v_xor_b32 v12, v15, v134
    v_xor_b32 v13, v16, v135
    v_mfma_f32_16x16x32_bf16 v[28:31], v[88:91], v[228:231], v[28:31]
    v_accvgpr_write_b32 a36, v10
    v_accvgpr_write_b32 a37, v11
    v_mfma_f32_16x16x32_bf16 v[28:31], v[92:95], v[232:235], v[28:31]
    v_accvgpr_write_b32 a38, v12
    v_accvgpr_write_b32 a39, v13
    v_mfma_f32_16x16x32_bf16 v[32:35], v[76:79], v[236:239], 0
    v_cvt_pk_bf16_f32 v162, v24, v25
    v_cvt_pk_bf16_f32 v163, v26, v27
    v_mfma_f32_16x16x32_bf16 v[32:35], v[80:83], v[240:243], v[32:35]
    v_xor_b32 v10, v15, v136
    v_xor_b32 v11, v16, v137
    v_mfma_f32_16x16x32_bf16 v[32:35], v[84:87], v[244:247], v[32:35]
    v_xor_b32 v12, v15, v138
    v_xor_b32 v13, v16, v139
    v_mfma_f32_16x16x32_bf16 v[32:35], v[88:91], v[248:251], v[32:35]
    v_accvgpr_write_b32 a40, v10
    v_accvgpr_write_b32 a41, v11
    v_mfma_f32_16x16x32_bf16 v[32:35], v[92:95], v[252:255], v[32:35]
    v_accvgpr_write_b32 a42, v12
    v_accvgpr_write_b32 a43, v13
    v_mfma_f32_16x16x32_bf16 v[168:171], v[96:99], v[144:147], 0
    v_cvt_pk_bf16_f32 v164, v28, v29
    v_cvt_pk_bf16_f32 v165, v30, v31
    v_mfma_f32_16x16x32_bf16 v[168:171], v[100:103], v[148:151], v[168:171]
    v_xor_b32 v10, v15, v140
    v_xor_b32 v11, v16, v141
    v_mfma_f32_16x16x32_bf16 v[172:175], v[104:107], v[144:147], 0
    v_xor_b32 v12, v15, v142
    v_xor_b32 v13, v16, v143
    v_mfma_f32_16x16x32_bf16 v[172:175], v[108:111], v[148:151], v[172:175]
    v_accvgpr_write_b32 a44, v10
    v_accvgpr_write_b32 a45, v11
    v_mfma_f32_16x16x32_bf16 v[20:23], a[0:3], v[144:147], 0
    v_accvgpr_write_b32 a46, v12
    v_accvgpr_write_b32 a47, v13
    v_mfma_f32_16x16x32_bf16 v[20:23], a[4:7], v[148:151], v[20:23]
    v_cvt_pk_bf16_f32 v166, v32, v33
    v_cvt_pk_bf16_f32 v167, v34, v35
    v_mfma_f32_16x16x32_bf16 v[24:27], a[8:11], v[144:147], 0
    v_mfma_f32_16x16x32_bf16 v[24:27], a[12:15], v[148:151], v[24:27]
    v_cvt_pk_bf16_f32 v168, v168, v169
    v_cvt_pk_bf16_f32 v169, v170, v171
    v_mfma_f32_16x16x32_bf16 v[28:31], v[112:115], v[152:155], 0
    v_cvt_pk_bf16_f32 v170, v172, v173
    v_cvt_pk_bf16_f32 v171, v174, v175
    v_mfma_f32_16x16x32_bf16 v[28:31], v[116:119], v[156:159], v[28:31]
    s_mov_b32 s64, 0
    buffer_store_dwordx4 v[168:171], v9, s[36:39], s64 offen sc1
    v_mfma_f32_16x16x32_bf16 v[32:35], v[120:123], v[152:155], 0
    v_mfma_f32_16x16x32_bf16 v[32:35], v[124:127], v[156:159], v[32:35]
    v_cvt_pk_bf16_f32 v20, v20, v21
    v_cvt_pk_bf16_f32 v21, v22, v23
    v_mfma_f32_16x16x32_bf16 v[168:171], a[16:19], v[152:155], 0
    v_cvt_pk_bf16_f32 v22, v24, v25
    v_cvt_pk_bf16_f32 v23, v26, v27
    v_mfma_f32_16x16x32_bf16 v[168:171], a[20:23], v[156:159], v[168:171]
    s_mov_b32 s64, 1024
    buffer_store_dwordx4 v[20:23], v9, s[36:39], s64 offen sc1
    v_mfma_f32_16x16x32_bf16 v[172:175], a[24:27], v[152:155], 0
    v_mfma_f32_16x16x32_bf16 v[172:175], a[28:31], v[156:159], v[172:175]
    v_cvt_pk_bf16_f32 v28, v28, v29
    v_cvt_pk_bf16_f32 v29, v30, v31
    v_mfma_f32_16x16x32_bf16 v[20:23], v[128:131], v[160:163], 0
    v_cvt_pk_bf16_f32 v30, v32, v33
    v_cvt_pk_bf16_f32 v31, v34, v35
    v_mfma_f32_16x16x32_bf16 v[20:23], v[132:135], v[164:167], v[20:23]
    s_mov_b32 s64, 2048
    buffer_store_dwordx4 v[28:31], v9, s[36:39], s64 offen sc1
    v_mfma_f32_16x16x32_bf16 v[24:27], v[136:139], v[160:163], 0
    v_mfma_f32_16x16x32_bf16 v[24:27], v[140:143], v[164:167], v[24:27]
    v_cvt_pk_bf16_f32 v168, v168, v169
    v_cvt_pk_bf16_f32 v169, v170, v171
    v_mfma_f32_16x16x32_bf16 v[28:31], a[32:35], v[160:163], 0
    v_cvt_pk_bf16_f32 v170, v172, v173
    v_cvt_pk_bf16_f32 v171, v174, v175
    v_mfma_f32_16x16x32_bf16 v[28:31], a[36:39], v[164:167], v[28:31]
    s_mov_b32 s64, 3072
    buffer_store_dwordx4 v[168:171], v9, s[36:39], s64 offen sc1
    v_mfma_f32_16x16x32_bf16 v[32:35], a[40:43], v[160:163], 0
    v_mfma_f32_16x16x32_bf16 v[32:35], a[44:47], v[164:167], v[32:35]
    v_cvt_pk_bf16_f32 v20, v20, v21
    v_cvt_pk_bf16_f32 v21, v22, v23
    v_cvt_pk_bf16_f32 v22, v24, v25
    v_cvt_pk_bf16_f32 v23, v26, v27
    s_mov_b32 s64, 4096
    buffer_store_dwordx4 v[20:23], v9, s[36:39], s64 offen sc1
    v_cvt_pk_bf16_f32 v28, v28, v29
    v_cvt_pk_bf16_f32 v29, v30, v31
    v_cvt_pk_bf16_f32 v30, v32, v33
    v_cvt_pk_bf16_f32 v31, v34, v35
    s_mov_b32 s64, 5120
    buffer_store_dwordx4 v[28:31], v9, s[36:39], s64 offen sc1
    s_cmp_gt_u32 s57, 108
    s_nop 0
    s_cbranch_scc1 f_end
    s_waitcnt vmcnt(6)
    s_branch f_t_w2b
f_t_w2:
    s_waitcnt vmcnt(3)
f_t_w2b:
    s_add_u32 s36, s28, 2330624
    s_addc_u32 s37, s29, 0
    s_and_b32 s37, s37, 0xffff
    s_mov_b32 s38, 2293760
    s_mov_b32 s39, 0x20000
    v_and_b32 v5, 4, v1
    v_lshlrev_b32 v5, 1, v5
    v_xor_b32 v5, v5, v1
    v_lshlrev_b32 v6, 2, v2
    v_xor_b32 v5, v5, v6
    v_lshlrev_b32 v5, 4, v5
    v_lshl_add_u32 v5, v1, 8, v5
    v_xor_b32 v6, 16, v5
    v_xor_b32 v7, 32, v5
    v_xor_b32 v8, 48, v5
    v_lshrrev_b32 v9, 1, v2
    v_mul_u32_u24 v9, 10240, v9
    v_lshrrev_b32 v4, 2, v1
    v_lshl_add_u32 v9, v4, 7, v9
    v_and_b32 v4, 3, v1
    v_lshl_add_u32 v9, v4, 4, v9
    v_and_b32 v4, 1, v2
    v_lshl_add_u32 v9, v4, 6, v9
    s_lshl_b32 s58, s66, 10
    s_mul_i32 s59, s57, 20480
    s_add_u32 s58, s58, s59
    v_add_u32 v9, s58, v9
    s_barrier
    ds_read_b128 v[176:179], v5 offset:24576
    ds_read_b128 v[180:183], v5 offset:28672
    ds_read_b128 v[184:187], v5 offset:32768
    ds_read_b128 v[188:191], v5 offset:36864
    ds_read_b128 v[192:195], v5 offset:40960
    ds_read_b128 v[196:199], v6 offset:24576
    ds_read_b128 v[200:203], v6 offset:28672
    ds_read_b128 v[204:207], v6 offset:32768
    ds_read_b128 v[208:211], v6 offset:36864
    ds_read_b128 v[212:215], v6 offset:40960
    ds_read_b128 v[216:219], v7 offset:24576
    ds_read_b128 v[220:223], v7 offset:28672
    ds_read_b128 v[224:227], v7 offset:32768
    ds_read_b128 v[228:231], v7 offset:36864
    ds_read_b128 v[232:235], v7 offset:40960
    ds_read_b128 v[236:239], v8 offset:24576
    ds_read_b128 v[240:243], v8 offset:28672
    ds_read_b128 v[244:247], v8 offset:32768
    ds_read_b128 v[248:251], v8 offset:36864
    ds_read_b128 v[252:255], v8 offset:40960
    s_waitcnt lgkmcnt(15)
    v_mfma_f32_16x16x32_bf16 v[20:23], v[36:39], v[176:179], 0
    v_mfma_f32_16x16x32_bf16 v[20:23], v[40:43], v[180:183], v[20:23]
    v_mfma_f32_16x16x32_bf16 v[20:23], v[44:47], v[184:187], v[20:23]
    v_mfma_f32_16x16x32_bf16 v[20:23], v[48:51], v[188:191], v[20:23]
    v_mfma_f32_16x16x32_bf16 v[20:23], v[52:55], v[192:195], v[20:23]
    s_waitcnt lgkmcnt(14)
    v_mfma_f32_16x16x32_bf16 v[24:27], v[36:39], v[196:199], 0
    s_waitcnt lgkmcnt(13)
    v_mfma_f32_16x16x32_bf16 v[24:27], v[40:43], v[200:203], v[24:27]
    s_waitcnt lgkmcnt(12)
    v_mfma_f32_16x16x32_bf16 v[24:27], v[44:47], v[204:207], v[24:27]
    s_waitcnt lgkmcnt(11)
    v_mfma_f32_16x16x32_bf16 v[24:27], v[48:51], v[208:211], v[24:27]
    s_waitcnt lgkmcnt(10)
    v_mfma_f32_16x16x32_bf16 v[24:27], v[52:55], v[212:215], v[24:27]
    s_waitcnt lgkmcnt(9)
    v_mfma_f32_16x16x32_bf16 v[28:31], v[36:39], v[216:219], 0
    v_cvt_pk_bf16_f32 v144, v20, v21
    v_cvt_pk_bf16_f32 v145, v22, v23
    s_waitcnt lgkmcnt(8)
    v_mfma_f32_16x16x32_bf16 v[28:31], v[40:43], v[220:223], v[28:31]
    s_waitcnt lgkmcnt(7)
    v_mfma_f32_16x16x32_bf16 v[28:31], v[44:47], v[224:227], v[28:31]
    s_waitcnt lgkmcnt(6)
    v_mfma_f32_16x16x32_bf16 v[28:31], v[48:51], v[228:231], v[28:31]
    s_waitcnt lgkmcnt(5)
    v_mfma_f32_16x16x32_bf16 v[28:31], v[52:55], v[232:235], v[28:31]
    s_waitcnt lgkmcnt(4)
    v_mfma_f32_16x16x32_bf16 v[32:35], v[36:39], v[236:239], 0
    v_cvt_pk_bf16_f32 v146, v24, v25
    v_cvt_pk_bf16_f32 v147, v26, v27
    s_waitcnt lgkmcnt(3)
    v_mfma_f32_16x16x32_bf16 v[32:35], v[40:43], v[240:243], v[32:35]
    s_waitcnt lgkmcnt(2)
    v_mfma_f32_16x16x32_bf16 v[32:35], v[44:47], v[244:247], v[32:35]
    s_waitcnt lgkmcnt(1)
    v_mfma_f32_16x16x32_bf16 v[32:35], v[48:51], v[248:251], v[32:35]
    s_waitcnt lgkmcnt(0)
    v_mfma_f32_16x16x32_bf16 v[32:35], v[52:55], v[252:255], v[32:35]
    v_mfma_f32_16x16x32_bf16 v[20:23], v[56:59], v[176:179], 0
    v_cvt_pk_bf16_f32 v148, v28, v29
    v_cvt_pk_bf16_f32 v149, v30, v31
    v_mfma_f32_16x16x32_bf16 v[20:23], v[60:63], v[180:183], v[20:23]
    v_mfma_f32_16x16x32_bf16 v[20:23], v[64:67], v[184:187], v[20:23]
    v_mfma_f32_16x16x32_bf16 v[20:23], v[68:71], v[188:191], v[20:23]
    v_mfma_f32_16x16x32_bf16 v[20:23], v[72:75], v[192:195], v[20:23]
    v_mfma_f32_16x16x32_bf16 v[24:27], v[56:59], v[196:199], 0
    v_cvt_pk_bf16_f32 v150, v32, v33
    v_cvt_pk_bf16_f32 v151, v34, v35
    v_mfma_f32_16x16x32_bf16 v[24:27], v[60:63], v[200:203], v[24:27]
    v_xor_b32 v36, v15, v96
    v_xor_b32 v37, v16, v97
    v_mfma_f32_16x16x32_bf16 v[24:27], v[64:67], v[204:207], v[24:27]
    v_xor_b32 v38, v15, v98
    v_xor_b32 v39, v16, v99
    v_mfma_f32_16x16x32_bf16 v[24:27], v[68:71], v[208:211], v[24:27]
    v_xor_b32 v40, v15, v100
    v_xor_b32 v41, v16, v101
    v_mfma_f32_16x16x32_bf16 v[24:27], v[72:75], v[212:215], v[24:27]
    v_xor_b32 v42, v15, v102
    v_xor_b32 v43, v16, v103
    v_mfma_f32_16x16x32_bf16 v[28:31], v[56:59], v[216:219], 0
    v_xor_b32 v44, v15, v104
    v_xor_b32 v45, v16, v105
    v_mfma_f32_16x16x32_bf16 v[28:31], v[60:63], v[220:223], v[28:31]
    v_xor_b32 v46, v15, v106
    v_xor_b32 v47, v16, v107
    v_mfma_f32_16x16x32_bf16 v[28:31], v[64:67], v[224:227], v[28:31]
    v_xor_b32 v48, v15, v108
    v_xor_b32 v49, v16, v109
    v_mfma_f32_16x16x32_bf16 v[28:31], v[68:71], v[228:231], v[28:31]
    v_xor_b32 v50, v15, v110
    v_xor_b32 v51, v16, v111
    v_mfma_f32_16x16x32_bf16 v[28:31], v[72:75], v[232:235], v[28:31]
    v_cvt_pk_bf16_f32 v152, v20, v21
    v_cvt_pk_bf16_f32 v153, v22, v23
    v_mfma_f32_16x16x32_bf16 v[32:35], v[56:59], v[236:239], 0
    v_cvt_pk_bf16_f32 v154, v24, v25
    v_cvt_pk_bf16_f32 v155, v26, v27
    v_mfma_f32_16x16x32_bf16 v[32:35], v[60:63], v[240:243], v[32:35]
    v_mfma_f32_16x16x32_bf16 v[32:35], v[64:67], v[244:247], v[32:35]
    v_mfma_f32_16x16x32_bf16 v[32:35], v[68:71], v[248:251], v[32:35]
    v_mfma_f32_16x16x32_bf16 v[32:35], v[72:75], v[252:255], v[32:35]
    s_getreg_b32 s59, hwreg(HW_REG_XCC_ID, 0, 3)
    s_add_u32 s59, s59, 8
    s_lshl_b32 s58, s3, 7
    s_add_u32 s58, s58, 311296
    v_lshl_add_u32 v12, v0, 20, s58
    s_waitcnt vmcnt(0)
    v_accvgpr_read_b32 v11, a255
    v_and_b32 v11, -8, v11
    v_add_u32 v11, s59, v11
    s_lshl_b32 s58, s96, 19
    s_and_b32 s58, s58, 1048576
    v_add_u32 v12, s58, v12
    s_barrier
    buffer_store_dword v11, v12, s[44:47], 0 offen sc1
    v_bfe_u32 v17, v1, 1, 1
    v_lshl_add_u32 v17, v2, 1, v17
    v_lshrrev_b32 v18, 2, v1
    v_xor_b32 v17, v17, v18
    v_lshlrev_b32 v17, 4, v17
    v_lshl_add_u32 v17, v18, 8, v17
    v_and_b32 v18, 1, v1
    v_lshl_add_u32 v17, v18, 3, v17
    s_lshr_b32 s58, s56, 1
    s_xor_b32 s59, s58, s56
    s_and_b32 s59, s59, 1
    s_lshl4_add_u32 s58, s58, s59
    s_lshl_b32 s58, s58, 7
    v_add_u32 v17, s58, v17
    v_xor_b32 v18, 1216, v17
    ds_read_b64_tr_b16 a[232:233], v17 offset:24576
    ds_read_b64_tr_b16 a[234:235], v18 offset:24576
    ds_read_b64_tr_b16 a[236:237], v17 offset:28672
    ds_read_b64_tr_b16 a[238:239], v18 offset:28672
    ds_read_b64_tr_b16 a[240:241], v17 offset:32768
    ds_read_b64_tr_b16 a[242:243], v18 offset:32768
    ds_read_b64_tr_b16 a[244:245], v17 offset:36864
    ds_read_b64_tr_b16 a[246:247], v18 offset:36864
    ds_read_b64_tr_b16 a[248:249], v17 offset:40960
    ds_read_b64_tr_b16 a[250:251], v18 offset:40960
    v_mfma_f32_16x16x32_bf16 v[20:23], v[76:79], v[176:179], 0
    v_cvt_pk_bf16_f32 v156, v28, v29
    v_cvt_pk_bf16_f32 v157, v30, v31
    v_mfma_f32_16x16x32_bf16 v[20:23], v[80:83], v[180:183], v[20:23]
    v_mfma_f32_16x16x32_bf16 v[20:23], v[84:87], v[184:187], v[20:23]
    v_mfma_f32_16x16x32_bf16 v[20:23], v[88:91], v[188:191], v[20:23]
    v_mfma_f32_16x16x32_bf16 v[20:23], v[92:95], v[192:195], v[20:23]
    v_mfma_f32_16x16x32_bf16 v[24:27], v[76:79], v[196:199], 0
    v_cvt_pk_bf16_f32 v158, v32, v33
    v_cvt_pk_bf16_f32 v159, v34, v35
    v_mfma_f32_16x16x32_bf16 v[24:27], v[80:83], v[200:203], v[24:27]
    v_xor_b32 v56, v15, v112
    v_xor_b32 v57, v16, v113
    v_mfma_f32_16x16x32_bf16 v[24:27], v[84:87], v[204:207], v[24:27]
    v_xor_b32 v58, v15, v114
    v_xor_b32 v59, v16, v115
    v_mfma_f32_16x16x32_bf16 v[24:27], v[88:91], v[208:211], v[24:27]
    v_xor_b32 v60, v15, v116
    v_xor_b32 v61, v16, v117
    v_mfma_f32_16x16x32_bf16 v[24:27], v[92:95], v[212:215], v[24:27]
    v_xor_b32 v62, v15, v118
    v_xor_b32 v63, v16, v119
    v_mfma_f32_16x16x32_bf16 v[28:31], v[76:79], v[216:219], 0
    v_xor_b32 v64, v15, v120
    v_xor_b32 v65, v16, v121
    v_mfma_f32_16x16x32_bf16 v[28:31], v[80:83], v[220:223], v[28:31]
    v_xor_b32 v66, v15, v122
    v_xor_b32 v67, v16, v123
    v_mfma_f32_16x16x32_bf16 v[28:31], v[84:87], v[224:227], v[28:31]
    v_xor_b32 v68, v15, v124
    v_xor_b32 v69, v16, v125
    v_mfma_f32_16x16x32_bf16 v[28:31], v[88:91], v[228:231], v[28:31]
    v_xor_b32 v70, v15, v126
    v_xor_b32 v71, v16, v127
    v_mfma_f32_16x16x32_bf16 v[28:31], v[92:95], v[232:235], v[28:31]
    v_cvt_pk_bf16_f32 v160, v20, v21
    v_cvt_pk_bf16_f32 v161, v22, v23
    v_mfma_f32_16x16x32_bf16 v[32:35], v[76:79], v[236:239], 0
    v_cvt_pk_bf16_f32 v162, v24, v25
    v_cvt_pk_bf16_f32 v163, v26, v27
    v_mfma_f32_16x16x32_bf16 v[32:35], v[80:83], v[240:243], v[32:35]
    v_mfma_f32_16x16x32_bf16 v[32:35], v[84:87], v[244:247], v[32:35]
    v_mfma_f32_16x16x32_bf16 v[32:35], v[88:91], v[248:251], v[32:35]
    v_mfma_f32_16x16x32_bf16 v[32:35], v[92:95], v[252:255], v[32:35]
    v_mfma_f32_16x16x32_bf16 v[168:171], v[144:147], v[96:99], 0
    v_cvt_pk_bf16_f32 v164, v28, v29
    v_cvt_pk_bf16_f32 v165, v30, v31
    v_mfma_f32_16x16x32_bf16 v[168:171], v[148:151], v[100:103], v[168:171]
    v_mfma_f32_16x16x32_bf16 v[172:175], v[144:147], v[104:107], 0
    v_mfma_f32_16x16x32_bf16 v[172:175], v[148:151], v[108:111], v[172:175]
    v_mfma_f32_16x16x32_bf16 v[20:23], v[144:147], v[36:39], 0
    v_mfma_f32_16x16x32_bf16 v[20:23], v[148:151], v[40:43], v[20:23]
    v_cvt_pk_bf16_f32 v166, v32, v33
    v_cvt_pk_bf16_f32 v167, v34, v35
    v_mfma_f32_16x16x32_bf16 v[24:27], v[144:147], v[44:47], 0
    v_xor_b32 v76, v15, v128
    v_xor_b32 v77, v16, v129
    v_mfma_f32_16x16x32_bf16 v[24:27], v[148:151], v[48:51], v[24:27]
    v_xor_b32 v78, v15, v130
    v_xor_b32 v79, v16, v131
    v_mfma_f32_16x16x32_bf16 v[28:31], v[152:155], v[112:115], 0
    v_xor_b32 v80, v15, v132
    v_xor_b32 v81, v16, v133
    v_mfma_f32_16x16x32_bf16 v[28:31], v[156:159], v[116:119], v[28:31]
    v_xor_b32 v82, v15, v134
    v_xor_b32 v83, v16, v135
    v_mfma_f32_16x16x32_bf16 v[32:35], v[152:155], v[120:123], 0
    v_xor_b32 v84, v15, v136
    v_xor_b32 v85, v16, v137
    v_mfma_f32_16x16x32_bf16 v[32:35], v[156:159], v[124:127], v[32:35]
    v_xor_b32 v86, v15, v138
    v_xor_b32 v87, v16, v139
    v_xor_b32 v88, v15, v140
    v_xor_b32 v89, v16, v141
    v_xor_b32 v90, v15, v142
    v_xor_b32 v91, v16, v143
    v_cvt_pk_bf16_f32 v168, v168, v169
    v_cvt_pk_bf16_f32 v169, v170, v171
    v_cvt_pk_bf16_f32 v170, v172, v173
    v_cvt_pk_bf16_f32 v171, v174, v175
    s_nop 0
    v_permlane16_swap_b32 v168, v170
    v_permlane16_swap_b32 v169, v171
    buffer_store_dwordx4 v[168:171], v9, s[36:39], 0 offen offset:0 sc1
    s_nop 1
    v_mfma_f32_16x16x32_bf16 v[168:171], v[152:155], v[56:59], 0
    v_cvt_pk_bf16_f32 v20, v20, v21
    v_cvt_pk_bf16_f32 v21, v22, v23
    v_mfma_f32_16x16x32_bf16 v[168:171], v[156:159], v[60:63], v[168:171]
    v_cvt_pk_bf16_f32 v22, v24, v25
    v_cvt_pk_bf16_f32 v23, v26, v27
    v_mfma_f32_16x16x32_bf16 v[172:175], v[152:155], v[64:67], 0
    v_permlane16_swap_b32 v20, v22
    v_permlane16_swap_b32 v21, v23
    v_mfma_f32_16x16x32_bf16 v[172:175], v[156:159], v[68:71], v[172:175]
    buffer_store_dwordx4 v[20:23], v9, s[36:39], 0 offen offset:512 sc1
    v_cvt_pk_bf16_f32 v28, v28, v29
    s_nop 0
    v_mfma_f32_16x16x32_bf16 v[20:23], v[160:163], v[128:131], 0
    v_cvt_pk_bf16_f32 v29, v30, v31
    v_cvt_pk_bf16_f32 v30, v32, v33
    v_mfma_f32_16x16x32_bf16 v[20:23], v[164:167], v[132:135], v[20:23]
    v_cvt_pk_bf16_f32 v31, v34, v35
    v_permlane16_swap_b32 v28, v30
    v_mfma_f32_16x16x32_bf16 v[24:27], v[160:163], v[136:139], 0
    v_permlane16_swap_b32 v29, v31
    buffer_store_dwordx4 v[28:31], v9, s[36:39], 0 offen offset:1024 sc1
    v_mfma_f32_16x16x32_bf16 v[24:27], v[164:167], v[140:143], v[24:27]
    v_cvt_pk_bf16_f32 v168, v168, v169
    v_cvt_pk_bf16_f32 v169, v170, v171
    v_mfma_f32_16x16x32_bf16 v[28:31], v[160:163], v[76:79], 0
    v_cvt_pk_bf16_f32 v170, v172, v173
    v_cvt_pk_bf16_f32 v171, v174, v175
    v_mfma_f32_16x16x32_bf16 v[28:31], v[164:167], v[80:83], v[28:31]
    v_permlane16_swap_b32 v168, v170
    v_permlane16_swap_b32 v169, v171
    v_mfma_f32_16x16x32_bf16 v[32:35], v[160:163], v[84:87], 0
    buffer_store_dwordx4 v[168:171], v9, s[36:39], 0 offen offset:1536 sc1
    v_mfma_f32_16x16x32_bf16 v[32:35], v[164:167], v[88:91], v[32:35]
    v_cvt_pk_bf16_f32 v20, v20, v21
    v_cvt_pk_bf16_f32 v21, v22, v23
    v_cvt_pk_bf16_f32 v22, v24, v25
    v_cvt_pk_bf16_f32 v23, v26, v27
    s_nop 0
    v_permlane16_swap_b32 v20, v22
    v_permlane16_swap_b32 v21, v23
    buffer_store_dwordx4 v[20:23], v9, s[36:39], 0 offen offset:2048 sc1
    v_cvt_pk_bf16_f32 v28, v28, v29
    v_cvt_pk_bf16_f32 v29, v30, v31
    v_cvt_pk_bf16_f32 v30, v32, v33
    v_cvt_pk_bf16_f32 v31, v34, v35
    s_nop 0
    v_permlane16_swap_b32 v28, v30
    v_permlane16_swap_b32 v29, v31
    buffer_store_dwordx4 v[28:31], v9, s[36:39], 0 offen offset:2560 sc1
    s_waitcnt lgkmcnt(0)
    s_nop 1
    s_branch f_end
f_sp:
    s_mov_b32 s66, 0
    v_fma_f32 v144, v35, v17, 0
    v_fmamk_f32 v145, v17, 0x40800000, v144
    v_fmamk_f32 v146, v17, 0x41000000, v144
    v_fmamk_f32 v147, v17, 0x41400000, v144
    v_fmamk_f32 v148, v17, 0x41800000, v144
    v_cos_f32 v144, v144
    v_cos_f32 v145, v145
    v_cos_f32 v146, v146
    v_cos_f32 v147, v147
    v_cos_f32 v148, v148
    v_mul_f32 v144, s97, v144
    v_mul_f32 v145, s97, v145
    v_mul_f32 v146, s97, v146
    v_mul_f32 v147, s97, v147
    v_mul_f32 v148, s97, v148
    v_cvt_pk_bf16_f32 v144, v144, v144
    v_cvt_pk_bf16_f32 v145, v145, v145
    v_cvt_pk_bf16_f32 v146, v146, v146
    v_cvt_pk_bf16_f32 v147, v147, v147
    v_cvt_pk_bf16_f32 v148, v148, v148
    v_and_b32 v36, v10, v144
    v_and_b32 v37, v11, v144
    v_and_b32 v38, v12, v144
    v_and_b32 v39, v13, v144
    v_and_b32 v40, v10, v145
    v_and_b32 v41, v11, v145
    v_and_b32 v42, v12, v145
    v_and_b32 v43, v13, v145
    v_and_b32 v44, v10, v146
    v_and_b32 v45, v11, v146
    v_and_b32 v46, v12, v146
    v_and_b32 v47, v13, v146
    v_and_b32 v48, v10, v147
    v_and_b32 v49, v11, v147
    v_and_b32 v50, v12, v147
    v_and_b32 v51, v13, v147
    v_and_b32 v52, v10, v148
    v_and_b32 v53, v11, v148
    v_and_b32 v54, v12, v148
    v_and_b32 v55, v13, v148
    v_mul_f32 v17, 0.5, v17
    v_cmp_eq_u32 vcc, 0, v1
    v_mov_b32 v19, 0.5
    s_nop 0
    v_cndmask_b32 v19, v18, v19, vcc
    v_cmp_gt_u32 vcc, 2, v1
    v_mov_b32 v14, 0x3e000000
    s_nop 0
    v_cndmask_b32 v14, v17, v14, vcc
    v_mul_f32 v152, v35, v19
    v_fma_f32 v144, v152, 2.0, v14
    v_fmamk_f32 v145, v19, 0x3f800000, v144
    v_fmamk_f32 v146, v19, 0x41000000, v144
    v_fmamk_f32 v147, v19, 0x41100000, v144
    v_fmamk_f32 v148, v19, 0x41800000, v144
    v_fmamk_f32 v149, v19, 0x41880000, v144
    v_fmamk_f32 v150, v19, 0x41c00000, v144
    v_fmamk_f32 v151, v19, 0x41c80000, v144
    v_cos_f32 v144, v144
    v_cos_f32 v145, v145
    v_cos_f32 v146, v146
    v_cos_f32 v147, v147
    v_cos_f32 v148, v148
    v_cos_f32 v149, v149
    v_cos_f32 v150, v150
    v_cos_f32 v151, v151
    v_cvt_pk_bf16_f32 v96, v144, 0
    v_cvt_pk_bf16_f32 v97, v145, 0
    v_cvt_pk_bf16_f32 v98, v146, 0
    v_cvt_pk_bf16_f32 v99, v147, 0
    v_cvt_pk_bf16_f32 v100, v148, 0
    v_cvt_pk_bf16_f32 v101, v149, 0
    v_cvt_pk_bf16_f32 v102, v150, 0
    v_cvt_pk_bf16_f32 v103, v151, 0
    v_add_f32 v19, 0x3e800000, v18
    v_mul_f32 v14, 1.0, v17
    v_mul_f32 v152, v35, v19
    v_fma_f32 v144, v152, 2.0, v14
    v_fmamk_f32 v145, v19, 0x3f800000, v144
    v_fmamk_f32 v146, v19, 0x41000000, v144
    v_fmamk_f32 v147, v19, 0x41100000, v144
    v_fmamk_f32 v148, v19, 0x41800000, v144
    v_fmamk_f32 v149, v19, 0x41880000, v144
    v_fmamk_f32 v150, v19, 0x41c00000, v144
    v_fmamk_f32 v151, v19, 0x41c80000, v144
    v_cos_f32 v144, v144
    v_cos_f32 v145, v145
    v_cos_f32 v146, v146
    v_cos_f32 v147, v147
    v_cos_f32 v148, v148
    v_cos_f32 v149, v149
    v_cos_f32 v150, v150
    v_cos_f32 v151, v151
    v_cvt_pk_bf16_f32 v104, v144, 0
    v_cvt_pk_bf16_f32 v105, v145, 0
    v_cvt_pk_bf16_f32 v106, v146, 0
    v_cvt_pk_bf16_f32 v107, v147, 0
    v_cvt_pk_bf16_f32 v108, v148, 0
    v_cvt_pk_bf16_f32 v109, v149, 0
    v_cvt_pk_bf16_f32 v110, v150, 0
    v_cvt_pk_bf16_f32 v111, v151, 0
    v_add_f32 v19, 0x3f040000, v18
    v_mul_f32 v14, -1.0, v17
    v_mul_f32 v152, v35, v19
    v_fma_f32 v144, v152, 2.0, v14
    v_fmamk_f32 v145, v19, 0x3f800000, v144
    v_fmamk_f32 v146, v19, 0x41000000, v144
    v_fmamk_f32 v147, v19, 0x41100000, v144
    v_fmamk_f32 v148, v19, 0x41800000, v144
    v_fmamk_f32 v149, v19, 0x41880000, v144
    v_fmamk_f32 v150, v19, 0x41c00000, v144
    v_fmamk_f32 v151, v19, 0x41c80000, v144
    v_cos_f32 v144, v144
    v_cos_f32 v145, v145
    v_cos_f32 v146, v146
    v_cos_f32 v147, v147
    v_cos_f32 v148, v148
    v_cos_f32 v149, v149
    v_cos_f32 v150, v150
    v_cos_f32 v151, v151
    v_cvt_pk_bf16_f32 v112, 0, v144
    v_cvt_pk_bf16_f32 v113, 0, v145
    v_cvt_pk_bf16_f32 v114, 0, v146
    v_cvt_pk_bf16_f32 v115, 0, v147
    v_cvt_pk_bf16_f32 v116, 0, v148
    v_cvt_pk_bf16_f32 v117, 0, v149
    v_cvt_pk_bf16_f32 v118, 0, v150
    v_cvt_pk_bf16_f32 v119, 0, v151
    v_add_f32 v19, 0x3f440000, v18
    v_mul_f32 v14, -1.0, v17
    v_mul_f32 v152, v35, v19
    v_fma_f32 v144, v152, 2.0, v14
    v_fmamk_f32 v145, v19, 0x3f800000, v144
    v_fmamk_f32 v146, v19, 0x41000000, v144
    v_fmamk_f32 v147, v19, 0x41100000, v144
    v_fmamk_f32 v148, v19, 0x41800000, v144
    v_fmamk_f32 v149, v19, 0x41880000, v144
    v_fmamk_f32 v150, v19, 0x41c00000, v144
    v_fmamk_f32 v151, v19, 0x41c80000, v144
    v_cos_f32 v144, v144
    v_cos_f32 v145, v145
    v_cos_f32 v146, v146
    v_cos_f32 v147, v147
    v_cos_f32 v148, v148
    v_cos_f32 v149, v149
    v_cos_f32 v150, v150
    v_cos_f32 v151, v151
    v_cvt_pk_bf16_f32 v120, 0, v144
    v_cvt_pk_bf16_f32 v121, 0, v145
    v_cvt_pk_bf16_f32 v122, 0, v146
    v_cvt_pk_bf16_f32 v123, 0, v147
    v_cvt_pk_bf16_f32 v124, 0, v148
    v_cvt_pk_bf16_f32 v125, 0, v149
    v_cvt_pk_bf16_f32 v126, 0, v150
    v_cvt_pk_bf16_f32 v127, 0, v151
    s_cmp_eq_u32 s96, 1
    s_nop 2
    s_cbranch_scc1 f_s_w1
    s_cmp_eq_u32 s96, 2
    s_cbranch_scc1 f_s_w2
    v_lshlrev_b32 v4, 4, v3
    buffer_load_dwordx4 v4, s[32:35], s60 offen offset:3072 nt lds
    s_add_u32 m0, s63, 28672
    s_nop 0
    buffer_load_dwordx4 v4, s[32:35], s61 offen offset:0 nt lds
    s_mov_b64 exec, 1
    buffer_load_dwordx4 v4, s[32:35], s61 offen offset:1024 nt lds
    s_mov_b64 exec, -1
    s_add_u32 s48, s28, 9641984
    s_addc_u32 s49, s29, 0
    s_and_b32 s49, s49, 0xffff
    s_mov_b32 s50, 2621440
    s_mov_b32 s51, 0x20000
    v_bfe_u32 v17, v3, 3, 1
    v_lshlrev_b32 v17, 2, v17
    v_add_u32 v17, v17, v2
    s_cmp_lt_u32 s56, 2
    s_cselect_b32 s98, 1, -1
    s_mul_i32 s58, s98, 80
    s_mul_i32 s59, s98, 40
    v_mul_i32_i24 v10, s58, v17
    v_and_b32 v17, 7, v3
    v_mul_u32_u24 v11, 642, v17
    v_add_u32 v10, v10, v11
    s_mul_i32 s99, s56, 5
    s_sub_u32 s100, 325, s99
    s_cmp_lt_u32 s56, 2
    s_cselect_b32 s100, s99, s100
    s_lshl_b32 s100, s100, 1
    v_add_u32 v10, s100, v10
    v_add_u32 v11, s59, v10
    v_cmp_gt_u32 vcc, 8, v0
    v_add_u32 v12, 640, v10
    s_nop 0
    v_cndmask_b32 v12, v10, v12, vcc
    v_lshrrev_b32 v13, 3, v3
    v_lshlrev_b32 v13, 14, v13
    v_lshl_add_u32 v13, v17, 4, v13
    s_lshl_b32 s58, s3, 7
    s_lshr_b32 s59, s56, 1
    s_lshl_b32 s59, s59, 17
    s_add_u32 s58, s58, s59
    v_add_u32 v13, s58, v13
    s_sub_u32 s100, s99, 5
    s_cmp_lt_u32 s56, 2
    s_cselect_b32 s99, s99, s100
    v_and_b32 v5, 4, v1
    v_lshlrev_b32 v5, 1, v5
    v_xor_b32 v5, v5, v1
    v_lshlrev_b32 v6, 2, v2
    v_xor_b32 v5, v5, v6
    v_lshlrev_b32 v5, 4, v5
    v_lshl_add_u32 v5, v1, 8, v5
    v_xor_b32 v6, 16, v5
    v_xor_b32 v7, 32, v5
    v_xor_b32 v8, 48, v5
    v_and_b32 v4, 1, v1
    v_lshl_add_u32 v9, v2, 1, v4
    v_mul_u32_u24 v9, 16640, v9
    v_and_b32 v4, 14, v1
    v_lshl_add_u32 v9, v4, 3, v9
    s_mul_i32 s58, s66, 266240
    s_lshl_b32 s59, s57, 7
    s_mov_b32 vcc_lo, 0x55555555
    s_mov_b32 vcc_hi, 0x55555555
    s_add_u32 s58, s58, s59
    v_add_u32 v9, s58, v9
    s_add_u32 s40, s28, 12263424
    s_addc_u32 s41, s29, 0
    s_and_b32 s41, s41, 0xffff
    s_mov_b32 s42, 8192
    s_mov_b32 s43, 0x20000
    s_lshr_b32 s58, s57, 4
    s_lshl_b32 s58, s58, 10
    s_and_b32 s59, s57, 7
    s_lshl_b32 s59, s59, 7
    s_add_u32 s58, s58, s59
    s_and_b32 s59, s57, 8
    s_add_u32 s58, s58, s59
    v_lshrrev_b32 v128, 1, v1
    v_lshlrev_b32 v128, 4, v128
    v_lshl_add_u32 v128, v15, 2, v128
    v_lshl_add_u32 v128, v2, 20, v128
    v_add_u32 v128, s58, v128
    s_mov_b32 s4, 0x100001
    s_mov_b32 s5, 0x10000100
    s_mov_b32 s6, 0x200002
    s_mov_b32 s7, 0x20000200
    s_mov_b32 s30, 0x400004
    s_mov_b32 s31, 0x40000400
    s_mov_b32 s70, 0x800008
    s_mov_b32 s71, 0x80000800
    v_and_b32 v144, 31, v3
    v_bfe_u32 v145, v3, 5, 1
    v_lshl_add_u32 v144, v145, 7, v144
    v_lshl_add_u32 v144, s56, 5, v144
    v_lshlrev_b32 v144, 7, v144
    v_add_u32 v144, 311296, v144
    s_lshl_b32 s58, s3, 2
    v_and_or_b32 v147, v0, 3, s58
    v_bfe_u32 v145, v0, 2, 1
    v_mad_u32_u24 v146, v145, 3, 4
    v_lshlrev_b32 v147, v146, v147
    v_lshl_add_u32 v147, v145, 14, v147
    v_lshrrev_b32 v145, 3, v0
    v_lshl_add_u32 v147, v145, 20, v147
    v_mov_b32 v148, 0
    v_mov_b32 v149, 0
    v_mov_b32 v150, 0
    v_mov_b32 v151, 0
    s_lshl_b32 s58, s3, 7
    s_add_u32 s65, s58, 311296
    s_add_u32 s58, s58, -114688
    v_lshl_add_u32 v145, v0, 15, s58
    v_subrev_u32 v146, 8, v0
    v_cmp_gt_u32 s[68:69], 5, v146
    s_nop 1
    v_cndmask_b32_e64 v147, v147, v145, s[68:69]
    s_add_u32 s44, s28, 12271616
    s_addc_u32 s45, s29, 0
    s_and_b32 s45, s45, 0xffff
    s_mov_b32 s46, 344064
    s_mov_b32 s47, 0x20000
    buffer_load_dword a254, v144, s[44:47], 0 offen
    buffer_load_dword a255, off, s[44:47], s65
    buffer_store_dwordx4 v[148:151], v147, s[44:47], 0 offen sc1
    s_waitcnt vmcnt(9)
    s_barrier
    ds_read_b128 v[176:179], v5 offset:0
    ds_read_b128 v[180:183], v5 offset:4096
    ds_read_b128 v[184:187], v5 offset:8192
    ds_read_b128 v[188:191], v5 offset:12288
    ds_read_b128 v[192:195], v5 offset:16384
    ds_read_b128 v[196:199], v6 offset:0
    ds_read_b128 v[200:203], v6 offset:4096
    ds_read_b128 v[204:207], v6 offset:8192
    ds_read_b128 v[208:211], v6 offset:12288
    ds_read_b128 v[212:215], v6 offset:16384
    ds_read_b128 v[216:219], v7 offset:0
    ds_read_b128 v[220:223], v7 offset:4096
    ds_read_b128 v[224:227], v7 offset:8192
    ds_read_b128 v[228:231], v7 offset:12288
    ds_read_b128 v[232:235], v7 offset:16384
    ds_read_b128 v[236:239], v8 offset:0
    ds_read_b128 v[240:243], v8 offset:4096
    ds_read_b128 v[244:247], v8 offset:8192
    ds_read_b128 v[248:251], v8 offset:12288
    ds_read_b128 v[252:255], v8 offset:16384
    s_waitcnt lgkmcnt(15)
    v_mfma_f32_16x16x32_bf16 v[20:23], v[36:39], v[176:179], 0
    v_mfma_f32_16x16x32_bf16 v[20:23], v[40:43], v[180:183], v[20:23]
    v_mfma_f32_16x16x32_bf16 v[20:23], v[44:47], v[184:187], v[20:23]
    v_mfma_f32_16x16x32_bf16 v[20:23], v[48:51], v[188:191], v[20:23]
    v_mfma_f32_16x16x32_bf16 v[20:23], v[52:55], v[192:195], v[20:23]
    s_waitcnt lgkmcnt(14)
    v_mfma_f32_16x16x32_bf16 v[24:27], v[36:39], v[196:199], 0
    s_waitcnt lgkmcnt(13)
    v_mfma_f32_16x16x32_bf16 v[24:27], v[40:43], v[200:203], v[24:27]
    s_waitcnt lgkmcnt(12)
    v_mfma_f32_16x16x32_bf16 v[24:27], v[44:47], v[204:207], v[24:27]
    s_waitcnt lgkmcnt(11)
    v_mfma_f32_16x16x32_bf16 v[24:27], v[48:51], v[208:211], v[24:27]
    s_waitcnt lgkmcnt(10)
    v_mfma_f32_16x16x32_bf16 v[24:27], v[52:55], v[212:215], v[24:27]
    s_waitcnt lgkmcnt(9)
    v_mfma_f32_16x16x32_bf16 v[28:31], v[36:39], v[216:219], 0
    v_add_f32 v136, v20, v22
    v_cvt_pk_bf16_f32 v144, v20, v21
    s_waitcnt lgkmcnt(8)
    v_mfma_f32_16x16x32_bf16 v[28:31], v[40:43], v[220:223], v[28:31]
    v_cvt_pk_bf16_f32 v145, v22, v23
    s_waitcnt lgkmcnt(7)
    v_mfma_f32_16x16x32_bf16 v[28:31], v[44:47], v[224:227], v[28:31]
    s_waitcnt lgkmcnt(6)
    v_mfma_f32_16x16x32_bf16 v[28:31], v[48:51], v[228:231], v[28:31]
    s_waitcnt lgkmcnt(5)
    v_mfma_f32_16x16x32_bf16 v[28:31], v[52:55], v[232:235], v[28:31]
    s_waitcnt lgkmcnt(4)
    v_mfma_f32_16x16x32_bf16 v[32:35], v[36:39], v[236:239], 0
    v_add_f32 v137, v24, v26
    v_cvt_pk_bf16_f32 v146, v24, v25
    s_waitcnt lgkmcnt(3)
    v_mfma_f32_16x16x32_bf16 v[32:35], v[40:43], v[240:243], v[32:35]
    v_cvt_pk_bf16_f32 v147, v26, v27
    s_waitcnt lgkmcnt(2)
    v_mfma_f32_16x16x32_bf16 v[32:35], v[44:47], v[244:247], v[32:35]
    s_waitcnt lgkmcnt(1)
    v_mfma_f32_16x16x32_bf16 v[32:35], v[48:51], v[248:251], v[32:35]
    s_waitcnt lgkmcnt(0)
    v_mfma_f32_16x16x32_bf16 v[32:35], v[52:55], v[252:255], v[32:35]
    v_mfma_f32_16x16x32_bf16 v[132:135], v[176:179], v[176:179], 0
    v_add_f32 v138, v28, v30
    v_cvt_pk_bf16_f32 v148, v28, v29
    v_mfma_f32_16x16x32_bf16 v[132:135], v[180:183], v[180:183], v[132:135]
    v_cvt_pk_bf16_f32 v149, v30, v31
    v_mfma_f32_16x16x32_bf16 v[132:135], v[184:187], v[184:187], v[132:135]
    v_mfma_f32_16x16x32_bf16 v[132:135], v[188:191], v[188:191], v[132:135]
    v_mfma_f32_16x16x32_bf16 v[132:135], v[192:195], v[192:195], v[132:135]
    v_mfma_f32_16x16x32_bf16 v[132:135], v[196:199], v[196:199], v[132:135]
    v_add_f32 v139, v32, v34
    v_cvt_pk_bf16_f32 v150, v32, v33
    v_mfma_f32_16x16x32_bf16 v[132:135], v[200:203], v[200:203], v[132:135]
    v_cvt_pk_bf16_f32 v151, v34, v35
    v_mfma_f32_16x16x32_bf16 v[132:135], v[204:207], v[204:207], v[132:135]
    v_mfma_f32_16x16x32_bf16 v[132:135], v[208:211], v[208:211], v[132:135]
    v_mfma_f32_16x16x32_bf16 v[132:135], v[212:215], v[212:215], v[132:135]
    v_mfma_f32_16x16x32_bf16 v[168:171], v[96:99], v[144:147], 0
    v_mfma_f32_16x16x32_bf16 v[168:171], v[100:103], v[148:151], v[168:171]
    v_mfma_f32_16x16x32_bf16 v[172:175], v[104:107], v[144:147], 0
    v_mfma_f32_16x16x32_bf16 v[172:175], v[108:111], v[148:151], v[172:175]
    v_mfma_f32_16x16x32_bf16 v[20:23], v[112:115], v[144:147], 0
    v_mfma_f32_16x16x32_bf16 v[20:23], v[116:119], v[148:151], v[20:23]
    v_mfma_f32_16x16x32_bf16 v[24:27], v[120:123], v[144:147], 0
    v_mfma_f32_16x16x32_bf16 v[24:27], v[124:127], v[148:151], v[24:27]
    s_nop 1
    v_cvt_pk_bf16_f32 v168, v168, v169
    v_cvt_pk_bf16_f32 v169, v170, v171
    v_mfma_f32_16x16x32_bf16 v[132:135], v[216:219], v[216:219], v[132:135]
    v_cvt_pk_bf16_f32 v170, v172, v173
    v_cvt_pk_bf16_f32 v171, v174, v175
    v_mfma_f32_16x16x32_bf16 v[132:135], v[220:223], v[220:223], v[132:135]
    v_cndmask_b32_dpp v172, v170, v168, vcc quad_perm:[1,0,3,2] row_mask:0xf bank_mask:0xf
    v_cndmask_b32_dpp v173, v171, v169, vcc quad_perm:[1,0,3,2] row_mask:0xf bank_mask:0xf
    v_mfma_f32_16x16x32_bf16 v[132:135], v[224:227], v[224:227], v[132:135]
    s_not_b64 vcc, vcc
    v_cndmask_b32_dpp v174, v168, v170, vcc quad_perm:[1,0,3,2] row_mask:0xf bank_mask:0xf
    v_mfma_f32_16x16x32_bf16 v[132:135], v[228:231], v[228:231], v[132:135]
    v_cndmask_b32_dpp v175, v169, v171, vcc quad_perm:[1,0,3,2] row_mask:0xf bank_mask:0xf
    s_mov_b32 s64, 0
    buffer_store_dwordx4 v[172:175], v9, s[36:39], s64 offen sc1
    v_mfma_f32_16x16x32_bf16 v[132:135], v[232:235], v[232:235], v[132:135]
    v_cvt_pk_bf16_f32 v20, v20, v21
    v_cvt_pk_bf16_f32 v21, v22, v23
    v_mfma_f32_16x16x32_bf16 v[132:135], v[236:239], v[236:239], v[132:135]
    v_cvt_pk_bf16_f32 v22, v24, v25
    v_cvt_pk_bf16_f32 v23, v26, v27
    v_mfma_f32_16x16x32_bf16 v[132:135], v[240:243], v[240:243], v[132:135]
    v_cndmask_b32_dpp v26, v20, v22, vcc quad_perm:[1,0,3,2] row_mask:0xf bank_mask:0xf
    v_cndmask_b32_dpp v27, v21, v23, vcc quad_perm:[1,0,3,2] row_mask:0xf bank_mask:0xf
    v_mfma_f32_16x16x32_bf16 v[132:135], v[244:247], v[244:247], v[132:135]
    s_not_b64 vcc, vcc
    v_cndmask_b32_dpp v24, v22, v20, vcc quad_perm:[1,0,3,2] row_mask:0xf bank_mask:0xf
    v_mfma_f32_16x16x32_bf16 v[132:135], v[248:251], v[248:251], v[132:135]
    v_cndmask_b32_dpp v25, v23, v21, vcc quad_perm:[1,0,3,2] row_mask:0xf bank_mask:0xf
    s_mov_b32 s64, 133120
    buffer_store_dwordx4 v[24:27], v9, s[36:39], s64 offen sc1
    v_mfma_f32_16x16x32_bf16 v[132:135], v[252:255], v[252:255], v[132:135]
    v_add_f32 v136, v136, v137
    v_add_f32 v138, v138, v139
    v_add_f32 v136, v136, v138
    v_mov_b32 v137, v136
    s_nop 1
    v_permlane32_swap_b32 v136, v137
    v_add_f32 v136, v136, v137
    v_mov_b32 v137, v136
    s_nop 1
    v_permlane16_swap_b32 v136, v137
    v_add_f32 v136, v136, v137
    v_mul_f32 v136, 0x70000000, v136
    v_mul_f32 v136, v136, v136
    v_cndmask_b32_e64 v140, 0, v132, s[4:5]
    v_cndmask_b32_e64 v140, v140, v133, s[6:7]
    v_cndmask_b32_e64 v140, v140, v134, s[30:31]
    v_cndmask_b32_e64 v140, v140, v135, s[70:71]
    v_mov_b32 v141, v140
    s_nop 1
    v_permlane32_swap_b32 v140, v141
    v_add_f32 v140, v140, v141
    v_mov_b32 v141, v140
    s_nop 1
    v_permlane16_swap_b32 v140, v141
    v_add_f32 v140, v140, v141
    v_fmamk_f32 v140, v136, 0xbefff0c1, v140
    v_max_f32 v140, 0, v140
    buffer_store_dword v140, v128, s[40:43], 0 offen sc1
    s_waitcnt vmcnt(6)
    s_nop 1
    s_branch f_xend
f_s_w1:
    v_and_b32 v5, 1, v2
    v_lshlrev_b32 v5, 7, v5
    v_lshl_add_u32 v5, v2, 10, v5
    v_lshl_add_u32 v5, v1, 3, v5
    v_xor_b32 v6, 128, v5
    v_lshlrev_b32 v9, 4, v3
    s_lshl_b32 s58, s66, 11
    s_mul_i32 s59, s67, 20480
    s_add_u32 s58, s58, s59
    v_add_u32 v9, s58, v9
    s_mov_b64 s[70:71], 0xffff
    s_lshl_b32 s60, s57, 4
    s_cmp_eq_u32 s57, 108
    s_cselect_b32 s60, 0, s60
    s_lshl2_add_u32 s60, s56, s60
    v_add_u32 v19, s60, v2
    s_and_b32 s58, s56, 1
    s_lshl_b32 s58, s58, 1
    s_xor_b32 s58, s58, s56
    s_lshl_b32 s58, s58, 2
    v_or_b32 v169, s58, v2
    v_xor_b32 v169, v169, v1
    v_mul_u32_u24 v19, 1280, v19
    v_lshl_add_u32 v19, v169, 4, v19
    s_waitcnt lgkmcnt(0)
    s_cmp_eq_u32 s57, 108
    s_mov_b32 s34, 2211840
    s_mov_b32 s35, 0x20000
    s_cselect_b32 s34, 1280, s34
    s_cselect_b32 s32, s22, s20
    s_cselect_b32 s33, s23, s21
    s_and_b32 s33, s33, 0xffff
    s_add_u32 m0, s62, 24576
    s_nop 0
    buffer_load_dwordx4 v19, s[32:35], 0 offen offset:0 nt lds
    s_add_u32 m0, s62, 28416
    s_nop 0
    buffer_load_dwordx4 v19, s[32:35], 0 offen offset:256 nt lds
    s_add_u32 m0, s62, 32256
    s_nop 0
    buffer_load_dwordx4 v19, s[32:35], 0 offen offset:512 nt lds
    s_add_u32 m0, s62, 36096
    s_nop 0
    buffer_load_dwordx4 v19, s[32:35], 0 offen offset:768 nt lds
    s_add_u32 m0, s62, 39936
    s_nop 0
    buffer_load_dwordx4 v19, s[32:35], 0 offen offset:1024 nt lds
    s_waitcnt vmcnt(5)
    s_barrier
    ds_read_b64_tr_b16 v[176:177], v5 offset:0
    ds_read_b64_tr_b16 v[178:179], v6 offset:0
    ds_read_b64_tr_b16 v[180:181], v5 offset:4096
    ds_read_b64_tr_b16 v[182:183], v6 offset:4096
    ds_read_b64_tr_b16 v[184:185], v5 offset:8192
    ds_read_b64_tr_b16 v[186:187], v6 offset:8192
    ds_read_b64_tr_b16 v[188:189], v5 offset:12288
    ds_read_b64_tr_b16 v[190:191], v6 offset:12288
    ds_read_b64_tr_b16 v[192:193], v5 offset:16384
    ds_read_b64_tr_b16 v[194:195], v6 offset:16384
    ds_read_b64_tr_b16 v[196:197], v5 offset:256
    ds_read_b64_tr_b16 v[198:199], v6 offset:256
    ds_read_b64_tr_b16 v[200:201], v5 offset:4352
    ds_read_b64_tr_b16 v[202:203], v6 offset:4352
    ds_read_b64_tr_b16 v[204:205], v5 offset:8448
    ds_read_b64_tr_b16 v[206:207], v6 offset:8448
    ds_read_b64_tr_b16 v[208:209], v5 offset:12544
    ds_read_b64_tr_b16 v[210:211], v6 offset:12544
    ds_read_b64_tr_b16 v[212:213], v5 offset:16640
    ds_read_b64_tr_b16 v[214:215], v6 offset:16640
    ds_read_b64_tr_b16 v[216:217], v5 offset:512
    ds_read_b64_tr_b16 v[218:219], v6 offset:512
    ds_read_b64_tr_b16 v[220:221], v5 offset:4608
    ds_read_b64_tr_b16 v[222:223], v6 offset:4608
    ds_read_b64_tr_b16 v[224:225], v5 offset:8704
    ds_read_b64_tr_b16 v[226:227], v6 offset:8704
    ds_read_b64_tr_b16 v[228:229], v5 offset:12800
    ds_read_b64_tr_b16 v[230:231], v6 offset:12800
    ds_read_b64_tr_b16 v[232:233], v5 offset:16896
    ds_read_b64_tr_b16 v[234:235], v6 offset:16896
    ds_read_b64_tr_b16 v[236:237], v5 offset:768
    ds_read_b64_tr_b16 v[238:239], v6 offset:768
    ds_read_b64_tr_b16 v[240:241], v5 offset:4864
    ds_read_b64_tr_b16 v[242:243], v6 offset:4864
    ds_read_b64_tr_b16 v[244:245], v5 offset:8960
    ds_read_b64_tr_b16 v[246:247], v6 offset:8960
    ds_read_b64_tr_b16 v[248:249], v5 offset:13056
    ds_read_b64_tr_b16 v[250:251], v6 offset:13056
    ds_read_b64_tr_b16 v[252:253], v5 offset:17152
    ds_read_b64_tr_b16 v[254:255], v6 offset:17152
    s_waitcnt lgkmcnt(15)
    v_mfma_f32_16x16x32_bf16 v[20:23], v[36:39], v[176:179], 0
    v_mfma_f32_16x16x32_bf16 v[20:23], v[40:43], v[180:183], v[20:23]
    v_mfma_f32_16x16x32_bf16 v[20:23], v[44:47], v[184:187], v[20:23]
    v_mfma_f32_16x16x32_bf16 v[20:23], v[48:51], v[188:191], v[20:23]
    v_mfma_f32_16x16x32_bf16 v[20:23], v[52:55], v[192:195], v[20:23]
    v_mfma_f32_16x16x32_bf16 v[24:27], v[36:39], v[196:199], 0
    v_mfma_f32_16x16x32_bf16 v[24:27], v[40:43], v[200:203], v[24:27]
    v_mfma_f32_16x16x32_bf16 v[24:27], v[44:47], v[204:207], v[24:27]
    v_mfma_f32_16x16x32_bf16 v[24:27], v[48:51], v[208:211], v[24:27]
    v_mfma_f32_16x16x32_bf16 v[24:27], v[52:55], v[212:215], v[24:27]
    v_mfma_f32_16x16x32_bf16 v[28:31], v[36:39], v[216:219], 0
    s_nop 1
    v_cvt_pk_bf16_f32 v144, v20, v21
    v_cvt_pk_bf16_f32 v145, v22, v23
    v_mfma_f32_16x16x32_bf16 v[28:31], v[40:43], v[220:223], v[28:31]
    s_waitcnt lgkmcnt(14)
    v_mfma_f32_16x16x32_bf16 v[28:31], v[44:47], v[224:227], v[28:31]
    s_waitcnt lgkmcnt(12)
    v_mfma_f32_16x16x32_bf16 v[28:31], v[48:51], v[228:231], v[28:31]
    s_waitcnt lgkmcnt(10)
    v_mfma_f32_16x16x32_bf16 v[28:31], v[52:55], v[232:235], v[28:31]
    s_waitcnt lgkmcnt(8)
    v_mfma_f32_16x16x32_bf16 v[32:35], v[36:39], v[236:239], 0
    v_cvt_pk_bf16_f32 v146, v24, v25
    v_cvt_pk_bf16_f32 v147, v26, v27
    s_waitcnt lgkmcnt(6)
    v_mfma_f32_16x16x32_bf16 v[32:35], v[40:43], v[240:243], v[32:35]
    s_waitcnt lgkmcnt(4)
    v_mfma_f32_16x16x32_bf16 v[32:35], v[44:47], v[244:247], v[32:35]
    s_waitcnt lgkmcnt(2)
    v_mfma_f32_16x16x32_bf16 v[32:35], v[48:51], v[248:251], v[32:35]
    s_waitcnt lgkmcnt(0)
    v_mfma_f32_16x16x32_bf16 v[32:35], v[52:55], v[252:255], v[32:35]
    v_mfma_f32_16x16x32_bf16 v[168:171], v[96:99], v[144:147], 0
    v_cvt_pk_bf16_f32 v148, v28, v29
    v_cvt_pk_bf16_f32 v149, v30, v31
    s_nop 4
    v_cvt_pk_bf16_f32 v150, v32, v33
    v_cvt_pk_bf16_f32 v151, v34, v35
    s_nop 1
    v_mfma_f32_16x16x32_bf16 v[168:171], v[100:103], v[148:151], v[168:171]
    v_mfma_f32_16x16x32_bf16 v[172:175], v[104:107], v[144:147], 0
    v_mfma_f32_16x16x32_bf16 v[172:175], v[108:111], v[148:151], v[172:175]
    v_mfma_f32_16x16x32_bf16 v[20:23], v[112:115], v[144:147], 0
    v_mfma_f32_16x16x32_bf16 v[20:23], v[116:119], v[148:151], v[20:23]
    v_mfma_f32_16x16x32_bf16 v[24:27], v[120:123], v[144:147], 0
    v_mfma_f32_16x16x32_bf16 v[24:27], v[124:127], v[148:151], v[24:27]
    v_accvgpr_read_b32 v130, a251
    v_lshlrev_b32 v130, 16, v130
    v_cndmask_b32_e64 v169, v169, v130, s[70:71]
    v_cvt_pk_bf16_f32 v168, v168, v169
    v_cvt_pk_bf16_f32 v169, v170, v171
    v_cvt_pk_bf16_f32 v170, v172, v173
    v_cvt_pk_bf16_f32 v171, v174, v175
    s_mov_b32 s64, 0
    buffer_store_dwordx4 v[168:171], v9, s[36:39], s64 offen sc1
    v_cvt_pk_bf16_f32 v20, v20, v21
    v_cvt_pk_bf16_f32 v21, v22, v23
    v_cvt_pk_bf16_f32 v22, v24, v25
    v_cvt_pk_bf16_f32 v23, v26, v27
    s_mov_b32 s64, 1024
    buffer_store_dwordx4 v[20:23], v9, s[36:39], s64 offen sc1
    s_cmp_gt_u32 s57, 108
    s_nop 0
    s_cbranch_scc1 f_end
    s_waitcnt vmcnt(2)
    s_branch f_s_w2b
f_s_w2:
    s_waitcnt vmcnt(3)
f_s_w2b:
    s_add_u32 s36, s28, 2330624
    s_addc_u32 s37, s29, 0
    s_and_b32 s37, s37, 0xffff
    s_mov_b32 s38, 2293760
    s_mov_b32 s39, 0x20000
    v_and_b32 v5, 4, v1
    v_lshlrev_b32 v5, 1, v5
    v_xor_b32 v5, v5, v1
    v_lshlrev_b32 v6, 2, v2
    v_xor_b32 v5, v5, v6
    v_lshlrev_b32 v5, 4, v5
    v_lshl_add_u32 v5, v1, 8, v5
    v_xor_b32 v6, 16, v5
    v_xor_b32 v7, 32, v5
    v_xor_b32 v8, 48, v5
    v_lshrrev_b32 v9, 1, v2
    v_mul_u32_u24 v9, 10240, v9
    v_lshrrev_b32 v4, 2, v1
    v_lshl_add_u32 v9, v4, 7, v9
    v_and_b32 v4, 3, v1
    v_lshl_add_u32 v9, v4, 4, v9
    v_and_b32 v4, 1, v2
    v_lshl_add_u32 v9, v4, 6, v9
    s_lshl_b32 s58, s66, 10
    s_mul_i32 s59, s57, 20480
    s_add_u32 s58, s58, s59
    v_add_u32 v9, s58, v9
    s_barrier
    ds_read_b128 v[176:179], v5 offset:24576
    ds_read_b128 v[180:183], v5 offset:28672
    ds_read_b128 v[184:187], v5 offset:32768
    ds_read_b128 v[188:191], v5 offset:36864
    ds_read_b128 v[192:195], v5 offset:40960
    ds_read_b128 v[196:199], v6 offset:24576
    ds_read_b128 v[200:203], v6 offset:28672
    ds_read_b128 v[204:207], v6 offset:32768
    ds_read_b128 v[208:211], v6 offset:36864
    ds_read_b128 v[212:215], v6 offset:40960
    ds_read_b128 v[216:219], v7 offset:24576
    ds_read_b128 v[220:223], v7 offset:28672
    ds_read_b128 v[224:227], v7 offset:32768
    ds_read_b128 v[228:231], v7 offset:36864
    ds_read_b128 v[232:235], v7 offset:40960
    ds_read_b128 v[236:239], v8 offset:24576
    ds_read_b128 v[240:243], v8 offset:28672
    ds_read_b128 v[244:247], v8 offset:32768
    ds_read_b128 v[248:251], v8 offset:36864
    ds_read_b128 v[252:255], v8 offset:40960
    s_waitcnt lgkmcnt(15)
    v_mfma_f32_16x16x32_bf16 v[20:23], v[36:39], v[176:179], 0
    v_mfma_f32_16x16x32_bf16 v[20:23], v[40:43], v[180:183], v[20:23]
    v_mfma_f32_16x16x32_bf16 v[20:23], v[44:47], v[184:187], v[20:23]
    v_mfma_f32_16x16x32_bf16 v[20:23], v[48:51], v[188:191], v[20:23]
    v_mfma_f32_16x16x32_bf16 v[20:23], v[52:55], v[192:195], v[20:23]
    s_waitcnt lgkmcnt(14)
    v_mfma_f32_16x16x32_bf16 v[24:27], v[36:39], v[196:199], 0
    s_waitcnt lgkmcnt(13)
    v_mfma_f32_16x16x32_bf16 v[24:27], v[40:43], v[200:203], v[24:27]
    s_waitcnt lgkmcnt(12)
    v_mfma_f32_16x16x32_bf16 v[24:27], v[44:47], v[204:207], v[24:27]
    s_waitcnt lgkmcnt(11)
    v_mfma_f32_16x16x32_bf16 v[24:27], v[48:51], v[208:211], v[24:27]
    s_waitcnt lgkmcnt(10)
    v_mfma_f32_16x16x32_bf16 v[24:27], v[52:55], v[212:215], v[24:27]
    s_waitcnt lgkmcnt(9)
    v_mfma_f32_16x16x32_bf16 v[28:31], v[36:39], v[216:219], 0
    v_cvt_pk_bf16_f32 v144, v20, v21
    v_cvt_pk_bf16_f32 v145, v22, v23
    s_waitcnt lgkmcnt(8)
    v_mfma_f32_16x16x32_bf16 v[28:31], v[40:43], v[220:223], v[28:31]
    s_waitcnt lgkmcnt(7)
    v_mfma_f32_16x16x32_bf16 v[28:31], v[44:47], v[224:227], v[28:31]
    s_waitcnt lgkmcnt(6)
    v_mfma_f32_16x16x32_bf16 v[28:31], v[48:51], v[228:231], v[28:31]
    s_waitcnt lgkmcnt(5)
    v_mfma_f32_16x16x32_bf16 v[28:31], v[52:55], v[232:235], v[28:31]
    s_waitcnt lgkmcnt(4)
    v_mfma_f32_16x16x32_bf16 v[32:35], v[36:39], v[236:239], 0
    v_cvt_pk_bf16_f32 v146, v24, v25
    v_cvt_pk_bf16_f32 v147, v26, v27
    s_waitcnt lgkmcnt(3)
    v_mfma_f32_16x16x32_bf16 v[32:35], v[40:43], v[240:243], v[32:35]
    s_waitcnt lgkmcnt(2)
    v_mfma_f32_16x16x32_bf16 v[32:35], v[44:47], v[244:247], v[32:35]
    s_waitcnt lgkmcnt(1)
    v_mfma_f32_16x16x32_bf16 v[32:35], v[48:51], v[248:251], v[32:35]
    s_waitcnt lgkmcnt(0)
    v_mfma_f32_16x16x32_bf16 v[32:35], v[52:55], v[252:255], v[32:35]
    v_bfe_u32 v17, v1, 1, 1
    v_lshl_add_u32 v17, v2, 1, v17
    v_lshrrev_b32 v18, 2, v1
    v_xor_b32 v17, v17, v18
    v_lshlrev_b32 v17, 4, v17
    v_lshl_add_u32 v17, v18, 8, v17
    v_and_b32 v18, 1, v1
    v_lshl_add_u32 v17, v18, 3, v17
    s_lshr_b32 s58, s56, 1
    s_xor_b32 s59, s58, s56
    s_and_b32 s59, s59, 1
    s_lshl4_add_u32 s58, s58, s59
    s_lshl_b32 s58, s58, 7
    v_add_u32 v17, s58, v17
    v_xor_b32 v18, 1216, v17
    ds_read_b64_tr_b16 a[232:233], v17 offset:24576
    ds_read_b64_tr_b16 a[234:235], v18 offset:24576
    ds_read_b64_tr_b16 a[236:237], v17 offset:28672
    ds_read_b64_tr_b16 a[238:239], v18 offset:28672
    ds_read_b64_tr_b16 a[240:241], v17 offset:32768
    ds_read_b64_tr_b16 a[242:243], v18 offset:32768
    ds_read_b64_tr_b16 a[244:245], v17 offset:36864
    ds_read_b64_tr_b16 a[246:247], v18 offset:36864
    ds_read_b64_tr_b16 a[248:249], v17 offset:40960
    ds_read_b64_tr_b16 a[250:251], v18 offset:40960
    s_waitcnt vmcnt(0)
    s_barrier
    v_mfma_f32_16x16x32_bf16 v[168:171], v[144:147], v[96:99], 0
    v_cvt_pk_bf16_f32 v148, v28, v29
    v_cvt_pk_bf16_f32 v149, v30, v31
    v_cvt_pk_bf16_f32 v150, v32, v33
    v_cvt_pk_bf16_f32 v151, v34, v35
    s_nop 1
    v_mfma_f32_16x16x32_bf16 v[168:171], v[148:151], v[100:103], v[168:171]
    v_mfma_f32_16x16x32_bf16 v[172:175], v[144:147], v[104:107], 0
    v_mfma_f32_16x16x32_bf16 v[172:175], v[148:151], v[108:111], v[172:175]
    v_mfma_f32_16x16x32_bf16 v[20:23], v[144:147], v[112:115], 0
    v_mfma_f32_16x16x32_bf16 v[20:23], v[148:151], v[116:119], v[20:23]
    v_mfma_f32_16x16x32_bf16 v[24:27], v[144:147], v[120:123], 0
    v_mfma_f32_16x16x32_bf16 v[24:27], v[148:151], v[124:127], v[24:27]
    s_nop 1
    v_cvt_pk_bf16_f32 v168, v168, v169
    v_cvt_pk_bf16_f32 v169, v170, v171
    v_cvt_pk_bf16_f32 v170, v172, v173
    v_cvt_pk_bf16_f32 v171, v174, v175
    s_nop 0
    v_permlane16_swap_b32 v168, v170
    v_permlane16_swap_b32 v169, v171
    buffer_store_dwordx4 v[168:171], v9, s[36:39], 0 offen offset:0 sc1
    v_cvt_pk_bf16_f32 v20, v20, v21
    v_cvt_pk_bf16_f32 v21, v22, v23
    v_cvt_pk_bf16_f32 v22, v24, v25
    v_cvt_pk_bf16_f32 v23, v26, v27
    s_nop 0
    v_permlane16_swap_b32 v20, v22
    v_permlane16_swap_b32 v21, v23
    buffer_store_dwordx4 v[20:23], v9, s[36:39], 0 offen offset:512 sc1
    s_waitcnt lgkmcnt(0)
    s_nop 1
    s_branch f_end
f_xend:
    s_barrier
    ds_read_u16 v176, v12 offset:24576
    ds_read_u16 v177, v12 offset:29824
    ds_read_u16 v178, v11 offset:24576
    ds_read_u16 v179, v11 offset:29824
    ds_read_u16 v180, v12 offset:35072
    ds_read_u16 v181, v12 offset:40320
    ds_read_u16 v182, v11 offset:35072
    ds_read_u16 v183, v11 offset:40320
    ds_read_u16 v184, v10 offset:24578
    ds_read_u16 v185, v10 offset:29826
    ds_read_u16 v186, v11 offset:24578
    ds_read_u16 v187, v11 offset:29826
    ds_read_u16 v188, v10 offset:35074
    ds_read_u16 v189, v10 offset:40322
    ds_read_u16 v190, v11 offset:35074
    ds_read_u16 v191, v11 offset:40322
    ds_read_u16 v192, v10 offset:24580
    ds_read_u16 v193, v10 offset:29828
    ds_read_u16 v194, v11 offset:24580
    ds_read_u16 v195, v11 offset:29828
    ds_read_u16 v196, v10 offset:35076
    ds_read_u16 v197, v10 offset:40324
    ds_read_u16 v198, v11 offset:35076
    ds_read_u16 v199, v11 offset:40324
    ds_read_u16 v200, v10 offset:24582
    ds_read_u16 v201, v10 offset:29830
    ds_read_u16 v202, v11 offset:24582
    ds_read_u16 v203, v11 offset:29830
    ds_read_u16 v204, v10 offset:35078
    ds_read_u16 v205, v10 offset:40326
    ds_read_u16 v206, v11 offset:35078
    ds_read_u16 v207, v11 offset:40326
    ds_read_u16 v208, v10 offset:24584
    ds_read_u16 v209, v10 offset:29832
    ds_read_u16 v210, v11 offset:24584
    ds_read_u16 v211, v11 offset:29832
    ds_read_u16 v212, v10 offset:35080
    ds_read_u16 v213, v10 offset:40328
    ds_read_u16 v214, v11 offset:35080
    ds_read_u16 v215, v11 offset:40328
    s_waitcnt lgkmcnt(15)
    v_lshl_or_b32 v216, v177, 16, v176
    v_lshl_or_b32 v217, v179, 16, v178
    v_lshl_or_b32 v218, v181, 16, v180
    v_lshl_or_b32 v219, v183, 16, v182
    s_cmp_eq_u32 s99, 10
    s_cselect_b32 s64, 0, s99
    s_lshl_b32 s64, s64, 18
    buffer_store_dwordx4 v[216:219], v13, s[48:51], s64 offen sc1
    v_lshl_or_b32 v220, v185, 16, v184
    v_lshl_or_b32 v221, v187, 16, v186
    v_lshl_or_b32 v222, v189, 16, v188
    v_lshl_or_b32 v223, v191, 16, v190
    s_add_i32 s99, s99, s98
    s_lshl_b32 s64, s99, 18
    buffer_store_dwordx4 v[220:223], v13, s[48:51], s64 offen sc1
    v_lshl_or_b32 v224, v193, 16, v192
    v_lshl_or_b32 v225, v195, 16, v194
    v_lshl_or_b32 v226, v197, 16, v196
    v_lshl_or_b32 v227, v199, 16, v198
    s_add_i32 s99, s99, s98
    s_lshl_b32 s64, s99, 18
    buffer_store_dwordx4 v[224:227], v13, s[48:51], s64 offen sc1
    s_waitcnt lgkmcnt(14)
    v_lshl_or_b32 v228, v201, 16, v200
    s_waitcnt lgkmcnt(12)
    v_lshl_or_b32 v229, v203, 16, v202
    s_waitcnt lgkmcnt(10)
    v_lshl_or_b32 v230, v205, 16, v204
    s_waitcnt lgkmcnt(8)
    v_lshl_or_b32 v231, v207, 16, v206
    s_add_i32 s99, s99, s98
    s_lshl_b32 s64, s99, 18
    buffer_store_dwordx4 v[228:231], v13, s[48:51], s64 offen sc1
    s_waitcnt lgkmcnt(6)
    v_lshl_or_b32 v232, v209, 16, v208
    s_waitcnt lgkmcnt(4)
    v_lshl_or_b32 v233, v211, 16, v210
    s_waitcnt lgkmcnt(2)
    v_lshl_or_b32 v234, v213, 16, v212
    s_waitcnt lgkmcnt(0)
    v_lshl_or_b32 v235, v215, 16, v214
    s_add_i32 s99, s99, s98
    s_lshl_b32 s64, s99, 18
    buffer_store_dwordx4 v[232:235], v13, s[48:51], s64 offen sc1
f_end:
    s_mov_b32 s57, s2
    s_add_u32 s12, s28, 12288000
    s_addc_u32 s13, s29, 0
    s_and_b32 s13, s13, 0xffff
    s_mov_b32 s14, 327680
    s_mov_b32 s15, 0x20000
    s_add_u32 s8, s28, 12615680
    s_addc_u32 s9, s29, 0
    s_and_b32 s9, s9, 0xffff
    s_mov_b32 s10, 7299072
    s_mov_b32 s11, 0x20000
    s_mov_b32 s99, 0
    v_accvgpr_write_b32 a0, -1
    v_accvgpr_write_b32 a1, -1
    v_accvgpr_write_b32 a2, -1
    v_accvgpr_write_b32 a3, -1
    s_cmp_ge_u32 s57, 160
    s_cbranch_scc1 idle0
    s_mul_i32 s59, s56, 3072
    v_lshlrev_b32 v6, 4, v0
    v_add_u32 v4, s59, v6
    s_lshl_b32 s59, s56, 10
    v_add_u32 v5, s59, v6
    s_mul_i32 s63, s57, 16640
    s_add_u32 s40, s28, 9641984
    s_addc_u32 s41, s29, 0
    s_and_b32 s41, s41, 0xffff
    s_mov_b32 s42, 2662400
    s_mov_b32 s43, 0x20000
    s_mul_i32 s58, s57, 256
    s_sub_u32 s40, s40, s58
    s_subb_u32 s41, s41, 0
    s_add_u32 s32, s28, 6979584
    s_addc_u32 s33, s29, 0
    s_and_b32 s33, s33, 0xffff
    s_mov_b32 s34, 2662400
    s_mov_b32 s35, 0x20000
    s_add_u32 s36, s28, 12263424
    s_addc_u32 s37, s29, 0
    s_and_b32 s37, s37, 0xffff
    s_mov_b32 s38, 8192
    s_mov_b32 s39, 0x20000
    s_lshl_b32 s58, s3, 7
    s_add_u32 s58, s58, 196608
    v_lshl_add_u32 v13, v0, 20, s58
    v_xor_b32 v7, 1024, v6
    v_xor_b32 v8, 2048, v6
    v_xor_b32 v9, 3072, v6
    v_and_b32 v176, 1, v1
    v_mul_u32_u24 v176, 0x8000, v176
    v_lshl_or_b32 v176, v176, 16, v176
    v_cvt_f32_u32 v177, v1
    v_lshlrev_b32 v178, 2, v2
    v_cvt_f32_u32 v178, v178
    v_mul_f32 v179, 0x3d000000, v177
    v_mul_f32 v200, v178, v179
    v_fmamk_f32 v203, v179, 0x3f800000, v200
    v_fmamk_f32 v206, v179, 0x40000000, v200
    v_fmamk_f32 v209, v179, 0x40400000, v200
    v_cos_f32 v201, v200
    v_sin_f32 v202, v200
    v_cos_f32 v204, v203
    v_sin_f32 v205, v203
    v_cos_f32 v207, v206
    v_sin_f32 v208, v206
    v_cos_f32 v210, v209
    v_sin_f32 v211, v209
    v_cvt_pk_bf16_f32 v56, v201, v202
    v_cvt_pk_bf16_f32 v60, -v202, v201
    v_cvt_pk_bf16_f32 v72, v201, v202
    v_cvt_pk_bf16_f32 v76, -v202, v201
    v_cvt_pk_bf16_f32 v57, v204, v205
    v_cvt_pk_bf16_f32 v61, -v205, v204
    v_cvt_pk_bf16_f32 v73, -v204, -v205
    v_cvt_pk_bf16_f32 v77, v205, -v204
    v_cvt_pk_bf16_f32 v58, v207, v208
    v_cvt_pk_bf16_f32 v62, -v208, v207
    v_cvt_pk_bf16_f32 v74, v207, v208
    v_cvt_pk_bf16_f32 v78, -v208, v207
    v_cvt_pk_bf16_f32 v59, v210, v211
    v_cvt_pk_bf16_f32 v63, -v211, v210
    v_cvt_pk_bf16_f32 v75, -v210, -v211
    v_cvt_pk_bf16_f32 v79, v211, -v210
    v_xor_b32 v64, v176, v56
    v_xor_b32 v65, v176, v57
    v_xor_b32 v66, v176, v58
    v_xor_b32 v67, v176, v59
    v_xor_b32 v68, v176, v60
    v_xor_b32 v69, v176, v61
    v_xor_b32 v70, v176, v62
    v_xor_b32 v71, v176, v63
    v_xor_b32 v80, v176, v72
    v_xor_b32 v81, v176, v73
    v_xor_b32 v82, v176, v74
    v_xor_b32 v83, v176, v75
    v_xor_b32 v84, v176, v76
    v_xor_b32 v85, v176, v77
    v_xor_b32 v86, v176, v78
    v_xor_b32 v87, v176, v79
    s_lshl_b32 s66, s56, 4
    v_cvt_f32_u32 v180, s66
    v_add_f32 v224, v180, v178
    v_add_f32 v180, v180, v177
    v_mul_f32 v225, 0x3a000000, v177
    v_add_f32 v226, 0x3c000000, v225
    v_add_f32 v200, 0x0, v224
    v_add_f32 v201, 0x3f800000, v224
    v_add_f32 v202, 0x40000000, v224
    v_add_f32 v203, 0x40400000, v224
    v_mul_f32 v204, v200, v225
    v_cos_f32 v120, v204
    v_sin_f32 v124, v204
    v_mul_f32 v205, v201, v225
    v_cos_f32 v121, v205
    v_sin_f32 v125, v205
    v_mul_f32 v206, v202, v225
    v_cos_f32 v122, v206
    v_sin_f32 v126, v206
    v_mul_f32 v207, v203, v225
    v_cos_f32 v123, v207
    v_sin_f32 v127, v207
    v_mul_f32 v208, v200, v226
    v_cos_f32 v128, v208
    v_sin_f32 v132, v208
    v_mul_f32 v209, v201, v226
    v_cos_f32 v129, v209
    v_sin_f32 v133, v209
    v_mul_f32 v210, v202, v226
    v_cos_f32 v130, v210
    v_sin_f32 v134, v210
    v_mul_f32 v211, v203, v226
    v_cos_f32 v131, v211
    v_sin_f32 v135, v211
    s_getreg_b32 s59, hwreg(HW_REG_XCC_ID, 0, 3)
    s_add_u32 s59, s59, 8
    s_lshl_b32 s58, s3, 7
    s_add_u32 s58, s58, 294912
    v_lshrrev_b32 v154, 1, v0
    v_lshl_add_u32 v154, v154, 20, s58
    v_and_b32 v152, 1, v0
    v_lshlrev_b32 v153, 15, v152
    v_sub_u32 v154, v154, v153
    s_waitcnt vmcnt(0)
    v_accvgpr_read_b32 v153, a255
    v_and_b32 v153, -8, v153
    v_add_u32 v153, s59, v153
    v_or_b32 v153, v152, v153
    s_barrier
    buffer_store_dword v153, v154, s[12:15], 0 offen sc1
    v_mul_f32 v179, 0x3c800000, v180
    s_xor_b32 s66, s66, 16
    v_cvt_f32_u32 v224, s66
    v_add_f32 v224, v224, v178
    v_mul_f32 v212, v200, v179
    v_cos_f32 v213, v212
    v_sin_f32 v214, v212
    v_mul_f32 v215, v201, v179
    v_cos_f32 v216, v215
    v_sin_f32 v217, v215
    v_mul_f32 v218, v202, v179
    v_cos_f32 v219, v218
    v_sin_f32 v220, v218
    v_mul_f32 v221, v203, v179
    v_cos_f32 v222, v221
    v_sin_f32 v223, v221
    v_cvt_pk_bf16_f32 v88, v213, v214
    v_cvt_pk_bf16_f32 v92, -v214, v213
    v_cvt_pk_bf16_f32 v89, v216, v217
    v_cvt_pk_bf16_f32 v93, -v217, v216
    v_cvt_pk_bf16_f32 v90, v219, v220
    v_cvt_pk_bf16_f32 v94, -v220, v219
    v_cvt_pk_bf16_f32 v91, v222, v223
    v_cvt_pk_bf16_f32 v95, -v223, v222
    v_add_f32 v212, 0x0, v224
    v_mul_f32 v212, v212, v179
    v_cos_f32 v213, v212
    v_sin_f32 v214, v212
    v_add_f32 v215, 0x3f800000, v224
    v_mul_f32 v215, v215, v179
    v_cos_f32 v216, v215
    v_sin_f32 v217, v215
    v_add_f32 v218, 0x40000000, v224
    v_mul_f32 v218, v218, v179
    v_cos_f32 v219, v218
    v_sin_f32 v220, v218
    v_add_f32 v221, 0x40400000, v224
    v_mul_f32 v221, v221, v179
    v_cos_f32 v222, v221
    v_sin_f32 v223, v221
    v_cvt_pk_bf16_f32 v96, v213, v214
    v_cvt_pk_bf16_f32 v100, -v214, v213
    v_cvt_pk_bf16_f32 v97, v216, v217
    v_cvt_pk_bf16_f32 v101, -v217, v216
    v_cvt_pk_bf16_f32 v98, v219, v220
    v_cvt_pk_bf16_f32 v102, -v220, v219
    v_cvt_pk_bf16_f32 v99, v222, v223
    v_cvt_pk_bf16_f32 v103, -v223, v222
    v_xor_b32 v104, v176, v88
    v_xor_b32 v105, v176, v89
    v_xor_b32 v106, v176, v90
    v_xor_b32 v107, v176, v91
    v_xor_b32 v108, v176, v92
    v_xor_b32 v109, v176, v93
    v_xor_b32 v110, v176, v94
    v_xor_b32 v111, v176, v95
    v_xor_b32 v112, v176, v96
    v_xor_b32 v113, v176, v97
    v_xor_b32 v114, v176, v98
    v_xor_b32 v115, v176, v99
    v_xor_b32 v116, v176, v100
    v_xor_b32 v117, v176, v101
    v_xor_b32 v118, v176, v102
    v_xor_b32 v119, v176, v103
    s_getreg_b32 s59, hwreg(HW_REG_XCC_ID, 0, 3)
    s_add_u32 s59, s59, 16
    s_lshl_b32 s58, s3, 7
    s_add_u32 s58, s58, 294912
    v_lshl_add_u32 v154, v0, 20, s58
    v_accvgpr_read_b32 v153, a255
    v_and_b32 v153, -8, v153
    v_add_u32 v153, s59, v153
    v_and_b32 v200, 31, v3
    v_bfe_u32 v201, v3, 5, 1
    v_lshl_add_u32 v200, v201, 7, v200
    v_lshl_add_u32 v200, s56, 5, v200
    v_lshlrev_b32 v200, 7, v200
    v_add_u32 v200, 294912, v200
    v_accvgpr_read_b32 v202, a254
c1_fw:
    buffer_load_dword v201, v200, s[12:15], 0 offen sc1
    s_add_u32 s99, s99, 1
    s_cmp_ge_u32 s99, 16384
    s_cbranch_scc1 c1_fwok
    s_waitcnt vmcnt(0)
    v_cmp_eq_u32 vcc, v202, v201
    s_nop 3
    s_cbranch_vccz c1_fwok
    s_mov_b64 exec, vcc
    s_branch c1_fw
c1_fwok:
    s_mov_b64 exec, -1
    s_waitcnt vmcnt(0)
    buffer_load_dwordx4 v[32:35], v5, s[36:39], 0 offen offset:0 sc1
    buffer_load_dwordx4 v[36:39], v5, s[36:39], 0 offen offset:1024 sc1
    buffer_load_dwordx4 v[16:19], v4, s[32:35], s63 offen offset:0 sc1
    buffer_load_dwordx4 v[20:23], v4, s[32:35], s63 offen offset:1024 sc1
    buffer_load_dwordx4 v[24:27], v4, s[32:35], s63 offen offset:2048 sc1
    buffer_load_dwordx4 v[28:31], v4, s[32:35], s63 offen offset:3072 sc1
    buffer_load_dwordx4 v[40:43], v4, s[40:43], s63 offen offset:0 sc1
    buffer_load_dwordx4 v[44:47], v4, s[40:43], s63 offen offset:1024 sc1
    buffer_load_dwordx4 v[48:51], v4, s[40:43], s63 offen offset:2048 sc1
    buffer_load_dwordx4 v[52:55], v4, s[40:43], s63 offen offset:3072 sc1
    s_getreg_b32 s59, hwreg(HW_REG_XCC_ID, 0, 3)
    s_lshl_b32 s59, s59, 20
    s_lshl_b32 s58, s3, 7
    s_add_u32 s58, s58, s59
    s_add_u32 s58, s58, 294912
    v_and_b32 v201, 7, v201
    v_lshl_add_u32 v201, v201, 20, v200
    v_cmp_gt_u32 vcc, s58, v201
    s_lshl_b32 s59, s56, 2
    v_mov_b32 v200, s59
    s_bcnt1_i32_b64 s58, vcc
    v_mov_b32 v201, s58
    ds_write_b32 v200, v201 offset:16384
    v_mov_b32 v200, 0
    s_waitcnt lgkmcnt(0)
    s_barrier
    buffer_store_dword v153, v154, s[12:15], 0 offen sc1
    ds_read_b128 v[200:203], v200 offset:16384
    s_waitcnt lgkmcnt(0)
    v_add_u32 v200, v200, v201
    v_add3_u32 v200, v200, v202, v203
    s_nop 0
    v_readfirstlane_b32 s100, v200
    s_nop 0
    s_and_b32 s58, s100, 31
    s_bfe_u32 s100, s100, 0x30005
    s_lshl3_add_u32 s100, s58, s100
    s_and_b32 s58, s100, 7
    s_lshr_b32 s59, s58, 1
    s_lshl_b32 s59, s59, 2
    s_bfe_u32 s96, s100, 0x20006
    s_add_u32 s96, s96, s59
    s_and_b32 s58, s58, 1
    s_lshl_b32 s58, s58, 3
    s_bfe_u32 s97, s100, 0x30003
    s_add_u32 s97, s97, s58
    s_lshl_b32 s98, s96, 7
    s_and_b32 s58, s97, 3
    s_cmp_eq_u32 s58, 3
    s_cselect_b32 s26, 0x40000000, 0
    s_lshr_b32 s59, s97, 3
    s_lshl2_add_u32 s16, s59, s58
    s_mul_i32 s19, s97, 7
    s_lshr_b32 s59, s97, 2
    s_sub_u32 s19, s19, s59
    s_mul_i32 s20, s56, 5120
    s_mul_i32 s21, s56, 15360
    s_mul_i32 s62, s56, 35840
    s_add_u32 m0, s62, 20480
    v_lshlrev_b32 v10, 4, v3
    s_mul_i32 s58, s19, 20480
    s_add_u32 s58, s58, 12288
    s_add_u32 s48, s28, s58
    s_addc_u32 s49, s29, 0
    s_and_b32 s49, s49, 0xffff
    s_mov_b32 s50, 163840
    s_cmp_lg_u32 s26, 0
    s_cselect_b32 s50, 143360, s50
    s_mov_b32 s51, 0x20000
    v_lshrrev_b32 v11, 1, v2
    v_and_b32 v12, 1, v2
    v_mad_u32_u24 v15, v11, 14, v12
    v_mul_u32_u24 v15, 10240, v15
    v_lshl_add_u32 v15, v1, 4, v15
    s_mul_i32 s58, s16, 1280
    s_mul_i32 s59, s56, 552960
    s_add_u32 s58, s58, s59
    v_add_u32 v15, s58, v15
    v_mul_u32_u24 v11, 33792, v11
    v_lshl_add_u32 v11, v1, 5, v11
    v_lshl_add_u32 v11, v12, 4, v11
    s_mul_i32 s58, s19, 67584
    s_lshl4_add_u32 s58, s98, s58
    s_lshl_b32 s59, s56, 9
    s_add_u32 s58, s58, s59
    v_add_u32 v11, s58, v11
    v_add_u32 v12, s26, v11
    s_add_u32 s52, s28, 2330624
    s_addc_u32 s53, s29, 0
    s_and_b32 s53, s53, 0xffff
    s_mov_b32 s54, 2232320
    s_mov_b32 s55, 0x20000
    s_add_u32 s58, s56, 1
    s_mul_i32 s58, s58, 552960
    s_cmp_eq_u32 s56, 3
    s_cselect_b32 s54, s54, s58
    buffer_load_dwordx4 v10, s[48:51], m0 offen offset:0 lds
    buffer_load_dwordx4 v10, s[48:51], m0 offen offset:1024 lds
    buffer_load_dwordx4 v10, s[48:51], m0 offen offset:2048 lds
    buffer_load_dwordx4 v10, s[48:51], m0 offen offset:3072 lds
    s_add_u32 m0, m0, 4096
    s_nop 0
    buffer_load_dwordx4 v10, s[48:51], m0 offen offset:0 lds
    s_mov_b32 s65, 0
    buffer_store_dwordx4 a[0:3], v11, s[8:11], s65 offen sc1
    buffer_load_dwordx4 v10, s[48:51], m0 offen offset:1024 lds
    buffer_load_dwordx4 v10, s[48:51], m0 offen offset:2048 lds
    v_mul_f32 v179, 0x3a000000, v180
    v_mul_f32 v200, v178, v179
    v_fmamk_f32 v201, v179, 0x3f800000, v200
    v_fmamk_f32 v202, v179, 0x40000000, v200
    v_fmamk_f32 v203, v179, 0x40400000, v200
    v_fmamk_f32 v204, v179, 0x41800000, v200
    v_fmamk_f32 v205, v179, 0x41880000, v200
    v_fmamk_f32 v206, v179, 0x41900000, v200
    v_fmamk_f32 v207, v179, 0x41980000, v200
    v_cos_f32 v136, v200
    v_sin_f32 v140, v200
    v_cos_f32 v137, v201
    v_sin_f32 v141, v201
    v_cos_f32 v138, v202
    v_sin_f32 v142, v202
    v_cos_f32 v139, v203
    buffer_load_dwordx4 v10, s[48:51], m0 offen offset:3072 lds
    s_add_u32 m0, m0, 4096
    v_sin_f32 v143, v203
    v_cos_f32 v144, v204
    v_sin_f32 v148, v204
    v_cos_f32 v145, v205
    v_sin_f32 v149, v205
    v_cos_f32 v146, v206
    v_sin_f32 v150, v206
    v_cos_f32 v147, v207
    v_sin_f32 v151, v207
    s_mov_b32 s67, 0xffff0000
    s_cmp_eq_u32 s57, 0
    s_cselect_b32 s68, 0, s67
    s_mov_b32 s66, 0xba000000
    s_cselect_b32 s69, 0, s66
    s_mov_b32 s58, 0x3acccccd
    s_mov_b32 s59, 0x3a000000
    s_mov_b32 s60, 0x24802480
    v_mov_b32 v179, 0x3727c5ac
    buffer_load_dwordx4 v10, s[48:51], m0 offen offset:0 lds
    s_waitcnt vmcnt(20)
    v_fma_f32 v32, v32, s58, v179
    v_fma_f32 v33, v33, s58, v179
    v_fma_f32 v34, v34, s58, v179
    v_fma_f32 v35, v35, s58, v179
    s_waitcnt vmcnt(19)
    v_fma_f32 v36, v36, s58, v179
    v_fma_f32 v37, v37, s58, v179
    v_fma_f32 v38, v38, s58, v179
    v_fma_f32 v39, v39, s58, v179
    v_rsq_f32 v32, v32
    v_rsq_f32 v33, v33
    v_rsq_f32 v34, v34
    v_rsq_f32 v35, v35
    v_rsq_f32 v36, v36
    v_rsq_f32 v37, v37
    v_rsq_f32 v38, v38
    v_rsq_f32 v39, v39
    buffer_load_dwordx4 v10, s[48:51], m0 offen offset:1024 lds
    s_waitcnt vmcnt(19)
    v_lshlrev_b32 v200, 16, v16
    v_and_b32 v201, s68, v16
    v_lshlrev_b32 v202, 16, v18
    v_and_b32 v203, s68, v18
    s_waitcnt vmcnt(18)
    v_lshlrev_b32 v204, 16, v20
    v_and_b32 v205, s68, v20
    v_lshlrev_b32 v206, 16, v22
    v_and_b32 v207, s68, v22
    s_waitcnt vmcnt(17)
    v_lshlrev_b32 v208, 16, v24
    v_and_b32 v209, s68, v24
    v_lshlrev_b32 v210, 16, v26
    v_and_b32 v211, s68, v26
    s_waitcnt vmcnt(16)
    v_lshlrev_b32 v212, 16, v28
    v_and_b32 v213, s68, v28
    v_lshlrev_b32 v214, 16, v30
    v_and_b32 v215, s68, v30
    v_pk_mul_f32 v[200:201], v[200:201], v[32:33] op_sel:[0,0] op_sel_hi:[1,0]
    v_pk_mul_f32 v[202:203], v[202:203], v[32:33] op_sel:[0,1] op_sel_hi:[1,1]
    v_pk_mul_f32 v[204:205], v[204:205], v[34:35] op_sel:[0,0] op_sel_hi:[1,0]
    v_pk_mul_f32 v[206:207], v[206:207], v[34:35] op_sel:[0,1] op_sel_hi:[1,1]
    v_pk_mul_f32 v[208:209], v[208:209], v[36:37] op_sel:[0,0] op_sel_hi:[1,0]
    s_mov_b32 s65, 67584
    buffer_store_dwordx4 a[0:3], v11, s[8:11], s65 offen sc1
    v_pk_mul_f32 v[210:211], v[210:211], v[36:37] op_sel:[0,1] op_sel_hi:[1,1]
    v_pk_mul_f32 v[212:213], v[212:213], v[38:39] op_sel:[0,0] op_sel_hi:[1,0]
    v_pk_mul_f32 v[214:215], v[214:215], v[38:39] op_sel:[0,1] op_sel_hi:[1,1]
    v_cvt_pk_bf16_f32 v184, v200, v201
    v_cvt_pk_bf16_f32 v185, v202, v203
    v_cvt_pk_bf16_f32 v186, v204, v205
    v_cvt_pk_bf16_f32 v187, v206, v207
    v_cvt_pk_bf16_f32 v188, v208, v209
    v_cvt_pk_bf16_f32 v189, v210, v211
    v_cvt_pk_bf16_f32 v190, v212, v213
    v_cvt_pk_bf16_f32 v191, v214, v215
    v_mfma_f32_16x16x32_bf16 v[152:155], v[184:187], v[56:59], 0
    v_lshlrev_b32 v216, 16, v17
    v_and_b32 v217, s67, v17
    v_mfma_f32_16x16x32_bf16 v[156:159], v[184:187], v[60:63], 0
    v_lshlrev_b32 v218, 16, v19
    v_and_b32 v219, s67, v19
    buffer_load_dwordx4 v10, s[48:51], m0 offen offset:2048 lds
    v_mfma_f32_16x16x32_bf16 v[160:163], v[184:187], v[72:75], 0
    v_lshlrev_b32 v220, 16, v21
    v_and_b32 v221, s67, v21
    v_mfma_f32_16x16x32_bf16 v[164:167], v[184:187], v[76:79], 0
    v_lshlrev_b32 v222, 16, v23
    v_and_b32 v223, s67, v23
    v_mfma_f32_16x16x32_bf16 v[152:155], v[188:191], v[64:67], v[152:155]
    v_lshlrev_b32 v224, 16, v25
    v_and_b32 v225, s67, v25
    v_mfma_f32_16x16x32_bf16 v[156:159], v[188:191], v[68:71], v[156:159]
    buffer_load_dwordx4 v10, s[48:51], m0 offen offset:3072 lds
    s_add_u32 m0, m0, 4096
    v_lshlrev_b32 v226, 16, v27
    v_and_b32 v227, s67, v27
    v_mfma_f32_16x16x32_bf16 v[160:163], v[188:191], v[80:83], v[160:163]
    v_lshlrev_b32 v228, 16, v29
    v_and_b32 v229, s67, v29
    v_mfma_f32_16x16x32_bf16 v[164:167], v[188:191], v[84:87], v[164:167]
    v_lshlrev_b32 v230, 16, v31
    v_and_b32 v231, s67, v31
    v_pk_mul_f32 v[216:217], v[216:217], v[32:33] op_sel:[0,0] op_sel_hi:[1,0]
    v_pk_mul_f32 v[218:219], v[218:219], v[32:33] op_sel:[0,1] op_sel_hi:[1,1]
    v_pk_mul_f32 v[220:221], v[220:221], v[34:35] op_sel:[0,0] op_sel_hi:[1,0]
    v_pk_mul_f32 v[222:223], v[222:223], v[34:35] op_sel:[0,1] op_sel_hi:[1,1]
    v_pk_mul_f32 v[224:225], v[224:225], v[36:37] op_sel:[0,0] op_sel_hi:[1,0]
    v_pk_mul_f32 v[226:227], v[226:227], v[36:37] op_sel:[0,1] op_sel_hi:[1,1]
    v_pk_mul_f32 v[228:229], v[228:229], v[38:39] op_sel:[0,0] op_sel_hi:[1,0]
    v_pk_mul_f32 v[230:231], v[230:231], v[38:39] op_sel:[0,1] op_sel_hi:[1,1]
    v_cvt_pk_bf16_f32 v192, v216, v217
    buffer_load_dwordx4 v10, s[48:51], m0 offen offset:0 lds
    v_cvt_pk_bf16_f32 v193, v218, v219
    v_cvt_pk_bf16_f32 v194, v220, v221
    v_cvt_pk_bf16_f32 v195, v222, v223
    v_cvt_pk_bf16_f32 v196, v224, v225
    v_cvt_pk_bf16_f32 v197, v226, v227
    v_cvt_pk_bf16_f32 v198, v228, v229
    v_cvt_pk_bf16_f32 v199, v230, v231
    v_mfma_f32_16x16x32_bf16 v[168:171], v[192:195], v[56:59], 0
    s_waitcnt vmcnt(19)
    v_lshlrev_b32 v232, 16, v40
    v_and_b32 v236, s67, v40
    v_mfma_f32_16x16x32_bf16 v[172:175], v[192:195], v[60:63], 0
    v_lshlrev_b32 v233, 16, v42
    v_and_b32 v237, s67, v42
    v_mfma_f32_16x16x32_bf16 v[176:179], v[192:195], v[72:75], 0
    buffer_load_dwordx4 v10, s[48:51], m0 offen offset:1024 lds
    s_waitcnt vmcnt(19)
    v_lshlrev_b32 v234, 16, v44
    v_and_b32 v238, s67, v44
    v_mfma_f32_16x16x32_bf16 v[180:183], v[192:195], v[76:79], 0
    v_lshlrev_b32 v235, 16, v46
    v_and_b32 v239, s67, v46
    v_mfma_f32_16x16x32_bf16 v[168:171], v[196:199], v[64:67], v[168:171]
    s_waitcnt vmcnt(18)
    v_lshlrev_b32 v240, 16, v48
    v_and_b32 v244, s67, v48
    v_mfma_f32_16x16x32_bf16 v[172:175], v[196:199], v[68:71], v[172:175]
    v_lshlrev_b32 v241, 16, v50
    v_and_b32 v245, s67, v50
    v_mfma_f32_16x16x32_bf16 v[176:179], v[196:199], v[80:83], v[176:179]
    buffer_load_dwordx4 v10, s[48:51], m0 offen offset:2048 lds
    s_waitcnt vmcnt(18)
    v_lshlrev_b32 v242, 16, v52
    v_and_b32 v246, s67, v52
    v_mfma_f32_16x16x32_bf16 v[180:183], v[196:199], v[84:87], v[180:183]
    v_lshlrev_b32 v243, 16, v54
    v_and_b32 v247, s67, v54
    v_pk_mul_f32 v[200:201], v[152:153], v[120:121]
    v_pk_mul_f32 v[202:203], v[156:157], v[120:121]
    v_pk_mul_f32 v[204:205], v[154:155], v[122:123]
    v_pk_mul_f32 v[206:207], v[158:159], v[122:123]
    v_pk_fma_f32 v[200:201], v[156:157], v[124:125], v[200:201]
    v_pk_fma_f32 v[202:203], v[152:153], v[124:125], v[202:203] neg_lo:[1,0,0] neg_hi:[1,0,0]
    v_pk_fma_f32 v[204:205], v[158:159], v[126:127], v[204:205]
    v_pk_fma_f32 v[206:207], v[154:155], v[126:127], v[206:207] neg_lo:[1,0,0] neg_hi:[1,0,0]
    v_cvt_pk_bf16_f32 v184, v200, v202
    v_cvt_pk_bf16_f32 v185, v201, v203
    v_cvt_pk_bf16_f32 v186, v204, v206
    v_cvt_pk_bf16_f32 v187, v205, v207
    s_mov_b32 s65, 135168
    buffer_store_dwordx4 a[0:3], v11, s[8:11], s65 offen sc1
    ds_write_b128 v6, v[184:187] offset:0
    v_pk_mul_f32 v[208:209], v[160:161], v[128:129]
    v_pk_mul_f32 v[210:211], v[164:165], v[128:129]
    v_pk_mul_f32 v[212:213], v[162:163], v[130:131]
    v_pk_mul_f32 v[214:215], v[166:167], v[130:131]
    v_pk_fma_f32 v[208:209], v[164:165], v[132:133], v[208:209]
    v_pk_fma_f32 v[210:211], v[160:161], v[132:133], v[210:211] neg_lo:[1,0,0] neg_hi:[1,0,0]
    v_pk_fma_f32 v[212:213], v[166:167], v[134:135], v[212:213]
    v_pk_fma_f32 v[214:215], v[162:163], v[134:135], v[214:215] neg_lo:[1,0,0] neg_hi:[1,0,0]
    v_cvt_pk_bf16_f32 v188, v208, v210
    v_cvt_pk_bf16_f32 v189, v209, v211
    v_cvt_pk_bf16_f32 v190, v212, v214
    v_cvt_pk_bf16_f32 v191, v213, v215
    ds_write_b128 v6, v[188:191] offset:4096
    v_pk_mul_f32 v[216:217], v[168:169], v[120:121]
    v_pk_mul_f32 v[218:219], v[172:173], v[120:121]
    v_pk_mul_f32 v[220:221], v[170:171], v[122:123]
    v_pk_mul_f32 v[222:223], v[174:175], v[122:123]
    v_pk_fma_f32 v[216:217], v[172:173], v[124:125], v[216:217]
    v_pk_fma_f32 v[218:219], v[168:169], v[124:125], v[218:219] neg_lo:[1,0,0] neg_hi:[1,0,0]
    v_pk_fma_f32 v[220:221], v[174:175], v[126:127], v[220:221]
    v_pk_fma_f32 v[222:223], v[170:171], v[126:127], v[222:223] neg_lo:[1,0,0] neg_hi:[1,0,0]
    v_cvt_pk_bf16_f32 v192, v216, v218
    buffer_load_dwordx4 v10, s[48:51], m0 offen offset:3072 lds
    s_add_u32 m0, m0, 4096
    v_cvt_pk_bf16_f32 v193, v217, v219
    v_cvt_pk_bf16_f32 v194, v220, v222
    v_cvt_pk_bf16_f32 v195, v221, v223
    ds_write_b128 v6, v[192:195] offset:8192
    v_pk_mul_f32 v[224:225], v[176:177], v[128:129]
    v_pk_mul_f32 v[226:227], v[180:181], v[128:129]
    v_pk_mul_f32 v[228:229], v[178:179], v[130:131]
    v_pk_mul_f32 v[230:231], v[182:183], v[130:131]
    v_pk_fma_f32 v[224:225], v[180:181], v[132:133], v[224:225]
    v_pk_fma_f32 v[226:227], v[176:177], v[132:133], v[226:227] neg_lo:[1,0,0] neg_hi:[1,0,0]
    v_pk_fma_f32 v[228:229], v[182:183], v[134:135], v[228:229]
    v_pk_fma_f32 v[230:231], v[178:179], v[134:135], v[230:231] neg_lo:[1,0,0] neg_hi:[1,0,0]
    v_cvt_pk_bf16_f32 v196, v224, v226
    v_cvt_pk_bf16_f32 v197, v225, v227
    v_cvt_pk_bf16_f32 v198, v228, v230
    v_cvt_pk_bf16_f32 v199, v229, v231
    ds_write_b128 v6, v[196:199] offset:12288
    s_waitcnt lgkmcnt(0)
    s_barrier
    ds_read_b128 v[200:203], v7 offset:0
    ds_read_b128 v[204:207], v7 offset:4096
    ds_read_b128 v[208:211], v8 offset:0
    buffer_load_dwordx4 v10, s[48:51], m0 offen offset:0 lds
    ds_read_b128 v[212:215], v8 offset:4096
    ds_read_b128 v[216:219], v9 offset:0
    ds_read_b128 v[220:223], v9 offset:4096
    ds_read_b128 v[224:227], v7 offset:8192
    ds_read_b128 v[228:231], v7 offset:12288
    ds_read_b128 v[32:35], v8 offset:8192
    ds_read_b128 v[36:39], v8 offset:12288
    ds_read_b128 v[248:251], v9 offset:8192
    ds_read_b128 v[252:255], v9 offset:12288
    v_mfma_f32_16x16x32_bf16 v[152:155], v[88:91], v[184:187], 0
    v_lshlrev_b32 v120, 16, v41
    v_and_b32 v124, s67, v41
    v_mfma_f32_16x16x32_bf16 v[156:159], v[92:95], v[184:187], 0
    v_lshlrev_b32 v121, 16, v43
    v_and_b32 v125, s67, v43
    v_mfma_f32_16x16x32_bf16 v[160:163], v[88:91], v[188:191], 0
    buffer_load_dwordx4 v10, s[48:51], m0 offen offset:1024 lds
    v_lshlrev_b32 v122, 16, v45
    v_and_b32 v126, s67, v45
    v_mfma_f32_16x16x32_bf16 v[164:167], v[92:95], v[188:191], 0
    v_lshlrev_b32 v123, 16, v47
    v_and_b32 v127, s67, v47
    v_mfma_f32_16x16x32_bf16 v[168:171], v[88:91], v[192:195], 0
    v_lshlrev_b32 v128, 16, v49
    v_and_b32 v132, s67, v49
    v_mfma_f32_16x16x32_bf16 v[172:175], v[92:95], v[192:195], 0
    v_lshlrev_b32 v129, 16, v51
    v_and_b32 v133, s67, v51
    buffer_load_dwordx4 v10, s[48:51], m0 offen offset:2048 lds
    v_mfma_f32_16x16x32_bf16 v[176:179], v[88:91], v[196:199], 0
    v_lshlrev_b32 v130, 16, v53
    v_and_b32 v134, s67, v53
    v_mfma_f32_16x16x32_bf16 v[180:183], v[92:95], v[196:199], 0
    v_lshlrev_b32 v131, 16, v55
    v_and_b32 v135, s67, v55
    s_waitcnt lgkmcnt(11)
    v_mfma_f32_16x16x32_bf16 v[152:155], v[96:99], v[200:203], v[152:155]
    v_mfma_f32_16x16x32_bf16 v[156:159], v[100:103], v[200:203], v[156:159]
    s_waitcnt lgkmcnt(10)
    v_mfma_f32_16x16x32_bf16 v[160:163], v[96:99], v[204:207], v[160:163]
    buffer_load_dwordx4 v10, s[48:51], m0 offen offset:3072 lds
    s_add_u32 m0, m0, 4096
    v_mfma_f32_16x16x32_bf16 v[164:167], v[100:103], v[204:207], v[164:167]
    s_waitcnt lgkmcnt(9)
    v_mfma_f32_16x16x32_bf16 v[152:155], v[104:107], v[208:211], v[152:155]
    v_mfma_f32_16x16x32_bf16 v[156:159], v[108:111], v[208:211], v[156:159]
    s_waitcnt lgkmcnt(8)
    v_mfma_f32_16x16x32_bf16 v[160:163], v[104:107], v[212:215], v[160:163]
    v_mfma_f32_16x16x32_bf16 v[164:167], v[108:111], v[212:215], v[164:167]
    s_waitcnt lgkmcnt(7)
    v_mfma_f32_16x16x32_bf16 v[152:155], v[112:115], v[216:219], v[152:155]
    s_mov_b32 s65, 202752
    buffer_store_dwordx4 a[0:3], v11, s[8:11], s65 offen sc1
    v_mfma_f32_16x16x32_bf16 v[156:159], v[116:119], v[216:219], v[156:159]
    s_waitcnt lgkmcnt(6)
    v_mfma_f32_16x16x32_bf16 v[160:163], v[112:115], v[220:223], v[160:163]
    v_mfma_f32_16x16x32_bf16 v[164:167], v[116:119], v[220:223], v[164:167]
    s_waitcnt lgkmcnt(5)
    v_mfma_f32_16x16x32_bf16 v[168:171], v[96:99], v[224:227], v[168:171]
    v_mfma_f32_16x16x32_bf16 v[172:175], v[100:103], v[224:227], v[172:175]
    buffer_load_dwordx4 v10, s[48:51], m0 offen offset:0 lds
    s_waitcnt lgkmcnt(4)
    v_mfma_f32_16x16x32_bf16 v[176:179], v[96:99], v[228:231], v[176:179]
    v_mfma_f32_16x16x32_bf16 v[180:183], v[100:103], v[228:231], v[180:183]
    s_waitcnt lgkmcnt(3)
    v_mfma_f32_16x16x32_bf16 v[168:171], v[104:107], v[32:35], v[168:171]
    v_mfma_f32_16x16x32_bf16 v[172:175], v[108:111], v[32:35], v[172:175]
    s_waitcnt lgkmcnt(2)
    v_mfma_f32_16x16x32_bf16 v[176:179], v[104:107], v[36:39], v[176:179]
    v_mfma_f32_16x16x32_bf16 v[180:183], v[108:111], v[36:39], v[180:183]
    buffer_load_dwordx4 v10, s[48:51], m0 offen offset:1024 lds
    s_waitcnt lgkmcnt(1)
    v_mfma_f32_16x16x32_bf16 v[168:171], v[112:115], v[248:251], v[168:171]
    v_mfma_f32_16x16x32_bf16 v[172:175], v[116:119], v[248:251], v[172:175]
    s_waitcnt lgkmcnt(0)
    v_mfma_f32_16x16x32_bf16 v[176:179], v[112:115], v[252:255], v[176:179]
    v_mfma_f32_16x16x32_bf16 v[180:183], v[116:119], v[252:255], v[180:183]
    buffer_store_dword v13, v13, s[12:15], 0 offen sc1
    v_pk_mul_f32 v[200:201], v[152:153], v[232:233]
    v_pk_mul_f32 v[202:203], v[156:157], v[232:233]
    v_pk_mul_f32 v[204:205], v[154:155], v[234:235]
    v_pk_mul_f32 v[206:207], v[158:159], v[234:235]
    v_pk_fma_f32 v[200:201], v[156:157], v[236:237], v[200:201] neg_lo:[1,0,0] neg_hi:[1,0,0]
    buffer_load_dwordx4 v10, s[48:51], m0 offen offset:2048 lds
    v_pk_fma_f32 v[202:203], v[152:153], v[236:237], v[202:203]
    v_pk_fma_f32 v[204:205], v[158:159], v[238:239], v[204:205] neg_lo:[1,0,0] neg_hi:[1,0,0]
    v_pk_fma_f32 v[206:207], v[154:155], v[238:239], v[206:207]
    v_cvt_pk_bf16_f32 v184, v200, -v202
    v_cvt_pk_bf16_f32 v185, v201, -v203
    v_cvt_pk_bf16_f32 v186, v204, -v206
    v_cvt_pk_bf16_f32 v187, v205, -v207
    s_barrier
    ds_write_b128 v6, v[184:187] offset:0
    v_pk_mul_f32 v[208:209], v[160:161], v[240:241]
    v_pk_mul_f32 v[210:211], v[164:165], v[240:241]
    v_pk_mul_f32 v[212:213], v[162:163], v[242:243]
    v_pk_mul_f32 v[214:215], v[166:167], v[242:243]
    v_pk_fma_f32 v[208:209], v[164:165], v[244:245], v[208:209] neg_lo:[1,0,0] neg_hi:[1,0,0]
    v_pk_fma_f32 v[210:211], v[160:161], v[244:245], v[210:211]
    v_pk_fma_f32 v[212:213], v[166:167], v[246:247], v[212:213] neg_lo:[1,0,0] neg_hi:[1,0,0]
    v_pk_fma_f32 v[214:215], v[162:163], v[246:247], v[214:215]
    v_cvt_pk_bf16_f32 v188, v208, -v210
    v_cvt_pk_bf16_f32 v189, v209, -v211
    v_cvt_pk_bf16_f32 v190, v212, -v214
    v_cvt_pk_bf16_f32 v191, v213, -v215
    ds_write_b128 v6, v[188:191] offset:4096
    buffer_load_dwordx4 v10, s[48:51], m0 offen offset:3072 lds
    s_add_u32 m0, m0, 4096
    v_pk_mul_f32 v[216:217], v[168:169], v[120:121]
    v_pk_mul_f32 v[218:219], v[172:173], v[120:121]
    v_pk_mul_f32 v[220:221], v[170:171], v[122:123]
    v_pk_mul_f32 v[222:223], v[174:175], v[122:123]
    v_pk_fma_f32 v[216:217], v[172:173], v[124:125], v[216:217] neg_lo:[1,0,0] neg_hi:[1,0,0]
    v_pk_fma_f32 v[218:219], v[168:169], v[124:125], v[218:219]
    v_pk_fma_f32 v[220:221], v[174:175], v[126:127], v[220:221] neg_lo:[1,0,0] neg_hi:[1,0,0]
    v_pk_fma_f32 v[222:223], v[170:171], v[126:127], v[222:223]
    v_cvt_pk_bf16_f32 v192, v216, -v218
    v_cvt_pk_bf16_f32 v193, v217, -v219
    v_cvt_pk_bf16_f32 v194, v220, -v222
    v_cvt_pk_bf16_f32 v195, v221, -v223
    ds_write_b128 v6, v[192:195] offset:8192
    v_pk_mul_f32 v[224:225], v[176:177], v[128:129]
    v_pk_mul_f32 v[226:227], v[180:181], v[128:129]
    v_pk_mul_f32 v[228:229], v[178:179], v[130:131]
    v_pk_mul_f32 v[230:231], v[182:183], v[130:131]
    v_pk_fma_f32 v[224:225], v[180:181], v[132:133], v[224:225] neg_lo:[1,0,0] neg_hi:[1,0,0]
    v_pk_fma_f32 v[226:227], v[176:177], v[132:133], v[226:227]
    v_pk_fma_f32 v[228:229], v[182:183], v[134:135], v[228:229] neg_lo:[1,0,0] neg_hi:[1,0,0]
    v_pk_fma_f32 v[230:231], v[178:179], v[134:135], v[230:231]
    v_cvt_pk_bf16_f32 v196, v224, -v226
    v_cvt_pk_bf16_f32 v197, v225, -v227
    buffer_load_dwordx4 v10, s[48:51], m0 offen offset:0 lds
    v_cvt_pk_bf16_f32 v198, v228, -v230
    v_cvt_pk_bf16_f32 v199, v229, -v231
    ds_write_b128 v6, v[196:199] offset:12288
    s_waitcnt lgkmcnt(0)
    s_barrier
    ds_read_b128 v[200:203], v7 offset:0
    ds_read_b128 v[204:207], v7 offset:4096
    ds_read_b128 v[208:211], v8 offset:0
    ds_read_b128 v[212:215], v8 offset:4096
    ds_read_b128 v[216:219], v9 offset:0
    ds_read_b128 v[220:223], v9 offset:4096
    ds_read_b128 v[224:227], v7 offset:8192
    ds_read_b128 v[228:231], v7 offset:12288
    ds_read_b128 v[32:35], v8 offset:8192
    ds_read_b128 v[36:39], v8 offset:12288
    ds_read_b128 v[248:251], v9 offset:8192
    ds_read_b128 v[252:255], v9 offset:12288
    v_mfma_f32_16x16x32_bf16 v[152:155], v[184:187], v[88:91], 0
    v_lshlrev_b32 v232, 16, v16
    s_mov_b32 s65, 270336
    buffer_store_dwordx4 a[0:3], v11, s[8:11], s65 offen sc1
    v_and_b32 v233, s67, v16
    v_mfma_f32_16x16x32_bf16 v[156:159], v[184:187], v[92:95], 0
    v_lshlrev_b32 v234, 16, v18
    v_and_b32 v235, s67, v18
    v_mfma_f32_16x16x32_bf16 v[160:163], v[188:191], v[88:91], 0
    v_lshlrev_b32 v236, 16, v20
    v_and_b32 v237, s67, v20
    v_mfma_f32_16x16x32_bf16 v[164:167], v[188:191], v[92:95], 0
    v_lshlrev_b32 v238, 16, v22
    v_and_b32 v239, s67, v22
    v_mfma_f32_16x16x32_bf16 v[168:171], v[192:195], v[88:91], 0
    buffer_load_dwordx4 v10, s[48:51], m0 offen offset:1024 lds
    v_lshlrev_b32 v240, 16, v24
    v_and_b32 v241, s67, v24
    v_mfma_f32_16x16x32_bf16 v[172:175], v[192:195], v[92:95], 0
    v_lshlrev_b32 v242, 16, v26
    v_and_b32 v243, s67, v26
    v_mfma_f32_16x16x32_bf16 v[176:179], v[196:199], v[88:91], 0
    v_lshlrev_b32 v244, 16, v28
    v_and_b32 v245, s67, v28
    v_mfma_f32_16x16x32_bf16 v[180:183], v[196:199], v[92:95], 0
    v_lshlrev_b32 v246, 16, v30
    v_and_b32 v247, s67, v30
    s_waitcnt lgkmcnt(11)
    v_mfma_f32_16x16x32_bf16 v[152:155], v[200:203], v[96:99], v[152:155]
    buffer_load_dwordx4 v10, s[48:51], m0 offen offset:2048 lds
    v_lshlrev_b32 v120, 16, v17
    v_and_b32 v121, s67, v17
    v_mfma_f32_16x16x32_bf16 v[156:159], v[200:203], v[100:103], v[156:159]
    v_lshlrev_b32 v122, 16, v19
    v_and_b32 v123, s67, v19
    s_waitcnt lgkmcnt(10)
    v_mfma_f32_16x16x32_bf16 v[160:163], v[204:207], v[96:99], v[160:163]
    v_lshlrev_b32 v124, 16, v21
    v_and_b32 v125, s67, v21
    v_mfma_f32_16x16x32_bf16 v[164:167], v[204:207], v[100:103], v[164:167]
    v_lshlrev_b32 v126, 16, v23
    v_and_b32 v127, s67, v23
    s_waitcnt lgkmcnt(9)
    v_mfma_f32_16x16x32_bf16 v[152:155], v[208:211], v[104:107], v[152:155]
    buffer_load_dwordx4 v10, s[48:51], m0 offen offset:3072 lds
    s_add_u32 m0, m0, 4096
    v_lshlrev_b32 v128, 16, v25
    v_and_b32 v129, s67, v25
    v_mfma_f32_16x16x32_bf16 v[156:159], v[208:211], v[108:111], v[156:159]
    v_lshlrev_b32 v130, 16, v27
    v_and_b32 v131, s67, v27
    s_waitcnt lgkmcnt(8)
    v_mfma_f32_16x16x32_bf16 v[160:163], v[212:215], v[104:107], v[160:163]
    v_lshlrev_b32 v132, 16, v29
    v_and_b32 v133, s67, v29
    v_mfma_f32_16x16x32_bf16 v[164:167], v[212:215], v[108:111], v[164:167]
    v_lshlrev_b32 v134, 16, v31
    buffer_load_dwordx4 v10, s[48:51], m0 offen offset:0 lds
    v_and_b32 v135, s67, v31
    s_waitcnt lgkmcnt(7)
    v_mfma_f32_16x16x32_bf16 v[152:155], v[216:219], v[112:115], v[152:155]
    v_mfma_f32_16x16x32_bf16 v[156:159], v[216:219], v[116:119], v[156:159]
    s_waitcnt lgkmcnt(6)
    v_mfma_f32_16x16x32_bf16 v[160:163], v[220:223], v[112:115], v[160:163]
    v_mfma_f32_16x16x32_bf16 v[164:167], v[220:223], v[116:119], v[164:167]
    s_waitcnt lgkmcnt(5)
    v_mfma_f32_16x16x32_bf16 v[168:171], v[224:227], v[96:99], v[168:171]
    v_mfma_f32_16x16x32_bf16 v[172:175], v[224:227], v[100:103], v[172:175]
    buffer_load_dwordx4 v10, s[48:51], m0 offen offset:1024 lds
    s_waitcnt lgkmcnt(4)
    v_mfma_f32_16x16x32_bf16 v[176:179], v[228:231], v[96:99], v[176:179]
    v_mfma_f32_16x16x32_bf16 v[180:183], v[228:231], v[100:103], v[180:183]
    s_waitcnt lgkmcnt(3)
    v_mfma_f32_16x16x32_bf16 v[168:171], v[32:35], v[104:107], v[168:171]
    v_mfma_f32_16x16x32_bf16 v[172:175], v[32:35], v[108:111], v[172:175]
    s_waitcnt lgkmcnt(2)
    v_mfma_f32_16x16x32_bf16 v[176:179], v[36:39], v[104:107], v[176:179]
    s_mov_b32 s65, 337920
    buffer_store_dwordx4 a[0:3], v11, s[8:11], s65 offen sc1
    v_mfma_f32_16x16x32_bf16 v[180:183], v[36:39], v[108:111], v[180:183]
    s_waitcnt lgkmcnt(1)
    v_mfma_f32_16x16x32_bf16 v[168:171], v[248:251], v[112:115], v[168:171]
    v_mfma_f32_16x16x32_bf16 v[172:175], v[248:251], v[116:119], v[172:175]
    s_waitcnt lgkmcnt(0)
    v_mfma_f32_16x16x32_bf16 v[176:179], v[252:255], v[112:115], v[176:179]
    v_mfma_f32_16x16x32_bf16 v[180:183], v[252:255], v[116:119], v[180:183]
    v_pk_mul_f32 v[200:201], v[152:153], v[136:137]
    v_pk_mul_f32 v[202:203], v[156:157], v[136:137]
    v_pk_mul_f32 v[204:205], v[154:155], v[138:139]
    v_pk_mul_f32 v[206:207], v[158:159], v[138:139]
    v_pk_fma_f32 v[200:201], v[156:157], v[140:141], v[200:201]
    v_pk_fma_f32 v[202:203], v[152:153], v[140:141], v[202:203] neg_lo:[1,0,0] neg_hi:[1,0,0]
    v_pk_fma_f32 v[204:205], v[158:159], v[142:143], v[204:205]
    v_pk_fma_f32 v[206:207], v[154:155], v[142:143], v[206:207] neg_lo:[1,0,0] neg_hi:[1,0,0]
    v_cvt_pk_bf16_f32 v184, v200, v202
    v_cvt_pk_bf16_f32 v185, v201, v203
    v_cvt_pk_bf16_f32 v186, v204, v206
    v_cvt_pk_bf16_f32 v187, v205, v207
    v_pk_mul_f32 v[208:209], v[160:161], v[144:145]
    v_pk_mul_f32 v[210:211], v[164:165], v[144:145]
    v_pk_mul_f32 v[212:213], v[162:163], v[146:147]
    v_pk_mul_f32 v[214:215], v[166:167], v[146:147]
    v_pk_fma_f32 v[208:209], v[164:165], v[148:149], v[208:209]
    v_pk_fma_f32 v[210:211], v[160:161], v[148:149], v[210:211] neg_lo:[1,0,0] neg_hi:[1,0,0]
    v_pk_fma_f32 v[212:213], v[166:167], v[150:151], v[212:213]
    v_pk_fma_f32 v[214:215], v[162:163], v[150:151], v[214:215] neg_lo:[1,0,0] neg_hi:[1,0,0]
    v_cvt_pk_bf16_f32 v188, v208, v210
    v_cvt_pk_bf16_f32 v189, v209, v211
    v_cvt_pk_bf16_f32 v190, v212, v214
    v_cvt_pk_bf16_f32 v191, v213, v215
    v_pk_mul_f32 v[216:217], v[168:169], v[136:137]
    v_pk_mul_f32 v[218:219], v[172:173], v[136:137]
    v_pk_mul_f32 v[220:221], v[170:171], v[138:139]
    v_pk_mul_f32 v[222:223], v[174:175], v[138:139]
    v_pk_fma_f32 v[216:217], v[172:173], v[140:141], v[216:217]
    v_pk_fma_f32 v[218:219], v[168:169], v[140:141], v[218:219] neg_lo:[1,0,0] neg_hi:[1,0,0]
    v_pk_fma_f32 v[220:221], v[174:175], v[142:143], v[220:221]
    v_pk_fma_f32 v[222:223], v[170:171], v[142:143], v[222:223] neg_lo:[1,0,0] neg_hi:[1,0,0]
    v_cvt_pk_bf16_f32 v192, v216, v218
    v_cvt_pk_bf16_f32 v193, v217, v219
    v_cvt_pk_bf16_f32 v194, v220, v222
    v_cvt_pk_bf16_f32 v195, v221, v223
    v_pk_mul_f32 v[224:225], v[176:177], v[144:145]
    v_pk_mul_f32 v[226:227], v[180:181], v[144:145]
    v_pk_mul_f32 v[228:229], v[178:179], v[146:147]
    v_pk_mul_f32 v[230:231], v[182:183], v[146:147]
    v_pk_fma_f32 v[224:225], v[180:181], v[148:149], v[224:225]
    v_pk_fma_f32 v[226:227], v[176:177], v[148:149], v[226:227] neg_lo:[1,0,0] neg_hi:[1,0,0]
    v_pk_fma_f32 v[228:229], v[182:183], v[150:151], v[228:229]
    v_pk_fma_f32 v[230:231], v[178:179], v[150:151], v[230:231] neg_lo:[1,0,0] neg_hi:[1,0,0]
    v_cvt_pk_bf16_f32 v196, v224, v226
    v_cvt_pk_bf16_f32 v197, v225, v227
    v_cvt_pk_bf16_f32 v198, v228, v230
    v_cvt_pk_bf16_f32 v199, v229, v231
    s_mul_i32 s64, s56, 27
    v_min_u32 v14, 27, v3
    v_add_u32 v14, s64, v14
    v_sub_u32 v14, 252, v14
    v_lshlrev_b32 v14, 7, v14
    s_mov_b32 s64, 262144
    buffer_load_dword v14, v14, s[12:15], s64 offen sc1
    buffer_load_dwordx4 v10, s[48:51], m0 offen offset:2048 lds
    buffer_load_dwordx4 v10, s[48:51], m0 offen offset:3072 lds
    s_add_u32 m0, m0, 4096
    s_nop 0
    buffer_load_dwordx4 v10, s[48:51], m0 offen offset:0 lds
    buffer_load_dwordx4 v10, s[48:51], m0 offen offset:1024 lds
    s_mov_b32 s65, 405504
    buffer_store_dwordx4 a[0:3], v12, s[8:11], s65 offen sc1
    buffer_load_dwordx4 v10, s[48:51], m0 offen offset:2048 lds
    v_mfma_f32_16x16x32_bf16 v[152:155], v[56:59], v[184:187], 0
    v_mfma_f32_16x16x32_bf16 v[156:159], v[60:63], v[184:187], 0
    v_mfma_f32_16x16x32_bf16 v[152:155], v[64:67], v[188:191], v[152:155]
    v_mfma_f32_16x16x32_bf16 v[156:159], v[68:71], v[188:191], v[156:159]
    v_mfma_f32_16x16x32_bf16 v[168:171], v[56:59], v[192:195], 0
    v_mfma_f32_16x16x32_bf16 v[172:175], v[60:63], v[192:195], 0
    v_mfma_f32_16x16x32_bf16 v[168:171], v[64:67], v[196:199], v[168:171]
    v_mfma_f32_16x16x32_bf16 v[172:175], v[68:71], v[196:199], v[172:175]
    v_mfma_f32_16x16x32_bf16 v[160:163], v[72:75], v[184:187], 0
    v_mfma_f32_16x16x32_bf16 v[164:167], v[76:79], v[184:187], 0
    v_mfma_f32_16x16x32_bf16 v[160:163], v[80:83], v[188:191], v[160:163]
    v_fma_f32 v232, v152, s59, v232
    v_fma_f32 v233, v156, s69, v233
    v_mfma_f32_16x16x32_bf16 v[164:167], v[84:87], v[188:191], v[164:167]
    v_fma_f32 v234, v153, s59, v234
    v_fma_f32 v235, v157, s69, v235
    v_mfma_f32_16x16x32_bf16 v[176:179], v[72:75], v[192:195], 0
    v_fma_f32 v120, v168, s59, v120
    v_fma_f32 v121, v172, s66, v121
    v_mfma_f32_16x16x32_bf16 v[180:183], v[76:79], v[192:195], 0
    v_fma_f32 v122, v169, s59, v122
    v_fma_f32 v123, v173, s66, v123
    v_mfma_f32_16x16x32_bf16 v[176:179], v[80:83], v[196:199], v[176:179]
    v_cvt_pk_bf16_f32 v16, v232, v233
    v_cvt_pk_bf16_f32 v18, v234, v235
    v_mfma_f32_16x16x32_bf16 v[180:183], v[84:87], v[196:199], v[180:183]
    v_cvt_pk_bf16_f32 v17, v120, v121
    v_cvt_pk_bf16_f32 v19, v122, v123
    v_add_u32 v16, s60, v16
    v_add_u32 v17, s60, v17
    v_add_u32 v18, s60, v18
    v_add_u32 v19, s60, v19
    buffer_store_dwordx4 v[16:19], v4, s[32:35], s63 offen offset:0 sc1
    v_fma_f32 v236, v154, s59, v236
    v_fma_f32 v237, v158, s69, v237
    v_fma_f32 v238, v155, s59, v238
    v_fma_f32 v239, v159, s69, v239
    v_fma_f32 v124, v170, s59, v124
    v_fma_f32 v125, v174, s66, v125
    v_fma_f32 v126, v171, s59, v126
    v_fma_f32 v127, v175, s66, v127
    v_cvt_pk_bf16_f32 v20, v236, v237
    v_cvt_pk_bf16_f32 v22, v238, v239
    v_cvt_pk_bf16_f32 v21, v124, v125
    v_cvt_pk_bf16_f32 v23, v126, v127
    v_add_u32 v20, s60, v20
    v_add_u32 v21, s60, v21
    v_add_u32 v22, s60, v22
    v_add_u32 v23, s60, v23
    buffer_store_dwordx4 v[20:23], v4, s[32:35], s63 offen offset:1024 sc1
    v_fma_f32 v240, v160, s59, v240
    v_fma_f32 v241, v164, s69, v241
    v_fma_f32 v242, v161, s59, v242
    v_fma_f32 v243, v165, s69, v243
    v_fma_f32 v128, v176, s59, v128
    v_fma_f32 v129, v180, s66, v129
    v_fma_f32 v130, v177, s59, v130
    v_fma_f32 v131, v181, s66, v131
    v_cvt_pk_bf16_f32 v24, v240, v241
    v_cvt_pk_bf16_f32 v26, v242, v243
    v_cvt_pk_bf16_f32 v25, v128, v129
    v_cvt_pk_bf16_f32 v27, v130, v131
    v_add_u32 v24, s60, v24
    v_add_u32 v25, s60, v25
    v_add_u32 v26, s60, v26
    v_add_u32 v27, s60, v27
    buffer_store_dwordx4 v[24:27], v4, s[32:35], s63 offen offset:2048 sc1
    v_fma_f32 v244, v162, s59, v244
    v_fma_f32 v245, v166, s69, v245
    v_fma_f32 v246, v163, s59, v246
    v_fma_f32 v247, v167, s69, v247
    v_fma_f32 v132, v178, s59, v132
    v_fma_f32 v133, v182, s66, v133
    v_fma_f32 v134, v179, s59, v134
    v_fma_f32 v135, v183, s66, v135
    v_cvt_pk_bf16_f32 v28, v244, v245
    v_cvt_pk_bf16_f32 v30, v246, v247
    v_cvt_pk_bf16_f32 v29, v132, v133
    v_cvt_pk_bf16_f32 v31, v134, v135
    v_add_u32 v28, s60, v28
    v_add_u32 v29, s60, v29
    v_add_u32 v30, s60, v30
    v_add_u32 v31, s60, v31
    buffer_store_dwordx4 v[28:31], v4, s[32:35], s63 offen offset:3072 sc1
    s_waitcnt vmcnt(10)
    v_cmp_eq_u32 vcc, 0, v14
    s_nop 3
    s_cbranch_vccnz c1_w2
c1_w2ok:
    s_mov_b32 s64, 0
    buffer_load_dwordx4 a[32:35], v15, s[52:55], s64 offen offset:0
    buffer_load_dwordx4 a[36:39], v15, s[52:55], s64 offen offset:256
    buffer_load_dwordx4 a[40:43], v15, s[52:55], s64 offen offset:512
    buffer_load_dwordx4 a[44:47], v15, s[52:55], s64 offen offset:768
    buffer_load_dwordx4 a[48:51], v15, s[52:55], s64 offen offset:1024
    s_mov_b32 s64, 286720
    buffer_load_dwordx4 a[52:55], v15, s[52:55], s64 offen offset:0
    buffer_load_dwordx4 a[56:59], v15, s[52:55], s64 offen offset:256
    buffer_load_dwordx4 a[60:63], v15, s[52:55], s64 offen offset:512
    buffer_load_dwordx4 a[64:67], v15, s[52:55], s64 offen offset:768
    buffer_load_dwordx4 a[68:71], v15, s[52:55], s64 offen offset:1024
    s_mov_b32 s64, 20480
    buffer_load_dwordx4 a[72:75], v15, s[52:55], s64 offen offset:0
    buffer_load_dwordx4 a[76:79], v15, s[52:55], s64 offen offset:256
    buffer_load_dwordx4 a[80:83], v15, s[52:55], s64 offen offset:512
    buffer_load_dwordx4 a[84:87], v15, s[52:55], s64 offen offset:768
    buffer_load_dwordx4 a[88:91], v15, s[52:55], s64 offen offset:1024
    s_mov_b32 s64, 307200
    buffer_load_dwordx4 a[92:95], v15, s[52:55], s64 offen offset:0
    buffer_load_dwordx4 a[96:99], v15, s[52:55], s64 offen offset:256
    buffer_load_dwordx4 a[100:103], v15, s[52:55], s64 offen offset:512
    buffer_load_dwordx4 a[104:107], v15, s[52:55], s64 offen offset:768
    buffer_load_dwordx4 a[108:111], v15, s[52:55], s64 offen offset:1024
    s_mov_b32 s64, 40960
    buffer_load_dwordx4 a[112:115], v15, s[52:55], s64 offen offset:0
    buffer_load_dwordx4 a[116:119], v15, s[52:55], s64 offen offset:256
    buffer_load_dwordx4 a[120:123], v15, s[52:55], s64 offen offset:512
    buffer_load_dwordx4 a[124:127], v15, s[52:55], s64 offen offset:768
    buffer_load_dwordx4 a[128:131], v15, s[52:55], s64 offen offset:1024
    s_mov_b32 s64, 327680
    buffer_load_dwordx4 a[132:135], v15, s[52:55], s64 offen offset:0
    buffer_load_dwordx4 a[136:139], v15, s[52:55], s64 offen offset:256
    buffer_load_dwordx4 a[140:143], v15, s[52:55], s64 offen offset:512
    buffer_load_dwordx4 a[144:147], v15, s[52:55], s64 offen offset:768
    buffer_load_dwordx4 a[148:151], v15, s[52:55], s64 offen offset:1024
    s_mov_b32 s64, 61440
    buffer_load_dwordx4 a[152:155], v15, s[52:55], s64 offen offset:0
    buffer_load_dwordx4 a[156:159], v15, s[52:55], s64 offen offset:256
    buffer_load_dwordx4 a[160:163], v15, s[52:55], s64 offen offset:512
    buffer_load_dwordx4 a[164:167], v15, s[52:55], s64 offen offset:768
    buffer_load_dwordx4 a[168:171], v15, s[52:55], s64 offen offset:1024
    s_mov_b32 s64, 348160
    buffer_load_dwordx4 a[172:175], v15, s[52:55], s64 offen offset:0
    buffer_load_dwordx4 a[176:179], v15, s[52:55], s64 offen offset:256
    buffer_load_dwordx4 a[180:183], v15, s[52:55], s64 offen offset:512
    buffer_load_dwordx4 a[184:187], v15, s[52:55], s64 offen offset:768
    buffer_load_dwordx4 a[188:191], v15, s[52:55], s64 offen offset:1024
join0:
    s_lshl_b32 s60, s96, 10
    s_lshl_b32 s58, s56, 8
    s_add_u32 s60, s60, s58
    v_mul_u32_u24 v4, 33280, v2
    v_lshl_add_u32 v4, v1, 4, v4
    v_add_u32 v4, s60, v4
    v_add_u32 v8, 16640, v4
    v_lshlrev_b32 v5, 4, v3
    v_add_u32 v6, 0x10000, v5
    v_add_u32 v7, 0x20000, v5
    s_mov_b64 s[44:45], s[8:9]
    s_mov_b32 s46, 7299072
    s_mov_b32 s47, 0x20000
    v_cmp_eq_u32 vcc, 0, v2
    v_mov_b32 v249, 0xffff0000
    s_nop 0
    v_cndmask_b32 v249, 0, v249, vcc
    s_mov_b32 s4, 0x100001
    s_mov_b32 s5, 0x10000100
    s_mov_b32 s6, 0x200002
    s_mov_b32 s7, 0x20000200
    s_mov_b32 s30, 0x400004
    s_mov_b32 s31, 0x40000400
    s_mov_b32 s70, 0x800008
    s_mov_b32 s71, 0x80000800
    s_bfe_u32 s58, s97, 0x10002
    s_lshl_b32 s58, s58, 6
    s_add_u32 s27, s98, s58
    s_lshl4_add_u32 s61, s56, s27
    s_mul_i32 s58, s56, 1824768
    s_add_u32 s10, s58, 1824768
    s_lshl4_add_u32 s58, s61, s58
    v_lshrrev_b32 v13, 1, v2
    v_and_b32 v9, 1, v2
    v_mad_u32_u24 v13, v13, 14, v9
    v_mul_u32_u24 v13, 33792, v13
    v_lshl_add_u32 v13, v1, 4, v13
    v_add_u32 v13, s58, v13
    v_xor_b32 v10, 0x300, v13
    s_mov_b32 s66, 0xab800000
    s_mov_b32 s67, 0xab800000
    s_mov_b32 s68, 0x1b000000
    s_mov_b32 s69, 0xffff0000
    s_add_u32 s36, s28, 12271616
    s_addc_u32 s37, s29, 0
    s_and_b32 s37, s37, 0xffff
    s_mov_b32 s38, 16384
    s_mov_b32 s39, 0x20000
    s_add_u32 s48, s28, 4657152
    s_addc_u32 s49, s29, 0
    s_and_b32 s49, s49, 0xffff
    s_mov_b32 s50, 9216
    s_mov_b32 s51, 0x20000
    s_sub_u32 s58, 252, s3
    s_cmp_gt_u32 s58, 108
    s_cselect_b32 s50, 0, s50
    s_cselect_b32 s58, 0, s58
    s_lshr_b32 s59, s56, 1
    s_lshl1_add_u32 s58, s58, s59
    s_mul_i32 s58, s58, 10240
    s_and_b32 s59, s56, 1
    s_lshl_b32 s59, s59, 10
    s_add_u32 s58, s58, s59
    s_add_u32 s48, s48, s58
    s_addc_u32 s49, s49, 0
    s_lshl4_add_u32 s58, s96, s97
    s_lshl_b32 s58, s58, 7
    s_add_u32 s58, s58, 131072
    v_lshl_add_u32 v248, v0, 20, s58
    s_lshl2_add_u32 s58, s96, s56
    s_lshl_b32 s58, s58, 9
    v_and_b32 v14, 3, v1
    v_lshl_add_u32 v14, v14, 7, s58
    s_waitcnt vmcnt(40)
    s_mov_b32 s65, 2529280
    buffer_load_dwordx4 v[16:19], v4, s[32:35], s65 offen sc1
    buffer_load_dwordx4 v[20:23], v8, s[32:35], s65 offen sc1
    s_mov_b32 s65, 2396160
    buffer_load_dwordx4 v[24:27], v4, s[32:35], s65 offen sc1
    buffer_load_dwordx4 v[28:31], v8, s[32:35], s65 offen sc1
    s_mov_b32 s65, 2263040
    buffer_load_dwordx4 v[32:35], v4, s[32:35], s65 offen sc1
    buffer_load_dwordx4 v[36:39], v8, s[32:35], s65 offen sc1
    s_mov_b32 s65, 2129920
    buffer_load_dwordx4 v[40:43], v4, s[32:35], s65 offen sc1
    buffer_load_dwordx4 v[44:47], v8, s[32:35], s65 offen sc1
    s_mov_b32 s65, 1996800
    buffer_load_dwordx4 v[48:51], v4, s[32:35], s65 offen sc1
    buffer_load_dwordx4 v[52:55], v8, s[32:35], s65 offen sc1
    s_barrier
    ds_read_b128 a[0:3], v5 offset:39936
    ds_read_b128 a[4:7], v5 offset:60416
    ds_read_b128 a[8:11], v6 offset:15360
    ds_read_b128 a[12:15], v6 offset:35840
    ds_read_b128 a[16:19], v5 offset:38912
    ds_read_b128 a[20:23], v5 offset:59392
    ds_read_b128 a[24:27], v6 offset:14336
    ds_read_b128 a[28:31], v6 offset:34816
    s_waitcnt vmcnt(8)
    v_min_f32_e64 v9, |v16|, |v20|
    v_cmp_gt_f32 vcc, 0x24800000, v9
    s_cbranch_vccnz m1_x0_again
m1_x0_ok:
    v_swap_b32 v18, v20
    v_swap_b32 v19, v21
    s_nop 1
    v_mfma_f32_16x16x32_bf16 v[232:235], v[16:19], v[16:19], 0
    buffer_store_dword v6, v248, s[12:15], 0 offen sc1
    v_mfma_f32_16x16x32_bf16 v[236:239], v[20:23], v[20:23], 0
    s_waitcnt lgkmcnt(4)
    s_mov_b32 s65, 1863680
    v_mfma_f32_16x16x32_bf16 v[176:179], a[0:3], v[16:19], 0
    buffer_load_dwordx4 v[56:59], v4, s[32:35], s65 offen sc1
    v_mfma_f32_16x16x32_bf16 v[180:183], a[0:3], v[20:23], 0
    s_waitcnt vmcnt(8)
    v_min_f32_e64 v9, |v24|, |v28|
    v_mfma_f32_16x16x32_bf16 v[184:187], a[4:7], v[16:19], 0
    ds_read_b128 a[0:3], v5 offset:37888
    v_cmp_gt_f32 vcc, 0x24800000, v9
    v_mfma_f32_16x16x32_bf16 v[188:191], a[4:7], v[20:23], 0
    ds_read_b128 a[4:7], v5 offset:58368
    buffer_load_dwordx4 v[60:63], v8, s[32:35], s65 offen sc1
    v_mfma_f32_16x16x32_bf16 v[192:195], a[8:11], v[16:19], 0
    s_cbranch_vccnz m1_x1_again
m1_x1_ok:
    v_mfma_f32_16x16x32_bf16 v[196:199], a[8:11], v[20:23], 0
    v_swap_b32 v26, v28
    v_mfma_f32_16x16x32_bf16 v[200:203], a[12:15], v[16:19], 0
    v_swap_b32 v27, v29
    v_mfma_f32_16x16x32_bf16 v[204:207], a[12:15], v[20:23], 0
    ds_read_b128 a[8:11], v6 offset:13312
    ds_read_b128 a[12:15], v6 offset:33792
    v_mfma_f32_16x16x32_bf16 v[232:235], v[24:27], v[24:27], v[232:235]
    s_mov_b32 s65, 1730560
    buffer_load_dwordx4 v[64:67], v4, s[32:35], s65 offen sc1
    v_mfma_f32_16x16x32_bf16 v[236:239], v[28:31], v[28:31], v[236:239]
    buffer_load_dwordx4 v[68:71], v8, s[32:35], s65 offen sc1
    s_waitcnt lgkmcnt(4)
    v_mfma_f32_16x16x32_bf16 v[176:179], a[16:19], v[24:27], v[176:179]
    s_mov_b32 s65, 1597440
    buffer_load_dwordx4 v[72:75], v4, s[32:35], s65 offen sc1
    v_mfma_f32_16x16x32_bf16 v[180:183], a[16:19], v[28:31], v[180:183]
    s_waitcnt vmcnt(10)
    v_min_f32_e64 v9, |v32|, |v36|
    v_mfma_f32_16x16x32_bf16 v[184:187], a[20:23], v[24:27], v[184:187]
    ds_read_b128 a[16:19], v5 offset:36864
    v_cmp_gt_f32 vcc, 0x24800000, v9
    v_mfma_f32_16x16x32_bf16 v[188:191], a[20:23], v[28:31], v[188:191]
    ds_read_b128 a[20:23], v5 offset:57344
    buffer_load_dwordx4 v[76:79], v8, s[32:35], s65 offen sc1
    v_mfma_f32_16x16x32_bf16 v[192:195], a[24:27], v[24:27], v[192:195]
    s_cbranch_vccnz m1_x2_again
m1_x2_ok:
    v_mfma_f32_16x16x32_bf16 v[196:199], a[24:27], v[28:31], v[196:199]
    v_swap_b32 v34, v36
    v_mfma_f32_16x16x32_bf16 v[200:203], a[28:31], v[24:27], v[200:203]
    v_swap_b32 v35, v37
    v_mfma_f32_16x16x32_bf16 v[204:207], a[28:31], v[28:31], v[204:207]
    ds_read_b128 a[24:27], v6 offset:12288
    ds_read_b128 a[28:31], v6 offset:32768
    v_mfma_f32_16x16x32_bf16 v[232:235], v[32:35], v[32:35], v[232:235]
    s_mov_b32 s65, 1464320
    buffer_load_dwordx4 v[80:83], v4, s[32:35], s65 offen sc1
    v_mfma_f32_16x16x32_bf16 v[236:239], v[36:39], v[36:39], v[236:239]
    buffer_load_dwordx4 v[84:87], v8, s[32:35], s65 offen sc1
    s_waitcnt lgkmcnt(4)
    v_mfma_f32_16x16x32_bf16 v[176:179], a[0:3], v[32:35], v[176:179]
    s_mov_b32 s65, 1331200
    buffer_load_dwordx4 v[88:91], v4, s[32:35], s65 offen sc1
    v_mfma_f32_16x16x32_bf16 v[180:183], a[0:3], v[36:39], v[180:183]
    s_waitcnt vmcnt(12)
    v_min_f32_e64 v9, |v40|, |v44|
    v_mfma_f32_16x16x32_bf16 v[184:187], a[4:7], v[32:35], v[184:187]
    ds_read_b128 a[0:3], v5 offset:35840
    v_cmp_gt_f32 vcc, 0x24800000, v9
    v_mfma_f32_16x16x32_bf16 v[188:191], a[4:7], v[36:39], v[188:191]
    ds_read_b128 a[4:7], v5 offset:56320
    buffer_load_dwordx4 v[92:95], v8, s[32:35], s65 offen sc1
    v_mfma_f32_16x16x32_bf16 v[192:195], a[8:11], v[32:35], v[192:195]
    s_cbranch_vccnz m1_x3_again
m1_x3_ok:
    v_mfma_f32_16x16x32_bf16 v[196:199], a[8:11], v[36:39], v[196:199]
    v_swap_b32 v42, v44
    v_mfma_f32_16x16x32_bf16 v[200:203], a[12:15], v[32:35], v[200:203]
    v_swap_b32 v43, v45
    v_mfma_f32_16x16x32_bf16 v[204:207], a[12:15], v[36:39], v[204:207]
    ds_read_b128 a[8:11], v6 offset:11264
    ds_read_b128 a[12:15], v6 offset:31744
    v_mfma_f32_16x16x32_bf16 v[232:235], v[40:43], v[40:43], v[232:235]
    s_mov_b32 s65, 1198080
    buffer_load_dwordx4 v[96:99], v4, s[32:35], s65 offen sc1
    v_mfma_f32_16x16x32_bf16 v[236:239], v[44:47], v[44:47], v[236:239]
    s_waitcnt lgkmcnt(4)
    v_mfma_f32_16x16x32_bf16 v[176:179], a[16:19], v[40:43], v[176:179]
    v_mfma_f32_16x16x32_bf16 v[180:183], a[16:19], v[44:47], v[180:183]
    s_waitcnt vmcnt(12)
    v_min_f32_e64 v9, |v48|, |v52|
    v_mfma_f32_16x16x32_bf16 v[184:187], a[20:23], v[40:43], v[184:187]
    ds_read_b128 a[16:19], v5 offset:34816
    v_cmp_gt_f32 vcc, 0x24800000, v9
    v_mfma_f32_16x16x32_bf16 v[188:191], a[20:23], v[44:47], v[188:191]
    ds_read_b128 a[20:23], v5 offset:55296
    v_mfma_f32_16x16x32_bf16 v[192:195], a[24:27], v[40:43], v[192:195]
    s_cbranch_vccnz m1_x4_again
m1_x4_ok:
    v_mfma_f32_16x16x32_bf16 v[196:199], a[24:27], v[44:47], v[196:199]
    v_swap_b32 v50, v52
    v_mfma_f32_16x16x32_bf16 v[200:203], a[28:31], v[40:43], v[200:203]
    v_swap_b32 v51, v53
    v_mfma_f32_16x16x32_bf16 v[204:207], a[28:31], v[44:47], v[204:207]
    ds_read_b128 a[24:27], v6 offset:10240
    ds_read_b128 a[28:31], v6 offset:30720
    v_mfma_f32_16x16x32_bf16 v[232:235], v[48:51], v[48:51], v[232:235]
    v_mfma_f32_16x16x32_bf16 v[236:239], v[52:55], v[52:55], v[236:239]
    s_waitcnt lgkmcnt(4)
    v_mfma_f32_16x16x32_bf16 v[176:179], a[0:3], v[48:51], v[176:179]
    v_mfma_f32_16x16x32_bf16 v[180:183], a[0:3], v[52:55], v[180:183]
    s_waitcnt vmcnt(9)
    v_min_f32_e64 v9, |v56|, |v60|
    v_mfma_f32_16x16x32_bf16 v[184:187], a[4:7], v[48:51], v[184:187]
    ds_read_b128 a[0:3], v5 offset:33792
    v_cmp_gt_f32 vcc, 0x24800000, v9
    v_mfma_f32_16x16x32_bf16 v[188:191], a[4:7], v[52:55], v[188:191]
    ds_read_b128 a[4:7], v5 offset:54272
    buffer_load_dwordx4 v[100:103], v8, s[32:35], s65 offen sc1
    v_mfma_f32_16x16x32_bf16 v[192:195], a[8:11], v[48:51], v[192:195]
    s_cbranch_vccnz m1_x5_again
m1_x5_ok:
    v_mfma_f32_16x16x32_bf16 v[196:199], a[8:11], v[52:55], v[196:199]
    v_swap_b32 v58, v60
    v_mfma_f32_16x16x32_bf16 v[200:203], a[12:15], v[48:51], v[200:203]
    v_swap_b32 v59, v61
    v_mfma_f32_16x16x32_bf16 v[204:207], a[12:15], v[52:55], v[204:207]
    ds_read_b128 a[8:11], v6 offset:9216
    ds_read_b128 a[12:15], v6 offset:29696
    v_mfma_f32_16x16x32_bf16 v[232:235], v[56:59], v[56:59], v[232:235]
    s_mov_b32 s65, 1064960
    buffer_load_dwordx4 v[104:107], v4, s[32:35], s65 offen sc1
    v_mfma_f32_16x16x32_bf16 v[236:239], v[60:63], v[60:63], v[236:239]
    buffer_load_dwordx4 v[108:111], v8, s[32:35], s65 offen sc1
    s_waitcnt lgkmcnt(4)
    v_mfma_f32_16x16x32_bf16 v[176:179], a[16:19], v[56:59], v[176:179]
    s_mov_b32 s65, 931840
    buffer_load_dwordx4 v[112:115], v4, s[32:35], s65 offen sc1
    v_mfma_f32_16x16x32_bf16 v[180:183], a[16:19], v[60:63], v[180:183]
    s_waitcnt vmcnt(11)
    v_min_f32_e64 v9, |v64|, |v68|
    v_mfma_f32_16x16x32_bf16 v[184:187], a[20:23], v[56:59], v[184:187]
    ds_read_b128 a[16:19], v5 offset:32768
    v_cmp_gt_f32 vcc, 0x24800000, v9
    v_mfma_f32_16x16x32_bf16 v[188:191], a[20:23], v[60:63], v[188:191]
    ds_read_b128 a[20:23], v5 offset:53248
    buffer_load_dwordx4 v[116:119], v8, s[32:35], s65 offen sc1
    v_mfma_f32_16x16x32_bf16 v[192:195], a[24:27], v[56:59], v[192:195]
    s_cbranch_vccnz m1_x6_again
m1_x6_ok:
    v_mfma_f32_16x16x32_bf16 v[196:199], a[24:27], v[60:63], v[196:199]
    v_swap_b32 v66, v68
    v_mfma_f32_16x16x32_bf16 v[200:203], a[28:31], v[56:59], v[200:203]
    v_swap_b32 v67, v69
    v_mfma_f32_16x16x32_bf16 v[204:207], a[28:31], v[60:63], v[204:207]
    ds_read_b128 a[24:27], v6 offset:8192
    ds_read_b128 a[28:31], v6 offset:28672
    v_mfma_f32_16x16x32_bf16 v[232:235], v[64:67], v[64:67], v[232:235]
    s_mov_b32 s65, 0
    buffer_load_dwordx4 v[168:171], v4, s[32:35], s65 offen sc1
    v_mfma_f32_16x16x32_bf16 v[236:239], v[68:71], v[68:71], v[236:239]
    buffer_load_dwordx4 v[172:175], v8, s[32:35], s65 offen sc1
    s_waitcnt lgkmcnt(4)
    v_mfma_f32_16x16x32_bf16 v[176:179], a[0:3], v[64:67], v[176:179]
    v_mfma_f32_16x16x32_bf16 v[180:183], a[0:3], v[68:71], v[180:183]
    s_waitcnt vmcnt(12)
    v_min_f32_e64 v9, |v72|, |v76|
    v_mfma_f32_16x16x32_bf16 v[184:187], a[4:7], v[64:67], v[184:187]
    ds_read_b128 a[0:3], v5 offset:31744
    v_cmp_gt_f32 vcc, 0x24800000, v9
    v_mfma_f32_16x16x32_bf16 v[188:191], a[4:7], v[68:71], v[188:191]
    ds_read_b128 a[4:7], v5 offset:52224
    s_mov_b32 s65, 798720
    v_mfma_f32_16x16x32_bf16 v[192:195], a[8:11], v[64:67], v[192:195]
    s_cbranch_vccnz m1_x7_again
m1_x7_ok:
    v_mfma_f32_16x16x32_bf16 v[196:199], a[8:11], v[68:71], v[196:199]
    v_swap_b32 v74, v76
    v_mfma_f32_16x16x32_bf16 v[200:203], a[12:15], v[64:67], v[200:203]
    v_swap_b32 v75, v77
    v_mfma_f32_16x16x32_bf16 v[204:207], a[12:15], v[68:71], v[204:207]
    ds_read_b128 a[8:11], v6 offset:7168
    ds_read_b128 a[12:15], v6 offset:27648
    v_mfma_f32_16x16x32_bf16 v[232:235], v[72:75], v[72:75], v[232:235]
    buffer_load_dwordx4 v[120:123], v4, s[32:35], s65 offen sc1
    v_mfma_f32_16x16x32_bf16 v[236:239], v[76:79], v[76:79], v[236:239]
    buffer_load_dwordx4 v[124:127], v8, s[32:35], s65 offen sc1
    s_waitcnt lgkmcnt(4)
    v_mfma_f32_16x16x32_bf16 v[176:179], a[16:19], v[72:75], v[176:179]
    v_mfma_f32_16x16x32_bf16 v[180:183], a[16:19], v[76:79], v[180:183]
    s_waitcnt vmcnt(12)
    v_min_f32_e64 v9, |v80|, |v84|
    v_mfma_f32_16x16x32_bf16 v[184:187], a[20:23], v[72:75], v[184:187]
    ds_read_b128 a[16:19], v5 offset:30720
    v_cmp_gt_f32 vcc, 0x24800000, v9
    v_mfma_f32_16x16x32_bf16 v[188:191], a[20:23], v[76:79], v[188:191]
    ds_read_b128 a[20:23], v5 offset:51200
    s_mov_b32 s65, 665600
    v_mfma_f32_16x16x32_bf16 v[192:195], a[24:27], v[72:75], v[192:195]
    s_cbranch_vccnz m1_x8_again
m1_x8_ok:
    v_mfma_f32_16x16x32_bf16 v[196:199], a[24:27], v[76:79], v[196:199]
    v_swap_b32 v82, v84
    v_mfma_f32_16x16x32_bf16 v[200:203], a[28:31], v[72:75], v[200:203]
    v_swap_b32 v83, v85
    v_mfma_f32_16x16x32_bf16 v[204:207], a[28:31], v[76:79], v[204:207]
    ds_read_b128 a[24:27], v6 offset:6144
    ds_read_b128 a[28:31], v6 offset:26624
    v_mfma_f32_16x16x32_bf16 v[232:235], v[80:83], v[80:83], v[232:235]
    buffer_load_dwordx4 v[128:131], v4, s[32:35], s65 offen sc1
    v_mfma_f32_16x16x32_bf16 v[236:239], v[84:87], v[84:87], v[236:239]
    buffer_load_dwordx4 v[132:135], v8, s[32:35], s65 offen sc1
    s_waitcnt lgkmcnt(4)
    v_mfma_f32_16x16x32_bf16 v[176:179], a[0:3], v[80:83], v[176:179]
    v_mfma_f32_16x16x32_bf16 v[180:183], a[0:3], v[84:87], v[180:183]
    s_waitcnt vmcnt(12)
    v_min_f32_e64 v9, |v88|, |v92|
    v_mfma_f32_16x16x32_bf16 v[184:187], a[4:7], v[80:83], v[184:187]
    ds_read_b128 a[0:3], v5 offset:29696
    v_cmp_gt_f32 vcc, 0x24800000, v9
    v_mfma_f32_16x16x32_bf16 v[188:191], a[4:7], v[84:87], v[188:191]
    ds_read_b128 a[4:7], v5 offset:50176
    s_mov_b32 s65, 532480
    v_mfma_f32_16x16x32_bf16 v[192:195], a[8:11], v[80:83], v[192:195]
    s_cbranch_vccnz m1_x9_again
m1_x9_ok:
    v_mfma_f32_16x16x32_bf16 v[196:199], a[8:11], v[84:87], v[196:199]
    v_swap_b32 v90, v92
    v_mfma_f32_16x16x32_bf16 v[200:203], a[12:15], v[80:83], v[200:203]
    v_swap_b32 v91, v93
    v_mfma_f32_16x16x32_bf16 v[204:207], a[12:15], v[84:87], v[204:207]
    ds_read_b128 a[8:11], v6 offset:5120
    ds_read_b128 a[12:15], v6 offset:25600
    v_mfma_f32_16x16x32_bf16 v[232:235], v[88:91], v[88:91], v[232:235]
    buffer_load_dwordx4 v[136:139], v4, s[32:35], s65 offen sc1
    v_mfma_f32_16x16x32_bf16 v[236:239], v[92:95], v[92:95], v[236:239]
    s_waitcnt lgkmcnt(4)
    v_mfma_f32_16x16x32_bf16 v[176:179], a[16:19], v[88:91], v[176:179]
    buffer_load_dwordx4 v[140:143], v8, s[32:35], s65 offen sc1
    v_mfma_f32_16x16x32_bf16 v[180:183], a[16:19], v[92:95], v[180:183]
    s_waitcnt vmcnt(12)
    v_min_f32_e64 v9, |v96|, |v100|
    v_mfma_f32_16x16x32_bf16 v[184:187], a[20:23], v[88:91], v[184:187]
    ds_read_b128 a[16:19], v5 offset:28672
    v_cmp_gt_f32 vcc, 0x24800000, v9
    v_mfma_f32_16x16x32_bf16 v[188:191], a[20:23], v[92:95], v[188:191]
    ds_read_b128 a[20:23], v5 offset:49152
    v_mfma_f32_16x16x32_bf16 v[192:195], a[24:27], v[88:91], v[192:195]
    s_cbranch_vccnz m1_x10_again
m1_x10_ok:
    v_mfma_f32_16x16x32_bf16 v[196:199], a[24:27], v[92:95], v[196:199]
    v_swap_b32 v98, v100
    v_mfma_f32_16x16x32_bf16 v[200:203], a[28:31], v[88:91], v[200:203]
    v_swap_b32 v99, v101
    v_mfma_f32_16x16x32_bf16 v[204:207], a[28:31], v[92:95], v[204:207]
    ds_read_b128 a[24:27], v6 offset:4096
    ds_read_b128 a[28:31], v6 offset:24576
    v_mfma_f32_16x16x32_bf16 v[232:235], v[96:99], v[96:99], v[232:235]
    s_mov_b32 s65, 399360
    buffer_load_dwordx4 v[144:147], v4, s[32:35], s65 offen sc1
    v_mfma_f32_16x16x32_bf16 v[236:239], v[100:103], v[100:103], v[236:239]
    buffer_load_dwordx4 v[148:151], v8, s[32:35], s65 offen sc1
    s_waitcnt lgkmcnt(4)
    v_mfma_f32_16x16x32_bf16 v[176:179], a[0:3], v[96:99], v[176:179]
    v_mfma_f32_16x16x32_bf16 v[180:183], a[0:3], v[100:103], v[180:183]
    s_waitcnt vmcnt(12)
    v_min_f32_e64 v9, |v104|, |v108|
    v_mfma_f32_16x16x32_bf16 v[184:187], a[4:7], v[96:99], v[184:187]
    ds_read_b128 a[0:3], v5 offset:27648
    v_cmp_gt_f32 vcc, 0x24800000, v9
    v_mfma_f32_16x16x32_bf16 v[188:191], a[4:7], v[100:103], v[188:191]
    ds_read_b128 a[4:7], v5 offset:48128
    v_mfma_f32_16x16x32_bf16 v[192:195], a[8:11], v[96:99], v[192:195]
    s_cbranch_vccnz m1_x11_again
m1_x11_ok:
    v_mfma_f32_16x16x32_bf16 v[196:199], a[8:11], v[100:103], v[196:199]
    v_swap_b32 v106, v108
    v_mfma_f32_16x16x32_bf16 v[200:203], a[12:15], v[96:99], v[200:203]
    v_swap_b32 v107, v109
    v_mfma_f32_16x16x32_bf16 v[204:207], a[12:15], v[100:103], v[204:207]
    ds_read_b128 a[8:11], v6 offset:3072
    ds_read_b128 a[12:15], v6 offset:23552
    v_mfma_f32_16x16x32_bf16 v[232:235], v[104:107], v[104:107], v[232:235]
    s_mov_b32 s65, 266240
    buffer_load_dwordx4 v[152:155], v4, s[32:35], s65 offen sc1
    v_mfma_f32_16x16x32_bf16 v[236:239], v[108:111], v[108:111], v[236:239]
    buffer_load_dwordx4 v[156:159], v8, s[32:35], s65 offen sc1
    s_waitcnt lgkmcnt(4)
    v_mfma_f32_16x16x32_bf16 v[176:179], a[16:19], v[104:107], v[176:179]
    v_mfma_f32_16x16x32_bf16 v[180:183], a[16:19], v[108:111], v[180:183]
    s_waitcnt vmcnt(12)
    v_min_f32_e64 v9, |v112|, |v116|
    v_mfma_f32_16x16x32_bf16 v[184:187], a[20:23], v[104:107], v[184:187]
    ds_read_b128 a[16:19], v5 offset:26624
    v_cmp_gt_f32 vcc, 0x24800000, v9
    v_mfma_f32_16x16x32_bf16 v[188:191], a[20:23], v[108:111], v[188:191]
    ds_read_b128 a[20:23], v5 offset:47104
    s_mov_b32 s65, 133120
    v_mfma_f32_16x16x32_bf16 v[192:195], a[24:27], v[104:107], v[192:195]
    s_cbranch_vccnz m1_x12_again
m1_x12_ok:
    v_mfma_f32_16x16x32_bf16 v[196:199], a[24:27], v[108:111], v[196:199]
    v_swap_b32 v114, v116
    v_mfma_f32_16x16x32_bf16 v[200:203], a[28:31], v[104:107], v[200:203]
    v_swap_b32 v115, v117
    v_mfma_f32_16x16x32_bf16 v[204:207], a[28:31], v[108:111], v[204:207]
    ds_read_b128 a[24:27], v6 offset:2048
    ds_read_b128 a[28:31], v6 offset:22528
    v_mfma_f32_16x16x32_bf16 v[232:235], v[112:115], v[112:115], v[232:235]
    buffer_load_dwordx4 v[160:163], v4, s[32:35], s65 offen sc1
    v_mfma_f32_16x16x32_bf16 v[236:239], v[116:119], v[116:119], v[236:239]
    buffer_load_dwordx4 v[164:167], v8, s[32:35], s65 offen sc1
    s_waitcnt lgkmcnt(4)
    v_mfma_f32_16x16x32_bf16 v[176:179], a[0:3], v[112:115], v[176:179]
    s_waitcnt vmcnt(10)
    v_min3_f32 v9, |v168|, |v172|, |v120|
    v_mfma_f32_16x16x32_bf16 v[180:183], a[0:3], v[116:119], v[180:183]
    v_min_f32_e64 v9, v9, |v124|
    v_cmp_gt_f32 vcc, 0x24800000, v9
    v_mfma_f32_16x16x32_bf16 v[184:187], a[4:7], v[112:115], v[184:187]
    ds_read_b128 a[0:3], v5 offset:25600
    s_mov_b32 s63, 0
    v_mfma_f32_16x16x32_bf16 v[188:191], a[4:7], v[116:119], v[188:191]
    s_cbranch_vccnz m1_x13_again
m1_x13_ok:
    v_mfma_f32_16x16x32_bf16 v[192:195], a[8:11], v[112:115], v[192:195]
    v_swap_b32 v122, v124
    v_mfma_f32_16x16x32_bf16 v[196:199], a[8:11], v[116:119], v[196:199]
    v_swap_b32 v123, v125
    v_mfma_f32_16x16x32_bf16 v[200:203], a[12:15], v[112:115], v[200:203]
    v_swap_b32 v170, v172
    v_mfma_f32_16x16x32_bf16 v[204:207], a[12:15], v[116:119], v[204:207]
    v_swap_b32 v171, v173
    v_mfma_f32_16x16x32_bf16 v[232:235], v[120:123], v[120:123], v[232:235]
    v_bfi_b32 v168, v249, 0, v168
    v_bfi_b32 v172, v249, 0, v172
    v_mfma_f32_16x16x32_bf16 v[236:239], v[124:127], v[124:127], v[236:239]
    ds_read_b128 a[4:7], v5 offset:46080
    ds_read_b128 a[8:11], v6 offset:1024
    v_mfma_f32_16x16x32_bf16 v[232:235], v[168:171], v[168:171], v[232:235]
    ds_read_b128 a[12:15], v6 offset:21504
    buffer_store_dwordx4 a[232:235], v5, s[48:51], s63 offen offset:0 sc1
    v_mfma_f32_16x16x32_bf16 v[236:239], v[172:175], v[172:175], v[236:239]
    buffer_store_dwordx4 a[236:239], v5, s[48:51], s63 offen offset:2048 sc1
    s_waitcnt lgkmcnt(4)
    v_mfma_f32_16x16x32_bf16 v[176:179], a[16:19], v[120:123], v[176:179]
    s_mov_b32 s63, 4096
    buffer_store_dwordx4 a[240:243], v5, s[48:51], s63 offen offset:0 sc1
    v_mfma_f32_16x16x32_bf16 v[180:183], a[16:19], v[124:127], v[180:183]
    s_waitcnt vmcnt(11)
    v_min_f32_e64 v9, |v128|, |v132|
    v_mfma_f32_16x16x32_bf16 v[184:187], a[20:23], v[120:123], v[184:187]
    ds_read_b128 a[16:19], v5 offset:24576
    v_cmp_gt_f32 vcc, 0x24800000, v9
    v_mfma_f32_16x16x32_bf16 v[188:191], a[20:23], v[124:127], v[188:191]
    ds_read_b128 a[20:23], v5 offset:45056
    buffer_store_dwordx4 a[244:247], v5, s[48:51], s63 offen offset:2048 sc1
    v_mfma_f32_16x16x32_bf16 v[192:195], a[24:27], v[120:123], v[192:195]
    s_cbranch_vccnz m1_x14_again
m1_x14_ok:
    v_mfma_f32_16x16x32_bf16 v[196:199], a[24:27], v[124:127], v[196:199]
    v_swap_b32 v130, v132
    v_mfma_f32_16x16x32_bf16 v[200:203], a[28:31], v[120:123], v[200:203]
    v_swap_b32 v131, v133
    v_mfma_f32_16x16x32_bf16 v[204:207], a[28:31], v[124:127], v[204:207]
    ds_read_b128 a[24:27], v6 offset:0
    ds_read_b128 a[28:31], v6 offset:20480
    v_mfma_f32_16x16x32_bf16 v[232:235], v[128:131], v[128:131], v[232:235]
    s_mov_b32 s63, 8192
    buffer_store_dwordx4 a[248:251], v5, s[48:51], s63 offen offset:0 sc1
    v_mfma_f32_16x16x32_bf16 v[236:239], v[132:135], v[132:135], v[236:239]
    s_waitcnt lgkmcnt(4)
    v_mfma_f32_16x16x32_bf16 v[176:179], a[0:3], v[128:131], v[176:179]
    v_mfma_f32_16x16x32_bf16 v[180:183], a[0:3], v[132:135], v[180:183]
    s_waitcnt vmcnt(11)
    v_min_f32_e64 v9, |v136|, |v140|
    v_mfma_f32_16x16x32_bf16 v[184:187], a[4:7], v[128:131], v[184:187]
    ds_read_b128 a[0:3], v5 offset:23552
    v_cmp_gt_f32 vcc, 0x24800000, v9
    v_mfma_f32_16x16x32_bf16 v[188:191], a[4:7], v[132:135], v[188:191]
    ds_read_b128 a[4:7], v5 offset:44032
    v_mfma_f32_16x16x32_bf16 v[192:195], a[8:11], v[128:131], v[192:195]
    s_cbranch_vccnz m1_x15_again
m1_x15_ok:
    v_mfma_f32_16x16x32_bf16 v[196:199], a[8:11], v[132:135], v[196:199]
    v_swap_b32 v138, v140
    v_mfma_f32_16x16x32_bf16 v[200:203], a[12:15], v[128:131], v[200:203]
    v_swap_b32 v139, v141
    v_mfma_f32_16x16x32_bf16 v[204:207], a[12:15], v[132:135], v[204:207]
    ds_read_b128 a[8:11], v5 offset:64512
    ds_read_b128 a[12:15], v6 offset:19456
    v_mfma_f32_16x16x32_bf16 v[232:235], v[136:139], v[136:139], v[232:235]
    v_mfma_f32_16x16x32_bf16 v[236:239], v[140:143], v[140:143], v[236:239]
    s_waitcnt lgkmcnt(4)
    v_mfma_f32_16x16x32_bf16 v[176:179], a[16:19], v[136:139], v[176:179]
    s_waitcnt vmcnt(7)
    v_min3_f32 v9, |v144|, |v148|, |v152|
    v_mfma_f32_16x16x32_bf16 v[180:183], a[16:19], v[140:143], v[180:183]
    v_min_f32_e64 v9, v9, |v156|
    v_cmp_gt_f32 vcc, 0x24800000, v9
    v_mfma_f32_16x16x32_bf16 v[184:187], a[20:23], v[136:139], v[184:187]
    ds_read_b128 a[16:19], v5 offset:22528
    v_mfma_f32_16x16x32_bf16 v[188:191], a[20:23], v[140:143], v[188:191]
    s_cbranch_vccnz m1_x16_again
m1_x16_ok:
    v_mfma_f32_16x16x32_bf16 v[192:195], a[24:27], v[136:139], v[192:195]
    v_swap_b32 v146, v148
    v_mfma_f32_16x16x32_bf16 v[196:199], a[24:27], v[140:143], v[196:199]
    v_swap_b32 v147, v149
    v_mfma_f32_16x16x32_bf16 v[200:203], a[28:31], v[136:139], v[200:203]
    v_swap_b32 v154, v156
    v_mfma_f32_16x16x32_bf16 v[204:207], a[28:31], v[140:143], v[204:207]
    v_swap_b32 v155, v157
    v_mfma_f32_16x16x32_bf16 v[232:235], v[144:147], v[144:147], v[232:235]
    ds_read_b128 a[20:23], v5 offset:43008
    ds_read_b128 a[24:27], v5 offset:63488
    v_mfma_f32_16x16x32_bf16 v[236:239], v[148:151], v[148:151], v[236:239]
    ds_read_b128 a[28:31], v6 offset:18432
    v_mfma_f32_16x16x32_bf16 v[232:235], v[152:155], v[152:155], v[232:235]
    v_mfma_f32_16x16x32_bf16 v[236:239], v[156:159], v[156:159], v[236:239]
    s_waitcnt lgkmcnt(4)
    v_mfma_f32_16x16x32_bf16 v[176:179], a[0:3], v[144:147], v[176:179]
    v_mfma_f32_16x16x32_bf16 v[180:183], a[0:3], v[148:151], v[180:183]
    s_waitcnt vmcnt(5)
    v_min_f32_e64 v9, |v160|, |v164|
    v_mfma_f32_16x16x32_bf16 v[184:187], a[4:7], v[144:147], v[184:187]
    ds_read_b128 a[0:3], v5 offset:21504
    v_cmp_gt_f32 vcc, 0x24800000, v9
    v_mfma_f32_16x16x32_bf16 v[188:191], a[4:7], v[148:151], v[188:191]
    ds_read_b128 a[4:7], v5 offset:41984
    v_mfma_f32_16x16x32_bf16 v[192:195], a[8:11], v[144:147], v[192:195]
    s_cbranch_vccnz m1_x18_again
m1_x18_ok:
    v_mfma_f32_16x16x32_bf16 v[196:199], a[8:11], v[148:151], v[196:199]
    v_swap_b32 v162, v164
    v_mfma_f32_16x16x32_bf16 v[200:203], a[12:15], v[144:147], v[200:203]
    v_swap_b32 v163, v165
    v_mfma_f32_16x16x32_bf16 v[204:207], a[12:15], v[148:151], v[204:207]
    ds_read_b128 a[8:11], v5 offset:62464
    ds_read_b128 a[12:15], v6 offset:17408
    v_mfma_f32_16x16x32_bf16 v[232:235], v[160:163], v[160:163], v[232:235]
    s_mov_b32 s63, 81920
    buffer_load_dwordx4 a[192:195], v15, s[52:55], s63 offen offset:0
    v_mfma_f32_16x16x32_bf16 v[236:239], v[164:167], v[164:167], v[236:239]
    buffer_load_dwordx4 a[196:199], v15, s[52:55], s63 offen offset:256
    s_waitcnt lgkmcnt(4)
    v_mfma_f32_16x16x32_bf16 v[176:179], a[16:19], v[152:155], v[176:179]
    buffer_load_dwordx4 a[200:203], v15, s[52:55], s63 offen offset:512
    v_mov_b32 v244, 0x16dbe6ff
    v_mfma_f32_16x16x32_bf16 v[180:183], a[16:19], v[156:159], v[180:183]
    ds_read_b128 a[16:19], v5 offset:20480
    buffer_load_dwordx4 a[204:207], v15, s[52:55], s63 offen offset:768
    v_mfma_f32_16x16x32_bf16 v[184:187], a[20:23], v[152:155], v[184:187]
    buffer_load_dwordx4 a[208:211], v15, s[52:55], s63 offen offset:1024
    v_xor_b32 v4, 0x100, v13
    v_mfma_f32_16x16x32_bf16 v[188:191], a[20:23], v[156:159], v[188:191]
    ds_read_b128 a[20:23], v5 offset:40960
    s_mov_b32 s63, 368640
    v_mfma_f32_16x16x32_bf16 v[192:195], a[24:27], v[152:155], v[192:195]
    buffer_load_dwordx4 a[212:215], v15, s[52:55], s63 offen offset:0
    v_xor_b32 v8, 0x200, v13
    v_mfma_f32_16x16x32_bf16 v[196:199], a[24:27], v[156:159], v[196:199]
    ds_read_b128 a[24:27], v5 offset:61440
    buffer_load_dwordx4 a[216:219], v15, s[52:55], s63 offen offset:256
    v_mfma_f32_16x16x32_bf16 v[200:203], a[28:31], v[152:155], v[200:203]
    buffer_load_dwordx4 a[220:223], v15, s[52:55], s63 offen offset:512
    v_cndmask_b32_e64 v240, 0, v232, s[4:5]
    v_mfma_f32_16x16x32_bf16 v[204:207], a[28:31], v[156:159], v[204:207]
    ds_read_b128 a[28:31], v6 offset:16384
    s_waitcnt lgkmcnt(4)
    v_mfma_f32_16x16x32_bf16 v[176:179], a[0:3], v[160:163], v[176:179]
    buffer_load_dwordx4 a[224:227], v15, s[52:55], s63 offen offset:768
    v_cndmask_b32_e64 v242, 0, v236, s[4:5]
    v_mfma_f32_16x16x32_bf16 v[180:183], a[0:3], v[164:167], v[180:183]
    ds_read_b128 a[0:3], v6 offset:56320
    v_cndmask_b32_e64 v240, v240, v233, s[6:7]
    v_mfma_f32_16x16x32_bf16 v[184:187], a[4:7], v[160:163], v[184:187]
    v_cndmask_b32_e64 v242, v242, v237, s[6:7]
    v_cndmask_b32_e64 v240, v240, v234, s[30:31]
    v_mfma_f32_16x16x32_bf16 v[188:191], a[4:7], v[164:167], v[188:191]
    ds_read_b128 a[4:7], v7 offset:11264
    v_cndmask_b32_e64 v242, v242, v238, s[30:31]
    v_mfma_f32_16x16x32_bf16 v[192:195], a[8:11], v[160:163], v[192:195]
    v_cndmask_b32_e64 v240, v240, v235, s[70:71]
    v_cndmask_b32_e64 v242, v242, v239, s[70:71]
    v_mfma_f32_16x16x32_bf16 v[196:199], a[8:11], v[164:167], v[196:199]
    ds_read_b128 a[8:11], v7 offset:31744
    v_mov_b32 v241, v240
    v_mfma_f32_16x16x32_bf16 v[200:203], a[12:15], v[160:163], v[200:203]
    v_mov_b32 v243, v242
    v_mfma_f32_16x16x32_bf16 v[204:207], a[12:15], v[164:167], v[204:207]
    ds_read_b128 a[12:15], v6 offset:55296
    s_waitcnt lgkmcnt(4)
    v_permlane32_swap_b32 v240, v241
    v_permlane32_swap_b32 v242, v243
    v_add_f32 v240, v240, v241
    v_add_f32 v242, v242, v243
    v_mov_b32 v241, v240
    v_mov_b32 v243, v242
    s_nop 0
    v_permlane16_swap_b32 v240, v241
    v_permlane16_swap_b32 v242, v243
    v_add_f32 v240, v240, v241
    v_add_f32 v242, v242, v243
    v_fmamk_f32 v240, v240, 0x3acccd53, v244
    v_fmamk_f32 v242, v242, 0x3acccd53, v244
    v_rsq_f32 v241, v240
    v_rsq_f32 v243, v242
    v_mul_f32 v254, v240, v241
    v_mul_f32 v255, v242, v243
    v_cvt_pk_bf16_f32 v240, v254, v254
    v_cvt_pk_bf16_f32 v242, v255, v255
    v_bfi_b32 v168, v249, v240, v168
    v_bfi_b32 v172, v249, v242, v172
    s_nop 0
    v_mfma_f32_16x16x32_bf16 v[176:179], a[16:19], v[168:171], v[176:179]
    buffer_load_dwordx4 a[228:231], v15, s[52:55], s63 offen offset:1024
    v_mul_f32 v250, 0xc0135761, v241
    v_mfma_f32_16x16x32_bf16 v[180:183], a[16:19], v[172:175], v[180:183]
    ds_read_b128 a[16:19], v7 offset:10240
    s_mov_b32 s63, 102400
    v_mfma_f32_16x16x32_bf16 v[184:187], a[20:23], v[168:171], v[184:187]
    buffer_load_dwordx4 a[232:235], v15, s[52:55], s63 offen offset:0
    v_mul_f32 v251, 0xc0135761, v243
    v_mfma_f32_16x16x32_bf16 v[188:191], a[20:23], v[172:175], v[188:191]
    ds_read_b128 a[20:23], v7 offset:30720
    v_mul_f32 v240, v241, v241
    v_mfma_f32_16x16x32_bf16 v[192:195], a[24:27], v[168:171], v[192:195]
    v_mul_f32 v242, v243, v243
    v_mul_f32 v240, 0x3d372713, v240
    v_mfma_f32_16x16x32_bf16 v[196:199], a[24:27], v[172:175], v[196:199]
    ds_read_b128 a[24:27], v6 offset:54272
    v_mul_f32 v242, 0x3d372713, v242
    v_mfma_f32_16x16x32_bf16 v[200:203], a[28:31], v[168:171], v[200:203]
    v_mul_f32 v252, v250, v240
    v_mul_f32 v253, v251, v242
    v_mfma_f32_16x16x32_bf16 v[204:207], a[28:31], v[172:175], v[204:207]
    ds_read_b128 a[28:31], v7 offset:9216
    s_waitcnt lgkmcnt(5)
    v_mul_f32 v254, 0x70000000, v254
    v_mul_f32 v255, 0x70000000, v255
    v_pk_mul_f32 v[232:233], v[176:177], v[176:177]
    v_pk_mul_f32 v[234:235], v[178:179], v[178:179]
    v_pk_mul_f32 v[236:237], v[180:181], v[180:181]
    v_pk_mul_f32 v[238:239], v[182:183], v[182:183]
    v_pk_fma_f32 v[232:233], v[232:233], v[252:253], v[250:251] op_sel:[0,0,0] op_sel_hi:[1,0,0]
    v_pk_fma_f32 v[234:235], v[234:235], v[252:253], v[250:251] op_sel:[0,0,0] op_sel_hi:[1,0,0]
    v_pk_fma_f32 v[236:237], v[236:237], v[252:253], v[250:251] op_sel:[0,1,1] op_sel_hi:[1,1,1]
    v_pk_fma_f32 v[238:239], v[238:239], v[252:253], v[250:251] op_sel:[0,1,1] op_sel_hi:[1,1,1]
    v_pk_mul_f32 v[232:233], v[232:233], v[176:177]
    v_pk_mul_f32 v[234:235], v[234:235], v[178:179]
    v_pk_mul_f32 v[236:237], v[236:237], v[180:181]
    v_pk_mul_f32 v[238:239], v[238:239], v[182:183]
    v_exp_f32 v232, v232
    buffer_load_dwordx4 a[236:239], v15, s[52:55], s63 offen offset:256
    v_exp_f32 v233, v233
    v_exp_f32 v234, v234
    v_exp_f32 v235, v235
    v_exp_f32 v236, v236
    v_exp_f32 v237, v237
    v_exp_f32 v238, v238
    v_exp_f32 v239, v239
    v_pk_fma_f32 v[232:233], v[232:233], v[254:255], v[254:255] op_sel:[0,0,0] op_sel_hi:[1,0,0]
    v_pk_fma_f32 v[234:235], v[234:235], v[254:255], v[254:255] op_sel:[0,0,0] op_sel_hi:[1,0,0]
    v_pk_fma_f32 v[236:237], v[236:237], v[254:255], v[254:255] op_sel:[0,1,1] op_sel_hi:[1,1,1]
    v_pk_fma_f32 v[238:239], v[238:239], v[254:255], v[254:255] op_sel:[0,1,1] op_sel_hi:[1,1,1]
    v_rcp_f32 v232, v232
    v_rcp_f32 v233, v233
    v_rcp_f32 v234, v234
    v_rcp_f32 v235, v235
    v_rcp_f32 v236, v236
    v_rcp_f32 v237, v237
    v_rcp_f32 v238, v238
    v_rcp_f32 v239, v239
    v_pk_mul_f32 v[232:233], v[232:233], v[176:177]
    v_pk_mul_f32 v[234:235], v[234:235], v[178:179]
    v_pk_mul_f32 v[236:237], v[236:237], v[180:181]
    v_pk_mul_f32 v[238:239], v[238:239], v[182:183]
    v_pk_mul_f32 v[240:241], v[184:185], v[184:185]
    v_pk_mul_f32 v[242:243], v[186:187], v[186:187]
    v_pk_mul_f32 v[244:245], v[188:189], v[188:189]
    v_pk_mul_f32 v[246:247], v[190:191], v[190:191]
    v_pk_fma_f32 v[240:241], v[240:241], v[252:253], v[250:251] op_sel:[0,0,0] op_sel_hi:[1,0,0]
    v_pk_fma_f32 v[242:243], v[242:243], v[252:253], v[250:251] op_sel:[0,0,0] op_sel_hi:[1,0,0]
    v_pk_fma_f32 v[244:245], v[244:245], v[252:253], v[250:251] op_sel:[0,1,1] op_sel_hi:[1,1,1]
    v_pk_fma_f32 v[246:247], v[246:247], v[252:253], v[250:251] op_sel:[0,1,1] op_sel_hi:[1,1,1]
    v_pk_mul_f32 v[240:241], v[240:241], v[184:185]
    v_pk_mul_f32 v[242:243], v[242:243], v[186:187]
    v_pk_mul_f32 v[244:245], v[244:245], v[188:189]
    v_pk_mul_f32 v[246:247], v[246:247], v[190:191]
    v_cvt_pk_bf16_f32 v232, v232, v233
    v_cvt_pk_bf16_f32 v233, v234, v235
    v_cvt_pk_bf16_f32 v234, v236, v237
    v_cvt_pk_bf16_f32 v235, v238, v239
    s_nop 0
    v_permlane16_swap_b32 v232, v234
    buffer_load_dwordx4 a[240:243], v15, s[52:55], s63 offen offset:512
    v_permlane16_swap_b32 v233, v235
    buffer_load_dwordx4 a[244:247], v15, s[52:55], s63 offen offset:768
    s_mov_b32 s18, 0
    buffer_store_dwordx4 v[232:235], v11, s[44:47], s18 offen sc1
    v_exp_f32 v240, v240
    v_exp_f32 v241, v241
    v_exp_f32 v242, v242
    v_exp_f32 v243, v243
    v_exp_f32 v244, v244
    v_exp_f32 v245, v245
    v_exp_f32 v246, v246
    v_exp_f32 v247, v247
    v_pk_fma_f32 v[240:241], v[240:241], v[254:255], v[254:255] op_sel:[0,0,0] op_sel_hi:[1,0,0]
    v_pk_fma_f32 v[242:243], v[242:243], v[254:255], v[254:255] op_sel:[0,0,0] op_sel_hi:[1,0,0]
    v_pk_fma_f32 v[244:245], v[244:245], v[254:255], v[254:255] op_sel:[0,1,1] op_sel_hi:[1,1,1]
    v_pk_fma_f32 v[246:247], v[246:247], v[254:255], v[254:255] op_sel:[0,1,1] op_sel_hi:[1,1,1]
    v_rcp_f32 v240, v240
    v_rcp_f32 v241, v241
    v_rcp_f32 v242, v242
    v_rcp_f32 v243, v243
    v_rcp_f32 v244, v244
    buffer_load_dwordx4 a[248:251], v15, s[52:55], s63 offen offset:1024
    v_rcp_f32 v245, v245
    v_rcp_f32 v246, v246
    v_rcp_f32 v247, v247
    v_pk_mul_f32 v[240:241], v[240:241], v[184:185]
    v_pk_mul_f32 v[242:243], v[242:243], v[186:187]
    v_pk_mul_f32 v[244:245], v[244:245], v[188:189]
    v_pk_mul_f32 v[246:247], v[246:247], v[190:191]
    v_pk_mul_f32 v[232:233], v[192:193], v[192:193]
    v_pk_mul_f32 v[234:235], v[194:195], v[194:195]
    v_pk_mul_f32 v[236:237], v[196:197], v[196:197]
    v_pk_mul_f32 v[238:239], v[198:199], v[198:199]
    v_pk_fma_f32 v[232:233], v[232:233], v[252:253], v[250:251] op_sel:[0,0,0] op_sel_hi:[1,0,0]
    v_pk_fma_f32 v[234:235], v[234:235], v[252:253], v[250:251] op_sel:[0,0,0] op_sel_hi:[1,0,0]
    v_pk_fma_f32 v[236:237], v[236:237], v[252:253], v[250:251] op_sel:[0,1,1] op_sel_hi:[1,1,1]
    v_pk_fma_f32 v[238:239], v[238:239], v[252:253], v[250:251] op_sel:[0,1,1] op_sel_hi:[1,1,1]
    v_pk_mul_f32 v[232:233], v[232:233], v[192:193]
    v_pk_mul_f32 v[234:235], v[234:235], v[194:195]
    v_pk_mul_f32 v[236:237], v[236:237], v[196:197]
    v_pk_mul_f32 v[238:239], v[238:239], v[198:199]
    v_cvt_pk_bf16_f32 v240, v240, v241
    v_cvt_pk_bf16_f32 v241, v242, v243
    v_cvt_pk_bf16_f32 v242, v244, v245
    v_cvt_pk_bf16_f32 v243, v246, v247
    s_nop 0
    v_permlane16_swap_b32 v240, v242
    s_add_u32 m0, s20, 0
    s_mov_b32 s63, 389120
    v_permlane16_swap_b32 v241, v243
    buffer_load_dwordx4 v15, s[52:55], s63 offen offset:0 lds
    s_mov_b32 s18, 67584
    buffer_store_dwordx4 v[240:243], v11, s[44:47], s18 offen sc1
    v_mfma_f32_16x16x32_bf16 v[208:211], a[0:3], v[16:19], 0
    v_exp_f32 v232, v232
    v_mfma_f32_16x16x32_bf16 v[212:215], a[0:3], v[20:23], 0
    v_exp_f32 v233, v233
    v_mfma_f32_16x16x32_bf16 v[216:219], a[4:7], v[16:19], 0
    v_exp_f32 v234, v234
    v_mfma_f32_16x16x32_bf16 v[220:223], a[4:7], v[20:23], 0
    ds_read_b128 a[0:3], v7 offset:29696
    ds_read_b128 a[4:7], v6 offset:53248
    v_mfma_f32_16x16x32_bf16 v[224:227], a[8:11], v[16:19], 0
    s_add_u32 m0, s20, 768
    s_nop 0
    buffer_load_dwordx4 v15, s[52:55], s63 offen offset:256 lds
    v_mfma_f32_16x16x32_bf16 v[228:231], a[8:11], v[20:23], 0
    ds_read_b128 a[8:11], v7 offset:8192
    s_waitcnt lgkmcnt(5)
    v_mfma_f32_16x16x32_bf16 v[208:211], a[12:15], v[24:27], v[208:211]
    s_mov_b32 s62, 131072
    buffer_load_dword v249, v14, s[12:15], s62 offen sc1
    v_mfma_f32_16x16x32_bf16 v[212:215], a[12:15], v[28:31], v[212:215]
    ds_read_b128 a[12:15], v7 offset:28672
    s_barrier
    v_mfma_f32_16x16x32_bf16 v[216:219], a[16:19], v[24:27], v[216:219]
    v_exp_f32 v235, v235
    v_mfma_f32_16x16x32_bf16 v[220:223], a[16:19], v[28:31], v[220:223]
    v_exp_f32 v236, v236
    v_mfma_f32_16x16x32_bf16 v[224:227], a[20:23], v[24:27], v[224:227]
    v_exp_f32 v237, v237
    v_mfma_f32_16x16x32_bf16 v[228:231], a[20:23], v[28:31], v[228:231]
    s_waitcnt lgkmcnt(3)
    v_exp_f32 v238, v238
    v_exp_f32 v239, v239
    v_pk_fma_f32 v[232:233], v[232:233], v[254:255], v[254:255] op_sel:[0,0,0] op_sel_hi:[1,0,0]
    v_pk_fma_f32 v[234:235], v[234:235], v[254:255], v[254:255] op_sel:[0,0,0] op_sel_hi:[1,0,0]
    v_pk_fma_f32 v[236:237], v[236:237], v[254:255], v[254:255] op_sel:[0,1,1] op_sel_hi:[1,1,1]
    v_pk_fma_f32 v[238:239], v[238:239], v[254:255], v[254:255] op_sel:[0,1,1] op_sel_hi:[1,1,1]
    v_rcp_f32 v232, v232
    v_mfma_f32_16x16x32_bf16 v[208:211], a[24:27], v[32:35], v[208:211]
    ds_read_b128 a[16:19], v6 offset:52224
    ds_read_b128 a[20:23], v7 offset:7168
    v_mfma_f32_16x16x32_bf16 v[212:215], a[24:27], v[36:39], v[212:215]
    ds_read_b128 a[24:27], v7 offset:27648
    s_add_u32 m0, s20, 1536
    v_mfma_f32_16x16x32_bf16 v[216:219], a[28:31], v[32:35], v[216:219]
    v_rcp_f32 v233, v233
    v_mfma_f32_16x16x32_bf16 v[220:223], a[28:31], v[36:39], v[220:223]
    ds_read_b128 a[28:31], v6 offset:51200
    buffer_load_dwordx4 v15, s[52:55], s63 offen offset:512 lds
    v_mfma_f32_16x16x32_bf16 v[224:227], a[0:3], v[32:35], v[224:227]
    s_add_u32 m0, s20, 2304
    s_nop 0
    buffer_load_dwordx4 v15, s[52:55], s63 offen offset:768 lds
    v_mfma_f32_16x16x32_bf16 v[228:231], a[0:3], v[36:39], v[228:231]
    ds_read_b128 a[0:3], v7 offset:6144
    s_waitcnt lgkmcnt(5)
    v_mfma_f32_16x16x32_bf16 v[208:211], a[4:7], v[40:43], v[208:211]
    v_rcp_f32 v234, v234
    v_mfma_f32_16x16x32_bf16 v[212:215], a[4:7], v[44:47], v[212:215]
    ds_read_b128 a[4:7], v7 offset:26624
    s_add_u32 m0, s20, 3072
    v_mfma_f32_16x16x32_bf16 v[216:219], a[8:11], v[40:43], v[216:219]
    v_rcp_f32 v235, v235
    v_mfma_f32_16x16x32_bf16 v[220:223], a[8:11], v[44:47], v[220:223]
    ds_read_b128 a[8:11], v6 offset:50176
    buffer_load_dwordx4 v15, s[52:55], s63 offen offset:1024 lds
    v_mfma_f32_16x16x32_bf16 v[224:227], a[12:15], v[40:43], v[224:227]
    v_rcp_f32 v236, v236
    v_mfma_f32_16x16x32_bf16 v[228:231], a[12:15], v[44:47], v[228:231]
    ds_read_b128 a[12:15], v7 offset:5120
    s_waitcnt lgkmcnt(5)
    v_mfma_f32_16x16x32_bf16 v[208:211], a[16:19], v[48:51], v[208:211]
    s_add_u32 m0, s20, 20480
    s_mov_b32 s63, 122880
    v_mfma_f32_16x16x32_bf16 v[212:215], a[16:19], v[52:55], v[212:215]
    ds_read_b128 a[16:19], v7 offset:25600
    buffer_load_dwordx4 v15, s[52:55], s63 offen offset:0 lds
    v_mfma_f32_16x16x32_bf16 v[216:219], a[20:23], v[48:51], v[216:219]
    v_rcp_f32 v237, v237
    v_mfma_f32_16x16x32_bf16 v[220:223], a[20:23], v[52:55], v[220:223]
    ds_read_b128 a[20:23], v6 offset:49152
    v_rcp_f32 v238, v238
    v_rcp_f32 v239, v239
    v_pk_mul_f32 v[232:233], v[232:233], v[192:193]
    v_pk_mul_f32 v[234:235], v[234:235], v[194:195]
    v_pk_mul_f32 v[236:237], v[236:237], v[196:197]
    v_pk_mul_f32 v[238:239], v[238:239], v[198:199]
    v_pk_mul_f32 v[240:241], v[200:201], v[200:201]
    v_pk_mul_f32 v[242:243], v[202:203], v[202:203]
    v_pk_mul_f32 v[244:245], v[204:205], v[204:205]
    v_pk_mul_f32 v[246:247], v[206:207], v[206:207]
    v_pk_fma_f32 v[240:241], v[240:241], v[252:253], v[250:251] op_sel:[0,0,0] op_sel_hi:[1,0,0]
    v_pk_fma_f32 v[242:243], v[242:243], v[252:253], v[250:251] op_sel:[0,0,0] op_sel_hi:[1,0,0]
    v_pk_fma_f32 v[244:245], v[244:245], v[252:253], v[250:251] op_sel:[0,1,1] op_sel_hi:[1,1,1]
    v_pk_fma_f32 v[246:247], v[246:247], v[252:253], v[250:251] op_sel:[0,1,1] op_sel_hi:[1,1,1]
    v_pk_mul_f32 v[240:241], v[240:241], v[200:201]
    v_pk_mul_f32 v[242:243], v[242:243], v[202:203]
    v_pk_mul_f32 v[244:245], v[244:245], v[204:205]
    v_pk_mul_f32 v[246:247], v[246:247], v[206:207]
    v_cvt_pk_bf16_f32 v232, v232, v233
    v_mfma_f32_16x16x32_bf16 v[224:227], a[24:27], v[48:51], v[224:227]
    s_add_u32 m0, s20, 21248
    s_nop 0
    buffer_load_dwordx4 v15, s[52:55], s63 offen offset:256 lds
    v_mfma_f32_16x16x32_bf16 v[228:231], a[24:27], v[52:55], v[228:231]
    ds_read_b128 a[24:27], v7 offset:4096
    s_waitcnt lgkmcnt(5)
    v_mfma_f32_16x16x32_bf16 v[208:211], a[28:31], v[56:59], v[208:211]
    s_add_u32 m0, s20, 22016
    s_nop 0
    buffer_load_dwordx4 v15, s[52:55], s63 offen offset:512 lds
    v_mfma_f32_16x16x32_bf16 v[212:215], a[28:31], v[60:63], v[212:215]
    ds_read_b128 a[28:31], v7 offset:24576
    v_cvt_pk_bf16_f32 v233, v234, v235
    v_mfma_f32_16x16x32_bf16 v[216:219], a[0:3], v[56:59], v[216:219]
    v_cvt_pk_bf16_f32 v234, v236, v237
    v_cvt_pk_bf16_f32 v235, v238, v239
    v_mfma_f32_16x16x32_bf16 v[220:223], a[0:3], v[60:63], v[220:223]
    v_permlane16_swap_b32 v232, v234
    v_mfma_f32_16x16x32_bf16 v[224:227], a[4:7], v[56:59], v[224:227]
    ds_read_b128 a[0:3], v6 offset:48128
    s_add_u32 m0, s20, 22784
    v_mfma_f32_16x16x32_bf16 v[228:231], a[4:7], v[60:63], v[228:231]
    ds_read_b128 a[4:7], v7 offset:3072
    s_waitcnt lgkmcnt(5)
    v_mfma_f32_16x16x32_bf16 v[208:211], a[8:11], v[64:67], v[208:211]
    v_permlane16_swap_b32 v233, v235
    v_mfma_f32_16x16x32_bf16 v[212:215], a[8:11], v[68:71], v[212:215]
    ds_read_b128 a[8:11], v7 offset:23552
    buffer_load_dwordx4 v15, s[52:55], s63 offen offset:768 lds
    v_mfma_f32_16x16x32_bf16 v[216:219], a[12:15], v[64:67], v[216:219]
    s_mov_b32 s18, 135168
    buffer_store_dwordx4 v[232:235], v11, s[44:47], s18 offen sc1
    v_mfma_f32_16x16x32_bf16 v[220:223], a[12:15], v[68:71], v[220:223]
    v_exp_f32 v240, v240
    v_mfma_f32_16x16x32_bf16 v[224:227], a[16:19], v[64:67], v[224:227]
    v_exp_f32 v241, v241
    v_mfma_f32_16x16x32_bf16 v[228:231], a[16:19], v[68:71], v[228:231]
    ds_read_b128 a[12:15], v6 offset:47104
    s_waitcnt lgkmcnt(4)
    v_mfma_f32_16x16x32_bf16 v[208:211], a[20:23], v[72:75], v[208:211]
    v_exp_f32 v242, v242
    v_mfma_f32_16x16x32_bf16 v[212:215], a[20:23], v[76:79], v[212:215]
    ds_read_b128 a[16:19], v7 offset:2048
    ds_read_b128 a[20:23], v7 offset:22528
    v_mfma_f32_16x16x32_bf16 v[216:219], a[24:27], v[72:75], v[216:219]
    s_add_u32 m0, s20, 23552
    s_nop 0
    buffer_load_dwordx4 v15, s[52:55], s63 offen offset:1024 lds
    v_mfma_f32_16x16x32_bf16 v[220:223], a[24:27], v[76:79], v[220:223]
    v_exp_f32 v243, v243
    v_mfma_f32_16x16x32_bf16 v[224:227], a[28:31], v[72:75], v[224:227]
    v_exp_f32 v244, v244
    v_mfma_f32_16x16x32_bf16 v[228:231], a[28:31], v[76:79], v[228:231]
    ds_read_b128 a[24:27], v6 offset:46080
    s_waitcnt lgkmcnt(4)
    v_mfma_f32_16x16x32_bf16 v[208:211], a[0:3], v[80:83], v[208:211]
    s_waitcnt vmcnt(9)
    v_cmp_eq_u32 vcc, 0, v249
    v_mfma_f32_16x16x32_bf16 v[212:215], a[0:3], v[84:87], v[212:215]
    ds_read_b128 a[28:31], v7 offset:1024
    ds_read_b128 a[0:3], v7 offset:21504
    v_mfma_f32_16x16x32_bf16 v[216:219], a[4:7], v[80:83], v[216:219]
    s_cbranch_vccnz m1_ready_spin
m1_ready_ok:
    v_mfma_f32_16x16x32_bf16 v[220:223], a[4:7], v[84:87], v[220:223]
    ds_read_b128 a[4:7], v6 offset:45056
    s_add_u32 m0, s20, 40960
    v_mfma_f32_16x16x32_bf16 v[224:227], a[8:11], v[80:83], v[224:227]
    s_mov_b32 s63, 409600
    buffer_load_dwordx4 v15, s[52:55], s63 offen offset:0 lds
    v_mfma_f32_16x16x32_bf16 v[228:231], a[8:11], v[84:87], v[228:231]
    ds_read_b128 a[8:11], v7 offset:0
    s_waitcnt lgkmcnt(5)
    v_mfma_f32_16x16x32_bf16 v[208:211], a[12:15], v[88:91], v[208:211]
    s_add_u32 m0, s20, 41728
    s_nop 0
    buffer_load_dwordx4 v15, s[52:55], s63 offen offset:256 lds
    v_mfma_f32_16x16x32_bf16 v[212:215], a[12:15], v[92:95], v[212:215]
    ds_read_b128 a[12:15], v7 offset:20480
    s_add_u32 m0, s20, 42496
    v_mfma_f32_16x16x32_bf16 v[216:219], a[16:19], v[88:91], v[216:219]
    v_exp_f32 v245, v245
    v_mfma_f32_16x16x32_bf16 v[220:223], a[16:19], v[92:95], v[220:223]
    ds_read_b128 a[16:19], v6 offset:44032
    v_exp_f32 v246, v246
    v_exp_f32 v247, v247
    v_pk_fma_f32 v[240:241], v[240:241], v[254:255], v[254:255] op_sel:[0,0,0] op_sel_hi:[1,0,0]
    v_pk_fma_f32 v[242:243], v[242:243], v[254:255], v[254:255] op_sel:[0,0,0] op_sel_hi:[1,0,0]
    v_pk_fma_f32 v[244:245], v[244:245], v[254:255], v[254:255] op_sel:[0,1,1] op_sel_hi:[1,1,1]
    v_pk_fma_f32 v[246:247], v[246:247], v[254:255], v[254:255] op_sel:[0,1,1] op_sel_hi:[1,1,1]
    v_rcp_f32 v240, v240
    v_mfma_f32_16x16x32_bf16 v[224:227], a[20:23], v[88:91], v[224:227]
    v_rcp_f32 v241, v241
    v_mfma_f32_16x16x32_bf16 v[228:231], a[20:23], v[92:95], v[228:231]
    ds_read_b128 a[20:23], v6 offset:64512
    s_waitcnt lgkmcnt(5)
    v_mfma_f32_16x16x32_bf16 v[208:211], a[24:27], v[96:99], v[208:211]
    v_rcp_f32 v242, v242
    v_mfma_f32_16x16x32_bf16 v[212:215], a[24:27], v[100:103], v[212:215]
    ds_read_b128 a[24:27], v7 offset:19456
    buffer_load_dwordx4 v15, s[52:55], s63 offen offset:512 lds
    v_mfma_f32_16x16x32_bf16 v[216:219], a[28:31], v[96:99], v[216:219]
    s_add_u32 m0, s20, 43264
    s_nop 0
    buffer_load_dwordx4 v15, s[52:55], s63 offen offset:768 lds
    v_mfma_f32_16x16x32_bf16 v[220:223], a[28:31], v[100:103], v[220:223]
    ds_read_b128 a[28:31], v6 offset:43008
    s_add_u32 m0, s20, 44032
    v_mfma_f32_16x16x32_bf16 v[224:227], a[0:3], v[96:99], v[224:227]
    v_rcp_f32 v243, v243
    v_mfma_f32_16x16x32_bf16 v[228:231], a[0:3], v[100:103], v[228:231]
    ds_read_b128 a[0:3], v6 offset:63488
    s_waitcnt lgkmcnt(5)
    v_mfma_f32_16x16x32_bf16 v[208:211], a[4:7], v[104:107], v[208:211]
    v_rcp_f32 v244, v244
    v_mfma_f32_16x16x32_bf16 v[212:215], a[4:7], v[108:111], v[212:215]
    ds_read_b128 a[4:7], v7 offset:18432
    buffer_load_dwordx4 v15, s[52:55], s63 offen offset:1024 lds
    v_mfma_f32_16x16x32_bf16 v[216:219], a[8:11], v[104:107], v[216:219]
    s_mov_b32 s65, 0
    buffer_load_dwordx4 v[16:19], v13, s[8:11], s65 offen sc1
    v_mfma_f32_16x16x32_bf16 v[220:223], a[8:11], v[108:111], v[220:223]
    ds_read_b128 a[8:11], v6 offset:41984
    buffer_load_dwordx4 v[20:23], v4, s[8:11], s65 offen sc1
    v_mfma_f32_16x16x32_bf16 v[224:227], a[12:15], v[104:107], v[224:227]
    v_rcp_f32 v245, v245
    v_mfma_f32_16x16x32_bf16 v[228:231], a[12:15], v[108:111], v[228:231]
    s_waitcnt lgkmcnt(4)
    v_rcp_f32 v246, v246
    v_rcp_f32 v247, v247
    v_pk_mul_f32 v[240:241], v[240:241], v[200:201]
    v_pk_mul_f32 v[242:243], v[242:243], v[202:203]
    v_pk_mul_f32 v[244:245], v[244:245], v[204:205]
    v_pk_mul_f32 v[246:247], v[246:247], v[206:207]
    v_cvt_pk_bf16_f32 v240, v240, v241
    v_mfma_f32_16x16x32_bf16 v[208:211], a[16:19], v[112:115], v[208:211]
    ds_read_b128 a[12:15], v6 offset:62464
    buffer_load_dwordx4 v[24:27], v8, s[8:11], s65 offen sc1
    v_mfma_f32_16x16x32_bf16 v[212:215], a[16:19], v[116:119], v[212:215]
    ds_read_b128 a[16:19], v7 offset:17408
    buffer_load_dwordx4 v[28:31], v10, s[8:11], s65 offen sc1
    v_mfma_f32_16x16x32_bf16 v[216:219], a[20:23], v[112:115], v[216:219]
    v_cvt_pk_bf16_f32 v241, v242, v243
    v_cvt_pk_bf16_f32 v242, v244, v245
    v_mfma_f32_16x16x32_bf16 v[220:223], a[20:23], v[116:119], v[220:223]
    ds_read_b128 a[20:23], v6 offset:40960
    s_mov_b32 s65, 946176
    v_mfma_f32_16x16x32_bf16 v[224:227], a[24:27], v[112:115], v[224:227]
    buffer_load_dwordx4 v[32:35], v13, s[8:11], s65 offen sc1
    v_cvt_pk_bf16_f32 v243, v246, v247
    v_mfma_f32_16x16x32_bf16 v[228:231], a[24:27], v[116:119], v[228:231]
    ds_read_b128 a[24:27], v6 offset:61440
    s_waitcnt lgkmcnt(5)
    v_mfma_f32_16x16x32_bf16 v[208:211], a[28:31], v[120:123], v[208:211]
    v_permlane16_swap_b32 v240, v242
    v_mfma_f32_16x16x32_bf16 v[212:215], a[28:31], v[124:127], v[212:215]
    v_permlane16_swap_b32 v241, v243
    v_mfma_f32_16x16x32_bf16 v[216:219], a[0:3], v[120:123], v[216:219]
    ds_read_b128 a[28:31], v7 offset:16384
    s_mov_b32 s18, 202752
    v_mfma_f32_16x16x32_bf16 v[220:223], a[0:3], v[124:127], v[220:223]
    ds_read_b128 a[0:3], v6 offset:39936
    buffer_store_dwordx4 v[240:243], v11, s[44:47], s18 offen sc1
    v_mfma_f32_16x16x32_bf16 v[224:227], a[4:7], v[120:123], v[224:227]
    v_mfma_f32_16x16x32_bf16 v[228:231], a[4:7], v[124:127], v[228:231]
    ds_read_b128 a[4:7], v6 offset:60416
    s_waitcnt lgkmcnt(5)
    v_mfma_f32_16x16x32_bf16 v[208:211], a[8:11], v[128:131], v[208:211]
    v_mfma_f32_16x16x32_bf16 v[212:215], a[8:11], v[132:135], v[212:215]
    ds_read_b128 a[8:11], v7 offset:15360
    v_mfma_f32_16x16x32_bf16 v[216:219], a[12:15], v[128:131], v[216:219]
    v_mfma_f32_16x16x32_bf16 v[220:223], a[12:15], v[132:135], v[220:223]
    ds_read_b128 a[12:15], v6 offset:38912
    buffer_load_dwordx4 v[36:39], v4, s[8:11], s65 offen sc1
    v_mfma_f32_16x16x32_bf16 v[224:227], a[16:19], v[128:131], v[224:227]
    v_mfma_f32_16x16x32_bf16 v[228:231], a[16:19], v[132:135], v[228:231]
    ds_read_b128 a[16:19], v6 offset:59392
    s_waitcnt lgkmcnt(5)
    v_mfma_f32_16x16x32_bf16 v[208:211], a[20:23], v[136:139], v[208:211]
    v_mfma_f32_16x16x32_bf16 v[212:215], a[20:23], v[140:143], v[212:215]
    ds_read_b128 a[20:23], v7 offset:14336
    v_mfma_f32_16x16x32_bf16 v[216:219], a[24:27], v[136:139], v[216:219]
    v_mfma_f32_16x16x32_bf16 v[220:223], a[24:27], v[140:143], v[220:223]
    ds_read_b128 a[24:27], v6 offset:37888
    v_mfma_f32_16x16x32_bf16 v[224:227], a[28:31], v[136:139], v[224:227]
    v_mfma_f32_16x16x32_bf16 v[228:231], a[28:31], v[140:143], v[228:231]
    ds_read_b128 a[28:31], v6 offset:58368
    s_waitcnt lgkmcnt(5)
    v_mfma_f32_16x16x32_bf16 v[208:211], a[0:3], v[144:147], v[208:211]
    buffer_load_dwordx4 v[40:43], v8, s[8:11], s65 offen sc1
    v_mfma_f32_16x16x32_bf16 v[212:215], a[0:3], v[148:151], v[212:215]
    ds_read_b128 a[0:3], v7 offset:13312
    v_mfma_f32_16x16x32_bf16 v[216:219], a[4:7], v[144:147], v[216:219]
    v_mfma_f32_16x16x32_bf16 v[220:223], a[4:7], v[148:151], v[220:223]
    ds_read_b128 a[4:7], v6 offset:36864
    v_mfma_f32_16x16x32_bf16 v[224:227], a[8:11], v[144:147], v[224:227]
    buffer_load_dwordx4 v[44:47], v10, s[8:11], s65 offen sc1
    v_mfma_f32_16x16x32_bf16 v[228:231], a[8:11], v[148:151], v[228:231]
    ds_read_b128 a[8:11], v6 offset:57344
    s_waitcnt lgkmcnt(5)
    v_mfma_f32_16x16x32_bf16 v[208:211], a[12:15], v[152:155], v[208:211]
    v_mfma_f32_16x16x32_bf16 v[212:215], a[12:15], v[156:159], v[212:215]
    ds_read_b128 a[12:15], v7 offset:12288
    v_mfma_f32_16x16x32_bf16 v[216:219], a[16:19], v[152:155], v[216:219]
    v_mfma_f32_16x16x32_bf16 v[220:223], a[16:19], v[156:159], v[220:223]
    v_mfma_f32_16x16x32_bf16 v[224:227], a[20:23], v[152:155], v[224:227]
    v_mfma_f32_16x16x32_bf16 v[228:231], a[20:23], v[156:159], v[228:231]
    s_waitcnt lgkmcnt(3)
    s_mov_b32 s65, 67584
    v_mfma_f32_16x16x32_bf16 v[208:211], a[24:27], v[160:163], v[208:211]
    buffer_load_dwordx4 v[48:51], v13, s[8:11], s65 offen sc1
    v_mfma_f32_16x16x32_bf16 v[212:215], a[24:27], v[164:167], v[212:215]
    v_mfma_f32_16x16x32_bf16 v[216:219], a[28:31], v[160:163], v[216:219]
    v_mfma_f32_16x16x32_bf16 v[220:223], a[28:31], v[164:167], v[220:223]
    buffer_load_dwordx4 v[52:55], v4, s[8:11], s65 offen sc1
    v_mfma_f32_16x16x32_bf16 v[224:227], a[0:3], v[160:163], v[224:227]
    v_mfma_f32_16x16x32_bf16 v[228:231], a[0:3], v[164:167], v[228:231]
    s_waitcnt lgkmcnt(0)
    v_mfma_f32_16x16x32_bf16 v[208:211], a[4:7], v[168:171], v[208:211]
    v_mfma_f32_16x16x32_bf16 v[212:215], a[4:7], v[172:175], v[212:215]
    buffer_load_dwordx4 v[56:59], v8, s[8:11], s65 offen sc1
    v_mfma_f32_16x16x32_bf16 v[216:219], a[8:11], v[168:171], v[216:219]
    v_mfma_f32_16x16x32_bf16 v[220:223], a[8:11], v[172:175], v[220:223]
    v_mfma_f32_16x16x32_bf16 v[224:227], a[12:15], v[168:171], v[224:227]
    v_mfma_f32_16x16x32_bf16 v[228:231], a[12:15], v[172:175], v[228:231]
    s_nop 1
    v_pk_mul_f32 v[232:233], v[208:209], v[208:209]
    v_pk_mul_f32 v[234:235], v[210:211], v[210:211]
    v_pk_mul_f32 v[236:237], v[212:213], v[212:213]
    v_pk_mul_f32 v[238:239], v[214:215], v[214:215]
    v_pk_fma_f32 v[232:233], v[232:233], v[252:253], v[250:251] op_sel:[0,0,0] op_sel_hi:[1,0,0]
    v_pk_fma_f32 v[234:235], v[234:235], v[252:253], v[250:251] op_sel:[0,0,0] op_sel_hi:[1,0,0]
    v_pk_fma_f32 v[236:237], v[236:237], v[252:253], v[250:251] op_sel:[0,1,1] op_sel_hi:[1,1,1]
    v_pk_fma_f32 v[238:239], v[238:239], v[252:253], v[250:251] op_sel:[0,1,1] op_sel_hi:[1,1,1]
    v_pk_mul_f32 v[232:233], v[232:233], v[208:209]
    v_pk_mul_f32 v[234:235], v[234:235], v[210:211]
    v_pk_mul_f32 v[236:237], v[236:237], v[212:213]
    v_pk_mul_f32 v[238:239], v[238:239], v[214:215]
    v_exp_f32 v232, v232
    buffer_load_dwordx4 v[60:63], v10, s[8:11], s65 offen sc1
    v_exp_f32 v233, v233
    s_mov_b32 s65, 1013760
    buffer_load_dwordx4 v[64:67], v13, s[8:11], s65 offen sc1
    v_exp_f32 v234, v234
    v_exp_f32 v235, v235
    v_exp_f32 v236, v236
    v_exp_f32 v237, v237
    v_exp_f32 v238, v238
    v_exp_f32 v239, v239
    buffer_load_dwordx4 v[68:71], v4, s[8:11], s65 offen sc1
    v_pk_fma_f32 v[232:233], v[232:233], v[254:255], v[254:255] op_sel:[0,0,0] op_sel_hi:[1,0,0]
    v_pk_fma_f32 v[234:235], v[234:235], v[254:255], v[254:255] op_sel:[0,0,0] op_sel_hi:[1,0,0]
    v_pk_fma_f32 v[236:237], v[236:237], v[254:255], v[254:255] op_sel:[0,1,1] op_sel_hi:[1,1,1]
    v_pk_fma_f32 v[238:239], v[238:239], v[254:255], v[254:255] op_sel:[0,1,1] op_sel_hi:[1,1,1]
    v_rcp_f32 v232, v232
    v_rcp_f32 v233, v233
    v_rcp_f32 v234, v234
    v_rcp_f32 v235, v235
    v_rcp_f32 v236, v236
    v_rcp_f32 v237, v237
    buffer_load_dwordx4 v[72:75], v8, s[8:11], s65 offen sc1
    v_rcp_f32 v238, v238
    v_rcp_f32 v239, v239
    v_pk_mul_f32 v[232:233], v[232:233], v[208:209]
    v_pk_mul_f32 v[234:235], v[234:235], v[210:211]
    v_pk_mul_f32 v[236:237], v[236:237], v[212:213]
    v_pk_mul_f32 v[238:239], v[238:239], v[214:215]
    v_pk_mul_f32 v[240:241], v[216:217], v[216:217]
    v_pk_mul_f32 v[242:243], v[218:219], v[218:219]
    v_pk_mul_f32 v[244:245], v[220:221], v[220:221]
    v_pk_mul_f32 v[246:247], v[222:223], v[222:223]
    v_pk_fma_f32 v[240:241], v[240:241], v[252:253], v[250:251] op_sel:[0,0,0] op_sel_hi:[1,0,0]
    v_pk_fma_f32 v[242:243], v[242:243], v[252:253], v[250:251] op_sel:[0,0,0] op_sel_hi:[1,0,0]
    v_pk_fma_f32 v[244:245], v[244:245], v[252:253], v[250:251] op_sel:[0,1,1] op_sel_hi:[1,1,1]
    v_pk_fma_f32 v[246:247], v[246:247], v[252:253], v[250:251] op_sel:[0,1,1] op_sel_hi:[1,1,1]
    v_pk_mul_f32 v[240:241], v[240:241], v[216:217]
    v_pk_mul_f32 v[242:243], v[242:243], v[218:219]
    v_pk_mul_f32 v[244:245], v[244:245], v[220:221]
    v_pk_mul_f32 v[246:247], v[246:247], v[222:223]
    v_cvt_pk_bf16_f32 v232, v232, v233
    v_cvt_pk_bf16_f32 v233, v234, v235
    v_cvt_pk_bf16_f32 v234, v236, v237
    v_cvt_pk_bf16_f32 v235, v238, v239
    s_nop 0
    v_permlane16_swap_b32 v232, v234
    buffer_load_dwordx4 v[76:79], v10, s[8:11], s65 offen sc1
    v_permlane16_swap_b32 v233, v235
    s_mov_b32 s18, 270336
    buffer_store_dwordx4 v[232:235], v11, s[44:47], s18 offen sc1
    s_waitcnt vmcnt(16)
    v_cmp_u_f32 vcc, v16, v20
    s_cbranch_vccnz m1_q0_again
m1_q0_ok:
    v_mfma_f32_16x16x32_bf16 v[96:99], a[32:35], v[16:19], 0
    v_exp_f32 v240, v240
    v_mfma_f32_16x16x32_bf16 v[100:103], a[36:39], v[16:19], 0
    v_exp_f32 v241, v241
    v_mfma_f32_16x16x32_bf16 v[104:107], a[40:43], v[16:19], 0
    v_exp_f32 v242, v242
    v_mfma_f32_16x16x32_bf16 v[108:111], a[44:47], v[16:19], 0
    s_waitcnt vmcnt(14)
    v_cmp_u_f32 vcc, v24, v28
    v_mfma_f32_16x16x32_bf16 v[112:115], a[48:51], v[16:19], 0
    v_exp_f32 v243, v243
    v_mfma_f32_16x16x32_bf16 v[116:119], a[32:35], v[20:23], 0
    s_cbranch_vccnz m1_q1_again
m1_q1_ok:
    v_mfma_f32_16x16x32_bf16 v[120:123], a[36:39], v[20:23], 0
    s_mov_b32 s65, 135168
    buffer_load_dwordx4 v[80:83], v13, s[8:11], s65 offen sc1
    v_mfma_f32_16x16x32_bf16 v[124:127], a[40:43], v[20:23], 0
    v_exp_f32 v244, v244
    v_mfma_f32_16x16x32_bf16 v[128:131], a[44:47], v[20:23], 0
    v_exp_f32 v245, v245
    v_mfma_f32_16x16x32_bf16 v[132:135], a[48:51], v[20:23], 0
    buffer_load_dwordx4 v[84:87], v4, s[8:11], s65 offen sc1
    v_exp_f32 v246, v246
    v_exp_f32 v247, v247
    v_pk_fma_f32 v[240:241], v[240:241], v[254:255], v[254:255] op_sel:[0,0,0] op_sel_hi:[1,0,0]
    v_pk_fma_f32 v[242:243], v[242:243], v[254:255], v[254:255] op_sel:[0,0,0] op_sel_hi:[1,0,0]
    v_pk_fma_f32 v[244:245], v[244:245], v[254:255], v[254:255] op_sel:[0,1,1] op_sel_hi:[1,1,1]
    v_pk_fma_f32 v[246:247], v[246:247], v[254:255], v[254:255] op_sel:[0,1,1] op_sel_hi:[1,1,1]
    v_rcp_f32 v240, v240
    v_mfma_f32_16x16x32_bf16 v[136:139], a[32:35], v[24:27], 0
    v_rcp_f32 v241, v241
    v_mfma_f32_16x16x32_bf16 v[140:143], a[36:39], v[24:27], 0
    v_rcp_f32 v242, v242
    v_mfma_f32_16x16x32_bf16 v[144:147], a[40:43], v[24:27], 0
    v_rcp_f32 v243, v243
    v_mfma_f32_16x16x32_bf16 v[148:151], a[44:47], v[24:27], 0
    s_waitcnt vmcnt(11)
    v_max3_u32 v9, v32, v36, v40
    v_mfma_f32_16x16x32_bf16 v[152:155], a[48:51], v[24:27], 0
    buffer_load_dwordx4 v[88:91], v8, s[8:11], s65 offen sc1
    v_cmp_u_f32 vcc, v9, v44
    v_mfma_f32_16x16x32_bf16 v[156:159], a[32:35], v[28:31], 0
    v_rcp_f32 v244, v244
    v_mfma_f32_16x16x32_bf16 v[160:163], a[36:39], v[28:31], 0
    s_cbranch_vccnz m1_q2_again
m1_q2_ok:
    v_mfma_f32_16x16x32_bf16 v[164:167], a[40:43], v[28:31], 0
    v_rcp_f32 v245, v245
    v_mfma_f32_16x16x32_bf16 v[168:171], a[44:47], v[28:31], 0
    buffer_load_dwordx4 v[92:95], v10, s[8:11], s65 offen sc1
    v_rcp_f32 v246, v246
    v_rcp_f32 v247, v247
    v_pk_mul_f32 v[240:241], v[240:241], v[216:217]
    v_pk_mul_f32 v[242:243], v[242:243], v[218:219]
    v_pk_mul_f32 v[244:245], v[244:245], v[220:221]
    v_pk_mul_f32 v[246:247], v[246:247], v[222:223]
    v_pk_mul_f32 v[232:233], v[224:225], v[224:225]
    v_pk_mul_f32 v[234:235], v[226:227], v[226:227]
    v_pk_mul_f32 v[236:237], v[228:229], v[228:229]
    v_pk_mul_f32 v[238:239], v[230:231], v[230:231]
    v_pk_fma_f32 v[232:233], v[232:233], v[252:253], v[250:251] op_sel:[0,0,0] op_sel_hi:[1,0,0]
    v_pk_fma_f32 v[234:235], v[234:235], v[252:253], v[250:251] op_sel:[0,0,0] op_sel_hi:[1,0,0]
    v_pk_fma_f32 v[236:237], v[236:237], v[252:253], v[250:251] op_sel:[0,1,1] op_sel_hi:[1,1,1]
    v_pk_fma_f32 v[238:239], v[238:239], v[252:253], v[250:251] op_sel:[0,1,1] op_sel_hi:[1,1,1]
    v_pk_mul_f32 v[232:233], v[232:233], v[224:225]
    v_pk_mul_f32 v[234:235], v[234:235], v[226:227]
    v_pk_mul_f32 v[236:237], v[236:237], v[228:229]
    v_pk_mul_f32 v[238:239], v[238:239], v[230:231]
    v_cvt_pk_bf16_f32 v240, v240, v241
    v_mfma_f32_16x16x32_bf16 v[172:175], a[48:51], v[28:31], 0
    s_mov_b32 s65, 1081344
    buffer_load_dwordx4 v[176:179], v13, s[8:11], s65 offen sc1
    v_mfma_f32_16x16x32_bf16 v[96:99], a[52:55], v[32:35], v[96:99]
    buffer_load_dwordx4 v[180:183], v4, s[8:11], s65 offen sc1
    v_cvt_pk_bf16_f32 v241, v242, v243
    v_mfma_f32_16x16x32_bf16 v[100:103], a[56:59], v[32:35], v[100:103]
    v_cvt_pk_bf16_f32 v242, v244, v245
    v_cvt_pk_bf16_f32 v243, v246, v247
    v_mfma_f32_16x16x32_bf16 v[104:107], a[60:63], v[32:35], v[104:107]
    v_permlane16_swap_b32 v240, v242
    v_mfma_f32_16x16x32_bf16 v[108:111], a[64:67], v[32:35], v[108:111]
    v_permlane16_swap_b32 v241, v243
    v_mfma_f32_16x16x32_bf16 v[112:115], a[68:71], v[32:35], v[112:115]
    buffer_load_dwordx4 v[184:187], v8, s[8:11], s65 offen sc1
    s_mov_b32 s18, 337920
    v_mfma_f32_16x16x32_bf16 v[116:119], a[52:55], v[36:39], v[116:119]
    buffer_store_dwordx4 v[240:243], v11, s[44:47], s18 offen sc1
    v_mfma_f32_16x16x32_bf16 v[120:123], a[56:59], v[36:39], v[120:123]
    v_exp_f32 v232, v232
    v_mfma_f32_16x16x32_bf16 v[124:127], a[60:63], v[36:39], v[124:127]
    v_exp_f32 v233, v233
    v_mfma_f32_16x16x32_bf16 v[128:131], a[64:67], v[36:39], v[128:131]
    v_exp_f32 v234, v234
    v_mfma_f32_16x16x32_bf16 v[132:135], a[68:71], v[36:39], v[132:135]
    v_exp_f32 v235, v235
    v_mfma_f32_16x16x32_bf16 v[136:139], a[52:55], v[40:43], v[136:139]
    v_exp_f32 v236, v236
    v_mfma_f32_16x16x32_bf16 v[140:143], a[56:59], v[40:43], v[140:143]
    v_exp_f32 v237, v237
    v_mfma_f32_16x16x32_bf16 v[144:147], a[60:63], v[40:43], v[144:147]
    buffer_load_dwordx4 v[188:191], v10, s[8:11], s65 offen sc1
    v_exp_f32 v238, v238
    v_exp_f32 v239, v239
    v_pk_fma_f32 v[232:233], v[232:233], v[254:255], v[254:255] op_sel:[0,0,0] op_sel_hi:[1,0,0]
    v_pk_fma_f32 v[234:235], v[234:235], v[254:255], v[254:255] op_sel:[0,0,0] op_sel_hi:[1,0,0]
    v_pk_fma_f32 v[236:237], v[236:237], v[254:255], v[254:255] op_sel:[0,1,1] op_sel_hi:[1,1,1]
    v_pk_fma_f32 v[238:239], v[238:239], v[254:255], v[254:255] op_sel:[0,1,1] op_sel_hi:[1,1,1]
    v_rcp_f32 v232, v232
    v_mfma_f32_16x16x32_bf16 v[148:151], a[64:67], v[40:43], v[148:151]
    s_waitcnt vmcnt(14)
    v_max3_u32 v9, v48, v52, v56
    v_mfma_f32_16x16x32_bf16 v[152:155], a[68:71], v[40:43], v[152:155]
    s_mov_b32 s65, 202752
    v_cmp_u_f32 vcc, v9, v60
    v_mfma_f32_16x16x32_bf16 v[156:159], a[52:55], v[44:47], v[156:159]
    v_rcp_f32 v233, v233
    v_mfma_f32_16x16x32_bf16 v[160:163], a[56:59], v[44:47], v[160:163]
    s_cbranch_vccnz m1_q3_again
m1_q3_ok:
    v_mfma_f32_16x16x32_bf16 v[164:167], a[60:63], v[44:47], v[164:167]
    v_rcp_f32 v234, v234
    v_mfma_f32_16x16x32_bf16 v[168:171], a[64:67], v[44:47], v[168:171]
    v_rcp_f32 v235, v235
    v_mfma_f32_16x16x32_bf16 v[172:175], a[68:71], v[44:47], v[172:175]
    v_rcp_f32 v236, v236
    v_mfma_f32_16x16x32_bf16 v[96:99], a[72:75], v[48:51], v[96:99]
    v_rcp_f32 v237, v237
    v_mfma_f32_16x16x32_bf16 v[100:103], a[76:79], v[48:51], v[100:103]
    buffer_load_dwordx4 v[16:19], v13, s[8:11], s65 offen sc1
    v_rcp_f32 v238, v238
    v_rcp_f32 v239, v239
    v_pk_mul_f32 v[232:233], v[232:233], v[224:225]
    v_pk_mul_f32 v[234:235], v[234:235], v[226:227]
    v_pk_mul_f32 v[236:237], v[236:237], v[228:229]
    v_pk_mul_f32 v[238:239], v[238:239], v[230:231]
    v_cvt_pk_bf16_f32 v232, v232, v233
    v_mfma_f32_16x16x32_bf16 v[104:107], a[80:83], v[48:51], v[104:107]
    buffer_load_dwordx4 v[20:23], v4, s[8:11], s65 offen sc1
    v_cvt_pk_bf16_f32 v233, v234, v235
    v_mfma_f32_16x16x32_bf16 v[108:111], a[84:87], v[48:51], v[108:111]
    v_cvt_pk_bf16_f32 v234, v236, v237
    v_cvt_pk_bf16_f32 v235, v238, v239
    v_mfma_f32_16x16x32_bf16 v[112:115], a[88:91], v[48:51], v[112:115]
    buffer_load_dwordx4 v[24:27], v8, s[8:11], s65 offen sc1
    v_add_u32 v11, s26, v11
    v_mfma_f32_16x16x32_bf16 v[116:119], a[72:75], v[52:55], v[116:119]
    v_permlane16_swap_b32 v232, v234
    v_mfma_f32_16x16x32_bf16 v[120:123], a[76:79], v[52:55], v[120:123]
    v_permlane16_swap_b32 v233, v235
    v_mfma_f32_16x16x32_bf16 v[124:127], a[80:83], v[52:55], v[124:127]
    s_mov_b32 s18, 405504
    buffer_store_dwordx4 v[232:235], v11, s[44:47], s18 offen sc1
    v_mfma_f32_16x16x32_bf16 v[128:131], a[84:87], v[52:55], v[128:131]
    v_lshl_add_u32 v205, v3, 4, s20
    s_mul_i32 s100, s16, 332800
    v_mfma_f32_16x16x32_bf16 v[132:135], a[88:91], v[52:55], v[132:135]
    ds_read_b128 a[0:3], v205 offset:0
    v_mfma_f32_16x16x32_bf16 v[136:139], a[72:75], v[56:59], v[136:139]
    ds_read_b128 a[4:7], v205 offset:1024
    ds_read_b128 a[8:11], v205 offset:2048
    v_mfma_f32_16x16x32_bf16 v[140:143], a[76:79], v[56:59], v[140:143]
    ds_read_b128 a[12:15], v205 offset:3072
    ds_read_b128 a[16:19], v205 offset:4096
    v_mfma_f32_16x16x32_bf16 v[144:147], a[80:83], v[56:59], v[144:147]
    ds_read_b128 a[32:35], v205 offset:20480
    v_mfma_f32_16x16x32_bf16 v[148:151], a[84:87], v[56:59], v[148:151]
    s_waitcnt vmcnt(14)
    v_max3_u32 v9, v64, v68, v72
    v_mfma_f32_16x16x32_bf16 v[152:155], a[88:91], v[56:59], v[152:155]
    ds_read_b128 a[36:39], v205 offset:21504
    v_cmp_u_f32 vcc, v9, v76
    v_mfma_f32_16x16x32_bf16 v[156:159], a[72:75], v[60:63], v[156:159]
    ds_read_b128 a[40:43], v205 offset:22528
    ds_read_b128 a[44:47], v205 offset:23552
    v_mfma_f32_16x16x32_bf16 v[160:163], a[76:79], v[60:63], v[160:163]
    s_cbranch_vccnz m1_q4_again
m1_q4_ok:
    v_mfma_f32_16x16x32_bf16 v[164:167], a[80:83], v[60:63], v[164:167]
    ds_read_b128 a[48:51], v205 offset:24576
    v_mfma_f32_16x16x32_bf16 v[168:171], a[84:87], v[60:63], v[168:171]
    ds_read_b128 a[52:55], v205 offset:40960
    ds_read_b128 a[56:59], v205 offset:41984
    v_mfma_f32_16x16x32_bf16 v[172:175], a[88:91], v[60:63], v[172:175]
    ds_read_b128 a[60:63], v205 offset:43008
    ds_read_b128 a[64:67], v205 offset:44032
    v_mfma_f32_16x16x32_bf16 v[96:99], a[92:95], v[64:67], v[96:99]
    ds_read_b128 a[68:71], v205 offset:45056
    buffer_load_dwordx4 v[28:31], v10, s[8:11], s65 offen sc1
    v_mfma_f32_16x16x32_bf16 v[100:103], a[96:99], v[64:67], v[100:103]
    s_mov_b32 s65, 1148928
    buffer_load_dwordx4 v[32:35], v13, s[8:11], s65 offen sc1
    v_mfma_f32_16x16x32_bf16 v[104:107], a[100:103], v[64:67], v[104:107]
    buffer_load_dwordx4 v[36:39], v4, s[8:11], s65 offen sc1
    s_lshl3_add_u32 s100, s61, s100
    v_mfma_f32_16x16x32_bf16 v[108:111], a[104:107], v[64:67], v[108:111]
    v_mul_u32_u24 v200, 16640, v2
    v_lshl_add_u32 v200, v1, 3, v200
    v_mfma_f32_16x16x32_bf16 v[112:115], a[108:111], v[64:67], v[112:115]
    v_add_u32 v200, s100, v200
    v_lshrrev_b32 v203, 1, v2
    v_mfma_f32_16x16x32_bf16 v[116:119], a[92:95], v[68:71], v[116:119]
    s_mov_b32 s100, 0x3f800f00
    v_mul_lo_u32 v203, v203, s100
    v_mfma_f32_16x16x32_bf16 v[120:123], a[96:99], v[68:71], v[120:123]
    buffer_load_dwordx4 v[40:43], v8, s[8:11], s65 offen sc1
    v_lshl_add_u32 v204, v3, 4, s21
    v_mfma_f32_16x16x32_bf16 v[124:127], a[100:103], v[68:71], v[124:127]
    s_xor_b32 s100, s56, 1
    s_mul_i32 s100, s100, 15360
    v_mfma_f32_16x16x32_bf16 v[128:131], a[104:107], v[68:71], v[128:131]
    v_lshl_add_u32 v5, v3, 4, s100
    s_xor_b32 s100, s56, 2
    v_mfma_f32_16x16x32_bf16 v[132:135], a[108:111], v[68:71], v[132:135]
    s_mul_i32 s100, s100, 15360
    s_add_u32 s100, s100, 5120
    v_mfma_f32_16x16x32_bf16 v[136:139], a[92:95], v[72:75], v[136:139]
    buffer_load_dwordx4 v[44:47], v10, s[8:11], s65 offen sc1
    v_lshl_add_u32 v6, v3, 4, s100
    v_mfma_f32_16x16x32_bf16 v[140:143], a[96:99], v[72:75], v[140:143]
    s_xor_b32 s100, s56, 3
    s_mul_i32 s100, s100, 15360
    v_mfma_f32_16x16x32_bf16 v[144:147], a[100:103], v[72:75], v[144:147]
    s_add_u32 s100, s100, 10240
    v_lshl_add_u32 v7, v3, 4, s100
    v_mfma_f32_16x16x32_bf16 v[148:151], a[104:107], v[72:75], v[148:151]
    s_waitcnt vmcnt(14)
    v_max3_u32 v9, v80, v84, v88
    v_mfma_f32_16x16x32_bf16 v[152:155], a[108:111], v[72:75], v[152:155]
    v_cmp_u_f32 vcc, v9, v92
    v_lshrrev_b32 v201, 1, v1
    v_mfma_f32_16x16x32_bf16 v[156:159], a[92:95], v[76:79], v[156:159]
    v_lshlrev_b32 v201, 4, v201
    v_and_b32 v202, 1, v1
    v_mfma_f32_16x16x32_bf16 v[160:163], a[96:99], v[76:79], v[160:163]
    s_cbranch_vccnz m1_q5_again
m1_q5_ok:
    v_mfma_f32_16x16x32_bf16 v[164:167], a[100:103], v[76:79], v[164:167]
    v_lshl_add_u32 v201, v202, 2, v201
    v_and_b32 v202, 1, v2
    v_mfma_f32_16x16x32_bf16 v[168:171], a[104:107], v[76:79], v[168:171]
    v_lshl_add_u32 v201, v202, 3, v201
    v_lshrrev_b32 v202, 1, v2
    v_mfma_f32_16x16x32_bf16 v[172:175], a[108:111], v[76:79], v[172:175]
    v_lshl_add_u32 v201, v202, 20, v201
    s_lshl_b32 s100, s61, 3
    v_mfma_f32_16x16x32_bf16 v[96:99], a[112:115], v[80:83], v[96:99]
    v_add_u32 v201, s100, v201
    v_add_u32 v202, s16, v2
    v_mfma_f32_16x16x32_bf16 v[100:103], a[116:119], v[80:83], v[100:103]
    v_min_u32 v202, 1, v202
    v_mul_u32_u24 v202, 0xffff, v202
    v_mfma_f32_16x16x32_bf16 v[104:107], a[120:123], v[80:83], v[104:107]
    v_lshlrev_b32 v202, 16, v202
    v_or_b32 v202, 0xffff, v202
    v_mfma_f32_16x16x32_bf16 v[108:111], a[124:127], v[80:83], v[108:111]
    v_mov_b32 v246, 0
    v_mov_b32 v247, 0
    v_mfma_f32_16x16x32_bf16 v[112:115], a[128:131], v[80:83], v[112:115]
    s_mov_b64 s[4:5], 0xffff
    s_mov_b32 s101, 0x30803080
    v_mfma_f32_16x16x32_bf16 v[116:119], a[112:115], v[84:87], v[116:119]
    s_mov_b32 s65, 270336
    buffer_load_dwordx4 v[48:51], v13, s[8:11], s65 offen sc1
    v_mfma_f32_16x16x32_bf16 v[120:123], a[116:119], v[84:87], v[120:123]
    buffer_load_dwordx4 v[52:55], v4, s[8:11], s65 offen sc1
    v_mfma_f32_16x16x32_bf16 v[124:127], a[120:123], v[84:87], v[124:127]
    buffer_load_dwordx4 v[56:59], v8, s[8:11], s65 offen sc1
    v_mfma_f32_16x16x32_bf16 v[128:131], a[124:127], v[84:87], v[128:131]
    v_mfma_f32_16x16x32_bf16 v[132:135], a[128:131], v[84:87], v[132:135]
    v_mfma_f32_16x16x32_bf16 v[136:139], a[112:115], v[88:91], v[136:139]
    v_mfma_f32_16x16x32_bf16 v[140:143], a[116:119], v[88:91], v[140:143]
    buffer_load_dwordx4 v[60:63], v10, s[8:11], s65 offen sc1
    v_mfma_f32_16x16x32_bf16 v[144:147], a[120:123], v[88:91], v[144:147]
    v_mfma_f32_16x16x32_bf16 v[148:151], a[124:127], v[88:91], v[148:151]
    s_waitcnt vmcnt(13)
    v_max3_u32 v9, v176, v180, v184
    v_mfma_f32_16x16x32_bf16 v[152:155], a[128:131], v[88:91], v[152:155]
    v_cmp_u_f32 vcc, v9, v188
    v_mfma_f32_16x16x32_bf16 v[156:159], a[112:115], v[92:95], v[156:159]
    s_mov_b32 s65, 1216512
    buffer_load_dwordx4 v[64:67], v13, s[8:11], s65 offen sc1
    v_mfma_f32_16x16x32_bf16 v[160:163], a[116:119], v[92:95], v[160:163]
    s_cbranch_vccnz m1_q6_again
m1_q6_ok:
    v_mfma_f32_16x16x32_bf16 v[164:167], a[120:123], v[92:95], v[164:167]
    v_mfma_f32_16x16x32_bf16 v[168:171], a[124:127], v[92:95], v[168:171]
    v_mfma_f32_16x16x32_bf16 v[172:175], a[128:131], v[92:95], v[172:175]
    buffer_load_dwordx4 v[68:71], v4, s[8:11], s65 offen sc1
    v_mfma_f32_16x16x32_bf16 v[96:99], a[132:135], v[176:179], v[96:99]
    s_waitcnt lgkmcnt(0)
    s_barrier
    v_mfma_f32_16x16x32_bf16 v[100:103], a[136:139], v[176:179], v[100:103]
    s_lshl4_add_u32 s62, s96, s97
    s_sub_u32 s62, s3, s62
    v_mfma_f32_16x16x32_bf16 v[104:107], a[140:143], v[176:179], v[104:107]
    s_lshl_b32 s62, s62, 7
    s_add_u32 s62, s62, 131076
    v_mfma_f32_16x16x32_bf16 v[108:111], a[144:147], v[176:179], v[108:111]
    buffer_store_dword v6, v248, s[12:15], s62 offen sc1
    v_mfma_f32_16x16x32_bf16 v[112:115], a[148:151], v[176:179], v[112:115]
    v_mfma_f32_16x16x32_bf16 v[116:119], a[132:135], v[180:183], v[116:119]
    v_mfma_f32_16x16x32_bf16 v[120:123], a[136:139], v[180:183], v[120:123]
    v_mfma_f32_16x16x32_bf16 v[124:127], a[140:143], v[180:183], v[124:127]
    v_mfma_f32_16x16x32_bf16 v[128:131], a[144:147], v[180:183], v[128:131]
    v_mfma_f32_16x16x32_bf16 v[132:135], a[148:151], v[180:183], v[132:135]
    v_mfma_f32_16x16x32_bf16 v[136:139], a[132:135], v[184:187], v[136:139]
    v_mfma_f32_16x16x32_bf16 v[140:143], a[136:139], v[184:187], v[140:143]
    buffer_load_dwordx4 v[72:75], v8, s[8:11], s65 offen sc1
    v_mfma_f32_16x16x32_bf16 v[144:147], a[140:143], v[184:187], v[144:147]
    v_mfma_f32_16x16x32_bf16 v[148:151], a[144:147], v[184:187], v[148:151]
    s_waitcnt vmcnt(12)
    v_max3_u32 v9, v16, v20, v24
    v_mfma_f32_16x16x32_bf16 v[152:155], a[148:151], v[184:187], v[152:155]
    v_cmp_u_f32 vcc, v9, v28
    v_mfma_f32_16x16x32_bf16 v[156:159], a[132:135], v[188:191], v[156:159]
    v_mfma_f32_16x16x32_bf16 v[160:163], a[136:139], v[188:191], v[160:163]
    s_cbranch_vccnz m1_q7_again
m1_q7_ok:
    v_mfma_f32_16x16x32_bf16 v[164:167], a[140:143], v[188:191], v[164:167]
    buffer_load_dwordx4 v[76:79], v10, s[8:11], s65 offen sc1
    v_mfma_f32_16x16x32_bf16 v[168:171], a[144:147], v[188:191], v[168:171]
    v_mfma_f32_16x16x32_bf16 v[172:175], a[148:151], v[188:191], v[172:175]
    v_mfma_f32_16x16x32_bf16 v[96:99], a[152:155], v[16:19], v[96:99]
    v_mfma_f32_16x16x32_bf16 v[100:103], a[156:159], v[16:19], v[100:103]
    s_mov_b32 s65, 337920
    buffer_load_dwordx4 v[80:83], v13, s[8:11], s65 offen sc1
    v_mfma_f32_16x16x32_bf16 v[104:107], a[160:163], v[16:19], v[104:107]
    v_mfma_f32_16x16x32_bf16 v[108:111], a[164:167], v[16:19], v[108:111]
    v_mfma_f32_16x16x32_bf16 v[112:115], a[168:171], v[16:19], v[112:115]
    buffer_load_dwordx4 v[84:87], v4, s[8:11], s65 offen sc1
    v_mfma_f32_16x16x32_bf16 v[116:119], a[152:155], v[20:23], v[116:119]
    v_mfma_f32_16x16x32_bf16 v[120:123], a[156:159], v[20:23], v[120:123]
    v_mfma_f32_16x16x32_bf16 v[124:127], a[160:163], v[20:23], v[124:127]
    v_mfma_f32_16x16x32_bf16 v[128:131], a[164:167], v[20:23], v[128:131]
    v_mfma_f32_16x16x32_bf16 v[132:135], a[168:171], v[20:23], v[132:135]
    buffer_load_dwordx4 v[88:91], v8, s[8:11], s65 offen sc1
    v_mfma_f32_16x16x32_bf16 v[136:139], a[152:155], v[24:27], v[136:139]
    v_mfma_f32_16x16x32_bf16 v[140:143], a[156:159], v[24:27], v[140:143]
    v_mfma_f32_16x16x32_bf16 v[144:147], a[160:163], v[24:27], v[144:147]
    v_mfma_f32_16x16x32_bf16 v[148:151], a[164:167], v[24:27], v[148:151]
    s_waitcnt vmcnt(12)
    v_max3_u32 v9, v32, v36, v40
    v_mfma_f32_16x16x32_bf16 v[152:155], a[168:171], v[24:27], v[152:155]
    buffer_load_dwordx4 v[92:95], v10, s[8:11], s65 offen sc1
    v_cmp_u_f32 vcc, v9, v44
    v_mfma_f32_16x16x32_bf16 v[156:159], a[152:155], v[28:31], v[156:159]
    v_mfma_f32_16x16x32_bf16 v[160:163], a[156:159], v[28:31], v[160:163]
    s_cbranch_vccnz m1_q8_again
m1_q8_ok:
    v_mfma_f32_16x16x32_bf16 v[164:167], a[160:163], v[28:31], v[164:167]
    s_mov_b32 s65, 1284096
    buffer_load_dwordx4 v[180:183], v4, s[8:11], s65 offen sc1
    v_mfma_f32_16x16x32_bf16 v[168:171], a[164:167], v[28:31], v[168:171]
    v_mfma_f32_16x16x32_bf16 v[172:175], a[168:171], v[28:31], v[172:175]
    v_mfma_f32_16x16x32_bf16 v[96:99], a[172:175], v[32:35], v[96:99]
    v_mfma_f32_16x16x32_bf16 v[100:103], a[176:179], v[32:35], v[100:103]
    v_mfma_f32_16x16x32_bf16 v[104:107], a[180:183], v[32:35], v[104:107]
    s_mov_b32 s64, 0
    buffer_load_dwordx2 v[208:209], v200, s[32:35], s64 offen sc1
    v_mfma_f32_16x16x32_bf16 v[108:111], a[184:187], v[32:35], v[108:111]
    v_mfma_f32_16x16x32_bf16 v[112:115], a[188:191], v[32:35], v[112:115]
    v_mfma_f32_16x16x32_bf16 v[116:119], a[172:175], v[36:39], v[116:119]
    v_mfma_f32_16x16x32_bf16 v[120:123], a[176:179], v[36:39], v[120:123]
    s_mov_b32 s64, 66560
    buffer_load_dwordx2 v[210:211], v200, s[32:35], s64 offen sc1
    v_mfma_f32_16x16x32_bf16 v[124:127], a[180:183], v[36:39], v[124:127]
    v_mfma_f32_16x16x32_bf16 v[128:131], a[184:187], v[36:39], v[128:131]
    v_mfma_f32_16x16x32_bf16 v[132:135], a[188:191], v[36:39], v[132:135]
    v_mfma_f32_16x16x32_bf16 v[136:139], a[172:175], v[40:43], v[136:139]
    s_mov_b32 s65, 405504
    buffer_load_dwordx4 v[20:23], v4, s[8:11], s65 offen sc1
    v_mfma_f32_16x16x32_bf16 v[140:143], a[176:179], v[40:43], v[140:143]
    v_mfma_f32_16x16x32_bf16 v[144:147], a[180:183], v[40:43], v[144:147]
    v_mfma_f32_16x16x32_bf16 v[148:151], a[184:187], v[40:43], v[148:151]
    s_waitcnt vmcnt(13)
    v_max3_u32 v9, v48, v52, v56
    v_mfma_f32_16x16x32_bf16 v[152:155], a[188:191], v[40:43], v[152:155]
    v_cmp_u_f32 vcc, v9, v60
    v_mfma_f32_16x16x32_bf16 v[156:159], a[172:175], v[44:47], v[156:159]
    s_mov_b32 s65, 1351680
    buffer_load_dwordx4 v[36:39], v4, s[8:11], s65 offen sc1
    v_mfma_f32_16x16x32_bf16 v[160:163], a[176:179], v[44:47], v[160:163]
    s_cbranch_vccnz m1_q9_again
m1_q9_ok:
    v_mfma_f32_16x16x32_bf16 v[164:167], a[180:183], v[44:47], v[164:167]
    s_mov_b32 s64, 133120
    buffer_load_dwordx2 v[212:213], v200, s[32:35], s64 offen sc1
    v_mfma_f32_16x16x32_bf16 v[168:171], a[184:187], v[44:47], v[168:171]
    v_mfma_f32_16x16x32_bf16 v[172:175], a[188:191], v[44:47], v[172:175]
    v_mfma_f32_16x16x32_bf16 v[96:99], a[192:195], v[48:51], v[96:99]
    v_mfma_f32_16x16x32_bf16 v[100:103], a[196:199], v[48:51], v[100:103]
    s_mov_b32 s64, 199680
    buffer_load_dwordx2 v[214:215], v200, s[32:35], s64 offen sc1
    v_mfma_f32_16x16x32_bf16 v[104:107], a[200:203], v[48:51], v[104:107]
    v_mfma_f32_16x16x32_bf16 v[108:111], a[204:207], v[48:51], v[108:111]
    v_mfma_f32_16x16x32_bf16 v[112:115], a[208:211], v[48:51], v[112:115]
    v_mfma_f32_16x16x32_bf16 v[116:119], a[192:195], v[52:55], v[116:119]
    s_mov_b32 s64, 266240
    buffer_load_dwordx2 v[216:217], v200, s[32:35], s64 offen sc1
    v_mfma_f32_16x16x32_bf16 v[120:123], a[196:199], v[52:55], v[120:123]
    v_mfma_f32_16x16x32_bf16 v[124:127], a[200:203], v[52:55], v[124:127]
    v_mfma_f32_16x16x32_bf16 v[128:131], a[204:207], v[52:55], v[128:131]
    v_mfma_f32_16x16x32_bf16 v[132:135], a[208:211], v[52:55], v[132:135]
    s_mov_b32 s65, 1284096
    buffer_load_dwordx4 v[184:187], v8, s[8:11], s65 offen sc1
    v_mfma_f32_16x16x32_bf16 v[136:139], a[192:195], v[56:59], v[136:139]
    v_mfma_f32_16x16x32_bf16 v[140:143], a[196:199], v[56:59], v[140:143]
    v_mfma_f32_16x16x32_bf16 v[144:147], a[200:203], v[56:59], v[144:147]
    v_mfma_f32_16x16x32_bf16 v[148:151], a[204:207], v[56:59], v[148:151]
    s_waitcnt vmcnt(13)
    v_max3_u32 v9, v64, v68, v72
    v_mfma_f32_16x16x32_bf16 v[152:155], a[208:211], v[56:59], v[152:155]
    s_mov_b32 s65, 405504
    v_cmp_u_f32 vcc, v9, v76
    v_mfma_f32_16x16x32_bf16 v[156:159], a[192:195], v[60:63], v[156:159]
    buffer_load_dwordx4 v[24:27], v8, s[8:11], s65 offen sc1
    v_mfma_f32_16x16x32_bf16 v[160:163], a[196:199], v[60:63], v[160:163]
    s_cbranch_vccnz m1_q10_again
m1_q10_ok:
    v_mfma_f32_16x16x32_bf16 v[164:167], a[200:203], v[60:63], v[164:167]
    v_mfma_f32_16x16x32_bf16 v[168:171], a[204:207], v[60:63], v[168:171]
    s_mov_b32 s65, 1351680
    buffer_load_dwordx4 v[40:43], v8, s[8:11], s65 offen sc1
    v_mfma_f32_16x16x32_bf16 v[172:175], a[208:211], v[60:63], v[172:175]
    v_mfma_f32_16x16x32_bf16 v[96:99], a[212:215], v[64:67], v[96:99]
    v_mfma_f32_16x16x32_bf16 v[100:103], a[216:219], v[64:67], v[100:103]
    v_mfma_f32_16x16x32_bf16 v[104:107], a[220:223], v[64:67], v[104:107]
    s_mov_b32 s65, 1284096
    buffer_load_dwordx4 v[188:191], v10, s[8:11], s65 offen sc1
    v_mfma_f32_16x16x32_bf16 v[108:111], a[224:227], v[64:67], v[108:111]
    v_mfma_f32_16x16x32_bf16 v[112:115], a[228:231], v[64:67], v[112:115]
    v_mfma_f32_16x16x32_bf16 v[116:119], a[212:215], v[68:71], v[116:119]
    v_mfma_f32_16x16x32_bf16 v[120:123], a[216:219], v[68:71], v[120:123]
    v_mfma_f32_16x16x32_bf16 v[124:127], a[220:223], v[68:71], v[124:127]
    s_mov_b32 s65, 405504
    buffer_load_dwordx4 v[28:31], v10, s[8:11], s65 offen sc1
    v_mfma_f32_16x16x32_bf16 v[128:131], a[224:227], v[68:71], v[128:131]
    v_mfma_f32_16x16x32_bf16 v[132:135], a[228:231], v[68:71], v[132:135]
    s_mov_b32 s65, 1351680
    buffer_load_dwordx4 v[44:47], v10, s[8:11], s65 offen sc1
    v_mfma_f32_16x16x32_bf16 v[136:139], a[212:215], v[72:75], v[136:139]
    v_mfma_f32_16x16x32_bf16 v[140:143], a[216:219], v[72:75], v[140:143]
    v_mfma_f32_16x16x32_bf16 v[144:147], a[220:223], v[72:75], v[144:147]
    v_mfma_f32_16x16x32_bf16 v[148:151], a[224:227], v[72:75], v[148:151]
    s_waitcnt vmcnt(14)
    v_max3_u32 v9, v80, v84, v88
    v_mfma_f32_16x16x32_bf16 v[152:155], a[228:231], v[72:75], v[152:155]
    s_mov_b32 s65, 1284096
    v_cmp_u_f32 vcc, v9, v92
    v_mfma_f32_16x16x32_bf16 v[156:159], a[212:215], v[76:79], v[156:159]
    buffer_load_dwordx4 v[176:179], v13, s[8:11], s65 offen sc1
    v_mfma_f32_16x16x32_bf16 v[160:163], a[216:219], v[76:79], v[160:163]
    s_cbranch_vccnz m1_q11_again
m1_q11_ok:
    v_mfma_f32_16x16x32_bf16 v[164:167], a[220:223], v[76:79], v[164:167]
    v_mfma_f32_16x16x32_bf16 v[168:171], a[224:227], v[76:79], v[168:171]
    s_mov_b32 s65, 405504
    buffer_load_dwordx4 v[16:19], v13, s[8:11], s65 offen sc1
    v_mfma_f32_16x16x32_bf16 v[172:175], a[228:231], v[76:79], v[172:175]
    v_mfma_f32_16x16x32_bf16 v[96:99], a[232:235], v[80:83], v[96:99]
    v_mfma_f32_16x16x32_bf16 v[100:103], a[236:239], v[80:83], v[100:103]
    v_mfma_f32_16x16x32_bf16 v[104:107], a[240:243], v[80:83], v[104:107]
    s_mov_b32 s65, 1351680
    buffer_load_dwordx4 v[32:35], v13, s[8:11], s65 offen sc1
    v_mfma_f32_16x16x32_bf16 v[108:111], a[244:247], v[80:83], v[108:111]
    v_mfma_f32_16x16x32_bf16 v[112:115], a[248:251], v[80:83], v[112:115]
    v_mfma_f32_16x16x32_bf16 v[116:119], a[232:235], v[84:87], v[116:119]
    v_mfma_f32_16x16x32_bf16 v[120:123], a[236:239], v[84:87], v[120:123]
    v_mfma_f32_16x16x32_bf16 v[124:127], a[240:243], v[84:87], v[124:127]
    v_mfma_f32_16x16x32_bf16 v[128:131], a[244:247], v[84:87], v[128:131]
    v_mfma_f32_16x16x32_bf16 v[132:135], a[248:251], v[84:87], v[132:135]
    v_mfma_f32_16x16x32_bf16 v[136:139], a[232:235], v[88:91], v[136:139]
    v_mfma_f32_16x16x32_bf16 v[140:143], a[236:239], v[88:91], v[140:143]
    v_mfma_f32_16x16x32_bf16 v[144:147], a[240:243], v[88:91], v[144:147]
    v_mfma_f32_16x16x32_bf16 v[148:151], a[244:247], v[88:91], v[148:151]
    s_waitcnt vmcnt(12)
    v_or_b32 v36, v36, v203
    v_mfma_f32_16x16x32_bf16 v[152:155], a[248:251], v[88:91], v[152:155]
    v_max_u32 v9, v180, v20
    v_cmp_u_f32 vcc, v9, v36
    v_mfma_f32_16x16x32_bf16 v[156:159], a[232:235], v[92:95], v[156:159]
    v_mfma_f32_16x16x32_bf16 v[160:163], a[236:239], v[92:95], v[160:163]
    s_cbranch_vccnz m1_q12_again
m1_q12_ok:
    v_mfma_f32_16x16x32_bf16 v[164:167], a[240:243], v[92:95], v[164:167]
    v_mfma_f32_16x16x32_bf16 v[168:171], a[244:247], v[92:95], v[168:171]
    v_mfma_f32_16x16x32_bf16 v[172:175], a[248:251], v[92:95], v[172:175]
    v_mfma_f32_16x16x32_bf16 v[116:119], a[0:3], v[180:183], v[116:119]
    s_waitcnt vmcnt(9)
    v_lshlrev_b32 v218, 16, v208
    v_mfma_f32_16x16x32_bf16 v[120:123], a[4:7], v[180:183], v[120:123]
    v_and_b32 v219, s69, v208
    v_fmac_f32 v96, s68, v218
    v_mfma_f32_16x16x32_bf16 v[124:127], a[8:11], v[180:183], v[124:127]
    v_fmac_f32 v97, s68, v219
    v_lshlrev_b32 v220, 16, v209
    v_mfma_f32_16x16x32_bf16 v[128:131], a[12:15], v[180:183], v[128:131]
    v_and_b32 v221, s69, v209
    v_fmac_f32 v98, s68, v220
    v_mfma_f32_16x16x32_bf16 v[132:135], a[16:19], v[180:183], v[132:135]
    v_fmac_f32 v99, s68, v221
    v_lshlrev_b32 v218, 16, v210
    v_mfma_f32_16x16x32_bf16 v[116:119], a[32:35], v[20:23], v[116:119]
    v_and_b32 v219, s69, v210
    v_fmac_f32 v100, s68, v218
    v_mfma_f32_16x16x32_bf16 v[120:123], a[36:39], v[20:23], v[120:123]
    v_fmac_f32 v101, s68, v219
    v_lshlrev_b32 v220, 16, v211
    v_mfma_f32_16x16x32_bf16 v[124:127], a[40:43], v[20:23], v[124:127]
    v_and_b32 v221, s69, v211
    v_fmac_f32 v102, s68, v220
    v_mfma_f32_16x16x32_bf16 v[128:131], a[44:47], v[20:23], v[128:131]
    s_waitcnt vmcnt(6)
    v_or_b32 v40, v40, v203
    v_mfma_f32_16x16x32_bf16 v[132:135], a[48:51], v[20:23], v[132:135]
    v_max_u32 v9, v184, v24
    v_cmp_u_f32 vcc, v9, v40
    v_mfma_f32_16x16x32_bf16 v[116:119], a[52:55], v[36:39], v[116:119]
    v_fmac_f32 v103, s68, v221
    v_lshlrev_b32 v218, 16, v212
    v_mfma_f32_16x16x32_bf16 v[120:123], a[56:59], v[36:39], v[120:123]
    s_cbranch_vccnz m1_q13_again
m1_q13_ok:
    v_mfma_f32_16x16x32_bf16 v[124:127], a[60:63], v[36:39], v[124:127]
    v_and_b32 v219, s69, v212
    v_fmac_f32 v104, s68, v218
    v_mfma_f32_16x16x32_bf16 v[128:131], a[64:67], v[36:39], v[128:131]
    v_fmac_f32 v105, s68, v219
    v_lshlrev_b32 v220, 16, v213
    v_mfma_f32_16x16x32_bf16 v[132:135], a[68:71], v[36:39], v[132:135]
    v_and_b32 v221, s69, v213
    v_fmac_f32 v106, s68, v220
    v_mfma_f32_16x16x32_bf16 v[136:139], a[0:3], v[184:187], v[136:139]
    ds_write_b128 v5, v[116:119] offset:0
    v_fmac_f32 v107, s68, v221
    v_mfma_f32_16x16x32_bf16 v[140:143], a[4:7], v[184:187], v[140:143]
    v_lshlrev_b32 v218, 16, v214
    v_and_b32 v219, s69, v214
    v_mfma_f32_16x16x32_bf16 v[144:147], a[8:11], v[184:187], v[144:147]
    ds_write_b128 v5, v[120:123] offset:1024
    v_fmac_f32 v108, s68, v218
    v_mfma_f32_16x16x32_bf16 v[148:151], a[12:15], v[184:187], v[148:151]
    v_fmac_f32 v109, s68, v219
    v_lshlrev_b32 v220, 16, v215
    v_mfma_f32_16x16x32_bf16 v[152:155], a[16:19], v[184:187], v[152:155]
    v_and_b32 v221, s69, v215
    v_fmac_f32 v110, s68, v220
    v_mfma_f32_16x16x32_bf16 v[136:139], a[32:35], v[24:27], v[136:139]
    ds_write_b128 v5, v[124:127] offset:2048
    v_fmac_f32 v111, s68, v221
    v_mfma_f32_16x16x32_bf16 v[140:143], a[36:39], v[24:27], v[140:143]
    v_lshlrev_b32 v218, 16, v216
    v_and_b32 v219, s69, v216
    v_mfma_f32_16x16x32_bf16 v[144:147], a[40:43], v[24:27], v[144:147]
    v_fmac_f32 v112, s68, v218
    v_fmac_f32 v113, s68, v219
    v_mfma_f32_16x16x32_bf16 v[148:151], a[44:47], v[24:27], v[148:151]
    s_waitcnt vmcnt(3)
    v_or_b32 v44, v44, v203
    v_mfma_f32_16x16x32_bf16 v[152:155], a[48:51], v[24:27], v[152:155]
    v_max_u32 v9, v188, v28
    v_cmp_u_f32 vcc, v9, v44
    v_mfma_f32_16x16x32_bf16 v[136:139], a[52:55], v[40:43], v[136:139]
    ds_write_b128 v5, v[128:131] offset:3072
    v_lshlrev_b32 v220, 16, v217
    v_mfma_f32_16x16x32_bf16 v[140:143], a[56:59], v[40:43], v[140:143]
    s_cbranch_vccnz m1_q14_again
m1_q14_ok:
    v_mfma_f32_16x16x32_bf16 v[144:147], a[60:63], v[40:43], v[144:147]
    ds_write_b128 v5, v[132:135] offset:4096
    v_and_b32 v221, s69, v217
    v_mfma_f32_16x16x32_bf16 v[148:151], a[64:67], v[40:43], v[148:151]
    v_fmac_f32 v114, s68, v220
    v_fmac_f32 v115, s68, v221
    v_mfma_f32_16x16x32_bf16 v[152:155], a[68:71], v[40:43], v[152:155]
    v_mfma_f32_16x16x32_bf16 v[156:159], a[0:3], v[188:191], v[156:159]
    ds_write_b128 v6, v[136:139] offset:0
    v_mfma_f32_16x16x32_bf16 v[160:163], a[4:7], v[188:191], v[160:163]
    v_mfma_f32_16x16x32_bf16 v[164:167], a[8:11], v[188:191], v[164:167]
    ds_write_b128 v6, v[140:143] offset:1024
    v_mfma_f32_16x16x32_bf16 v[168:171], a[12:15], v[188:191], v[168:171]
    v_mfma_f32_16x16x32_bf16 v[172:175], a[16:19], v[188:191], v[172:175]
    v_mfma_f32_16x16x32_bf16 v[156:159], a[32:35], v[28:31], v[156:159]
    ds_write_b128 v6, v[144:147] offset:2048
    v_mfma_f32_16x16x32_bf16 v[160:163], a[36:39], v[28:31], v[160:163]
    v_mfma_f32_16x16x32_bf16 v[164:167], a[40:43], v[28:31], v[164:167]
    v_mfma_f32_16x16x32_bf16 v[168:171], a[44:47], v[28:31], v[168:171]
    s_waitcnt vmcnt(0)
    v_or_b32 v32, v32, v203
    v_mfma_f32_16x16x32_bf16 v[172:175], a[48:51], v[28:31], v[172:175]
    v_max_u32 v9, v176, v16
    v_cmp_u_f32 vcc, v9, v32
    v_mfma_f32_16x16x32_bf16 v[156:159], a[52:55], v[44:47], v[156:159]
    ds_write_b128 v6, v[148:151] offset:3072
    v_mfma_f32_16x16x32_bf16 v[160:163], a[56:59], v[44:47], v[160:163]
    s_cbranch_vccnz m1_q15_again
m1_q15_ok:
    v_mfma_f32_16x16x32_bf16 v[164:167], a[60:63], v[44:47], v[164:167]
    ds_write_b128 v6, v[152:155] offset:4096
    v_mfma_f32_16x16x32_bf16 v[168:171], a[64:67], v[44:47], v[168:171]
    v_mfma_f32_16x16x32_bf16 v[172:175], a[68:71], v[44:47], v[172:175]
    s_waitcnt lgkmcnt(0)
    s_barrier
    v_mfma_f32_16x16x32_bf16 v[96:99], a[0:3], v[176:179], v[96:99]
    ds_write_b128 v7, v[156:159] offset:0
    v_mfma_f32_16x16x32_bf16 v[100:103], a[4:7], v[176:179], v[100:103]
    v_mfma_f32_16x16x32_bf16 v[104:107], a[8:11], v[176:179], v[104:107]
    ds_write_b128 v7, v[160:163] offset:1024
    v_mfma_f32_16x16x32_bf16 v[108:111], a[12:15], v[176:179], v[108:111]
    v_mfma_f32_16x16x32_bf16 v[112:115], a[16:19], v[176:179], v[112:115]
    v_mfma_f32_16x16x32_bf16 v[96:99], a[32:35], v[16:19], v[96:99]
    ds_write_b128 v7, v[164:167] offset:2048
    v_mfma_f32_16x16x32_bf16 v[100:103], a[36:39], v[16:19], v[100:103]
    v_mfma_f32_16x16x32_bf16 v[104:107], a[40:43], v[16:19], v[104:107]
    v_mfma_f32_16x16x32_bf16 v[108:111], a[44:47], v[16:19], v[108:111]
    ds_write_b128 v7, v[168:171] offset:3072
    v_mfma_f32_16x16x32_bf16 v[112:115], a[48:51], v[16:19], v[112:115]
    v_mfma_f32_16x16x32_bf16 v[96:99], a[52:55], v[32:35], v[96:99]
    v_mfma_f32_16x16x32_bf16 v[100:103], a[56:59], v[32:35], v[100:103]
    ds_write_b128 v7, v[172:175] offset:4096
    ds_read_b128 v[116:119], v204 offset:0
    v_mfma_f32_16x16x32_bf16 v[104:107], a[60:63], v[32:35], v[104:107]
    ds_read_b128 v[120:123], v204 offset:1024
    ds_read_b128 v[124:127], v204 offset:2048
    v_mfma_f32_16x16x32_bf16 v[108:111], a[64:67], v[32:35], v[108:111]
    ds_read_b128 v[128:131], v204 offset:3072
    ds_read_b128 v[132:135], v204 offset:4096
    v_mfma_f32_16x16x32_bf16 v[112:115], a[68:71], v[32:35], v[112:115]
    ds_read_b128 v[136:139], v204 offset:5120
    ds_read_b128 v[140:143], v204 offset:6144
    ds_read_b128 v[144:147], v204 offset:7168
    ds_read_b128 v[148:151], v204 offset:8192
    ds_read_b128 v[152:155], v204 offset:9216
    s_waitcnt lgkmcnt(0)
    s_barrier
    ds_read_b128 v[156:159], v204 offset:10240
    ds_read_b128 v[160:163], v204 offset:11264
    ds_read_b128 v[164:167], v204 offset:12288
    ds_read_b128 v[168:171], v204 offset:13312
    ds_read_b128 v[172:175], v204 offset:14336
    s_mov_b32 s62, 32768
    buffer_store_dword v6, v248, s[12:15], s62 offen sc1
    v_pk_add_f32 v[116:117], v[116:117], v[136:137]
    v_pk_add_f32 v[118:119], v[118:119], v[138:139]
    v_pk_add_f32 v[120:121], v[120:121], v[140:141]
    v_pk_add_f32 v[122:123], v[122:123], v[142:143]
    v_pk_add_f32 v[124:125], v[124:125], v[144:145]
    v_pk_add_f32 v[126:127], v[126:127], v[146:147]
    v_pk_add_f32 v[128:129], v[128:129], v[148:149]
    v_pk_add_f32 v[130:131], v[130:131], v[150:151]
    v_pk_add_f32 v[132:133], v[132:133], v[152:153]
    v_pk_add_f32 v[134:135], v[134:135], v[154:155]
    v_pk_add_f32 v[96:97], v[96:97], v[116:117]
    v_pk_add_f32 v[98:99], v[98:99], v[118:119]
    v_pk_add_f32 v[100:101], v[100:101], v[120:121]
    v_pk_add_f32 v[102:103], v[102:103], v[122:123]
    v_pk_add_f32 v[104:105], v[104:105], v[124:125]
    v_pk_add_f32 v[106:107], v[106:107], v[126:127]
    v_pk_add_f32 v[108:109], v[108:109], v[128:129]
    v_pk_add_f32 v[110:111], v[110:111], v[130:131]
    v_pk_add_f32 v[112:113], v[112:113], v[132:133]
    v_pk_add_f32 v[114:115], v[114:115], v[134:135]
    s_waitcnt lgkmcnt(4)
    v_pk_add_f32 v[96:97], v[96:97], v[156:157]
    v_pk_add_f32 v[98:99], v[98:99], v[158:159]
    v_cvt_pk_bf16_f32 v96, v96, v97
    v_cvt_pk_bf16_f32 v97, v98, v99
    s_mov_b32 s64, 0
    buffer_store_dwordx2 v[96:97], v200, s[32:35], s64 offen sc1
    s_waitcnt lgkmcnt(3)
    v_pk_add_f32 v[100:101], v[100:101], v[160:161]
    v_pk_add_f32 v[102:103], v[102:103], v[162:163]
    v_cvt_pk_bf16_f32 v100, v100, v101
    v_cvt_pk_bf16_f32 v101, v102, v103
    s_mov_b32 s64, 66560
    buffer_store_dwordx2 v[100:101], v200, s[32:35], s64 offen sc1
    s_waitcnt lgkmcnt(2)
    v_pk_add_f32 v[104:105], v[104:105], v[164:165]
    v_pk_add_f32 v[106:107], v[106:107], v[166:167]
    v_cvt_pk_bf16_f32 v104, v104, v105
    v_cvt_pk_bf16_f32 v105, v106, v107
    s_mov_b32 s64, 133120
    buffer_store_dwordx2 v[104:105], v200, s[32:35], s64 offen sc1
    s_waitcnt lgkmcnt(1)
    v_pk_add_f32 v[108:109], v[108:109], v[168:169]
    v_pk_add_f32 v[110:111], v[110:111], v[170:171]
    v_cvt_pk_bf16_f32 v108, v108, v109
    v_cvt_pk_bf16_f32 v109, v110, v111
    s_mov_b32 s64, 199680
    buffer_store_dwordx2 v[108:109], v200, s[32:35], s64 offen sc1
    s_waitcnt lgkmcnt(0)
    v_pk_add_f32 v[112:113], v[112:113], v[172:173]
    v_pk_add_f32 v[114:115], v[114:115], v[174:175]
    v_cvt_pk_bf16_f32 v112, v112, v113
    v_cvt_pk_bf16_f32 v113, v114, v115
    s_mov_b32 s64, 266240
    buffer_store_dwordx2 v[112:113], v200, s[32:35], s64 offen sc1
    v_add_u32 v98, s101, v96
    v_add_u32 v99, s101, v97
    v_and_b32 v98, v202, v98
    v_add_u32 v102, s101, v100
    v_add_u32 v103, s101, v101
    v_add_u32 v106, s101, v104
    v_add_u32 v107, s101, v105
    v_add_u32 v110, s101, v108
    v_add_u32 v111, s101, v109
    v_add_u32 v114, s101, v112
    v_add_u32 v115, s101, v113
    v_dot2c_f32_bf16 v246, v98, v98
    v_dot2c_f32_bf16 v247, v99, v99
    v_dot2c_f32_bf16 v246, v102, v102
    v_dot2c_f32_bf16 v247, v103, v103
    v_dot2c_f32_bf16 v246, v106, v106
    v_dot2c_f32_bf16 v247, v107, v107
    v_dot2c_f32_bf16 v246, v110, v110
    v_dot2c_f32_bf16 v247, v111, v111
    v_dot2c_f32_bf16 v246, v114, v114
    v_dot2c_f32_bf16 v247, v115, v115
    s_nop 2
    v_add_f32 v246, v246, v247
    v_mov_b32 v247, v246
    s_nop 1
    v_permlane32_swap_b32 v246, v247
    v_add_f32 v246, v246, v247
    v_mov_b32 v247, v246
    s_nop 1
    v_permlane16_swap_b32 v246, v247
    v_add_f32 v246, v246, v247
    v_cndmask_b32_e64 v246, 1.0, v246, s[4:5]
    buffer_atomic_add_f32 v246, v201, s[36:39], 0 offen sc1
    s_cmp_ge_u32 s57, 160
    s_cbranch_scc1 idle1
    s_mul_i32 s59, s56, 3072
    v_lshlrev_b32 v6, 4, v0
    v_add_u32 v4, s59, v6
    s_mul_i32 s63, s57, 16640
    s_add_u32 s40, s28, 9641984
    s_addc_u32 s41, s29, 0
    s_and_b32 s41, s41, 0xffff
    s_mov_b32 s42, 2662400
    s_mov_b32 s43, 0x20000
    s_mul_i32 s58, s57, 256
    s_sub_u32 s40, s40, s58
    s_subb_u32 s41, s41, 0
    buffer_load_dwordx4 v[40:43], v4, s[40:43], s63 offen offset:0 sc1
    buffer_load_dwordx4 v[44:47], v4, s[40:43], s63 offen offset:1024 sc1
    buffer_load_dwordx4 v[48:51], v4, s[40:43], s63 offen offset:2048 sc1
    buffer_load_dwordx4 v[52:55], v4, s[40:43], s63 offen offset:3072 sc1
    s_mul_i32 s62, s56, 10240
    s_add_u32 m0, s62, 20480
    v_lshlrev_b32 v10, 4, v3
    s_mul_i32 s58, s19, 20480
    s_add_u32 s58, s58, 12288
    s_add_u32 s48, s28, s58
    s_addc_u32 s49, s29, 0
    s_and_b32 s49, s49, 0xffff
    s_mov_b32 s50, 163840
    s_cmp_lg_u32 s26, 0
    s_cselect_b32 s50, 143360, s50
    s_mov_b32 s51, 0x20000
    v_lshrrev_b32 v11, 1, v2
    v_and_b32 v12, 1, v2
    v_mul_u32_u24 v11, 33792, v11
    v_lshl_add_u32 v11, v1, 5, v11
    v_lshl_add_u32 v11, v12, 4, v11
    s_mul_i32 s58, s19, 67584
    s_lshl4_add_u32 s58, s98, s58
    s_lshl_b32 s59, s56, 9
    s_add_u32 s58, s58, s59
    v_add_u32 v11, s58, v11
    s_add_u32 s52, s52, 2326528
    s_addc_u32 s53, s53, 0
    s_lshl_b32 s58, s3, 7
    s_add_u32 s58, s58, 229376
    v_lshl_add_u32 v13, v0, 20, s58
    s_barrier
    s_mul_i32 s64, s56, 27
    v_min_u32 v14, 27, v3
    v_add_u32 v14, s64, v14
    v_sub_u32 v14, 252, v14
    v_lshlrev_b32 v14, 7, v14
    s_mov_b32 s64, 262148
    buffer_load_dword v14, v14, s[12:15], s64 offen sc1
    buffer_load_dwordx4 v10, s[48:51], m0 offen offset:0 lds
    buffer_load_dwordx4 v10, s[48:51], m0 offen offset:1024 lds
    buffer_load_dwordx4 v10, s[48:51], m0 offen offset:2048 lds
    v_xor_b32 v7, 1024, v6
    v_xor_b32 v8, 2048, v6
    v_xor_b32 v9, 3072, v6
    v_and_b32 v176, 1, v1
    v_mul_u32_u24 v176, 0x8000, v176
    v_lshl_or_b32 v176, v176, 16, v176
    v_cvt_f32_u32 v177, v1
    v_lshlrev_b32 v178, 2, v2
    v_cvt_f32_u32 v178, v178
    v_mul_f32 v179, 0x3d000000, v177
    v_mul_f32 v200, v178, v179
    v_fmamk_f32 v203, v179, 0x3f800000, v200
    v_fmamk_f32 v206, v179, 0x40000000, v200
    v_fmamk_f32 v209, v179, 0x40400000, v200
    v_cos_f32 v201, v200
    v_sin_f32 v202, v200
    v_cos_f32 v204, v203
    v_sin_f32 v205, v203
    v_cos_f32 v207, v206
    v_sin_f32 v208, v206
    v_cos_f32 v210, v209
    v_sin_f32 v211, v209
    v_cvt_pk_bf16_f32 v56, v201, v202
    v_cvt_pk_bf16_f32 v60, -v202, v201
    v_cvt_pk_bf16_f32 v72, v201, v202
    v_cvt_pk_bf16_f32 v76, -v202, v201
    v_cvt_pk_bf16_f32 v57, v204, v205
    v_cvt_pk_bf16_f32 v61, -v205, v204
    v_cvt_pk_bf16_f32 v73, -v204, -v205
    v_cvt_pk_bf16_f32 v77, v205, -v204
    v_cvt_pk_bf16_f32 v58, v207, v208
    v_cvt_pk_bf16_f32 v62, -v208, v207
    v_cvt_pk_bf16_f32 v74, v207, v208
    v_cvt_pk_bf16_f32 v78, -v208, v207
    v_cvt_pk_bf16_f32 v59, v210, v211
    v_cvt_pk_bf16_f32 v63, -v211, v210
    v_cvt_pk_bf16_f32 v75, -v210, -v211
    v_cvt_pk_bf16_f32 v79, v211, -v210
    v_xor_b32 v64, v176, v56
    v_xor_b32 v65, v176, v57
    v_xor_b32 v66, v176, v58
    v_xor_b32 v67, v176, v59
    v_xor_b32 v68, v176, v60
    v_xor_b32 v69, v176, v61
    v_xor_b32 v70, v176, v62
    v_xor_b32 v71, v176, v63
    v_xor_b32 v80, v176, v72
    v_xor_b32 v81, v176, v73
    v_xor_b32 v82, v176, v74
    v_xor_b32 v83, v176, v75
    v_xor_b32 v84, v176, v76
    v_xor_b32 v85, v176, v77
    v_xor_b32 v86, v176, v78
    v_xor_b32 v87, v176, v79
    s_lshl_b32 s66, s56, 4
    v_cvt_f32_u32 v180, s66
    v_add_f32 v224, v180, v178
    v_add_f32 v180, v180, v177
    v_mul_f32 v225, 0x3a000000, v177
    v_add_f32 v226, 0x3c000000, v225
    v_add_f32 v200, 0x0, v224
    v_add_f32 v201, 0x3f800000, v224
    v_add_f32 v202, 0x40000000, v224
    v_add_f32 v203, 0x40400000, v224
    v_mul_f32 v204, v200, v225
    v_cos_f32 v120, v204
    v_sin_f32 v124, v204
    v_mul_f32 v205, v201, v225
    v_cos_f32 v121, v205
    v_sin_f32 v125, v205
    v_mul_f32 v206, v202, v225
    v_cos_f32 v122, v206
    v_sin_f32 v126, v206
    v_mul_f32 v207, v203, v225
    v_cos_f32 v123, v207
    v_sin_f32 v127, v207
    v_mul_f32 v208, v200, v226
    v_cos_f32 v128, v208
    v_sin_f32 v132, v208
    v_mul_f32 v209, v201, v226
    v_cos_f32 v129, v209
    v_sin_f32 v133, v209
    v_mul_f32 v210, v202, v226
    v_cos_f32 v130, v210
    v_sin_f32 v134, v210
    v_mul_f32 v211, v203, v226
    v_cos_f32 v131, v211
    v_sin_f32 v135, v211
    v_mul_f32 v179, 0x3c800000, v180
    s_xor_b32 s66, s66, 16
    v_cvt_f32_u32 v224, s66
    v_add_f32 v224, v224, v178
    v_mul_f32 v212, v200, v179
    v_cos_f32 v213, v212
    v_sin_f32 v214, v212
    v_mul_f32 v215, v201, v179
    v_cos_f32 v216, v215
    v_sin_f32 v217, v215
    v_mul_f32 v218, v202, v179
    v_cos_f32 v219, v218
    v_sin_f32 v220, v218
    v_mul_f32 v221, v203, v179
    v_cos_f32 v222, v221
    v_sin_f32 v223, v221
    v_cvt_pk_bf16_f32 v88, v213, v214
    v_cvt_pk_bf16_f32 v92, -v214, v213
    v_cvt_pk_bf16_f32 v89, v216, v217
    v_cvt_pk_bf16_f32 v93, -v217, v216
    v_cvt_pk_bf16_f32 v90, v219, v220
    v_cvt_pk_bf16_f32 v94, -v220, v219
    v_cvt_pk_bf16_f32 v91, v222, v223
    v_cvt_pk_bf16_f32 v95, -v223, v222
    v_add_f32 v212, 0x0, v224
    v_mul_f32 v212, v212, v179
    v_cos_f32 v213, v212
    v_sin_f32 v214, v212
    v_add_f32 v215, 0x3f800000, v224
    v_mul_f32 v215, v215, v179
    v_cos_f32 v216, v215
    v_sin_f32 v217, v215
    v_add_f32 v218, 0x40000000, v224
    v_mul_f32 v218, v218, v179
    v_cos_f32 v219, v218
    v_sin_f32 v220, v218
    v_add_f32 v221, 0x40400000, v224
    v_mul_f32 v221, v221, v179
    v_cos_f32 v222, v221
    v_sin_f32 v223, v221
    v_cvt_pk_bf16_f32 v96, v213, v214
    v_cvt_pk_bf16_f32 v100, -v214, v213
    v_cvt_pk_bf16_f32 v97, v216, v217
    v_cvt_pk_bf16_f32 v101, -v217, v216
    v_cvt_pk_bf16_f32 v98, v219, v220
    v_cvt_pk_bf16_f32 v102, -v220, v219
    v_cvt_pk_bf16_f32 v99, v222, v223
    v_cvt_pk_bf16_f32 v103, -v223, v222
    v_xor_b32 v104, v176, v88
    v_xor_b32 v105, v176, v89
    v_xor_b32 v106, v176, v90
    v_xor_b32 v107, v176, v91
    v_xor_b32 v108, v176, v92
    v_xor_b32 v109, v176, v93
    v_xor_b32 v110, v176, v94
    v_xor_b32 v111, v176, v95
    v_xor_b32 v112, v176, v96
    v_xor_b32 v113, v176, v97
    v_xor_b32 v114, v176, v98
    v_xor_b32 v115, v176, v99
    v_xor_b32 v116, v176, v100
    v_xor_b32 v117, v176, v101
    v_xor_b32 v118, v176, v102
    v_xor_b32 v119, v176, v103
    v_lshlrev_b32 v200, 7, v0
    v_add_u32 v200, 163840, v200
c2_poll:
    buffer_load_dword v201, v200, s[12:15], 0 offen sc1
    s_add_u32 s99, s99, 1
    s_cmp_ge_u32 s99, 16384
    s_cbranch_scc1 c2_seen
    s_waitcnt vmcnt(0)
    v_cmp_eq_u32 vcc, 0, v201
    s_nop 3
    s_cbranch_vccnz c2_poll
c2_seen:
    s_waitcnt vmcnt(0)
    buffer_load_dwordx4 v[16:19], v4, s[32:35], s63 offen offset:0 sc1
    buffer_load_dwordx4 v[20:23], v4, s[32:35], s63 offen offset:1024 sc1
    buffer_load_dwordx4 v[24:27], v4, s[32:35], s63 offen offset:2048 sc1
    buffer_load_dwordx4 v[28:31], v4, s[32:35], s63 offen offset:3072 sc1
    buffer_load_dwordx3 v[152:154], v4, s[36:39], 0 offen offset:0 sc1
    buffer_load_dwordx3 v[156:158], v4, s[36:39], 0 offen offset:1024 sc1
    buffer_load_dwordx3 v[160:162], v4, s[36:39], 0 offen offset:2048 sc1
    buffer_load_dwordx3 v[164:166], v4, s[36:39], 0 offen offset:3072 sc1
    v_mul_f32 v179, 0x3a000000, v180
    v_mul_f32 v200, v178, v179
    v_fmamk_f32 v201, v179, 0x3f800000, v200
    v_fmamk_f32 v202, v179, 0x40000000, v200
    v_fmamk_f32 v203, v179, 0x40400000, v200
    v_fmamk_f32 v204, v179, 0x41800000, v200
    v_fmamk_f32 v205, v179, 0x41880000, v200
    v_fmamk_f32 v206, v179, 0x41900000, v200
    v_fmamk_f32 v207, v179, 0x41980000, v200
    v_cos_f32 v136, v200
    v_sin_f32 v140, v200
    v_cos_f32 v137, v201
    v_sin_f32 v141, v201
    v_cos_f32 v138, v202
    v_sin_f32 v142, v202
    v_cos_f32 v139, v203
    v_sin_f32 v143, v203
    v_cos_f32 v144, v204
    v_sin_f32 v148, v204
    v_cos_f32 v145, v205
    v_sin_f32 v149, v205
    v_cos_f32 v146, v206
    v_sin_f32 v150, v206
    v_cos_f32 v147, v207
    v_sin_f32 v151, v207
    s_mov_b32 s67, 0xffff0000
    s_cmp_eq_u32 s57, 0
    s_cselect_b32 s68, 0, s67
    s_mov_b32 s66, 0xba000000
    s_cselect_b32 s69, 0, s66
    s_mov_b32 s58, 0x3acccccd
    s_mov_b32 s59, 0x3a000000
    s_mov_b32 s60, 0x3c803c80
    v_mov_b32 v179, 0x3727c5ac
    s_waitcnt vmcnt(6)
    v_max3_f32 v177, |v16|, |v18|, |v20|
    s_waitcnt vmcnt(5)
    v_max3_f32 v180, |v22|, |v24|, |v26|
    s_waitcnt vmcnt(4)
    v_max3_f32 v177, v177, |v28|, |v30|
    v_max_f32 v177, v177, v180
    s_waitcnt vmcnt(1)
    v_min3_f32 v178, v154, v158, v162
    s_waitcnt vmcnt(0)
    v_min_f32 v178, v178, v166
    v_fmamk_f32 v178, v177, 0xdc000000, v178
    v_cmp_gt_f32 vcc, 0x40f00000, v178
    v_fma_f32 v32, v152, s58, v179
    v_fma_f32 v33, v153, s58, v179
    v_fma_f32 v34, v156, s58, v179
    v_fma_f32 v35, v157, s58, v179
    v_fma_f32 v36, v160, s58, v179
    v_fma_f32 v37, v161, s58, v179
    v_fma_f32 v38, v164, s58, v179
    v_fma_f32 v39, v165, s58, v179
    s_cbranch_vccnz c2_again
c2_ok:
    v_rsq_f32 v32, v32
    v_rsq_f32 v33, v33
    v_rsq_f32 v34, v34
    v_rsq_f32 v35, v35
    v_rsq_f32 v36, v36
    v_rsq_f32 v37, v37
    v_rsq_f32 v38, v38
    v_rsq_f32 v39, v39
    v_lshlrev_b32 v200, 16, v16
    v_and_b32 v201, s68, v16
    v_lshlrev_b32 v202, 16, v18
    v_and_b32 v203, s68, v18
    v_lshlrev_b32 v204, 16, v20
    v_and_b32 v205, s68, v20
    v_lshlrev_b32 v206, 16, v22
    buffer_load_dwordx4 v10, s[48:51], m0 offen offset:3072 lds
    s_add_u32 m0, m0, 4096
    v_and_b32 v207, s68, v22
    v_lshlrev_b32 v208, 16, v24
    v_and_b32 v209, s68, v24
    v_lshlrev_b32 v210, 16, v26
    v_and_b32 v211, s68, v26
    v_lshlrev_b32 v212, 16, v28
    v_and_b32 v213, s68, v28
    v_lshlrev_b32 v214, 16, v30
    v_and_b32 v215, s68, v30
    v_pk_mul_f32 v[200:201], v[200:201], v[32:33] op_sel:[0,0] op_sel_hi:[1,0]
    v_pk_mul_f32 v[202:203], v[202:203], v[32:33] op_sel:[0,1] op_sel_hi:[1,1]
    v_pk_mul_f32 v[204:205], v[204:205], v[34:35] op_sel:[0,0] op_sel_hi:[1,0]
    v_pk_mul_f32 v[206:207], v[206:207], v[34:35] op_sel:[0,1] op_sel_hi:[1,1]
    v_pk_mul_f32 v[208:209], v[208:209], v[36:37] op_sel:[0,0] op_sel_hi:[1,0]
    v_pk_mul_f32 v[210:211], v[210:211], v[36:37] op_sel:[0,1] op_sel_hi:[1,1]
    v_pk_mul_f32 v[212:213], v[212:213], v[38:39] op_sel:[0,0] op_sel_hi:[1,0]
    v_pk_mul_f32 v[214:215], v[214:215], v[38:39] op_sel:[0,1] op_sel_hi:[1,1]
    v_cvt_pk_bf16_f32 v184, v200, v201
    v_cvt_pk_bf16_f32 v185, v202, v203
    v_cvt_pk_bf16_f32 v186, v204, v205
    v_cvt_pk_bf16_f32 v187, v206, v207
    v_cvt_pk_bf16_f32 v188, v208, v209
    buffer_load_dwordx4 v10, s[48:51], m0 offen offset:0 lds
    v_cvt_pk_bf16_f32 v189, v210, v211
    v_cvt_pk_bf16_f32 v190, v212, v213
    v_cvt_pk_bf16_f32 v191, v214, v215
    v_mfma_f32_16x16x32_bf16 v[152:155], v[184:187], v[56:59], 0
    v_lshlrev_b32 v216, 16, v17
    v_and_b32 v217, s67, v17
    v_mfma_f32_16x16x32_bf16 v[156:159], v[184:187], v[60:63], 0
    v_lshlrev_b32 v218, 16, v19
    v_and_b32 v219, s67, v19
    v_mfma_f32_16x16x32_bf16 v[160:163], v[184:187], v[72:75], 0
    v_lshlrev_b32 v220, 16, v21
    v_and_b32 v221, s67, v21
    v_mfma_f32_16x16x32_bf16 v[164:167], v[184:187], v[76:79], 0
    buffer_load_dwordx4 v10, s[48:51], m0 offen offset:1024 lds
    v_lshlrev_b32 v222, 16, v23
    v_and_b32 v223, s67, v23
    v_mfma_f32_16x16x32_bf16 v[152:155], v[188:191], v[64:67], v[152:155]
    v_lshlrev_b32 v224, 16, v25
    v_and_b32 v225, s67, v25
    v_mfma_f32_16x16x32_bf16 v[156:159], v[188:191], v[68:71], v[156:159]
    v_lshlrev_b32 v226, 16, v27
    v_and_b32 v227, s67, v27
    v_mfma_f32_16x16x32_bf16 v[160:163], v[188:191], v[80:83], v[160:163]
    v_lshlrev_b32 v228, 16, v29
    v_and_b32 v229, s67, v29
    buffer_load_dwordx4 v10, s[48:51], m0 offen offset:2048 lds
    v_mfma_f32_16x16x32_bf16 v[164:167], v[188:191], v[84:87], v[164:167]
    v_lshlrev_b32 v230, 16, v31
    v_and_b32 v231, s67, v31
    v_pk_mul_f32 v[216:217], v[216:217], v[32:33] op_sel:[0,0] op_sel_hi:[1,0]
    v_pk_mul_f32 v[218:219], v[218:219], v[32:33] op_sel:[0,1] op_sel_hi:[1,1]
    v_pk_mul_f32 v[220:221], v[220:221], v[34:35] op_sel:[0,0] op_sel_hi:[1,0]
    v_pk_mul_f32 v[222:223], v[222:223], v[34:35] op_sel:[0,1] op_sel_hi:[1,1]
    v_pk_mul_f32 v[224:225], v[224:225], v[36:37] op_sel:[0,0] op_sel_hi:[1,0]
    v_pk_mul_f32 v[226:227], v[226:227], v[36:37] op_sel:[0,1] op_sel_hi:[1,1]
    v_pk_mul_f32 v[228:229], v[228:229], v[38:39] op_sel:[0,0] op_sel_hi:[1,0]
    v_pk_mul_f32 v[230:231], v[230:231], v[38:39] op_sel:[0,1] op_sel_hi:[1,1]
    v_cvt_pk_bf16_f32 v192, v216, v217
    v_cvt_pk_bf16_f32 v193, v218, v219
    v_cvt_pk_bf16_f32 v194, v220, v221
    v_cvt_pk_bf16_f32 v195, v222, v223
    v_cvt_pk_bf16_f32 v196, v224, v225
    v_cvt_pk_bf16_f32 v197, v226, v227
    v_cvt_pk_bf16_f32 v198, v228, v229
    v_cvt_pk_bf16_f32 v199, v230, v231
    v_mfma_f32_16x16x32_bf16 v[168:171], v[192:195], v[56:59], 0
    buffer_load_dwordx4 v10, s[48:51], m0 offen offset:3072 lds
    s_add_u32 m0, m0, 4096
    v_lshlrev_b32 v232, 16, v40
    v_and_b32 v236, s67, v40
    v_mfma_f32_16x16x32_bf16 v[172:175], v[192:195], v[60:63], 0
    v_lshlrev_b32 v233, 16, v42
    v_and_b32 v237, s67, v42
    v_mfma_f32_16x16x32_bf16 v[176:179], v[192:195], v[72:75], 0
    v_lshlrev_b32 v234, 16, v44
    v_and_b32 v238, s67, v44
    v_mfma_f32_16x16x32_bf16 v[180:183], v[192:195], v[76:79], 0
    v_lshlrev_b32 v235, 16, v46
    buffer_load_dwordx4 v10, s[48:51], m0 offen offset:0 lds
    v_and_b32 v239, s67, v46
    v_mfma_f32_16x16x32_bf16 v[168:171], v[196:199], v[64:67], v[168:171]
    v_lshlrev_b32 v240, 16, v48
    v_and_b32 v244, s67, v48
    v_mfma_f32_16x16x32_bf16 v[172:175], v[196:199], v[68:71], v[172:175]
    v_lshlrev_b32 v241, 16, v50
    v_and_b32 v245, s67, v50
    v_mfma_f32_16x16x32_bf16 v[176:179], v[196:199], v[80:83], v[176:179]
    v_lshlrev_b32 v242, 16, v52
    v_and_b32 v246, s67, v52
    v_mfma_f32_16x16x32_bf16 v[180:183], v[196:199], v[84:87], v[180:183]
    buffer_load_dwordx4 v10, s[48:51], m0 offen offset:1024 lds
    v_lshlrev_b32 v243, 16, v54
    v_and_b32 v247, s67, v54
    v_pk_mul_f32 v[200:201], v[152:153], v[120:121]
    v_pk_mul_f32 v[202:203], v[156:157], v[120:121]
    v_pk_mul_f32 v[204:205], v[154:155], v[122:123]
    v_pk_mul_f32 v[206:207], v[158:159], v[122:123]
    v_pk_fma_f32 v[200:201], v[156:157], v[124:125], v[200:201]
    v_pk_fma_f32 v[202:203], v[152:153], v[124:125], v[202:203] neg_lo:[1,0,0] neg_hi:[1,0,0]
    v_pk_fma_f32 v[204:205], v[158:159], v[126:127], v[204:205]
    v_pk_fma_f32 v[206:207], v[154:155], v[126:127], v[206:207] neg_lo:[1,0,0] neg_hi:[1,0,0]
    v_cvt_pk_bf16_f32 v184, v200, v202
    v_cvt_pk_bf16_f32 v185, v201, v203
    v_cvt_pk_bf16_f32 v186, v204, v206
    v_cvt_pk_bf16_f32 v187, v205, v207
    ds_write_b128 v6, v[184:187] offset:0
    v_pk_mul_f32 v[208:209], v[160:161], v[128:129]
    v_pk_mul_f32 v[210:211], v[164:165], v[128:129]
    v_pk_mul_f32 v[212:213], v[162:163], v[130:131]
    v_pk_mul_f32 v[214:215], v[166:167], v[130:131]
    v_pk_fma_f32 v[208:209], v[164:165], v[132:133], v[208:209]
    v_pk_fma_f32 v[210:211], v[160:161], v[132:133], v[210:211] neg_lo:[1,0,0] neg_hi:[1,0,0]
    v_pk_fma_f32 v[212:213], v[166:167], v[134:135], v[212:213]
    v_cmp_eq_u32 vcc, 0, v14
    s_nop 3
    s_cbranch_vccnz c2_w2
c2_w2ok:
    s_mov_b32 s64, 0
    buffer_load_dwordx4 a[32:35], v15, s[52:55], s64 offen offset:0
    v_pk_fma_f32 v[214:215], v[162:163], v[134:135], v[214:215] neg_lo:[1,0,0] neg_hi:[1,0,0]
    v_cvt_pk_bf16_f32 v188, v208, v210
    v_cvt_pk_bf16_f32 v189, v209, v211
    v_cvt_pk_bf16_f32 v190, v212, v214
    v_cvt_pk_bf16_f32 v191, v213, v215
    ds_write_b128 v6, v[188:191] offset:4096
    v_pk_mul_f32 v[216:217], v[168:169], v[120:121]
    v_pk_mul_f32 v[218:219], v[172:173], v[120:121]
    v_pk_mul_f32 v[220:221], v[170:171], v[122:123]
    v_pk_mul_f32 v[222:223], v[174:175], v[122:123]
    v_pk_fma_f32 v[216:217], v[172:173], v[124:125], v[216:217]
    v_pk_fma_f32 v[218:219], v[168:169], v[124:125], v[218:219] neg_lo:[1,0,0] neg_hi:[1,0,0]
    v_pk_fma_f32 v[220:221], v[174:175], v[126:127], v[220:221]
    v_pk_fma_f32 v[222:223], v[170:171], v[126:127], v[222:223] neg_lo:[1,0,0] neg_hi:[1,0,0]
    v_cvt_pk_bf16_f32 v192, v216, v218
    v_cvt_pk_bf16_f32 v193, v217, v219
    v_cvt_pk_bf16_f32 v194, v220, v222
    v_cvt_pk_bf16_f32 v195, v221, v223
    ds_write_b128 v6, v[192:195] offset:8192
    v_pk_mul_f32 v[224:225], v[176:177], v[128:129]
    v_pk_mul_f32 v[226:227], v[180:181], v[128:129]
    v_pk_mul_f32 v[228:229], v[178:179], v[130:131]
    v_pk_mul_f32 v[230:231], v[182:183], v[130:131]
    buffer_load_dwordx4 a[36:39], v15, s[52:55], s64 offen offset:256
    v_pk_fma_f32 v[224:225], v[180:181], v[132:133], v[224:225]
    v_pk_fma_f32 v[226:227], v[176:177], v[132:133], v[226:227] neg_lo:[1,0,0] neg_hi:[1,0,0]
    v_pk_fma_f32 v[228:229], v[182:183], v[134:135], v[228:229]
    v_pk_fma_f32 v[230:231], v[178:179], v[134:135], v[230:231] neg_lo:[1,0,0] neg_hi:[1,0,0]
    v_cvt_pk_bf16_f32 v196, v224, v226
    v_cvt_pk_bf16_f32 v197, v225, v227
    v_cvt_pk_bf16_f32 v198, v228, v230
    v_cvt_pk_bf16_f32 v199, v229, v231
    ds_write_b128 v6, v[196:199] offset:12288
    s_waitcnt lgkmcnt(0)
    s_barrier
    ds_read_b128 v[200:203], v7 offset:0
    ds_read_b128 v[204:207], v7 offset:4096
    ds_read_b128 v[208:211], v8 offset:0
    ds_read_b128 v[212:215], v8 offset:4096
    ds_read_b128 v[216:219], v9 offset:0
    ds_read_b128 v[220:223], v9 offset:4096
    ds_read_b128 v[224:227], v7 offset:8192
    ds_read_b128 v[228:231], v7 offset:12288
    ds_read_b128 v[32:35], v8 offset:8192
    ds_read_b128 v[36:39], v8 offset:12288
    ds_read_b128 v[248:251], v9 offset:8192
    buffer_load_dwordx4 a[40:43], v15, s[52:55], s64 offen offset:512
    ds_read_b128 v[252:255], v9 offset:12288
    v_mfma_f32_16x16x32_bf16 v[152:155], v[88:91], v[184:187], 0
    v_lshlrev_b32 v120, 16, v41
    v_and_b32 v124, s67, v41
    v_mfma_f32_16x16x32_bf16 v[156:159], v[92:95], v[184:187], 0
    v_lshlrev_b32 v121, 16, v43
    v_and_b32 v125, s67, v43
    v_mfma_f32_16x16x32_bf16 v[160:163], v[88:91], v[188:191], 0
    v_lshlrev_b32 v122, 16, v45
    v_and_b32 v126, s67, v45
    v_mfma_f32_16x16x32_bf16 v[164:167], v[92:95], v[188:191], 0
    buffer_load_dwordx4 a[44:47], v15, s[52:55], s64 offen offset:768
    v_lshlrev_b32 v123, 16, v47
    v_and_b32 v127, s67, v47
    v_mfma_f32_16x16x32_bf16 v[168:171], v[88:91], v[192:195], 0
    v_lshlrev_b32 v128, 16, v49
    v_and_b32 v132, s67, v49
    v_mfma_f32_16x16x32_bf16 v[172:175], v[92:95], v[192:195], 0
    v_lshlrev_b32 v129, 16, v51
    v_and_b32 v133, s67, v51
    v_mfma_f32_16x16x32_bf16 v[176:179], v[88:91], v[196:199], 0
    v_lshlrev_b32 v130, 16, v53
    v_and_b32 v134, s67, v53
    v_mfma_f32_16x16x32_bf16 v[180:183], v[92:95], v[196:199], 0
    buffer_load_dwordx4 a[48:51], v15, s[52:55], s64 offen offset:1024
    v_lshlrev_b32 v131, 16, v55
    v_and_b32 v135, s67, v55
    s_waitcnt lgkmcnt(11)
    v_mfma_f32_16x16x32_bf16 v[152:155], v[96:99], v[200:203], v[152:155]
    v_mfma_f32_16x16x32_bf16 v[156:159], v[100:103], v[200:203], v[156:159]
    s_waitcnt lgkmcnt(10)
    v_mfma_f32_16x16x32_bf16 v[160:163], v[96:99], v[204:207], v[160:163]
    v_mfma_f32_16x16x32_bf16 v[164:167], v[100:103], v[204:207], v[164:167]
    s_waitcnt lgkmcnt(9)
    v_mfma_f32_16x16x32_bf16 v[152:155], v[104:107], v[208:211], v[152:155]
    s_mov_b32 s64, 286720
    buffer_load_dwordx4 a[52:55], v15, s[52:55], s64 offen offset:0
    v_mfma_f32_16x16x32_bf16 v[156:159], v[108:111], v[208:211], v[156:159]
    s_waitcnt lgkmcnt(8)
    v_mfma_f32_16x16x32_bf16 v[160:163], v[104:107], v[212:215], v[160:163]
    v_mfma_f32_16x16x32_bf16 v[164:167], v[108:111], v[212:215], v[164:167]
    s_waitcnt lgkmcnt(7)
    v_mfma_f32_16x16x32_bf16 v[152:155], v[112:115], v[216:219], v[152:155]
    v_mfma_f32_16x16x32_bf16 v[156:159], v[116:119], v[216:219], v[156:159]
    s_waitcnt lgkmcnt(6)
    v_mfma_f32_16x16x32_bf16 v[160:163], v[112:115], v[220:223], v[160:163]
    buffer_load_dwordx4 a[56:59], v15, s[52:55], s64 offen offset:256
    v_mfma_f32_16x16x32_bf16 v[164:167], v[116:119], v[220:223], v[164:167]
    s_waitcnt lgkmcnt(5)
    v_mfma_f32_16x16x32_bf16 v[168:171], v[96:99], v[224:227], v[168:171]
    v_mfma_f32_16x16x32_bf16 v[172:175], v[100:103], v[224:227], v[172:175]
    s_waitcnt lgkmcnt(4)
    v_mfma_f32_16x16x32_bf16 v[176:179], v[96:99], v[228:231], v[176:179]
    v_mfma_f32_16x16x32_bf16 v[180:183], v[100:103], v[228:231], v[180:183]
    buffer_load_dwordx4 a[60:63], v15, s[52:55], s64 offen offset:512
    s_waitcnt lgkmcnt(3)
    v_mfma_f32_16x16x32_bf16 v[168:171], v[104:107], v[32:35], v[168:171]
    v_mfma_f32_16x16x32_bf16 v[172:175], v[108:111], v[32:35], v[172:175]
    s_waitcnt lgkmcnt(2)
    v_mfma_f32_16x16x32_bf16 v[176:179], v[104:107], v[36:39], v[176:179]
    v_mfma_f32_16x16x32_bf16 v[180:183], v[108:111], v[36:39], v[180:183]
    s_waitcnt lgkmcnt(1)
    v_mfma_f32_16x16x32_bf16 v[168:171], v[112:115], v[248:251], v[168:171]
    v_mfma_f32_16x16x32_bf16 v[172:175], v[116:119], v[248:251], v[172:175]
    buffer_load_dwordx4 a[64:67], v15, s[52:55], s64 offen offset:768
    s_waitcnt lgkmcnt(0)
    v_mfma_f32_16x16x32_bf16 v[176:179], v[112:115], v[252:255], v[176:179]
    v_mfma_f32_16x16x32_bf16 v[180:183], v[116:119], v[252:255], v[180:183]
    buffer_store_dword v13, v13, s[12:15], 0 offen sc1
    v_pk_mul_f32 v[200:201], v[152:153], v[232:233]
    v_pk_mul_f32 v[202:203], v[156:157], v[232:233]
    v_pk_mul_f32 v[204:205], v[154:155], v[234:235]
    v_pk_mul_f32 v[206:207], v[158:159], v[234:235]
    v_pk_fma_f32 v[200:201], v[156:157], v[236:237], v[200:201] neg_lo:[1,0,0] neg_hi:[1,0,0]
    v_pk_fma_f32 v[202:203], v[152:153], v[236:237], v[202:203]
    v_pk_fma_f32 v[204:205], v[158:159], v[238:239], v[204:205] neg_lo:[1,0,0] neg_hi:[1,0,0]
    v_pk_fma_f32 v[206:207], v[154:155], v[238:239], v[206:207]
    v_cvt_pk_bf16_f32 v184, v200, -v202
    v_cvt_pk_bf16_f32 v185, v201, -v203
    v_cvt_pk_bf16_f32 v186, v204, -v206
    v_cvt_pk_bf16_f32 v187, v205, -v207
    s_barrier
    buffer_load_dwordx4 a[68:71], v15, s[52:55], s64 offen offset:1024
    ds_write_b128 v6, v[184:187] offset:0
    v_pk_mul_f32 v[208:209], v[160:161], v[240:241]
    v_pk_mul_f32 v[210:211], v[164:165], v[240:241]
    v_pk_mul_f32 v[212:213], v[162:163], v[242:243]
    v_pk_mul_f32 v[214:215], v[166:167], v[242:243]
    v_pk_fma_f32 v[208:209], v[164:165], v[244:245], v[208:209] neg_lo:[1,0,0] neg_hi:[1,0,0]
    v_pk_fma_f32 v[210:211], v[160:161], v[244:245], v[210:211]
    v_pk_fma_f32 v[212:213], v[166:167], v[246:247], v[212:213] neg_lo:[1,0,0] neg_hi:[1,0,0]
    v_pk_fma_f32 v[214:215], v[162:163], v[246:247], v[214:215]
    v_cvt_pk_bf16_f32 v188, v208, -v210
    v_cvt_pk_bf16_f32 v189, v209, -v211
    v_cvt_pk_bf16_f32 v190, v212, -v214
    v_cvt_pk_bf16_f32 v191, v213, -v215
    ds_write_b128 v6, v[188:191] offset:4096
    v_pk_mul_f32 v[216:217], v[168:169], v[120:121]
    v_pk_mul_f32 v[218:219], v[172:173], v[120:121]
    v_pk_mul_f32 v[220:221], v[170:171], v[122:123]
    v_pk_mul_f32 v[222:223], v[174:175], v[122:123]
    v_pk_fma_f32 v[216:217], v[172:173], v[124:125], v[216:217] neg_lo:[1,0,0] neg_hi:[1,0,0]
    v_pk_fma_f32 v[218:219], v[168:169], v[124:125], v[218:219]
    v_pk_fma_f32 v[220:221], v[174:175], v[126:127], v[220:221] neg_lo:[1,0,0] neg_hi:[1,0,0]
    v_pk_fma_f32 v[222:223], v[170:171], v[126:127], v[222:223]
    s_mov_b32 s64, 20480
    buffer_load_dwordx4 a[72:75], v15, s[52:55], s64 offen offset:0
    v_cvt_pk_bf16_f32 v192, v216, -v218
    v_cvt_pk_bf16_f32 v193, v217, -v219
    v_cvt_pk_bf16_f32 v194, v220, -v222
    v_cvt_pk_bf16_f32 v195, v221, -v223
    ds_write_b128 v6, v[192:195] offset:8192
    v_pk_mul_f32 v[224:225], v[176:177], v[128:129]
    v_pk_mul_f32 v[226:227], v[180:181], v[128:129]
    v_pk_mul_f32 v[228:229], v[178:179], v[130:131]
    v_pk_mul_f32 v[230:231], v[182:183], v[130:131]
    v_pk_fma_f32 v[224:225], v[180:181], v[132:133], v[224:225] neg_lo:[1,0,0] neg_hi:[1,0,0]
    v_pk_fma_f32 v[226:227], v[176:177], v[132:133], v[226:227]
    v_pk_fma_f32 v[228:229], v[182:183], v[134:135], v[228:229] neg_lo:[1,0,0] neg_hi:[1,0,0]
    v_pk_fma_f32 v[230:231], v[178:179], v[134:135], v[230:231]
    v_cvt_pk_bf16_f32 v196, v224, -v226
    v_cvt_pk_bf16_f32 v197, v225, -v227
    v_cvt_pk_bf16_f32 v198, v228, -v230
    v_cvt_pk_bf16_f32 v199, v229, -v231
    ds_write_b128 v6, v[196:199] offset:12288
    s_waitcnt lgkmcnt(0)
    s_barrier
    ds_read_b128 v[200:203], v7 offset:0
    ds_read_b128 v[204:207], v7 offset:4096
    ds_read_b128 v[208:211], v8 offset:0
    buffer_load_dwordx4 a[76:79], v15, s[52:55], s64 offen offset:256
    ds_read_b128 v[212:215], v8 offset:4096
    ds_read_b128 v[216:219], v9 offset:0
    ds_read_b128 v[220:223], v9 offset:4096
    ds_read_b128 v[224:227], v7 offset:8192
    ds_read_b128 v[228:231], v7 offset:12288
    ds_read_b128 v[32:35], v8 offset:8192
    ds_read_b128 v[36:39], v8 offset:12288
    ds_read_b128 v[248:251], v9 offset:8192
    ds_read_b128 v[252:255], v9 offset:12288
    v_mfma_f32_16x16x32_bf16 v[152:155], v[184:187], v[88:91], 0
    v_lshlrev_b32 v232, 16, v16
    v_and_b32 v233, s67, v16
    v_mfma_f32_16x16x32_bf16 v[156:159], v[184:187], v[92:95], 0
    v_lshlrev_b32 v234, 16, v18
    v_and_b32 v235, s67, v18
    v_mfma_f32_16x16x32_bf16 v[160:163], v[188:191], v[88:91], 0
    buffer_load_dwordx4 a[80:83], v15, s[52:55], s64 offen offset:512
    v_lshlrev_b32 v236, 16, v20
    v_and_b32 v237, s67, v20
    v_mfma_f32_16x16x32_bf16 v[164:167], v[188:191], v[92:95], 0
    v_lshlrev_b32 v238, 16, v22
    v_and_b32 v239, s67, v22
    v_mfma_f32_16x16x32_bf16 v[168:171], v[192:195], v[88:91], 0
    v_lshlrev_b32 v240, 16, v24
    v_and_b32 v241, s67, v24
    v_mfma_f32_16x16x32_bf16 v[172:175], v[192:195], v[92:95], 0
    v_lshlrev_b32 v242, 16, v26
    v_and_b32 v243, s67, v26
    buffer_load_dwordx4 a[84:87], v15, s[52:55], s64 offen offset:768
    v_mfma_f32_16x16x32_bf16 v[176:179], v[196:199], v[88:91], 0
    v_lshlrev_b32 v244, 16, v28
    v_and_b32 v245, s67, v28
    v_mfma_f32_16x16x32_bf16 v[180:183], v[196:199], v[92:95], 0
    v_lshlrev_b32 v246, 16, v30
    v_and_b32 v247, s67, v30
    s_waitcnt lgkmcnt(11)
    v_mfma_f32_16x16x32_bf16 v[152:155], v[200:203], v[96:99], v[152:155]
    v_lshlrev_b32 v120, 16, v17
    v_and_b32 v121, s67, v17
    v_mfma_f32_16x16x32_bf16 v[156:159], v[200:203], v[100:103], v[156:159]
    buffer_load_dwordx4 a[88:91], v15, s[52:55], s64 offen offset:1024
    v_lshlrev_b32 v122, 16, v19
    v_and_b32 v123, s67, v19
    s_waitcnt lgkmcnt(10)
    v_mfma_f32_16x16x32_bf16 v[160:163], v[204:207], v[96:99], v[160:163]
    v_lshlrev_b32 v124, 16, v21
    v_and_b32 v125, s67, v21
    v_mfma_f32_16x16x32_bf16 v[164:167], v[204:207], v[100:103], v[164:167]
    v_lshlrev_b32 v126, 16, v23
    v_and_b32 v127, s67, v23
    s_waitcnt lgkmcnt(9)
    v_mfma_f32_16x16x32_bf16 v[152:155], v[208:211], v[104:107], v[152:155]
    v_lshlrev_b32 v128, 16, v25
    v_and_b32 v129, s67, v25
    v_mfma_f32_16x16x32_bf16 v[156:159], v[208:211], v[108:111], v[156:159]
    s_mov_b32 s64, 307200
    buffer_load_dwordx4 a[92:95], v15, s[52:55], s64 offen offset:0
    v_lshlrev_b32 v130, 16, v27
    v_and_b32 v131, s67, v27
    s_waitcnt lgkmcnt(8)
    v_mfma_f32_16x16x32_bf16 v[160:163], v[212:215], v[104:107], v[160:163]
    v_lshlrev_b32 v132, 16, v29
    v_and_b32 v133, s67, v29
    v_mfma_f32_16x16x32_bf16 v[164:167], v[212:215], v[108:111], v[164:167]
    v_lshlrev_b32 v134, 16, v31
    v_and_b32 v135, s67, v31
    s_waitcnt lgkmcnt(7)
    v_mfma_f32_16x16x32_bf16 v[152:155], v[216:219], v[112:115], v[152:155]
    v_mfma_f32_16x16x32_bf16 v[156:159], v[216:219], v[116:119], v[156:159]
    buffer_load_dwordx4 a[96:99], v15, s[52:55], s64 offen offset:256
    s_waitcnt lgkmcnt(6)
    v_mfma_f32_16x16x32_bf16 v[160:163], v[220:223], v[112:115], v[160:163]
    v_mfma_f32_16x16x32_bf16 v[164:167], v[220:223], v[116:119], v[164:167]
    s_waitcnt lgkmcnt(5)
    v_mfma_f32_16x16x32_bf16 v[168:171], v[224:227], v[96:99], v[168:171]
    v_mfma_f32_16x16x32_bf16 v[172:175], v[224:227], v[100:103], v[172:175]
    s_waitcnt lgkmcnt(4)
    v_mfma_f32_16x16x32_bf16 v[176:179], v[228:231], v[96:99], v[176:179]
    v_mfma_f32_16x16x32_bf16 v[180:183], v[228:231], v[100:103], v[180:183]
    buffer_load_dwordx4 a[100:103], v15, s[52:55], s64 offen offset:512
    s_waitcnt lgkmcnt(3)
    v_mfma_f32_16x16x32_bf16 v[168:171], v[32:35], v[104:107], v[168:171]
    v_mfma_f32_16x16x32_bf16 v[172:175], v[32:35], v[108:111], v[172:175]
    s_waitcnt lgkmcnt(2)
    v_mfma_f32_16x16x32_bf16 v[176:179], v[36:39], v[104:107], v[176:179]
    v_mfma_f32_16x16x32_bf16 v[180:183], v[36:39], v[108:111], v[180:183]
    s_waitcnt lgkmcnt(1)
    v_mfma_f32_16x16x32_bf16 v[168:171], v[248:251], v[112:115], v[168:171]
    buffer_load_dwordx4 a[104:107], v15, s[52:55], s64 offen offset:768
    v_mfma_f32_16x16x32_bf16 v[172:175], v[248:251], v[116:119], v[172:175]
    s_waitcnt lgkmcnt(0)
    v_mfma_f32_16x16x32_bf16 v[176:179], v[252:255], v[112:115], v[176:179]
    v_mfma_f32_16x16x32_bf16 v[180:183], v[252:255], v[116:119], v[180:183]
    v_pk_mul_f32 v[200:201], v[152:153], v[136:137]
    v_pk_mul_f32 v[202:203], v[156:157], v[136:137]
    v_pk_mul_f32 v[204:205], v[154:155], v[138:139]
    v_pk_mul_f32 v[206:207], v[158:159], v[138:139]
    v_pk_fma_f32 v[200:201], v[156:157], v[140:141], v[200:201]
    v_pk_fma_f32 v[202:203], v[152:153], v[140:141], v[202:203] neg_lo:[1,0,0] neg_hi:[1,0,0]
    v_pk_fma_f32 v[204:205], v[158:159], v[142:143], v[204:205]
    v_pk_fma_f32 v[206:207], v[154:155], v[142:143], v[206:207] neg_lo:[1,0,0] neg_hi:[1,0,0]
    v_cvt_pk_bf16_f32 v184, v200, v202
    v_cvt_pk_bf16_f32 v185, v201, v203
    v_cvt_pk_bf16_f32 v186, v204, v206
    v_cvt_pk_bf16_f32 v187, v205, v207
    v_pk_mul_f32 v[208:209], v[160:161], v[144:145]
    v_pk_mul_f32 v[210:211], v[164:165], v[144:145]
    v_pk_mul_f32 v[212:213], v[162:163], v[146:147]
    v_pk_mul_f32 v[214:215], v[166:167], v[146:147]
    v_pk_fma_f32 v[208:209], v[164:165], v[148:149], v[208:209]
    v_pk_fma_f32 v[210:211], v[160:161], v[148:149], v[210:211] neg_lo:[1,0,0] neg_hi:[1,0,0]
    v_pk_fma_f32 v[212:213], v[166:167], v[150:151], v[212:213]
    v_pk_fma_f32 v[214:215], v[162:163], v[150:151], v[214:215] neg_lo:[1,0,0] neg_hi:[1,0,0]
    v_cvt_pk_bf16_f32 v188, v208, v210
    v_cvt_pk_bf16_f32 v189, v209, v211
    v_cvt_pk_bf16_f32 v190, v212, v214
    v_cvt_pk_bf16_f32 v191, v213, v215
    v_pk_mul_f32 v[216:217], v[168:169], v[136:137]
    v_pk_mul_f32 v[218:219], v[172:173], v[136:137]
    v_pk_mul_f32 v[220:221], v[170:171], v[138:139]
    v_pk_mul_f32 v[222:223], v[174:175], v[138:139]
    v_pk_fma_f32 v[216:217], v[172:173], v[140:141], v[216:217]
    v_pk_fma_f32 v[218:219], v[168:169], v[140:141], v[218:219] neg_lo:[1,0,0] neg_hi:[1,0,0]
    v_pk_fma_f32 v[220:221], v[174:175], v[142:143], v[220:221]
    v_pk_fma_f32 v[222:223], v[170:171], v[142:143], v[222:223] neg_lo:[1,0,0] neg_hi:[1,0,0]
    v_cvt_pk_bf16_f32 v192, v216, v218
    v_cvt_pk_bf16_f32 v193, v217, v219
    v_cvt_pk_bf16_f32 v194, v220, v222
    v_cvt_pk_bf16_f32 v195, v221, v223
    v_pk_mul_f32 v[224:225], v[176:177], v[144:145]
    v_pk_mul_f32 v[226:227], v[180:181], v[144:145]
    v_pk_mul_f32 v[228:229], v[178:179], v[146:147]
    v_pk_mul_f32 v[230:231], v[182:183], v[146:147]
    v_pk_fma_f32 v[224:225], v[180:181], v[148:149], v[224:225]
    v_pk_fma_f32 v[226:227], v[176:177], v[148:149], v[226:227] neg_lo:[1,0,0] neg_hi:[1,0,0]
    v_pk_fma_f32 v[228:229], v[182:183], v[150:151], v[228:229]
    v_pk_fma_f32 v[230:231], v[178:179], v[150:151], v[230:231] neg_lo:[1,0,0] neg_hi:[1,0,0]
    v_cvt_pk_bf16_f32 v196, v224, v226
    v_cvt_pk_bf16_f32 v197, v225, v227
    v_cvt_pk_bf16_f32 v198, v228, v230
    v_cvt_pk_bf16_f32 v199, v229, v231
    v_mfma_f32_16x16x32_bf16 v[152:155], v[56:59], v[184:187], 0
    v_mfma_f32_16x16x32_bf16 v[156:159], v[60:63], v[184:187], 0
    v_mfma_f32_16x16x32_bf16 v[152:155], v[64:67], v[188:191], v[152:155]
    v_mfma_f32_16x16x32_bf16 v[156:159], v[68:71], v[188:191], v[156:159]
    v_mfma_f32_16x16x32_bf16 v[168:171], v[56:59], v[192:195], 0
    v_mfma_f32_16x16x32_bf16 v[172:175], v[60:63], v[192:195], 0
    v_mfma_f32_16x16x32_bf16 v[168:171], v[64:67], v[196:199], v[168:171]
    v_mfma_f32_16x16x32_bf16 v[172:175], v[68:71], v[196:199], v[172:175]
    v_mfma_f32_16x16x32_bf16 v[160:163], v[72:75], v[184:187], 0
    v_mfma_f32_16x16x32_bf16 v[164:167], v[76:79], v[184:187], 0
    v_mfma_f32_16x16x32_bf16 v[160:163], v[80:83], v[188:191], v[160:163]
    v_fma_f32 v232, v152, s59, v232
    v_fma_f32 v233, v156, s69, v233
    v_mfma_f32_16x16x32_bf16 v[164:167], v[84:87], v[188:191], v[164:167]
    v_fma_f32 v234, v153, s59, v234
    v_fma_f32 v235, v157, s69, v235
    v_mfma_f32_16x16x32_bf16 v[176:179], v[72:75], v[192:195], 0
    v_fma_f32 v120, v168, s59, v120
    v_fma_f32 v121, v172, s66, v121
    v_mfma_f32_16x16x32_bf16 v[180:183], v[76:79], v[192:195], 0
    v_fma_f32 v122, v169, s59, v122
    v_fma_f32 v123, v173, s66, v123
    v_mfma_f32_16x16x32_bf16 v[176:179], v[80:83], v[196:199], v[176:179]
    v_cvt_pk_bf16_f32 v16, v232, v233
    v_cvt_pk_bf16_f32 v18, v234, v235
    v_mfma_f32_16x16x32_bf16 v[180:183], v[84:87], v[196:199], v[180:183]
    v_cvt_pk_bf16_f32 v17, v120, v121
    v_cvt_pk_bf16_f32 v19, v122, v123
    v_add_u32 v16, s60, v16
    v_add_u32 v17, s60, v17
    v_add_u32 v18, s60, v18
    v_add_u32 v19, s60, v19
    buffer_store_dwordx4 v[16:19], v4, s[32:35], s63 offen offset:0 sc1
    v_fma_f32 v236, v154, s59, v236
    v_fma_f32 v237, v158, s69, v237
    v_fma_f32 v238, v155, s59, v238
    v_fma_f32 v239, v159, s69, v239
    v_fma_f32 v124, v170, s59, v124
    v_fma_f32 v125, v174, s66, v125
    v_fma_f32 v126, v171, s59, v126
    v_fma_f32 v127, v175, s66, v127
    v_cvt_pk_bf16_f32 v20, v236, v237
    v_cvt_pk_bf16_f32 v22, v238, v239
    v_cvt_pk_bf16_f32 v21, v124, v125
    v_cvt_pk_bf16_f32 v23, v126, v127
    v_add_u32 v20, s60, v20
    v_add_u32 v21, s60, v21
    v_add_u32 v22, s60, v22
    v_add_u32 v23, s60, v23
    buffer_store_dwordx4 v[20:23], v4, s[32:35], s63 offen offset:1024 sc1
    v_fma_f32 v240, v160, s59, v240
    v_fma_f32 v241, v164, s69, v241
    v_fma_f32 v242, v161, s59, v242
    v_fma_f32 v243, v165, s69, v243
    v_fma_f32 v128, v176, s59, v128
    v_fma_f32 v129, v180, s66, v129
    v_fma_f32 v130, v177, s59, v130
    v_fma_f32 v131, v181, s66, v131
    v_cvt_pk_bf16_f32 v24, v240, v241
    v_cvt_pk_bf16_f32 v26, v242, v243
    v_cvt_pk_bf16_f32 v25, v128, v129
    v_cvt_pk_bf16_f32 v27, v130, v131
    v_add_u32 v24, s60, v24
    v_add_u32 v25, s60, v25
    v_add_u32 v26, s60, v26
    v_add_u32 v27, s60, v27
    buffer_store_dwordx4 v[24:27], v4, s[32:35], s63 offen offset:2048 sc1
    v_fma_f32 v244, v162, s59, v244
    v_fma_f32 v245, v166, s69, v245
    v_fma_f32 v246, v163, s59, v246
    v_fma_f32 v247, v167, s69, v247
    v_fma_f32 v132, v178, s59, v132
    v_fma_f32 v133, v182, s66, v133
    v_fma_f32 v134, v179, s59, v134
    v_fma_f32 v135, v183, s66, v135
    v_cvt_pk_bf16_f32 v28, v244, v245
    v_cvt_pk_bf16_f32 v30, v246, v247
    v_cvt_pk_bf16_f32 v29, v132, v133
    v_cvt_pk_bf16_f32 v31, v134, v135
    v_add_u32 v28, s60, v28
    v_add_u32 v29, s60, v29
    v_add_u32 v30, s60, v30
    v_add_u32 v31, s60, v31
    buffer_store_dwordx4 v[28:31], v4, s[32:35], s63 offen offset:3072 sc1
    buffer_load_dwordx4 a[108:111], v15, s[52:55], s64 offen offset:1024
    s_mov_b32 s64, 40960
    buffer_load_dwordx4 a[112:115], v15, s[52:55], s64 offen offset:0
    buffer_load_dwordx4 a[116:119], v15, s[52:55], s64 offen offset:256
    buffer_load_dwordx4 a[120:123], v15, s[52:55], s64 offen offset:512
    buffer_load_dwordx4 a[124:127], v15, s[52:55], s64 offen offset:768
    buffer_load_dwordx4 a[128:131], v15, s[52:55], s64 offen offset:1024
    s_mov_b32 s64, 327680
    buffer_load_dwordx4 a[132:135], v15, s[52:55], s64 offen offset:0
    buffer_load_dwordx4 a[136:139], v15, s[52:55], s64 offen offset:256
    buffer_load_dwordx4 a[140:143], v15, s[52:55], s64 offen offset:512
    buffer_load_dwordx4 a[144:147], v15, s[52:55], s64 offen offset:768
    buffer_load_dwordx4 a[148:151], v15, s[52:55], s64 offen offset:1024
    s_mov_b32 s64, 61440
    buffer_load_dwordx4 a[152:155], v15, s[52:55], s64 offen offset:0
    buffer_load_dwordx4 a[156:159], v15, s[52:55], s64 offen offset:256
    buffer_load_dwordx4 a[160:163], v15, s[52:55], s64 offen offset:512
    buffer_load_dwordx4 a[164:167], v15, s[52:55], s64 offen offset:768
    buffer_load_dwordx4 a[168:171], v15, s[52:55], s64 offen offset:1024
    s_mov_b32 s64, 348160
    buffer_load_dwordx4 a[172:175], v15, s[52:55], s64 offen offset:0
    buffer_load_dwordx4 a[176:179], v15, s[52:55], s64 offen offset:256
    buffer_load_dwordx4 a[180:183], v15, s[52:55], s64 offen offset:512
    buffer_load_dwordx4 a[184:187], v15, s[52:55], s64 offen offset:768
    buffer_load_dwordx4 a[188:191], v15, s[52:55], s64 offen offset:1024
join1:
    s_lshl_b32 s60, s96, 10
    s_lshl_b32 s58, s56, 8
    s_add_u32 s60, s60, s58
    v_mul_u32_u24 v4, 33280, v2
    v_lshl_add_u32 v4, v1, 4, v4
    v_add_u32 v4, s60, v4
    v_add_u32 v8, 16640, v4
    v_lshlrev_b32 v5, 4, v3
    v_add_u32 v6, 0x10000, v5
    v_add_u32 v7, 0x20000, v5
    s_mov_b64 s[44:45], s[8:9]
    s_mov_b32 s46, 7299072
    s_mov_b32 s47, 0x20000
    v_cmp_eq_u32 vcc, 0, v2
    v_mov_b32 v249, 0xffff0000
    s_nop 0
    v_cndmask_b32 v249, 0, v249, vcc
    s_mov_b32 s4, 0x100001
    s_mov_b32 s5, 0x10000100
    s_mov_b32 s6, 0x200002
    s_mov_b32 s7, 0x20000200
    s_mov_b32 s30, 0x400004
    s_mov_b32 s31, 0x40000400
    s_mov_b32 s70, 0x800008
    s_mov_b32 s71, 0x80000800
    s_bfe_u32 s58, s97, 0x10002
    s_lshl_b32 s58, s58, 6
    s_add_u32 s27, s98, s58
    s_lshl4_add_u32 s61, s56, s27
    s_mul_i32 s58, s56, 1824768
    s_add_u32 s10, s58, 1824768
    s_lshl4_add_u32 s58, s61, s58
    v_lshrrev_b32 v13, 1, v2
    v_and_b32 v9, 1, v2
    v_mad_u32_u24 v13, v13, 14, v9
    v_mul_u32_u24 v13, 33792, v13
    v_lshl_add_u32 v13, v1, 4, v13
    v_add_u32 v13, s58, v13
    v_xor_b32 v10, 0x300, v13
    s_mov_b32 s66, 0xab800000
    s_mov_b32 s67, 0xab800000
    s_mov_b32 s68, 0x33800000
    s_mov_b32 s69, 0xffff0000
    s_getpc_b64 s[48:49]
    s_add_u32 s48, s48, ft2@rel32@lo+4
    s_addc_u32 s49, s49, ft2@rel32@hi+12
    s_and_b32 s49, s49, 0xffff
    s_mov_b32 s50, 819200
    s_mov_b32 s51, 0x20000
    s_mul_i32 s59, s97, 5
    s_lshr_b32 s59, s59, 1
    s_mul_i32 s58, s59, 20480
    s_add_u32 s48, s48, s58
    s_addc_u32 s49, s49, 0
    s_sub_u32 s48, s48, 40960
    s_subb_u32 s49, s49, 0
    s_mov_b32 s50, 102400
    s_mul_i32 s58, s59, 66560
    s_add_u32 s58, s58, s60
    v_mul_u32_u24 v12, 16640, v2
    v_lshl_add_u32 v12, v1, 4, v12
    v_add_u32 v12, s58, v12
    s_add_u32 s40, s28, 19914752
    s_addc_u32 s41, s29, 0
    s_and_b32 s41, s41, 0xffff
    s_mov_b32 s42, 2662400
    s_mov_b32 s43, 0x20000
    s_mov_b32 s36, s24
    s_and_b32 s37, s25, 0xffff
    s_mov_b32 s38, 2621440
    s_mov_b32 s39, 0x20000
    s_lshl_b32 s59, s96, 13
    s_lshl2_add_u32 s58, s97, s56
    s_lshl_b32 s58, s58, 7
    s_add_u32 s58, s58, s59
    v_lshl_add_u32 v248, v3, 20, s58
    s_bfe_u32 s58, s61, 0x20005
    s_lshl3_add_u32 s58, s16, s58
    s_lshl_b32 s58, s58, 7
    s_add_u32 s58, s58, s59
    v_and_b32 v14, 1, v1
    v_lshl_add_u32 v14, v14, 9, s58
    s_waitcnt vmcnt(21)
    s_mov_b32 s65, 2529280
    buffer_load_dwordx4 v[16:19], v4, s[32:35], s65 offen sc1
    buffer_load_dwordx4 v[20:23], v8, s[32:35], s65 offen sc1
    s_mov_b32 s65, 2396160
    buffer_load_dwordx4 v[24:27], v4, s[32:35], s65 offen sc1
    buffer_load_dwordx4 v[28:31], v8, s[32:35], s65 offen sc1
    s_mov_b32 s65, 2263040
    buffer_load_dwordx4 v[32:35], v4, s[32:35], s65 offen sc1
    buffer_load_dwordx4 v[36:39], v8, s[32:35], s65 offen sc1
    s_mov_b32 s65, 2129920
    buffer_load_dwordx4 v[40:43], v4, s[32:35], s65 offen sc1
    buffer_load_dwordx4 v[44:47], v8, s[32:35], s65 offen sc1
    s_mov_b32 s65, 1996800
    buffer_load_dwordx4 v[48:51], v4, s[32:35], s65 offen sc1
    buffer_load_dwordx4 v[52:55], v8, s[32:35], s65 offen sc1
    s_barrier
    ds_read_b128 a[0:3], v5 offset:39936
    ds_read_b128 a[4:7], v5 offset:60416
    ds_read_b128 a[8:11], v6 offset:15360
    ds_read_b128 a[12:15], v6 offset:35840
    ds_read_b128 a[16:19], v5 offset:38912
    ds_read_b128 a[20:23], v5 offset:59392
    ds_read_b128 a[24:27], v6 offset:14336
    ds_read_b128 a[28:31], v6 offset:34816
    s_waitcnt vmcnt(8)
    v_min_f32_e64 v9, |v16|, |v20|
    v_cmp_gt_f32 vcc, 0x3c800000, v9
    s_cbranch_vccnz m2_x0_again
m2_x0_ok:
    v_swap_b32 v18, v20
    v_swap_b32 v19, v21
    s_nop 1
    v_mfma_f32_16x16x32_bf16 v[232:235], v[16:19], v[16:19], 0
    s_mov_b32 s65, 1863680
    buffer_load_dwordx4 v[56:59], v4, s[32:35], s65 offen sc1
    v_mfma_f32_16x16x32_bf16 v[236:239], v[20:23], v[20:23], 0
    buffer_load_dwordx4 v[60:63], v8, s[32:35], s65 offen sc1
    s_waitcnt lgkmcnt(4)
    v_mfma_f32_16x16x32_bf16 v[176:179], a[0:3], v[16:19], 0
    s_mov_b32 s65, 1730560
    buffer_load_dwordx4 v[64:67], v4, s[32:35], s65 offen sc1
    v_mfma_f32_16x16x32_bf16 v[180:183], a[0:3], v[20:23], 0
    s_waitcnt vmcnt(9)
    v_min_f32_e64 v9, |v24|, |v28|
    v_mfma_f32_16x16x32_bf16 v[184:187], a[4:7], v[16:19], 0
    ds_read_b128 a[0:3], v5 offset:37888
    v_cmp_gt_f32 vcc, 0x3c800000, v9
    v_mfma_f32_16x16x32_bf16 v[188:191], a[4:7], v[20:23], 0
    ds_read_b128 a[4:7], v5 offset:58368
    buffer_load_dwordx4 v[68:71], v8, s[32:35], s65 offen sc1
    v_mfma_f32_16x16x32_bf16 v[192:195], a[8:11], v[16:19], 0
    s_cbranch_vccnz m2_x1_again
m2_x1_ok:
    v_mfma_f32_16x16x32_bf16 v[196:199], a[8:11], v[20:23], 0
    v_swap_b32 v26, v28
    v_mfma_f32_16x16x32_bf16 v[200:203], a[12:15], v[16:19], 0
    v_swap_b32 v27, v29
    v_mfma_f32_16x16x32_bf16 v[204:207], a[12:15], v[20:23], 0
    ds_read_b128 a[8:11], v6 offset:13312
    ds_read_b128 a[12:15], v6 offset:33792
    v_mfma_f32_16x16x32_bf16 v[232:235], v[24:27], v[24:27], v[232:235]
    s_mov_b32 s65, 1597440
    buffer_load_dwordx4 v[72:75], v4, s[32:35], s65 offen sc1
    v_mfma_f32_16x16x32_bf16 v[236:239], v[28:31], v[28:31], v[236:239]
    buffer_load_dwordx4 v[76:79], v8, s[32:35], s65 offen sc1
    s_waitcnt lgkmcnt(4)
    v_mfma_f32_16x16x32_bf16 v[176:179], a[16:19], v[24:27], v[176:179]
    s_mov_b32 s65, 1464320
    buffer_load_dwordx4 v[80:83], v4, s[32:35], s65 offen sc1
    v_mfma_f32_16x16x32_bf16 v[180:183], a[16:19], v[28:31], v[180:183]
    s_waitcnt vmcnt(11)
    v_min_f32_e64 v9, |v32|, |v36|
    v_mfma_f32_16x16x32_bf16 v[184:187], a[20:23], v[24:27], v[184:187]
    ds_read_b128 a[16:19], v5 offset:36864
    v_cmp_gt_f32 vcc, 0x3c800000, v9
    v_mfma_f32_16x16x32_bf16 v[188:191], a[20:23], v[28:31], v[188:191]
    ds_read_b128 a[20:23], v5 offset:57344
    buffer_load_dwordx4 v[84:87], v8, s[32:35], s65 offen sc1
    v_mfma_f32_16x16x32_bf16 v[192:195], a[24:27], v[24:27], v[192:195]
    s_cbranch_vccnz m2_x2_again
m2_x2_ok:
    v_mfma_f32_16x16x32_bf16 v[196:199], a[24:27], v[28:31], v[196:199]
    v_swap_b32 v34, v36
    v_mfma_f32_16x16x32_bf16 v[200:203], a[28:31], v[24:27], v[200:203]
    v_swap_b32 v35, v37
    v_mfma_f32_16x16x32_bf16 v[204:207], a[28:31], v[28:31], v[204:207]
    ds_read_b128 a[24:27], v6 offset:12288
    ds_read_b128 a[28:31], v6 offset:32768
    v_mfma_f32_16x16x32_bf16 v[232:235], v[32:35], v[32:35], v[232:235]
    s_mov_b32 s65, 1331200
    buffer_load_dwordx4 v[88:91], v4, s[32:35], s65 offen sc1
    v_mfma_f32_16x16x32_bf16 v[236:239], v[36:39], v[36:39], v[236:239]
    buffer_load_dwordx4 v[92:95], v8, s[32:35], s65 offen sc1
    s_waitcnt lgkmcnt(4)
    v_mfma_f32_16x16x32_bf16 v[176:179], a[0:3], v[32:35], v[176:179]
    v_mfma_f32_16x16x32_bf16 v[180:183], a[0:3], v[36:39], v[180:183]
    s_waitcnt vmcnt(12)
    v_min_f32_e64 v9, |v40|, |v44|
    v_mfma_f32_16x16x32_bf16 v[184:187], a[4:7], v[32:35], v[184:187]
    ds_read_b128 a[0:3], v5 offset:35840
    v_cmp_gt_f32 vcc, 0x3c800000, v9
    v_mfma_f32_16x16x32_bf16 v[188:191], a[4:7], v[36:39], v[188:191]
    ds_read_b128 a[4:7], v5 offset:56320
    s_mov_b32 s65, 1198080
    v_mfma_f32_16x16x32_bf16 v[192:195], a[8:11], v[32:35], v[192:195]
    s_cbranch_vccnz m2_x3_again
m2_x3_ok:
    v_mfma_f32_16x16x32_bf16 v[196:199], a[8:11], v[36:39], v[196:199]
    v_swap_b32 v42, v44
    v_mfma_f32_16x16x32_bf16 v[200:203], a[12:15], v[32:35], v[200:203]
    v_swap_b32 v43, v45
    v_mfma_f32_16x16x32_bf16 v[204:207], a[12:15], v[36:39], v[204:207]
    ds_read_b128 a[8:11], v6 offset:11264
    ds_read_b128 a[12:15], v6 offset:31744
    v_mfma_f32_16x16x32_bf16 v[232:235], v[40:43], v[40:43], v[232:235]
    buffer_load_dwordx4 v[96:99], v4, s[32:35], s65 offen sc1
    v_mfma_f32_16x16x32_bf16 v[236:239], v[44:47], v[44:47], v[236:239]
    buffer_load_dwordx4 v[100:103], v8, s[32:35], s65 offen sc1
    s_waitcnt lgkmcnt(4)
    v_mfma_f32_16x16x32_bf16 v[176:179], a[16:19], v[40:43], v[176:179]
    v_mfma_f32_16x16x32_bf16 v[180:183], a[16:19], v[44:47], v[180:183]
    s_waitcnt vmcnt(12)
    v_min_f32_e64 v9, |v48|, |v52|
    v_mfma_f32_16x16x32_bf16 v[184:187], a[20:23], v[40:43], v[184:187]
    ds_read_b128 a[16:19], v5 offset:34816
    v_cmp_gt_f32 vcc, 0x3c800000, v9
    v_mfma_f32_16x16x32_bf16 v[188:191], a[20:23], v[44:47], v[188:191]
    ds_read_b128 a[20:23], v5 offset:55296
    v_mfma_f32_16x16x32_bf16 v[192:195], a[24:27], v[40:43], v[192:195]
    s_cbranch_vccnz m2_x4_again
m2_x4_ok:
    v_mfma_f32_16x16x32_bf16 v[196:199], a[24:27], v[44:47], v[196:199]
    v_swap_b32 v50, v52
    v_mfma_f32_16x16x32_bf16 v[200:203], a[28:31], v[40:43], v[200:203]
    v_swap_b32 v51, v53
    v_mfma_f32_16x16x32_bf16 v[204:207], a[28:31], v[44:47], v[204:207]
    ds_read_b128 a[24:27], v6 offset:10240
    ds_read_b128 a[28:31], v6 offset:30720
    v_mfma_f32_16x16x32_bf16 v[232:235], v[48:51], v[48:51], v[232:235]
    v_mfma_f32_16x16x32_bf16 v[236:239], v[52:55], v[52:55], v[236:239]
    s_waitcnt lgkmcnt(4)
    v_mfma_f32_16x16x32_bf16 v[176:179], a[0:3], v[48:51], v[176:179]
    v_mfma_f32_16x16x32_bf16 v[180:183], a[0:3], v[52:55], v[180:183]
    s_waitcnt vmcnt(10)
    v_min_f32_e64 v9, |v56|, |v60|
    v_mfma_f32_16x16x32_bf16 v[184:187], a[4:7], v[48:51], v[184:187]
    ds_read_b128 a[0:3], v5 offset:33792
    v_cmp_gt_f32 vcc, 0x3c800000, v9
    v_mfma_f32_16x16x32_bf16 v[188:191], a[4:7], v[52:55], v[188:191]
    ds_read_b128 a[4:7], v5 offset:54272
    s_mov_b32 s65, 1064960
    v_mfma_f32_16x16x32_bf16 v[192:195], a[8:11], v[48:51], v[192:195]
    s_cbranch_vccnz m2_x5_again
m2_x5_ok:
    v_mfma_f32_16x16x32_bf16 v[196:199], a[8:11], v[52:55], v[196:199]
    v_swap_b32 v58, v60
    v_mfma_f32_16x16x32_bf16 v[200:203], a[12:15], v[48:51], v[200:203]
    v_swap_b32 v59, v61
    v_mfma_f32_16x16x32_bf16 v[204:207], a[12:15], v[52:55], v[204:207]
    ds_read_b128 a[8:11], v6 offset:9216
    ds_read_b128 a[12:15], v6 offset:29696
    v_mfma_f32_16x16x32_bf16 v[232:235], v[56:59], v[56:59], v[232:235]
    buffer_load_dwordx4 v[104:107], v4, s[32:35], s65 offen sc1
    v_mfma_f32_16x16x32_bf16 v[236:239], v[60:63], v[60:63], v[236:239]
    buffer_load_dwordx4 v[108:111], v8, s[32:35], s65 offen sc1
    s_waitcnt lgkmcnt(4)
    v_mfma_f32_16x16x32_bf16 v[176:179], a[16:19], v[56:59], v[176:179]
    s_mov_b32 s65, 931840
    buffer_load_dwordx4 v[112:115], v4, s[32:35], s65 offen sc1
    v_mfma_f32_16x16x32_bf16 v[180:183], a[16:19], v[60:63], v[180:183]
    s_waitcnt vmcnt(11)
    v_min_f32_e64 v9, |v64|, |v68|
    v_mfma_f32_16x16x32_bf16 v[184:187], a[20:23], v[56:59], v[184:187]
    ds_read_b128 a[16:19], v5 offset:32768
    v_cmp_gt_f32 vcc, 0x3c800000, v9
    v_mfma_f32_16x16x32_bf16 v[188:191], a[20:23], v[60:63], v[188:191]
    ds_read_b128 a[20:23], v5 offset:53248
    buffer_load_dwordx4 v[116:119], v8, s[32:35], s65 offen sc1
    v_mfma_f32_16x16x32_bf16 v[192:195], a[24:27], v[56:59], v[192:195]
    s_cbranch_vccnz m2_x6_again
m2_x6_ok:
    v_mfma_f32_16x16x32_bf16 v[196:199], a[24:27], v[60:63], v[196:199]
    v_swap_b32 v66, v68
    v_mfma_f32_16x16x32_bf16 v[200:203], a[28:31], v[56:59], v[200:203]
    v_swap_b32 v67, v69
    v_mfma_f32_16x16x32_bf16 v[204:207], a[28:31], v[60:63], v[204:207]
    ds_read_b128 a[24:27], v6 offset:8192
    ds_read_b128 a[28:31], v6 offset:28672
    v_mfma_f32_16x16x32_bf16 v[232:235], v[64:67], v[64:67], v[232:235]
    s_mov_b32 s65, 0
    buffer_load_dwordx4 v[168:171], v4, s[32:35], s65 offen sc1
    v_mfma_f32_16x16x32_bf16 v[236:239], v[68:71], v[68:71], v[236:239]
    buffer_load_dwordx4 v[172:175], v8, s[32:35], s65 offen sc1
    s_waitcnt lgkmcnt(4)
    v_mfma_f32_16x16x32_bf16 v[176:179], a[0:3], v[64:67], v[176:179]
    v_mfma_f32_16x16x32_bf16 v[180:183], a[0:3], v[68:71], v[180:183]
    s_waitcnt vmcnt(12)
    v_min_f32_e64 v9, |v72|, |v76|
    v_mfma_f32_16x16x32_bf16 v[184:187], a[4:7], v[64:67], v[184:187]
    ds_read_b128 a[0:3], v5 offset:31744
    v_cmp_gt_f32 vcc, 0x3c800000, v9
    v_mfma_f32_16x16x32_bf16 v[188:191], a[4:7], v[68:71], v[188:191]
    ds_read_b128 a[4:7], v5 offset:52224
    s_mov_b32 s65, 798720
    v_mfma_f32_16x16x32_bf16 v[192:195], a[8:11], v[64:67], v[192:195]
    s_cbranch_vccnz m2_x7_again
m2_x7_ok:
    v_mfma_f32_16x16x32_bf16 v[196:199], a[8:11], v[68:71], v[196:199]
    v_swap_b32 v74, v76
    v_mfma_f32_16x16x32_bf16 v[200:203], a[12:15], v[64:67], v[200:203]
    v_swap_b32 v75, v77
    v_mfma_f32_16x16x32_bf16 v[204:207], a[12:15], v[68:71], v[204:207]
    ds_read_b128 a[8:11], v6 offset:7168
    ds_read_b128 a[12:15], v6 offset:27648
    v_mfma_f32_16x16x32_bf16 v[232:235], v[72:75], v[72:75], v[232:235]
    buffer_load_dwordx4 v[120:123], v4, s[32:35], s65 offen sc1
    v_mfma_f32_16x16x32_bf16 v[236:239], v[76:79], v[76:79], v[236:239]
    buffer_load_dwordx4 v[124:127], v8, s[32:35], s65 offen sc1
    s_waitcnt lgkmcnt(4)
    v_mfma_f32_16x16x32_bf16 v[176:179], a[16:19], v[72:75], v[176:179]
    v_mfma_f32_16x16x32_bf16 v[180:183], a[16:19], v[76:79], v[180:183]
    s_waitcnt vmcnt(12)
    v_min_f32_e64 v9, |v80|, |v84|
    v_mfma_f32_16x16x32_bf16 v[184:187], a[20:23], v[72:75], v[184:187]
    ds_read_b128 a[16:19], v5 offset:30720
    v_cmp_gt_f32 vcc, 0x3c800000, v9
    v_mfma_f32_16x16x32_bf16 v[188:191], a[20:23], v[76:79], v[188:191]
    ds_read_b128 a[20:23], v5 offset:51200
    s_mov_b32 s65, 665600
    v_mfma_f32_16x16x32_bf16 v[192:195], a[24:27], v[72:75], v[192:195]
    s_cbranch_vccnz m2_x8_again
m2_x8_ok:
    v_mfma_f32_16x16x32_bf16 v[196:199], a[24:27], v[76:79], v[196:199]
    v_swap_b32 v82, v84
    v_mfma_f32_16x16x32_bf16 v[200:203], a[28:31], v[72:75], v[200:203]
    v_swap_b32 v83, v85
    v_mfma_f32_16x16x32_bf16 v[204:207], a[28:31], v[76:79], v[204:207]
    ds_read_b128 a[24:27], v6 offset:6144
    ds_read_b128 a[28:31], v6 offset:26624
    v_mfma_f32_16x16x32_bf16 v[232:235], v[80:83], v[80:83], v[232:235]
    buffer_load_dwordx4 v[128:131], v4, s[32:35], s65 offen sc1
    v_mfma_f32_16x16x32_bf16 v[236:239], v[84:87], v[84:87], v[236:239]
    buffer_load_dwordx4 v[132:135], v8, s[32:35], s65 offen sc1
    s_waitcnt lgkmcnt(4)
    v_mfma_f32_16x16x32_bf16 v[176:179], a[0:3], v[80:83], v[176:179]
    v_mfma_f32_16x16x32_bf16 v[180:183], a[0:3], v[84:87], v[180:183]
    s_waitcnt vmcnt(12)
    v_min_f32_e64 v9, |v88|, |v92|
    v_mfma_f32_16x16x32_bf16 v[184:187], a[4:7], v[80:83], v[184:187]
    ds_read_b128 a[0:3], v5 offset:29696
    v_cmp_gt_f32 vcc, 0x3c800000, v9
    v_mfma_f32_16x16x32_bf16 v[188:191], a[4:7], v[84:87], v[188:191]
    ds_read_b128 a[4:7], v5 offset:50176
    s_mov_b32 s65, 532480
    v_mfma_f32_16x16x32_bf16 v[192:195], a[8:11], v[80:83], v[192:195]
    s_cbranch_vccnz m2_x9_again
m2_x9_ok:
    v_mfma_f32_16x16x32_bf16 v[196:199], a[8:11], v[84:87], v[196:199]
    v_swap_b32 v90, v92
    v_mfma_f32_16x16x32_bf16 v[200:203], a[12:15], v[80:83], v[200:203]
    v_swap_b32 v91, v93
    v_mfma_f32_16x16x32_bf16 v[204:207], a[12:15], v[84:87], v[204:207]
    ds_read_b128 a[8:11], v6 offset:5120
    ds_read_b128 a[12:15], v6 offset:25600
    v_mfma_f32_16x16x32_bf16 v[232:235], v[88:91], v[88:91], v[232:235]
    buffer_load_dwordx4 v[136:139], v4, s[32:35], s65 offen sc1
    v_mfma_f32_16x16x32_bf16 v[236:239], v[92:95], v[92:95], v[236:239]
    buffer_load_dwordx4 v[140:143], v8, s[32:35], s65 offen sc1
    s_waitcnt lgkmcnt(4)
    v_mfma_f32_16x16x32_bf16 v[176:179], a[16:19], v[88:91], v[176:179]
    v_mfma_f32_16x16x32_bf16 v[180:183], a[16:19], v[92:95], v[180:183]
    s_waitcnt vmcnt(12)
    v_min_f32_e64 v9, |v96|, |v100|
    v_mfma_f32_16x16x32_bf16 v[184:187], a[20:23], v[88:91], v[184:187]
    ds_read_b128 a[16:19], v5 offset:28672
    v_cmp_gt_f32 vcc, 0x3c800000, v9
    v_mfma_f32_16x16x32_bf16 v[188:191], a[20:23], v[92:95], v[188:191]
    ds_read_b128 a[20:23], v5 offset:49152
    v_mfma_f32_16x16x32_bf16 v[192:195], a[24:27], v[88:91], v[192:195]
    s_cbranch_vccnz m2_x10_again
m2_x10_ok:
    v_mfma_f32_16x16x32_bf16 v[196:199], a[24:27], v[92:95], v[196:199]
    v_swap_b32 v98, v100
    v_mfma_f32_16x16x32_bf16 v[200:203], a[28:31], v[88:91], v[200:203]
    v_swap_b32 v99, v101
    v_mfma_f32_16x16x32_bf16 v[204:207], a[28:31], v[92:95], v[204:207]
    ds_read_b128 a[24:27], v6 offset:4096
    ds_read_b128 a[28:31], v6 offset:24576
    v_mfma_f32_16x16x32_bf16 v[232:235], v[96:99], v[96:99], v[232:235]
    s_mov_b32 s65, 399360
    buffer_load_dwordx4 v[144:147], v4, s[32:35], s65 offen sc1
    v_mfma_f32_16x16x32_bf16 v[236:239], v[100:103], v[100:103], v[236:239]
    buffer_load_dwordx4 v[148:151], v8, s[32:35], s65 offen sc1
    s_waitcnt lgkmcnt(4)
    v_mfma_f32_16x16x32_bf16 v[176:179], a[0:3], v[96:99], v[176:179]
    v_mfma_f32_16x16x32_bf16 v[180:183], a[0:3], v[100:103], v[180:183]
    s_waitcnt vmcnt(12)
    v_min_f32_e64 v9, |v104|, |v108|
    v_mfma_f32_16x16x32_bf16 v[184:187], a[4:7], v[96:99], v[184:187]
    ds_read_b128 a[0:3], v5 offset:27648
    v_cmp_gt_f32 vcc, 0x3c800000, v9
    v_mfma_f32_16x16x32_bf16 v[188:191], a[4:7], v[100:103], v[188:191]
    ds_read_b128 a[4:7], v5 offset:48128
    s_mov_b32 s65, 266240
    v_mfma_f32_16x16x32_bf16 v[192:195], a[8:11], v[96:99], v[192:195]
    s_cbranch_vccnz m2_x11_again
m2_x11_ok:
    v_mfma_f32_16x16x32_bf16 v[196:199], a[8:11], v[100:103], v[196:199]
    v_swap_b32 v106, v108
    v_mfma_f32_16x16x32_bf16 v[200:203], a[12:15], v[96:99], v[200:203]
    v_swap_b32 v107, v109
    v_mfma_f32_16x16x32_bf16 v[204:207], a[12:15], v[100:103], v[204:207]
    ds_read_b128 a[8:11], v6 offset:3072
    ds_read_b128 a[12:15], v6 offset:23552
    v_mfma_f32_16x16x32_bf16 v[232:235], v[104:107], v[104:107], v[232:235]
    buffer_load_dwordx4 v[152:155], v4, s[32:35], s65 offen sc1
    v_mfma_f32_16x16x32_bf16 v[236:239], v[108:111], v[108:111], v[236:239]
    buffer_load_dwordx4 v[156:159], v8, s[32:35], s65 offen sc1
    s_waitcnt lgkmcnt(4)
    v_mfma_f32_16x16x32_bf16 v[176:179], a[16:19], v[104:107], v[176:179]
    v_mfma_f32_16x16x32_bf16 v[180:183], a[16:19], v[108:111], v[180:183]
    s_waitcnt vmcnt(12)
    v_min_f32_e64 v9, |v112|, |v116|
    v_mfma_f32_16x16x32_bf16 v[184:187], a[20:23], v[104:107], v[184:187]
    ds_read_b128 a[16:19], v5 offset:26624
    v_cmp_gt_f32 vcc, 0x3c800000, v9
    v_mfma_f32_16x16x32_bf16 v[188:191], a[20:23], v[108:111], v[188:191]
    ds_read_b128 a[20:23], v5 offset:47104
    s_mov_b32 s65, 133120
    v_mfma_f32_16x16x32_bf16 v[192:195], a[24:27], v[104:107], v[192:195]
    s_cbranch_vccnz m2_x12_again
m2_x12_ok:
    v_mfma_f32_16x16x32_bf16 v[196:199], a[24:27], v[108:111], v[196:199]
    v_swap_b32 v114, v116
    v_mfma_f32_16x16x32_bf16 v[200:203], a[28:31], v[104:107], v[200:203]
    v_swap_b32 v115, v117
    v_mfma_f32_16x16x32_bf16 v[204:207], a[28:31], v[108:111], v[204:207]
    ds_read_b128 a[24:27], v6 offset:2048
    ds_read_b128 a[28:31], v6 offset:22528
    v_mfma_f32_16x16x32_bf16 v[232:235], v[112:115], v[112:115], v[232:235]
    buffer_load_dwordx4 v[160:163], v4, s[32:35], s65 offen sc1
    v_mfma_f32_16x16x32_bf16 v[236:239], v[116:119], v[116:119], v[236:239]
    buffer_load_dwordx4 v[164:167], v8, s[32:35], s65 offen sc1
    s_waitcnt lgkmcnt(4)
    v_mfma_f32_16x16x32_bf16 v[176:179], a[0:3], v[112:115], v[176:179]
    s_waitcnt vmcnt(10)
    v_min3_f32 v9, |v168|, |v172|, |v120|
    v_mfma_f32_16x16x32_bf16 v[180:183], a[0:3], v[116:119], v[180:183]
    v_min_f32_e64 v9, v9, |v124|
    v_cmp_gt_f32 vcc, 0x3c800000, v9
    v_mfma_f32_16x16x32_bf16 v[184:187], a[4:7], v[112:115], v[184:187]
    ds_read_b128 a[0:3], v5 offset:25600
    v_mfma_f32_16x16x32_bf16 v[188:191], a[4:7], v[116:119], v[188:191]
    s_cbranch_vccnz m2_x13_again
m2_x13_ok:
    v_mfma_f32_16x16x32_bf16 v[192:195], a[8:11], v[112:115], v[192:195]
    v_swap_b32 v122, v124
    v_mfma_f32_16x16x32_bf16 v[196:199], a[8:11], v[116:119], v[196:199]
    v_swap_b32 v123, v125
    v_mfma_f32_16x16x32_bf16 v[200:203], a[12:15], v[112:115], v[200:203]
    v_swap_b32 v170, v172
    v_mfma_f32_16x16x32_bf16 v[204:207], a[12:15], v[116:119], v[204:207]
    v_swap_b32 v171, v173
    v_mfma_f32_16x16x32_bf16 v[232:235], v[120:123], v[120:123], v[232:235]
    v_accvgpr_write_b32 a254, v168
    v_bfi_b32 v168, v249, 0, v168
    v_mfma_f32_16x16x32_bf16 v[236:239], v[124:127], v[124:127], v[236:239]
    v_accvgpr_write_b32 a255, v172
    v_bfi_b32 v172, v249, 0, v172
    v_mfma_f32_16x16x32_bf16 v[232:235], v[168:171], v[168:171], v[232:235]
    ds_read_b128 a[4:7], v5 offset:46080
    ds_read_b128 a[8:11], v6 offset:1024
    v_mfma_f32_16x16x32_bf16 v[236:239], v[172:175], v[172:175], v[236:239]
    ds_read_b128 a[12:15], v6 offset:21504
    s_waitcnt lgkmcnt(4)
    v_mfma_f32_16x16x32_bf16 v[176:179], a[16:19], v[120:123], v[176:179]
    v_mfma_f32_16x16x32_bf16 v[180:183], a[16:19], v[124:127], v[180:183]
    s_waitcnt vmcnt(8)
    v_min_f32_e64 v9, |v128|, |v132|
    v_mfma_f32_16x16x32_bf16 v[184:187], a[20:23], v[120:123], v[184:187]
    ds_read_b128 a[16:19], v5 offset:24576
    v_cmp_gt_f32 vcc, 0x3c800000, v9
    v_mfma_f32_16x16x32_bf16 v[188:191], a[20:23], v[124:127], v[188:191]
    ds_read_b128 a[20:23], v5 offset:45056
    v_mfma_f32_16x16x32_bf16 v[192:195], a[24:27], v[120:123], v[192:195]
    s_cbranch_vccnz m2_x14_again
m2_x14_ok:
    v_mfma_f32_16x16x32_bf16 v[196:199], a[24:27], v[124:127], v[196:199]
    v_swap_b32 v130, v132
    v_mfma_f32_16x16x32_bf16 v[200:203], a[28:31], v[120:123], v[200:203]
    v_swap_b32 v131, v133
    v_mfma_f32_16x16x32_bf16 v[204:207], a[28:31], v[124:127], v[204:207]
    ds_read_b128 a[24:27], v6 offset:0
    ds_read_b128 a[28:31], v6 offset:20480
    v_mfma_f32_16x16x32_bf16 v[232:235], v[128:131], v[128:131], v[232:235]
    v_mfma_f32_16x16x32_bf16 v[236:239], v[132:135], v[132:135], v[236:239]
    s_waitcnt lgkmcnt(4)
    v_mfma_f32_16x16x32_bf16 v[176:179], a[0:3], v[128:131], v[176:179]
    v_mfma_f32_16x16x32_bf16 v[180:183], a[0:3], v[132:135], v[180:183]
    s_waitcnt vmcnt(6)
    v_min_f32_e64 v9, |v136|, |v140|
    v_mfma_f32_16x16x32_bf16 v[184:187], a[4:7], v[128:131], v[184:187]
    ds_read_b128 a[0:3], v5 offset:23552
    v_cmp_gt_f32 vcc, 0x3c800000, v9
    v_mfma_f32_16x16x32_bf16 v[188:191], a[4:7], v[132:135], v[188:191]
    ds_read_b128 a[4:7], v5 offset:44032
    v_mfma_f32_16x16x32_bf16 v[192:195], a[8:11], v[128:131], v[192:195]
    s_cbranch_vccnz m2_x15_again
m2_x15_ok:
    v_mfma_f32_16x16x32_bf16 v[196:199], a[8:11], v[132:135], v[196:199]
    v_swap_b32 v138, v140
    v_mfma_f32_16x16x32_bf16 v[200:203], a[12:15], v[128:131], v[200:203]
    v_swap_b32 v139, v141
    v_mfma_f32_16x16x32_bf16 v[204:207], a[12:15], v[132:135], v[204:207]
    ds_read_b128 a[8:11], v5 offset:64512
    ds_read_b128 a[12:15], v6 offset:19456
    v_mfma_f32_16x16x32_bf16 v[232:235], v[136:139], v[136:139], v[232:235]
    v_mfma_f32_16x16x32_bf16 v[236:239], v[140:143], v[140:143], v[236:239]
    s_waitcnt lgkmcnt(4)
    v_mfma_f32_16x16x32_bf16 v[176:179], a[16:19], v[136:139], v[176:179]
    s_waitcnt vmcnt(2)
    v_min3_f32 v9, |v144|, |v148|, |v152|
    v_mfma_f32_16x16x32_bf16 v[180:183], a[16:19], v[140:143], v[180:183]
    v_min_f32_e64 v9, v9, |v156|
    v_cmp_gt_f32 vcc, 0x3c800000, v9
    v_mfma_f32_16x16x32_bf16 v[184:187], a[20:23], v[136:139], v[184:187]
    ds_read_b128 a[16:19], v5 offset:22528
    v_mfma_f32_16x16x32_bf16 v[188:191], a[20:23], v[140:143], v[188:191]
    s_cbranch_vccnz m2_x16_again
m2_x16_ok:
    v_mfma_f32_16x16x32_bf16 v[192:195], a[24:27], v[136:139], v[192:195]
    v_swap_b32 v146, v148
    v_mfma_f32_16x16x32_bf16 v[196:199], a[24:27], v[140:143], v[196:199]
    v_swap_b32 v147, v149
    v_mfma_f32_16x16x32_bf16 v[200:203], a[28:31], v[136:139], v[200:203]
    v_swap_b32 v154, v156
    v_mfma_f32_16x16x32_bf16 v[204:207], a[28:31], v[140:143], v[204:207]
    v_swap_b32 v155, v157
    v_mfma_f32_16x16x32_bf16 v[232:235], v[144:147], v[144:147], v[232:235]
    ds_read_b128 a[20:23], v5 offset:43008
    ds_read_b128 a[24:27], v5 offset:63488
    v_mfma_f32_16x16x32_bf16 v[236:239], v[148:151], v[148:151], v[236:239]
    ds_read_b128 a[28:31], v6 offset:18432
    v_mfma_f32_16x16x32_bf16 v[232:235], v[152:155], v[152:155], v[232:235]
    v_mfma_f32_16x16x32_bf16 v[236:239], v[156:159], v[156:159], v[236:239]
    s_waitcnt lgkmcnt(4)
    v_mfma_f32_16x16x32_bf16 v[176:179], a[0:3], v[144:147], v[176:179]
    v_mfma_f32_16x16x32_bf16 v[180:183], a[0:3], v[148:151], v[180:183]
    s_waitcnt vmcnt(0)
    v_min_f32_e64 v9, |v160|, |v164|
    v_mfma_f32_16x16x32_bf16 v[184:187], a[4:7], v[144:147], v[184:187]
    ds_read_b128 a[0:3], v5 offset:21504
    v_cmp_gt_f32 vcc, 0x3c800000, v9
    v_mfma_f32_16x16x32_bf16 v[188:191], a[4:7], v[148:151], v[188:191]
    ds_read_b128 a[4:7], v5 offset:41984
    v_mfma_f32_16x16x32_bf16 v[192:195], a[8:11], v[144:147], v[192:195]
    s_cbranch_vccnz m2_x18_again
m2_x18_ok:
    v_mfma_f32_16x16x32_bf16 v[196:199], a[8:11], v[148:151], v[196:199]
    v_swap_b32 v162, v164
    v_mfma_f32_16x16x32_bf16 v[200:203], a[12:15], v[144:147], v[200:203]
    v_swap_b32 v163, v165
    v_mfma_f32_16x16x32_bf16 v[204:207], a[12:15], v[148:151], v[204:207]
    ds_read_b128 a[8:11], v5 offset:62464
    ds_read_b128 a[12:15], v6 offset:17408
    v_mfma_f32_16x16x32_bf16 v[232:235], v[160:163], v[160:163], v[232:235]
    s_mov_b32 s63, 81920
    buffer_load_dwordx4 a[192:195], v15, s[52:55], s63 offen offset:0
    v_mfma_f32_16x16x32_bf16 v[236:239], v[164:167], v[164:167], v[236:239]
    buffer_load_dwordx4 a[196:199], v15, s[52:55], s63 offen offset:256
    s_waitcnt lgkmcnt(4)
    v_mfma_f32_16x16x32_bf16 v[176:179], a[16:19], v[152:155], v[176:179]
    buffer_load_dwordx4 a[200:203], v15, s[52:55], s63 offen offset:512
    v_mov_b32 v244, 0x46dbe6ff
    v_mfma_f32_16x16x32_bf16 v[180:183], a[16:19], v[156:159], v[180:183]
    ds_read_b128 a[16:19], v5 offset:20480
    buffer_load_dwordx4 a[204:207], v15, s[52:55], s63 offen offset:768
    v_mfma_f32_16x16x32_bf16 v[184:187], a[20:23], v[152:155], v[184:187]
    buffer_load_dwordx4 a[208:211], v15, s[52:55], s63 offen offset:1024
    v_xor_b32 v4, 0x100, v13
    v_mfma_f32_16x16x32_bf16 v[188:191], a[20:23], v[156:159], v[188:191]
    ds_read_b128 a[20:23], v5 offset:40960
    s_mov_b32 s63, 368640
    v_mfma_f32_16x16x32_bf16 v[192:195], a[24:27], v[152:155], v[192:195]
    buffer_load_dwordx4 a[212:215], v15, s[52:55], s63 offen offset:0
    v_xor_b32 v8, 0x200, v13
    v_mfma_f32_16x16x32_bf16 v[196:199], a[24:27], v[156:159], v[196:199]
    ds_read_b128 a[24:27], v5 offset:61440
    buffer_load_dwordx4 a[216:219], v15, s[52:55], s63 offen offset:256
    v_mfma_f32_16x16x32_bf16 v[200:203], a[28:31], v[152:155], v[200:203]
    buffer_load_dwordx4 a[220:223], v15, s[52:55], s63 offen offset:512
    v_cndmask_b32_e64 v240, 0, v232, s[4:5]
    v_mfma_f32_16x16x32_bf16 v[204:207], a[28:31], v[156:159], v[204:207]
    ds_read_b128 a[28:31], v6 offset:16384
    s_waitcnt lgkmcnt(4)
    v_mfma_f32_16x16x32_bf16 v[176:179], a[0:3], v[160:163], v[176:179]
    buffer_load_dwordx4 a[224:227], v15, s[52:55], s63 offen offset:768
    v_cndmask_b32_e64 v242, 0, v236, s[4:5]
    v_mfma_f32_16x16x32_bf16 v[180:183], a[0:3], v[164:167], v[180:183]
    ds_read_b128 a[0:3], v6 offset:56320
    buffer_load_dwordx4 a[228:231], v15, s[52:55], s63 offen offset:1024
    v_mfma_f32_16x16x32_bf16 v[184:187], a[4:7], v[160:163], v[184:187]
    s_mov_b32 s63, 102400
    buffer_load_dwordx4 a[232:235], v15, s[52:55], s63 offen offset:0
    v_mfma_f32_16x16x32_bf16 v[188:191], a[4:7], v[164:167], v[188:191]
    ds_read_b128 a[4:7], v7 offset:11264
    buffer_load_dwordx4 a[236:239], v15, s[52:55], s63 offen offset:256
    v_mfma_f32_16x16x32_bf16 v[192:195], a[8:11], v[160:163], v[192:195]
    v_cndmask_b32_e64 v240, v240, v233, s[6:7]
    v_cndmask_b32_e64 v242, v242, v237, s[6:7]
    v_mfma_f32_16x16x32_bf16 v[196:199], a[8:11], v[164:167], v[196:199]
    ds_read_b128 a[8:11], v7 offset:31744
    v_cndmask_b32_e64 v240, v240, v234, s[30:31]
    v_mfma_f32_16x16x32_bf16 v[200:203], a[12:15], v[160:163], v[200:203]
    v_cndmask_b32_e64 v242, v242, v238, s[30:31]
    v_cndmask_b32_e64 v240, v240, v235, s[70:71]
    v_mfma_f32_16x16x32_bf16 v[204:207], a[12:15], v[164:167], v[204:207]
    ds_read_b128 a[12:15], v6 offset:55296
    s_waitcnt lgkmcnt(4)
    v_cndmask_b32_e64 v242, v242, v239, s[70:71]
    v_mov_b32 v241, v240
    v_mov_b32 v243, v242
    s_nop 0
    v_permlane32_swap_b32 v240, v241
    v_permlane32_swap_b32 v242, v243
    v_add_f32 v240, v240, v241
    v_add_f32 v242, v242, v243
    v_mov_b32 v241, v240
    v_mov_b32 v243, v242
    s_nop 0
    v_permlane16_swap_b32 v240, v241
    v_permlane16_swap_b32 v242, v243
    v_add_f32 v240, v240, v241
    v_add_f32 v242, v242, v243
    v_fmamk_f32 v240, v240, 0x3acccd53, v244
    v_fmamk_f32 v242, v242, 0x3acccd53, v244
    v_rsq_f32 v241, v240
    v_rsq_f32 v243, v242
    v_mul_f32 v254, v240, v241
    v_mul_f32 v255, v242, v243
    v_cvt_pk_bf16_f32 v240, v254, v254
    v_cvt_pk_bf16_f32 v242, v255, v255
    v_bfi_b32 v168, v249, v240, v168
    v_bfi_b32 v172, v249, v242, v172
    s_nop 0
    v_mfma_f32_16x16x32_bf16 v[176:179], a[16:19], v[168:171], v[176:179]
    v_mul_f32 v250, 0xc0135761, v241
    v_mul_f32 v251, 0xc0135761, v243
    v_mfma_f32_16x16x32_bf16 v[180:183], a[16:19], v[172:175], v[180:183]
    ds_read_b128 a[16:19], v7 offset:10240
    v_mul_f32 v240, v241, v241
    v_mfma_f32_16x16x32_bf16 v[184:187], a[20:23], v[168:171], v[184:187]
    v_mul_f32 v242, v243, v243
    v_mul_f32 v240, 0x3d372713, v240
    v_mfma_f32_16x16x32_bf16 v[188:191], a[20:23], v[172:175], v[188:191]
    ds_read_b128 a[20:23], v7 offset:30720
    v_mul_f32 v242, 0x3d372713, v242
    v_mfma_f32_16x16x32_bf16 v[192:195], a[24:27], v[168:171], v[192:195]
    v_mul_f32 v252, v250, v240
    v_mul_f32 v253, v251, v242
    v_mfma_f32_16x16x32_bf16 v[196:199], a[24:27], v[172:175], v[196:199]
    ds_read_b128 a[24:27], v6 offset:54272
    v_mfma_f32_16x16x32_bf16 v[200:203], a[28:31], v[168:171], v[200:203]
    v_mfma_f32_16x16x32_bf16 v[204:207], a[28:31], v[172:175], v[204:207]
    ds_read_b128 a[28:31], v7 offset:9216
    s_waitcnt lgkmcnt(5)
    v_pk_mul_f32 v[232:233], v[176:177], v[176:177]
    v_pk_mul_f32 v[234:235], v[178:179], v[178:179]
    v_pk_mul_f32 v[236:237], v[180:181], v[180:181]
    v_pk_mul_f32 v[238:239], v[182:183], v[182:183]
    v_pk_fma_f32 v[232:233], v[232:233], v[252:253], v[250:251] op_sel:[0,0,0] op_sel_hi:[1,0,0]
    v_pk_fma_f32 v[234:235], v[234:235], v[252:253], v[250:251] op_sel:[0,0,0] op_sel_hi:[1,0,0]
    v_pk_fma_f32 v[236:237], v[236:237], v[252:253], v[250:251] op_sel:[0,1,1] op_sel_hi:[1,1,1]
    v_pk_fma_f32 v[238:239], v[238:239], v[252:253], v[250:251] op_sel:[0,1,1] op_sel_hi:[1,1,1]
    v_pk_mul_f32 v[232:233], v[232:233], v[176:177]
    v_pk_mul_f32 v[234:235], v[234:235], v[178:179]
    v_pk_mul_f32 v[236:237], v[236:237], v[180:181]
    v_pk_mul_f32 v[238:239], v[238:239], v[182:183]
    v_exp_f32 v232, v232
    v_exp_f32 v233, v233
    v_exp_f32 v234, v234
    v_exp_f32 v235, v235
    v_exp_f32 v236, v236
    v_exp_f32 v237, v237
    v_exp_f32 v238, v238
    v_exp_f32 v239, v239
    v_pk_fma_f32 v[232:233], v[232:233], v[254:255], v[254:255] op_sel:[0,0,0] op_sel_hi:[1,0,0]
    v_pk_fma_f32 v[234:235], v[234:235], v[254:255], v[254:255] op_sel:[0,0,0] op_sel_hi:[1,0,0]
    v_pk_fma_f32 v[236:237], v[236:237], v[254:255], v[254:255] op_sel:[0,1,1] op_sel_hi:[1,1,1]
    v_pk_fma_f32 v[238:239], v[238:239], v[254:255], v[254:255] op_sel:[0,1,1] op_sel_hi:[1,1,1]
    v_rcp_f32 v232, v232
    v_rcp_f32 v233, v233
    v_rcp_f32 v234, v234
    v_rcp_f32 v235, v235
    v_rcp_f32 v236, v236
    v_rcp_f32 v237, v237
    v_rcp_f32 v238, v238
    v_rcp_f32 v239, v239
    v_pk_fma_f32 v[232:233], v[232:233], v[176:177], s[66:67]
    v_pk_fma_f32 v[234:235], v[234:235], v[178:179], s[66:67]
    v_pk_fma_f32 v[236:237], v[236:237], v[180:181], s[66:67]
    v_pk_fma_f32 v[238:239], v[238:239], v[182:183], s[66:67]
    v_pk_mul_f32 v[240:241], v[184:185], v[184:185]
    v_pk_mul_f32 v[242:243], v[186:187], v[186:187]
    v_pk_mul_f32 v[244:245], v[188:189], v[188:189]
    v_pk_mul_f32 v[246:247], v[190:191], v[190:191]
    v_pk_fma_f32 v[240:241], v[240:241], v[252:253], v[250:251] op_sel:[0,0,0] op_sel_hi:[1,0,0]
    v_pk_fma_f32 v[242:243], v[242:243], v[252:253], v[250:251] op_sel:[0,0,0] op_sel_hi:[1,0,0]
    v_pk_fma_f32 v[244:245], v[244:245], v[252:253], v[250:251] op_sel:[0,1,1] op_sel_hi:[1,1,1]
    v_pk_fma_f32 v[246:247], v[246:247], v[252:253], v[250:251] op_sel:[0,1,1] op_sel_hi:[1,1,1]
    v_pk_mul_f32 v[240:241], v[240:241], v[184:185]
    v_pk_mul_f32 v[242:243], v[242:243], v[186:187]
    v_pk_mul_f32 v[244:245], v[244:245], v[188:189]
    v_pk_mul_f32 v[246:247], v[246:247], v[190:191]
    v_cvt_pk_bf16_f32 v232, v232, v233
    v_cvt_pk_bf16_f32 v233, v234, v235
    v_cvt_pk_bf16_f32 v234, v236, v237
    v_cvt_pk_bf16_f32 v235, v238, v239
    s_nop 0
    v_permlane16_swap_b32 v232, v234
    buffer_load_dwordx4 a[240:243], v15, s[52:55], s63 offen offset:512
    v_permlane16_swap_b32 v233, v235
    buffer_load_dwordx4 a[244:247], v15, s[52:55], s63 offen offset:768
    s_mov_b32 s18, 0
    buffer_store_dwordx4 v[232:235], v11, s[44:47], s18 offen sc1
    v_mfma_f32_16x16x32_bf16 v[208:211], a[0:3], v[16:19], 0
    v_exp_f32 v240, v240
    v_mfma_f32_16x16x32_bf16 v[212:215], a[0:3], v[20:23], 0
    v_exp_f32 v241, v241
    v_mfma_f32_16x16x32_bf16 v[216:219], a[4:7], v[16:19], 0
    v_exp_f32 v242, v242
    v_mfma_f32_16x16x32_bf16 v[220:223], a[4:7], v[20:23], 0
    ds_read_b128 a[0:3], v7 offset:29696
    ds_read_b128 a[4:7], v6 offset:53248
    v_mfma_f32_16x16x32_bf16 v[224:227], a[8:11], v[16:19], 0
    v_exp_f32 v243, v243
    v_mfma_f32_16x16x32_bf16 v[228:231], a[8:11], v[20:23], 0
    ds_read_b128 a[8:11], v7 offset:8192
    s_waitcnt lgkmcnt(5)
    v_mfma_f32_16x16x32_bf16 v[208:211], a[12:15], v[24:27], v[208:211]
    s_barrier
    v_mfma_f32_16x16x32_bf16 v[212:215], a[12:15], v[28:31], v[212:215]
    ds_read_b128 a[12:15], v7 offset:28672
    s_add_u32 m0, s21, 40960
    v_mfma_f32_16x16x32_bf16 v[216:219], a[16:19], v[24:27], v[216:219]
    v_exp_f32 v244, v244
    v_mfma_f32_16x16x32_bf16 v[220:223], a[16:19], v[28:31], v[220:223]
    ds_read_b128 a[16:19], v6 offset:52224
    buffer_load_dwordx4 v5, s[48:51], m0 offen offset:0 lds
    v_mfma_f32_16x16x32_bf16 v[224:227], a[20:23], v[24:27], v[224:227]
    v_exp_f32 v245, v245
    v_mfma_f32_16x16x32_bf16 v[228:231], a[20:23], v[28:31], v[228:231]
    s_waitcnt lgkmcnt(4)
    v_exp_f32 v246, v246
    v_exp_f32 v247, v247
    v_pk_fma_f32 v[240:241], v[240:241], v[254:255], v[254:255] op_sel:[0,0,0] op_sel_hi:[1,0,0]
    v_pk_fma_f32 v[242:243], v[242:243], v[254:255], v[254:255] op_sel:[0,0,0] op_sel_hi:[1,0,0]
    v_pk_fma_f32 v[244:245], v[244:245], v[254:255], v[254:255] op_sel:[0,1,1] op_sel_hi:[1,1,1]
    v_pk_fma_f32 v[246:247], v[246:247], v[254:255], v[254:255] op_sel:[0,1,1] op_sel_hi:[1,1,1]
    v_rcp_f32 v240, v240
    v_mfma_f32_16x16x32_bf16 v[208:211], a[24:27], v[32:35], v[208:211]
    ds_read_b128 a[20:23], v7 offset:7168
    buffer_load_dwordx4 v5, s[48:51], m0 offen offset:1024 lds
    v_mfma_f32_16x16x32_bf16 v[212:215], a[24:27], v[36:39], v[212:215]
    v_rcp_f32 v241, v241
    v_mfma_f32_16x16x32_bf16 v[216:219], a[28:31], v[32:35], v[216:219]
    ds_read_b128 a[24:27], v7 offset:27648
    buffer_load_dwordx4 v5, s[48:51], m0 offen offset:2048 lds
    v_mfma_f32_16x16x32_bf16 v[220:223], a[28:31], v[36:39], v[220:223]
    v_rcp_f32 v242, v242
    v_mfma_f32_16x16x32_bf16 v[224:227], a[0:3], v[32:35], v[224:227]
    v_rcp_f32 v243, v243
    v_mfma_f32_16x16x32_bf16 v[228:231], a[0:3], v[36:39], v[228:231]
    ds_read_b128 a[28:31], v6 offset:51200
    s_waitcnt lgkmcnt(4)
    v_mfma_f32_16x16x32_bf16 v[208:211], a[4:7], v[40:43], v[208:211]
    ds_read_b128 a[0:3], v7 offset:6144
    buffer_load_dwordx4 v5, s[48:51], m0 offen offset:3072 lds
    v_mfma_f32_16x16x32_bf16 v[212:215], a[4:7], v[44:47], v[212:215]
    v_rcp_f32 v244, v244
    v_mfma_f32_16x16x32_bf16 v[216:219], a[8:11], v[40:43], v[216:219]
    v_rcp_f32 v245, v245
    v_mfma_f32_16x16x32_bf16 v[220:223], a[8:11], v[44:47], v[220:223]
    ds_read_b128 a[4:7], v7 offset:26624
    v_rcp_f32 v246, v246
    v_rcp_f32 v247, v247
    v_pk_fma_f32 v[240:241], v[240:241], v[184:185], s[66:67]
    v_pk_fma_f32 v[242:243], v[242:243], v[186:187], s[66:67]
    v_pk_fma_f32 v[244:245], v[244:245], v[188:189], s[66:67]
    v_pk_fma_f32 v[246:247], v[246:247], v[190:191], s[66:67]
    v_pk_mul_f32 v[232:233], v[192:193], v[192:193]
    v_pk_mul_f32 v[234:235], v[194:195], v[194:195]
    v_pk_mul_f32 v[236:237], v[196:197], v[196:197]
    v_pk_mul_f32 v[238:239], v[198:199], v[198:199]
    v_pk_fma_f32 v[232:233], v[232:233], v[252:253], v[250:251] op_sel:[0,0,0] op_sel_hi:[1,0,0]
    v_pk_fma_f32 v[234:235], v[234:235], v[252:253], v[250:251] op_sel:[0,0,0] op_sel_hi:[1,0,0]
    v_pk_fma_f32 v[236:237], v[236:237], v[252:253], v[250:251] op_sel:[0,1,1] op_sel_hi:[1,1,1]
    v_pk_fma_f32 v[238:239], v[238:239], v[252:253], v[250:251] op_sel:[0,1,1] op_sel_hi:[1,1,1]
    v_pk_mul_f32 v[232:233], v[232:233], v[192:193]
    v_pk_mul_f32 v[234:235], v[234:235], v[194:195]
    v_pk_mul_f32 v[236:237], v[236:237], v[196:197]
    v_pk_mul_f32 v[238:239], v[238:239], v[198:199]
    v_cvt_pk_bf16_f32 v240, v240, v241
    v_mfma_f32_16x16x32_bf16 v[224:227], a[12:15], v[40:43], v[224:227]
    ds_read_b128 a[8:11], v6 offset:50176
    s_add_u32 m0, s21, 45056
    v_mfma_f32_16x16x32_bf16 v[228:231], a[12:15], v[44:47], v[228:231]
    ds_read_b128 a[12:15], v7 offset:5120
    s_waitcnt lgkmcnt(5)
    v_mfma_f32_16x16x32_bf16 v[208:211], a[16:19], v[48:51], v[208:211]
    buffer_load_dwordx4 v5, s[48:51], m0 offen offset:0 lds
    v_cvt_pk_bf16_f32 v241, v242, v243
    v_mfma_f32_16x16x32_bf16 v[212:215], a[16:19], v[52:55], v[212:215]
    ds_read_b128 a[16:19], v7 offset:25600
    buffer_load_dwordx4 v5, s[48:51], m0 offen offset:1024 lds
    v_mfma_f32_16x16x32_bf16 v[216:219], a[20:23], v[48:51], v[216:219]
    buffer_load_dwordx4 v5, s[48:51], m0 offen offset:2048 lds
    v_cvt_pk_bf16_f32 v242, v244, v245
    v_mfma_f32_16x16x32_bf16 v[220:223], a[20:23], v[52:55], v[220:223]
    ds_read_b128 a[20:23], v6 offset:49152
    v_cvt_pk_bf16_f32 v243, v246, v247
    v_mfma_f32_16x16x32_bf16 v[224:227], a[24:27], v[48:51], v[224:227]
    v_permlane16_swap_b32 v240, v242
    v_mfma_f32_16x16x32_bf16 v[228:231], a[24:27], v[52:55], v[228:231]
    ds_read_b128 a[24:27], v7 offset:4096
    s_waitcnt lgkmcnt(5)
    v_mfma_f32_16x16x32_bf16 v[208:211], a[28:31], v[56:59], v[208:211]
    v_permlane16_swap_b32 v241, v243
    v_mfma_f32_16x16x32_bf16 v[212:215], a[28:31], v[60:63], v[212:215]
    ds_read_b128 a[28:31], v7 offset:24576
    buffer_load_dwordx4 v5, s[48:51], m0 offen offset:3072 lds
    v_mfma_f32_16x16x32_bf16 v[216:219], a[0:3], v[56:59], v[216:219]
    s_mov_b32 s18, 67584
    buffer_store_dwordx4 v[240:243], v11, s[44:47], s18 offen sc1
    v_mfma_f32_16x16x32_bf16 v[220:223], a[0:3], v[60:63], v[220:223]
    v_exp_f32 v232, v232
    v_mfma_f32_16x16x32_bf16 v[224:227], a[4:7], v[56:59], v[224:227]
    v_exp_f32 v233, v233
    v_mfma_f32_16x16x32_bf16 v[228:231], a[4:7], v[60:63], v[228:231]
    ds_read_b128 a[0:3], v6 offset:48128
    s_waitcnt lgkmcnt(4)
    v_mfma_f32_16x16x32_bf16 v[208:211], a[8:11], v[64:67], v[208:211]
    v_exp_f32 v234, v234
    v_mfma_f32_16x16x32_bf16 v[212:215], a[8:11], v[68:71], v[212:215]
    ds_read_b128 a[4:7], v7 offset:3072
    ds_read_b128 a[8:11], v7 offset:23552
    v_mfma_f32_16x16x32_bf16 v[216:219], a[12:15], v[64:67], v[216:219]
    v_exp_f32 v235, v235
    v_mfma_f32_16x16x32_bf16 v[220:223], a[12:15], v[68:71], v[220:223]
    ds_read_b128 a[12:15], v6 offset:47104
    s_add_u32 m0, s21, 49152
    v_mfma_f32_16x16x32_bf16 v[224:227], a[16:19], v[64:67], v[224:227]
    v_exp_f32 v236, v236
    v_mfma_f32_16x16x32_bf16 v[228:231], a[16:19], v[68:71], v[228:231]
    ds_read_b128 a[16:19], v7 offset:2048
    s_waitcnt lgkmcnt(5)
    v_mfma_f32_16x16x32_bf16 v[208:211], a[20:23], v[72:75], v[208:211]
    v_exp_f32 v237, v237
    v_mfma_f32_16x16x32_bf16 v[212:215], a[20:23], v[76:79], v[212:215]
    ds_read_b128 a[20:23], v7 offset:22528
    v_exp_f32 v238, v238
    v_exp_f32 v239, v239
    v_pk_fma_f32 v[232:233], v[232:233], v[254:255], v[254:255] op_sel:[0,0,0] op_sel_hi:[1,0,0]
    v_pk_fma_f32 v[234:235], v[234:235], v[254:255], v[254:255] op_sel:[0,0,0] op_sel_hi:[1,0,0]
    v_pk_fma_f32 v[236:237], v[236:237], v[254:255], v[254:255] op_sel:[0,1,1] op_sel_hi:[1,1,1]
    v_pk_fma_f32 v[238:239], v[238:239], v[254:255], v[254:255] op_sel:[0,1,1] op_sel_hi:[1,1,1]
    v_rcp_f32 v232, v232
    v_mfma_f32_16x16x32_bf16 v[216:219], a[24:27], v[72:75], v[216:219]
    v_rcp_f32 v233, v233
    v_mfma_f32_16x16x32_bf16 v[220:223], a[24:27], v[76:79], v[220:223]
    ds_read_b128 a[24:27], v6 offset:46080
    buffer_load_dwordx4 v5, s[48:51], m0 offen offset:0 lds
    v_mfma_f32_16x16x32_bf16 v[224:227], a[28:31], v[72:75], v[224:227]
    v_rcp_f32 v234, v234
    v_mfma_f32_16x16x32_bf16 v[228:231], a[28:31], v[76:79], v[228:231]
    ds_read_b128 a[28:31], v7 offset:1024
    s_waitcnt lgkmcnt(5)
    v_mfma_f32_16x16x32_bf16 v[208:211], a[0:3], v[80:83], v[208:211]
    v_rcp_f32 v235, v235
    v_mfma_f32_16x16x32_bf16 v[212:215], a[0:3], v[84:87], v[212:215]
    ds_read_b128 a[0:3], v7 offset:21504
    buffer_load_dwordx4 v5, s[48:51], m0 offen offset:1024 lds
    v_mfma_f32_16x16x32_bf16 v[216:219], a[4:7], v[80:83], v[216:219]
    v_rcp_f32 v236, v236
    v_mfma_f32_16x16x32_bf16 v[220:223], a[4:7], v[84:87], v[220:223]
    ds_read_b128 a[4:7], v6 offset:45056
    buffer_load_dwordx4 v5, s[48:51], m0 offen offset:2048 lds
    v_mfma_f32_16x16x32_bf16 v[224:227], a[8:11], v[80:83], v[224:227]
    v_rcp_f32 v237, v237
    v_mfma_f32_16x16x32_bf16 v[228:231], a[8:11], v[84:87], v[228:231]
    s_waitcnt lgkmcnt(4)
    v_rcp_f32 v238, v238
    v_rcp_f32 v239, v239
    v_pk_fma_f32 v[232:233], v[232:233], v[192:193], s[66:67]
    v_pk_fma_f32 v[234:235], v[234:235], v[194:195], s[66:67]
    v_pk_fma_f32 v[236:237], v[236:237], v[196:197], s[66:67]
    v_pk_fma_f32 v[238:239], v[238:239], v[198:199], s[66:67]
    v_pk_mul_f32 v[240:241], v[200:201], v[200:201]
    v_pk_mul_f32 v[242:243], v[202:203], v[202:203]
    v_pk_mul_f32 v[244:245], v[204:205], v[204:205]
    v_pk_mul_f32 v[246:247], v[206:207], v[206:207]
    v_pk_fma_f32 v[240:241], v[240:241], v[252:253], v[250:251] op_sel:[0,0,0] op_sel_hi:[1,0,0]
    v_pk_fma_f32 v[242:243], v[242:243], v[252:253], v[250:251] op_sel:[0,0,0] op_sel_hi:[1,0,0]
    v_pk_fma_f32 v[244:245], v[244:245], v[252:253], v[250:251] op_sel:[0,1,1] op_sel_hi:[1,1,1]
    v_pk_fma_f32 v[246:247], v[246:247], v[252:253], v[250:251] op_sel:[0,1,1] op_sel_hi:[1,1,1]
    v_pk_mul_f32 v[240:241], v[240:241], v[200:201]
    v_pk_mul_f32 v[242:243], v[242:243], v[202:203]
    v_pk_mul_f32 v[244:245], v[244:245], v[204:205]
    v_pk_mul_f32 v[246:247], v[246:247], v[206:207]
    v_cvt_pk_bf16_f32 v232, v232, v233
    v_mfma_f32_16x16x32_bf16 v[208:211], a[12:15], v[88:91], v[208:211]
    ds_read_b128 a[8:11], v7 offset:0
    buffer_load_dwordx4 v5, s[48:51], m0 offen offset:3072 lds
    v_mfma_f32_16x16x32_bf16 v[212:215], a[12:15], v[92:95], v[212:215]
    ds_read_b128 a[12:15], v7 offset:20480
    s_add_u32 m0, s21, 53248
    v_mfma_f32_16x16x32_bf16 v[216:219], a[16:19], v[88:91], v[216:219]
    buffer_load_dwordx4 v5, s[48:51], m0 offen offset:0 lds
    v_cvt_pk_bf16_f32 v233, v234, v235
    v_mfma_f32_16x16x32_bf16 v[220:223], a[16:19], v[92:95], v[220:223]
    ds_read_b128 a[16:19], v6 offset:44032
    buffer_load_dwordx4 v5, s[48:51], m0 offen offset:1024 lds
    v_mfma_f32_16x16x32_bf16 v[224:227], a[20:23], v[88:91], v[224:227]
    v_cvt_pk_bf16_f32 v234, v236, v237
    v_cvt_pk_bf16_f32 v235, v238, v239
    v_mfma_f32_16x16x32_bf16 v[228:231], a[20:23], v[92:95], v[228:231]
    ds_read_b128 a[20:23], v6 offset:64512
    s_waitcnt lgkmcnt(5)
    v_mfma_f32_16x16x32_bf16 v[208:211], a[24:27], v[96:99], v[208:211]
    v_permlane16_swap_b32 v232, v234
    v_mfma_f32_16x16x32_bf16 v[212:215], a[24:27], v[100:103], v[212:215]
    ds_read_b128 a[24:27], v7 offset:19456
    buffer_load_dwordx4 v5, s[48:51], m0 offen offset:2048 lds
    v_mfma_f32_16x16x32_bf16 v[216:219], a[28:31], v[96:99], v[216:219]
    v_permlane16_swap_b32 v233, v235
    v_mfma_f32_16x16x32_bf16 v[220:223], a[28:31], v[100:103], v[220:223]
    ds_read_b128 a[28:31], v6 offset:43008
    s_mov_b32 s18, 135168
    v_mfma_f32_16x16x32_bf16 v[224:227], a[0:3], v[96:99], v[224:227]
    buffer_store_dwordx4 v[232:235], v11, s[44:47], s18 offen sc1
    v_mfma_f32_16x16x32_bf16 v[228:231], a[0:3], v[100:103], v[228:231]
    ds_read_b128 a[0:3], v6 offset:63488
    s_waitcnt lgkmcnt(5)
    v_mfma_f32_16x16x32_bf16 v[208:211], a[4:7], v[104:107], v[208:211]
    v_exp_f32 v240, v240
    v_mfma_f32_16x16x32_bf16 v[212:215], a[4:7], v[108:111], v[212:215]
    v_exp_f32 v241, v241
    v_mfma_f32_16x16x32_bf16 v[216:219], a[8:11], v[104:107], v[216:219]
    v_exp_f32 v242, v242
    v_mfma_f32_16x16x32_bf16 v[220:223], a[8:11], v[108:111], v[220:223]
    ds_read_b128 a[4:7], v7 offset:18432
    ds_read_b128 a[8:11], v6 offset:41984
    v_mfma_f32_16x16x32_bf16 v[224:227], a[12:15], v[104:107], v[224:227]
    v_exp_f32 v243, v243
    v_mfma_f32_16x16x32_bf16 v[228:231], a[12:15], v[108:111], v[228:231]
    ds_read_b128 a[12:15], v6 offset:62464
    s_waitcnt lgkmcnt(5)
    v_mfma_f32_16x16x32_bf16 v[208:211], a[16:19], v[112:115], v[208:211]
    v_exp_f32 v244, v244
    v_mfma_f32_16x16x32_bf16 v[212:215], a[16:19], v[116:119], v[212:215]
    ds_read_b128 a[16:19], v7 offset:17408
    buffer_load_dwordx4 a[248:251], v15, s[52:55], s63 offen offset:1024
    v_mfma_f32_16x16x32_bf16 v[216:219], a[20:23], v[112:115], v[216:219]
    v_exp_f32 v245, v245
    v_mfma_f32_16x16x32_bf16 v[220:223], a[20:23], v[116:119], v[220:223]
    ds_read_b128 a[20:23], v6 offset:40960
    v_exp_f32 v246, v246
    v_exp_f32 v247, v247
    v_pk_fma_f32 v[240:241], v[240:241], v[254:255], v[254:255] op_sel:[0,0,0] op_sel_hi:[1,0,0]
    v_pk_fma_f32 v[242:243], v[242:243], v[254:255], v[254:255] op_sel:[0,0,0] op_sel_hi:[1,0,0]
    v_pk_fma_f32 v[244:245], v[244:245], v[254:255], v[254:255] op_sel:[0,1,1] op_sel_hi:[1,1,1]
    v_pk_fma_f32 v[246:247], v[246:247], v[254:255], v[254:255] op_sel:[0,1,1] op_sel_hi:[1,1,1]
    v_rcp_f32 v240, v240
    v_mfma_f32_16x16x32_bf16 v[224:227], a[24:27], v[112:115], v[224:227]
    s_add_u32 m0, s20, 0
    s_mov_b32 s63, 389120
    v_mfma_f32_16x16x32_bf16 v[228:231], a[24:27], v[116:119], v[228:231]
    ds_read_b128 a[24:27], v6 offset:61440
    s_waitcnt lgkmcnt(5)
    v_mfma_f32_16x16x32_bf16 v[208:211], a[28:31], v[120:123], v[208:211]
    v_rcp_f32 v241, v241
    v_mfma_f32_16x16x32_bf16 v[212:215], a[28:31], v[124:127], v[212:215]
    ds_read_b128 a[28:31], v7 offset:16384
    buffer_load_dwordx4 v15, s[52:55], s63 offen offset:0 lds
    v_mfma_f32_16x16x32_bf16 v[216:219], a[0:3], v[120:123], v[216:219]
    s_add_u32 m0, s20, 768
    s_nop 0
    buffer_load_dwordx4 v15, s[52:55], s63 offen offset:256 lds
    v_mfma_f32_16x16x32_bf16 v[220:223], a[0:3], v[124:127], v[220:223]
    v_rcp_f32 v242, v242
    v_mfma_f32_16x16x32_bf16 v[224:227], a[4:7], v[120:123], v[224:227]
    v_rcp_f32 v243, v243
    v_mfma_f32_16x16x32_bf16 v[228:231], a[4:7], v[124:127], v[228:231]
    ds_read_b128 a[0:3], v6 offset:39936
    s_waitcnt lgkmcnt(4)
    v_mfma_f32_16x16x32_bf16 v[208:211], a[8:11], v[128:131], v[208:211]
    ds_read_b128 a[4:7], v6 offset:60416
    s_add_u32 m0, s20, 1536
    v_mfma_f32_16x16x32_bf16 v[212:215], a[8:11], v[132:135], v[212:215]
    ds_read_b128 a[8:11], v7 offset:15360
    buffer_load_dwordx4 v15, s[52:55], s63 offen offset:512 lds
    v_mfma_f32_16x16x32_bf16 v[216:219], a[12:15], v[128:131], v[216:219]
    v_rcp_f32 v244, v244
    v_mfma_f32_16x16x32_bf16 v[220:223], a[12:15], v[132:135], v[220:223]
    v_rcp_f32 v245, v245
    v_mfma_f32_16x16x32_bf16 v[224:227], a[16:19], v[128:131], v[224:227]
    ds_read_b128 a[12:15], v6 offset:38912
    v_rcp_f32 v246, v246
    v_rcp_f32 v247, v247
    v_pk_fma_f32 v[240:241], v[240:241], v[200:201], s[66:67]
    v_pk_fma_f32 v[242:243], v[242:243], v[202:203], s[66:67]
    v_pk_fma_f32 v[244:245], v[244:245], v[204:205], s[66:67]
    v_pk_fma_f32 v[246:247], v[246:247], v[206:207], s[66:67]
    v_cvt_pk_bf16_f32 v240, v240, v241
    v_mfma_f32_16x16x32_bf16 v[228:231], a[16:19], v[132:135], v[228:231]
    ds_read_b128 a[16:19], v6 offset:59392
    s_waitcnt lgkmcnt(5)
    v_mfma_f32_16x16x32_bf16 v[208:211], a[20:23], v[136:139], v[208:211]
    s_add_u32 m0, s20, 2304
    s_nop 0
    buffer_load_dwordx4 v15, s[52:55], s63 offen offset:768 lds
    v_mfma_f32_16x16x32_bf16 v[212:215], a[20:23], v[140:143], v[212:215]
    ds_read_b128 a[20:23], v7 offset:14336
    s_add_u32 m0, s20, 3072
    v_mfma_f32_16x16x32_bf16 v[216:219], a[24:27], v[136:139], v[216:219]
    buffer_load_dwordx4 v15, s[52:55], s63 offen offset:1024 lds
    v_cvt_pk_bf16_f32 v241, v242, v243
    v_mfma_f32_16x16x32_bf16 v[220:223], a[24:27], v[140:143], v[220:223]
    ds_read_b128 a[24:27], v6 offset:37888
    v_cvt_pk_bf16_f32 v242, v244, v245
    v_mfma_f32_16x16x32_bf16 v[224:227], a[28:31], v[136:139], v[224:227]
    v_cvt_pk_bf16_f32 v243, v246, v247
    v_mfma_f32_16x16x32_bf16 v[228:231], a[28:31], v[140:143], v[228:231]
    ds_read_b128 a[28:31], v6 offset:58368
    s_waitcnt lgkmcnt(5)
    v_mfma_f32_16x16x32_bf16 v[208:211], a[0:3], v[144:147], v[208:211]
    s_add_u32 m0, s20, 20480
    s_mov_b32 s63, 122880
    v_mfma_f32_16x16x32_bf16 v[212:215], a[0:3], v[148:151], v[212:215]
    ds_read_b128 a[0:3], v7 offset:13312
    buffer_load_dwordx4 v15, s[52:55], s63 offen offset:0 lds
    v_mfma_f32_16x16x32_bf16 v[216:219], a[4:7], v[144:147], v[216:219]
    v_permlane16_swap_b32 v240, v242
    v_mfma_f32_16x16x32_bf16 v[220:223], a[4:7], v[148:151], v[220:223]
    v_permlane16_swap_b32 v241, v243
    v_mfma_f32_16x16x32_bf16 v[224:227], a[8:11], v[144:147], v[224:227]
    ds_read_b128 a[4:7], v6 offset:36864
    s_add_u32 m0, s20, 21248
    v_mfma_f32_16x16x32_bf16 v[228:231], a[8:11], v[148:151], v[228:231]
    ds_read_b128 a[8:11], v6 offset:57344
    s_waitcnt lgkmcnt(5)
    v_mfma_f32_16x16x32_bf16 v[208:211], a[12:15], v[152:155], v[208:211]
    s_waitcnt vmcnt(8)
    s_barrier
    v_mfma_f32_16x16x32_bf16 v[212:215], a[12:15], v[156:159], v[212:215]
    ds_read_b128 a[12:15], v7 offset:12288
    buffer_load_dwordx4 v15, s[52:55], s63 offen offset:256 lds
    v_mfma_f32_16x16x32_bf16 v[216:219], a[16:19], v[152:155], v[216:219]
    s_add_u32 m0, s20, 22016
    s_nop 0
    buffer_load_dwordx4 v15, s[52:55], s63 offen offset:512 lds
    v_mfma_f32_16x16x32_bf16 v[220:223], a[16:19], v[156:159], v[220:223]
    ds_read_b128 a[16:19], v5 offset:60416
    s_add_u32 m0, s20, 22784
    v_mfma_f32_16x16x32_bf16 v[224:227], a[20:23], v[152:155], v[224:227]
    buffer_load_dwordx4 v15, s[52:55], s63 offen offset:768 lds
    s_mov_b32 s18, 202752
    v_mfma_f32_16x16x32_bf16 v[228:231], a[20:23], v[156:159], v[228:231]
    ds_read_b128 a[20:23], v6 offset:15360
    s_waitcnt lgkmcnt(5)
    v_mfma_f32_16x16x32_bf16 v[208:211], a[24:27], v[160:163], v[208:211]
    s_add_u32 m0, s20, 23552
    s_nop 0
    buffer_load_dwordx4 v15, s[52:55], s63 offen offset:1024 lds
    v_mfma_f32_16x16x32_bf16 v[212:215], a[24:27], v[164:167], v[212:215]
    ds_read_b128 a[24:27], v6 offset:35840
    buffer_store_dwordx4 v[240:243], v11, s[44:47], s18 offen sc1
    v_mfma_f32_16x16x32_bf16 v[216:219], a[28:31], v[160:163], v[216:219]
    v_mfma_f32_16x16x32_bf16 v[220:223], a[28:31], v[164:167], v[220:223]
    ds_read_b128 a[28:31], v5 offset:59392
    v_mfma_f32_16x16x32_bf16 v[224:227], a[0:3], v[160:163], v[224:227]
    v_mfma_f32_16x16x32_bf16 v[228:231], a[0:3], v[164:167], v[228:231]
    ds_read_b128 a[0:3], v6 offset:14336
    s_waitcnt lgkmcnt(5)
    v_mfma_f32_16x16x32_bf16 v[208:211], a[4:7], v[168:171], v[208:211]
    v_mfma_f32_16x16x32_bf16 v[212:215], a[4:7], v[172:175], v[212:215]
    ds_read_b128 a[4:7], v6 offset:34816
    v_mfma_f32_16x16x32_bf16 v[216:219], a[8:11], v[168:171], v[216:219]
    v_mfma_f32_16x16x32_bf16 v[220:223], a[8:11], v[172:175], v[220:223]
    ds_read_b128 a[8:11], v5 offset:58368
    v_mfma_f32_16x16x32_bf16 v[224:227], a[12:15], v[168:171], v[224:227]
    v_mfma_f32_16x16x32_bf16 v[228:231], a[12:15], v[172:175], v[228:231]
    ds_read_b128 a[12:15], v6 offset:13312
    s_waitcnt lgkmcnt(5)
    v_mfma_f32_16x16x32_bf16 v[176:179], a[16:19], v[16:19], 0
    v_accvgpr_read_b32 v168, a254
    v_accvgpr_read_b32 v172, a255
    v_mfma_f32_16x16x32_bf16 v[180:183], a[16:19], v[20:23], 0
    ds_read_b128 a[16:19], v6 offset:33792
    v_pk_mul_f32 v[232:233], v[208:209], v[208:209]
    v_pk_mul_f32 v[234:235], v[210:211], v[210:211]
    v_pk_mul_f32 v[236:237], v[212:213], v[212:213]
    v_pk_mul_f32 v[238:239], v[214:215], v[214:215]
    v_pk_fma_f32 v[232:233], v[232:233], v[252:253], v[250:251] op_sel:[0,0,0] op_sel_hi:[1,0,0]
    v_pk_fma_f32 v[234:235], v[234:235], v[252:253], v[250:251] op_sel:[0,0,0] op_sel_hi:[1,0,0]
    v_pk_fma_f32 v[236:237], v[236:237], v[252:253], v[250:251] op_sel:[0,1,1] op_sel_hi:[1,1,1]
    v_pk_fma_f32 v[238:239], v[238:239], v[252:253], v[250:251] op_sel:[0,1,1] op_sel_hi:[1,1,1]
    v_pk_mul_f32 v[232:233], v[232:233], v[208:209]
    v_pk_mul_f32 v[234:235], v[234:235], v[210:211]
    v_pk_mul_f32 v[236:237], v[236:237], v[212:213]
    v_pk_mul_f32 v[238:239], v[238:239], v[214:215]
    v_exp_f32 v232, v232
    v_mfma_f32_16x16x32_bf16 v[184:187], a[20:23], v[16:19], 0
    v_exp_f32 v233, v233
    v_mfma_f32_16x16x32_bf16 v[188:191], a[20:23], v[20:23], 0
    v_exp_f32 v234, v234
    v_mfma_f32_16x16x32_bf16 v[192:195], a[24:27], v[16:19], 0
    v_exp_f32 v235, v235
    v_mfma_f32_16x16x32_bf16 v[196:199], a[24:27], v[20:23], 0
    ds_read_b128 a[20:23], v5 offset:57344
    s_waitcnt lgkmcnt(4)
    v_mfma_f32_16x16x32_bf16 v[176:179], a[28:31], v[24:27], v[176:179]
    ds_read_b128 a[24:27], v6 offset:12288
    s_mov_b32 s65, 0
    v_mfma_f32_16x16x32_bf16 v[180:183], a[28:31], v[28:31], v[180:183]
    ds_read_b128 a[28:31], v6 offset:32768
    buffer_load_dwordx4 v[16:19], v13, s[8:11], s65 offen sc1
    v_mfma_f32_16x16x32_bf16 v[184:187], a[0:3], v[24:27], v[184:187]
    v_exp_f32 v236, v236
    v_mfma_f32_16x16x32_bf16 v[188:191], a[0:3], v[28:31], v[188:191]
    ds_read_b128 a[0:3], v5 offset:56320
    buffer_load_dwordx4 v[20:23], v4, s[8:11], s65 offen sc1
    v_mfma_f32_16x16x32_bf16 v[192:195], a[4:7], v[24:27], v[192:195]
    v_exp_f32 v237, v237
    v_mfma_f32_16x16x32_bf16 v[196:199], a[4:7], v[28:31], v[196:199]
    s_waitcnt lgkmcnt(4)
    v_exp_f32 v238, v238
    v_exp_f32 v239, v239
    v_pk_fma_f32 v[232:233], v[232:233], v[254:255], v[254:255] op_sel:[0,0,0] op_sel_hi:[1,0,0]
    v_pk_fma_f32 v[234:235], v[234:235], v[254:255], v[254:255] op_sel:[0,0,0] op_sel_hi:[1,0,0]
    v_pk_fma_f32 v[236:237], v[236:237], v[254:255], v[254:255] op_sel:[0,1,1] op_sel_hi:[1,1,1]
    v_pk_fma_f32 v[238:239], v[238:239], v[254:255], v[254:255] op_sel:[0,1,1] op_sel_hi:[1,1,1]
    v_rcp_f32 v232, v232
    v_mfma_f32_16x16x32_bf16 v[176:179], a[8:11], v[32:35], v[176:179]
    ds_read_b128 a[4:7], v6 offset:11264
    buffer_load_dwordx4 v[24:27], v8, s[8:11], s65 offen sc1
    v_mfma_f32_16x16x32_bf16 v[180:183], a[8:11], v[36:39], v[180:183]
    ds_read_b128 a[8:11], v6 offset:31744
    buffer_load_dwordx4 v[28:31], v10, s[8:11], s65 offen sc1
    v_mfma_f32_16x16x32_bf16 v[184:187], a[12:15], v[32:35], v[184:187]
    v_rcp_f32 v233, v233
    v_mfma_f32_16x16x32_bf16 v[188:191], a[12:15], v[36:39], v[188:191]
    v_rcp_f32 v234, v234
    v_mfma_f32_16x16x32_bf16 v[192:195], a[16:19], v[32:35], v[192:195]
    v_rcp_f32 v235, v235
    v_mfma_f32_16x16x32_bf16 v[196:199], a[16:19], v[36:39], v[196:199]
    ds_read_b128 a[12:15], v5 offset:55296
    s_waitcnt lgkmcnt(4)
    v_mfma_f32_16x16x32_bf16 v[176:179], a[20:23], v[40:43], v[176:179]
    ds_read_b128 a[16:19], v6 offset:10240
    s_mov_b32 s65, 946176
    v_mfma_f32_16x16x32_bf16 v[180:183], a[20:23], v[44:47], v[180:183]
    ds_read_b128 a[20:23], v6 offset:30720
    buffer_load_dwordx4 v[32:35], v13, s[8:11], s65 offen sc1
    v_mfma_f32_16x16x32_bf16 v[184:187], a[24:27], v[40:43], v[184:187]
    v_rcp_f32 v236, v236
    v_mfma_f32_16x16x32_bf16 v[188:191], a[24:27], v[44:47], v[188:191]
    ds_read_b128 a[24:27], v5 offset:54272
    buffer_load_dwordx4 v[36:39], v4, s[8:11], s65 offen sc1
    v_mfma_f32_16x16x32_bf16 v[192:195], a[28:31], v[40:43], v[192:195]
    v_rcp_f32 v237, v237
    v_mfma_f32_16x16x32_bf16 v[196:199], a[28:31], v[44:47], v[196:199]
    s_waitcnt lgkmcnt(4)
    v_rcp_f32 v238, v238
    v_rcp_f32 v239, v239
    v_pk_fma_f32 v[232:233], v[232:233], v[208:209], s[66:67]
    v_pk_fma_f32 v[234:235], v[234:235], v[210:211], s[66:67]
    v_pk_fma_f32 v[236:237], v[236:237], v[212:213], s[66:67]
    v_pk_fma_f32 v[238:239], v[238:239], v[214:215], s[66:67]
    v_pk_mul_f32 v[240:241], v[216:217], v[216:217]
    v_pk_mul_f32 v[242:243], v[218:219], v[218:219]
    v_pk_mul_f32 v[244:245], v[220:221], v[220:221]
    v_pk_mul_f32 v[246:247], v[222:223], v[222:223]
    v_pk_fma_f32 v[240:241], v[240:241], v[252:253], v[250:251] op_sel:[0,0,0] op_sel_hi:[1,0,0]
    v_pk_fma_f32 v[242:243], v[242:243], v[252:253], v[250:251] op_sel:[0,0,0] op_sel_hi:[1,0,0]
    v_pk_fma_f32 v[244:245], v[244:245], v[252:253], v[250:251] op_sel:[0,1,1] op_sel_hi:[1,1,1]
    v_pk_fma_f32 v[246:247], v[246:247], v[252:253], v[250:251] op_sel:[0,1,1] op_sel_hi:[1,1,1]
    v_pk_mul_f32 v[240:241], v[240:241], v[216:217]
    v_pk_mul_f32 v[242:243], v[242:243], v[218:219]
    v_pk_mul_f32 v[244:245], v[244:245], v[220:221]
    v_pk_mul_f32 v[246:247], v[246:247], v[222:223]
    v_cvt_pk_bf16_f32 v232, v232, v233
    v_mfma_f32_16x16x32_bf16 v[176:179], a[0:3], v[48:51], v[176:179]
    ds_read_b128 a[28:31], v6 offset:9216
    buffer_load_dwordx4 v[40:43], v8, s[8:11], s65 offen sc1
    v_mfma_f32_16x16x32_bf16 v[180:183], a[0:3], v[52:55], v[180:183]
    ds_read_b128 a[0:3], v6 offset:29696
    buffer_load_dwordx4 v[44:47], v10, s[8:11], s65 offen sc1
    v_mfma_f32_16x16x32_bf16 v[184:187], a[4:7], v[48:51], v[184:187]
    v_cvt_pk_bf16_f32 v233, v234, v235
    v_cvt_pk_bf16_f32 v234, v236, v237
    v_mfma_f32_16x16x32_bf16 v[188:191], a[4:7], v[52:55], v[188:191]
    ds_read_b128 a[4:7], v5 offset:53248
    v_cvt_pk_bf16_f32 v235, v238, v239
    v_mfma_f32_16x16x32_bf16 v[192:195], a[8:11], v[48:51], v[192:195]
    v_permlane16_swap_b32 v232, v234
    v_mfma_f32_16x16x32_bf16 v[196:199], a[8:11], v[52:55], v[196:199]
    ds_read_b128 a[8:11], v6 offset:8192
    s_waitcnt lgkmcnt(5)
    v_mfma_f32_16x16x32_bf16 v[176:179], a[12:15], v[56:59], v[176:179]
    s_mov_b32 s65, 67584
    buffer_load_dwordx4 v[48:51], v13, s[8:11], s65 offen sc1
    v_mfma_f32_16x16x32_bf16 v[180:183], a[12:15], v[60:63], v[180:183]
    ds_read_b128 a[12:15], v6 offset:28672
    buffer_load_dwordx4 v[52:55], v4, s[8:11], s65 offen sc1
    v_mfma_f32_16x16x32_bf16 v[184:187], a[16:19], v[56:59], v[184:187]
    v_permlane16_swap_b32 v233, v235
    v_mfma_f32_16x16x32_bf16 v[188:191], a[16:19], v[60:63], v[188:191]
    ds_read_b128 a[16:19], v5 offset:52224
    s_mov_b32 s18, 270336
    v_mfma_f32_16x16x32_bf16 v[192:195], a[20:23], v[56:59], v[192:195]
    buffer_store_dwordx4 v[232:235], v11, s[44:47], s18 offen sc1
    v_mfma_f32_16x16x32_bf16 v[196:199], a[20:23], v[60:63], v[196:199]
    ds_read_b128 a[20:23], v6 offset:7168
    s_waitcnt lgkmcnt(5)
    v_mfma_f32_16x16x32_bf16 v[176:179], a[24:27], v[64:67], v[176:179]
    v_exp_f32 v240, v240
    v_mfma_f32_16x16x32_bf16 v[180:183], a[24:27], v[68:71], v[180:183]
    v_exp_f32 v241, v241
    v_mfma_f32_16x16x32_bf16 v[184:187], a[28:31], v[64:67], v[184:187]
    v_exp_f32 v242, v242
    v_mfma_f32_16x16x32_bf16 v[188:191], a[28:31], v[68:71], v[188:191]
    ds_read_b128 a[24:27], v6 offset:27648
    ds_read_b128 a[28:31], v5 offset:51200
    v_mfma_f32_16x16x32_bf16 v[192:195], a[0:3], v[64:67], v[192:195]
    v_exp_f32 v243, v243
    v_mfma_f32_16x16x32_bf16 v[196:199], a[0:3], v[68:71], v[196:199]
    ds_read_b128 a[0:3], v6 offset:6144
    s_waitcnt lgkmcnt(5)
    v_mfma_f32_16x16x32_bf16 v[176:179], a[4:7], v[72:75], v[176:179]
    v_exp_f32 v244, v244
    v_mfma_f32_16x16x32_bf16 v[180:183], a[4:7], v[76:79], v[180:183]
    ds_read_b128 a[4:7], v6 offset:26624
    buffer_load_dwordx4 v[56:59], v8, s[8:11], s65 offen sc1
    v_mfma_f32_16x16x32_bf16 v[184:187], a[8:11], v[72:75], v[184:187]
    v_exp_f32 v245, v245
    v_mfma_f32_16x16x32_bf16 v[188:191], a[8:11], v[76:79], v[188:191]
    ds_read_b128 a[8:11], v5 offset:50176
    v_exp_f32 v246, v246
    v_exp_f32 v247, v247
    v_pk_fma_f32 v[240:241], v[240:241], v[254:255], v[254:255] op_sel:[0,0,0] op_sel_hi:[1,0,0]
    v_pk_fma_f32 v[242:243], v[242:243], v[254:255], v[254:255] op_sel:[0,0,0] op_sel_hi:[1,0,0]
    v_pk_fma_f32 v[244:245], v[244:245], v[254:255], v[254:255] op_sel:[0,1,1] op_sel_hi:[1,1,1]
    v_pk_fma_f32 v[246:247], v[246:247], v[254:255], v[254:255] op_sel:[0,1,1] op_sel_hi:[1,1,1]
    v_rcp_f32 v240, v240
    v_mfma_f32_16x16x32_bf16 v[192:195], a[12:15], v[72:75], v[192:195]
    v_rcp_f32 v241, v241
    v_mfma_f32_16x16x32_bf16 v[196:199], a[12:15], v[76:79], v[196:199]
    ds_read_b128 a[12:15], v6 offset:5120
    s_waitcnt lgkmcnt(5)
    v_mfma_f32_16x16x32_bf16 v[176:179], a[16:19], v[80:83], v[176:179]
    v_rcp_f32 v242, v242
    v_mfma_f32_16x16x32_bf16 v[180:183], a[16:19], v[84:87], v[180:183]
    ds_read_b128 a[16:19], v6 offset:25600
    buffer_load_dwordx4 v[60:63], v10, s[8:11], s65 offen sc1
    v_mfma_f32_16x16x32_bf16 v[184:187], a[20:23], v[80:83], v[184:187]
    s_mov_b32 s65, 1013760
    buffer_load_dwordx4 v[64:67], v13, s[8:11], s65 offen sc1
    v_mfma_f32_16x16x32_bf16 v[188:191], a[20:23], v[84:87], v[188:191]
    v_rcp_f32 v243, v243
    v_mfma_f32_16x16x32_bf16 v[192:195], a[24:27], v[80:83], v[192:195]
    v_rcp_f32 v244, v244
    v_mfma_f32_16x16x32_bf16 v[196:199], a[24:27], v[84:87], v[196:199]
    ds_read_b128 a[20:23], v5 offset:49152
    s_waitcnt lgkmcnt(4)
    v_mfma_f32_16x16x32_bf16 v[176:179], a[28:31], v[88:91], v[176:179]
    ds_read_b128 a[24:27], v6 offset:4096
    buffer_load_dwordx4 v[68:71], v4, s[8:11], s65 offen sc1
    v_mfma_f32_16x16x32_bf16 v[180:183], a[28:31], v[92:95], v[180:183]
    v_rcp_f32 v245, v245
    v_mfma_f32_16x16x32_bf16 v[184:187], a[0:3], v[88:91], v[184:187]
    ds_read_b128 a[28:31], v6 offset:24576
    v_rcp_f32 v246, v246
    v_rcp_f32 v247, v247
    v_pk_fma_f32 v[240:241], v[240:241], v[216:217], s[66:67]
    v_pk_fma_f32 v[242:243], v[242:243], v[218:219], s[66:67]
    v_pk_fma_f32 v[244:245], v[244:245], v[220:221], s[66:67]
    v_pk_fma_f32 v[246:247], v[246:247], v[222:223], s[66:67]
    v_pk_mul_f32 v[232:233], v[224:225], v[224:225]
    v_pk_mul_f32 v[234:235], v[226:227], v[226:227]
    v_pk_mul_f32 v[236:237], v[228:229], v[228:229]
    v_pk_mul_f32 v[238:239], v[230:231], v[230:231]
    v_pk_fma_f32 v[232:233], v[232:233], v[252:253], v[250:251] op_sel:[0,0,0] op_sel_hi:[1,0,0]
    v_pk_fma_f32 v[234:235], v[234:235], v[252:253], v[250:251] op_sel:[0,0,0] op_sel_hi:[1,0,0]
    v_pk_fma_f32 v[236:237], v[236:237], v[252:253], v[250:251] op_sel:[0,1,1] op_sel_hi:[1,1,1]
    v_pk_fma_f32 v[238:239], v[238:239], v[252:253], v[250:251] op_sel:[0,1,1] op_sel_hi:[1,1,1]
    v_pk_mul_f32 v[232:233], v[232:233], v[224:225]
    v_pk_mul_f32 v[234:235], v[234:235], v[226:227]
    v_pk_mul_f32 v[236:237], v[236:237], v[228:229]
    v_pk_mul_f32 v[238:239], v[238:239], v[230:231]
    v_cvt_pk_bf16_f32 v240, v240, v241
    v_mfma_f32_16x16x32_bf16 v[188:191], a[0:3], v[92:95], v[188:191]
    ds_read_b128 a[0:3], v5 offset:48128
    buffer_load_dwordx4 v[72:75], v8, s[8:11], s65 offen sc1
    v_mfma_f32_16x16x32_bf16 v[192:195], a[4:7], v[88:91], v[192:195]
    buffer_load_dwordx4 v[76:79], v10, s[8:11], s65 offen sc1
    v_cvt_pk_bf16_f32 v241, v242, v243
    v_mfma_f32_16x16x32_bf16 v[196:199], a[4:7], v[92:95], v[196:199]
    ds_read_b128 a[4:7], v6 offset:3072
    s_waitcnt lgkmcnt(5)
    v_mfma_f32_16x16x32_bf16 v[176:179], a[8:11], v[96:99], v[176:179]
    v_cvt_pk_bf16_f32 v242, v244, v245
    v_cvt_pk_bf16_f32 v243, v246, v247
    v_mfma_f32_16x16x32_bf16 v[180:183], a[8:11], v[100:103], v[180:183]
    v_permlane16_swap_b32 v240, v242
    v_mfma_f32_16x16x32_bf16 v[184:187], a[12:15], v[96:99], v[184:187]
    ds_read_b128 a[8:11], v6 offset:23552
    s_mov_b32 s65, 135168
    v_mfma_f32_16x16x32_bf16 v[188:191], a[12:15], v[100:103], v[188:191]
    ds_read_b128 a[12:15], v5 offset:47104
    buffer_load_dwordx4 v[80:83], v13, s[8:11], s65 offen sc1
    v_mfma_f32_16x16x32_bf16 v[192:195], a[16:19], v[96:99], v[192:195]
    v_permlane16_swap_b32 v241, v243
    v_mfma_f32_16x16x32_bf16 v[196:199], a[16:19], v[100:103], v[196:199]
    ds_read_b128 a[16:19], v6 offset:2048
    s_waitcnt lgkmcnt(5)
    v_mfma_f32_16x16x32_bf16 v[176:179], a[20:23], v[104:107], v[176:179]
    buffer_load_dwordx4 v[84:87], v4, s[8:11], s65 offen sc1
    s_mov_b32 s18, 337920
    v_mfma_f32_16x16x32_bf16 v[180:183], a[20:23], v[108:111], v[180:183]
    ds_read_b128 a[20:23], v6 offset:22528
    buffer_store_dwordx4 v[240:243], v11, s[44:47], s18 offen sc1
    v_mfma_f32_16x16x32_bf16 v[184:187], a[24:27], v[104:107], v[184:187]
    v_exp_f32 v232, v232
    v_mfma_f32_16x16x32_bf16 v[188:191], a[24:27], v[108:111], v[188:191]
    v_exp_f32 v233, v233
    v_mfma_f32_16x16x32_bf16 v[192:195], a[28:31], v[104:107], v[192:195]
    v_exp_f32 v234, v234
    v_mfma_f32_16x16x32_bf16 v[196:199], a[28:31], v[108:111], v[196:199]
    ds_read_b128 a[24:27], v5 offset:46080
    s_waitcnt lgkmcnt(4)
    v_mfma_f32_16x16x32_bf16 v[176:179], a[0:3], v[112:115], v[176:179]
    v_exp_f32 v235, v235
    v_mfma_f32_16x16x32_bf16 v[180:183], a[0:3], v[116:119], v[180:183]
    ds_read_b128 a[28:31], v6 offset:1024
    ds_read_b128 a[0:3], v6 offset:21504
    v_mfma_f32_16x16x32_bf16 v[184:187], a[4:7], v[112:115], v[184:187]
    v_exp_f32 v236, v236
    v_mfma_f32_16x16x32_bf16 v[188:191], a[4:7], v[116:119], v[188:191]
    ds_read_b128 a[4:7], v5 offset:45056
    buffer_load_dwordx4 v[88:91], v8, s[8:11], s65 offen sc1
    v_mfma_f32_16x16x32_bf16 v[192:195], a[8:11], v[112:115], v[192:195]
    v_exp_f32 v237, v237
    v_mfma_f32_16x16x32_bf16 v[196:199], a[8:11], v[116:119], v[196:199]
    s_waitcnt lgkmcnt(4)
    v_exp_f32 v238, v238
    v_exp_f32 v239, v239
    v_pk_fma_f32 v[232:233], v[232:233], v[254:255], v[254:255] op_sel:[0,0,0] op_sel_hi:[1,0,0]
    v_pk_fma_f32 v[234:235], v[234:235], v[254:255], v[254:255] op_sel:[0,0,0] op_sel_hi:[1,0,0]
    v_pk_fma_f32 v[236:237], v[236:237], v[254:255], v[254:255] op_sel:[0,1,1] op_sel_hi:[1,1,1]
    v_pk_fma_f32 v[238:239], v[238:239], v[254:255], v[254:255] op_sel:[0,1,1] op_sel_hi:[1,1,1]
    v_rcp_f32 v232, v232
    v_mfma_f32_16x16x32_bf16 v[176:179], a[12:15], v[120:123], v[176:179]
    ds_read_b128 a[8:11], v6 offset:0
    buffer_load_dwordx4 v[92:95], v10, s[8:11], s65 offen sc1
    v_mfma_f32_16x16x32_bf16 v[180:183], a[12:15], v[124:127], v[180:183]
    v_rcp_f32 v233, v233
    v_mfma_f32_16x16x32_bf16 v[184:187], a[16:19], v[120:123], v[184:187]
    v_rcp_f32 v234, v234
    v_mfma_f32_16x16x32_bf16 v[188:191], a[16:19], v[124:127], v[188:191]
    ds_read_b128 a[12:15], v6 offset:20480
    ds_read_b128 a[16:19], v5 offset:44032
    v_mfma_f32_16x16x32_bf16 v[192:195], a[20:23], v[120:123], v[192:195]
    v_rcp_f32 v235, v235
    v_mfma_f32_16x16x32_bf16 v[196:199], a[20:23], v[124:127], v[196:199]
    ds_read_b128 a[20:23], v5 offset:64512
    s_waitcnt lgkmcnt(5)
    v_mfma_f32_16x16x32_bf16 v[176:179], a[24:27], v[128:131], v[176:179]
    v_rcp_f32 v236, v236
    v_mfma_f32_16x16x32_bf16 v[180:183], a[24:27], v[132:135], v[180:183]
    v_rcp_f32 v237, v237
    v_mfma_f32_16x16x32_bf16 v[184:187], a[28:31], v[128:131], v[184:187]
    ds_read_b128 a[24:27], v6 offset:19456
    v_rcp_f32 v238, v238
    v_rcp_f32 v239, v239
    v_pk_fma_f32 v[232:233], v[232:233], v[224:225], s[66:67]
    v_pk_fma_f32 v[234:235], v[234:235], v[226:227], s[66:67]
    v_pk_fma_f32 v[236:237], v[236:237], v[228:229], s[66:67]
    v_pk_fma_f32 v[238:239], v[238:239], v[230:231], s[66:67]
    v_cvt_pk_bf16_f32 v232, v232, v233
    v_mfma_f32_16x16x32_bf16 v[188:191], a[28:31], v[132:135], v[188:191]
    ds_read_b128 a[28:31], v5 offset:43008
    v_cvt_pk_bf16_f32 v233, v234, v235
    v_mfma_f32_16x16x32_bf16 v[192:195], a[0:3], v[128:131], v[192:195]
    v_cvt_pk_bf16_f32 v234, v236, v237
    v_cvt_pk_bf16_f32 v235, v238, v239
    v_mfma_f32_16x16x32_bf16 v[196:199], a[0:3], v[132:135], v[196:199]
    ds_read_b128 a[0:3], v5 offset:63488
    s_waitcnt lgkmcnt(5)
    v_mfma_f32_16x16x32_bf16 v[176:179], a[4:7], v[136:139], v[176:179]
    v_add_u32 v11, s26, v11
    v_mfma_f32_16x16x32_bf16 v[180:183], a[4:7], v[140:143], v[180:183]
    v_permlane16_swap_b32 v232, v234
    v_mfma_f32_16x16x32_bf16 v[184:187], a[8:11], v[136:139], v[184:187]
    v_permlane16_swap_b32 v233, v235
    v_mfma_f32_16x16x32_bf16 v[188:191], a[8:11], v[140:143], v[188:191]
    ds_read_b128 a[4:7], v6 offset:18432
    ds_read_b128 a[8:11], v5 offset:41984
    v_mfma_f32_16x16x32_bf16 v[192:195], a[12:15], v[136:139], v[192:195]
    s_mov_b32 s18, 405504
    buffer_store_dwordx4 v[232:235], v11, s[44:47], s18 offen sc1
    v_mfma_f32_16x16x32_bf16 v[196:199], a[12:15], v[140:143], v[196:199]
    ds_read_b128 a[12:15], v5 offset:62464
    s_waitcnt lgkmcnt(5)
    v_mfma_f32_16x16x32_bf16 v[176:179], a[16:19], v[144:147], v[176:179]
    v_mfma_f32_16x16x32_bf16 v[180:183], a[16:19], v[148:151], v[180:183]
    ds_read_b128 a[16:19], v6 offset:17408
    v_mfma_f32_16x16x32_bf16 v[184:187], a[20:23], v[144:147], v[184:187]
    v_mfma_f32_16x16x32_bf16 v[188:191], a[20:23], v[148:151], v[188:191]
    ds_read_b128 a[20:23], v5 offset:40960
    v_mfma_f32_16x16x32_bf16 v[192:195], a[24:27], v[144:147], v[192:195]
    v_mfma_f32_16x16x32_bf16 v[196:199], a[24:27], v[148:151], v[196:199]
    ds_read_b128 a[24:27], v5 offset:61440
    s_waitcnt lgkmcnt(5)
    v_mfma_f32_16x16x32_bf16 v[176:179], a[28:31], v[152:155], v[176:179]
    v_mfma_f32_16x16x32_bf16 v[180:183], a[28:31], v[156:159], v[180:183]
    ds_read_b128 a[28:31], v6 offset:16384
    v_mfma_f32_16x16x32_bf16 v[184:187], a[0:3], v[152:155], v[184:187]
    v_mfma_f32_16x16x32_bf16 v[188:191], a[0:3], v[156:159], v[188:191]
    v_mfma_f32_16x16x32_bf16 v[192:195], a[4:7], v[152:155], v[192:195]
    v_mfma_f32_16x16x32_bf16 v[196:199], a[4:7], v[156:159], v[196:199]
    s_waitcnt lgkmcnt(3)
    v_mfma_f32_16x16x32_bf16 v[176:179], a[8:11], v[160:163], v[176:179]
    v_mfma_f32_16x16x32_bf16 v[180:183], a[8:11], v[164:167], v[180:183]
    v_mfma_f32_16x16x32_bf16 v[184:187], a[12:15], v[160:163], v[184:187]
    v_mfma_f32_16x16x32_bf16 v[188:191], a[12:15], v[164:167], v[188:191]
    v_mfma_f32_16x16x32_bf16 v[192:195], a[16:19], v[160:163], v[192:195]
    v_mfma_f32_16x16x32_bf16 v[196:199], a[16:19], v[164:167], v[196:199]
    s_waitcnt lgkmcnt(0)
    v_mfma_f32_16x16x32_bf16 v[176:179], a[20:23], v[168:171], v[176:179]
    v_mfma_f32_16x16x32_bf16 v[180:183], a[20:23], v[172:175], v[180:183]
    v_mfma_f32_16x16x32_bf16 v[184:187], a[24:27], v[168:171], v[184:187]
    v_mfma_f32_16x16x32_bf16 v[188:191], a[24:27], v[172:175], v[188:191]
    v_mfma_f32_16x16x32_bf16 v[192:195], a[28:31], v[168:171], v[192:195]
    v_mfma_f32_16x16x32_bf16 v[196:199], a[28:31], v[172:175], v[196:199]
    s_waitcnt vmcnt(21)
    v_min_f32_e64 v9, |v16|, |v20|
    v_cmp_gt_f32 vcc, 0x24800000, v9
    s_cbranch_vccnz m2_q0_again
m2_q0_ok:
    v_mfma_f32_16x16x32_bf16 v[96:99], a[32:35], v[16:19], 0
    s_waitcnt vmcnt(19)
    v_min_f32_e64 v9, |v24|, |v28|
    v_mfma_f32_16x16x32_bf16 v[100:103], a[36:39], v[16:19], 0
    v_cmp_gt_f32 vcc, 0x24800000, v9
    v_lshl_add_u32 v205, v3, 4, s20
    v_mfma_f32_16x16x32_bf16 v[104:107], a[40:43], v[16:19], 0
    ds_read_b128 a[0:3], v205 offset:0
    v_mfma_f32_16x16x32_bf16 v[108:111], a[44:47], v[16:19], 0
    s_cbranch_vccnz m2_q1_again
m2_q1_ok:
    v_mfma_f32_16x16x32_bf16 v[112:115], a[48:51], v[16:19], 0
    v_cvt_pk_bf16_f32 v176, v176, v177
    v_cvt_pk_bf16_f32 v177, v178, v179
    v_mfma_f32_16x16x32_bf16 v[116:119], a[32:35], v[20:23], 0
    v_cvt_pk_bf16_f32 v178, v180, v181
    v_cvt_pk_bf16_f32 v179, v182, v183
    v_mfma_f32_16x16x32_bf16 v[120:123], a[36:39], v[20:23], 0
    s_mov_b32 s62, 0
    buffer_store_dwordx4 v[176:179], v12, s[40:43], s62 offen sc1
    v_mfma_f32_16x16x32_bf16 v[124:127], a[40:43], v[20:23], 0
    v_cvt_pk_bf16_f32 v184, v184, v185
    v_cvt_pk_bf16_f32 v185, v186, v187
    v_mfma_f32_16x16x32_bf16 v[128:131], a[44:47], v[20:23], 0
    v_cvt_pk_bf16_f32 v186, v188, v189
    v_cvt_pk_bf16_f32 v187, v190, v191
    v_mfma_f32_16x16x32_bf16 v[132:135], a[48:51], v[20:23], 0
    s_mov_b32 s62, 66560
    buffer_store_dwordx4 v[184:187], v12, s[40:43], s62 offen sc1
    v_mfma_f32_16x16x32_bf16 v[136:139], a[32:35], v[24:27], 0
    v_cvt_pk_bf16_f32 v192, v192, v193
    v_cvt_pk_bf16_f32 v193, v194, v195
    v_mfma_f32_16x16x32_bf16 v[140:143], a[36:39], v[24:27], 0
    v_cvt_pk_bf16_f32 v194, v196, v197
    v_cvt_pk_bf16_f32 v195, v198, v199
    v_mfma_f32_16x16x32_bf16 v[144:147], a[40:43], v[24:27], 0
    s_mov_b32 s62, 133120
    buffer_store_dwordx4 v[192:195], v12, s[40:43], s62 offen sc1
    v_mfma_f32_16x16x32_bf16 v[148:151], a[44:47], v[24:27], 0
    s_waitcnt vmcnt(18)
    v_min3_f32 v9, |v32|, |v36|, |v40|
    v_mfma_f32_16x16x32_bf16 v[152:155], a[48:51], v[24:27], 0
    v_min_f32_e64 v9, v9, |v44|
    v_cmp_gt_f32 vcc, 0x24800000, v9
    v_mfma_f32_16x16x32_bf16 v[156:159], a[32:35], v[28:31], 0
    ds_read_b128 a[4:7], v205 offset:1024
    ds_read_b128 a[8:11], v205 offset:2048
    v_mfma_f32_16x16x32_bf16 v[160:163], a[36:39], v[28:31], 0
    s_cbranch_vccnz m2_q2_again
m2_q2_ok:
    v_mfma_f32_16x16x32_bf16 v[164:167], a[40:43], v[28:31], 0
    ds_read_b128 a[12:15], v205 offset:3072
    ds_read_b128 a[16:19], v205 offset:4096
    v_mfma_f32_16x16x32_bf16 v[168:171], a[44:47], v[28:31], 0
    s_mov_b32 s65, 1081344
    buffer_load_dwordx4 v[176:179], v13, s[8:11], s65 offen sc1
    v_mfma_f32_16x16x32_bf16 v[172:175], a[48:51], v[28:31], 0
    buffer_load_dwordx4 v[180:183], v4, s[8:11], s65 offen sc1
    s_mul_i32 s100, s16, 332800
    v_mfma_f32_16x16x32_bf16 v[96:99], a[52:55], v[32:35], v[96:99]
    ds_read_b128 a[32:35], v205 offset:20480
    v_mfma_f32_16x16x32_bf16 v[100:103], a[56:59], v[32:35], v[100:103]
    ds_read_b128 a[36:39], v205 offset:21504
    ds_read_b128 a[40:43], v205 offset:22528
    v_mfma_f32_16x16x32_bf16 v[104:107], a[60:63], v[32:35], v[104:107]
    ds_read_b128 a[44:47], v205 offset:23552
    ds_read_b128 a[48:51], v205 offset:24576
    v_mfma_f32_16x16x32_bf16 v[108:111], a[64:67], v[32:35], v[108:111]
    buffer_load_dwordx4 v[184:187], v8, s[8:11], s65 offen sc1
    s_lshl3_add_u32 s100, s61, s100
    v_mfma_f32_16x16x32_bf16 v[112:115], a[68:71], v[32:35], v[112:115]
    buffer_load_dwordx4 v[188:191], v10, s[8:11], s65 offen sc1
    v_mul_u32_u24 v200, 16640, v2
    v_mfma_f32_16x16x32_bf16 v[116:119], a[52:55], v[36:39], v[116:119]
    s_mov_b32 s65, 202752
    buffer_load_dwordx4 v[16:19], v13, s[8:11], s65 offen sc1
    v_mfma_f32_16x16x32_bf16 v[120:123], a[56:59], v[36:39], v[120:123]
    buffer_load_dwordx4 v[20:23], v4, s[8:11], s65 offen sc1
    v_lshl_add_u32 v200, v1, 3, v200
    v_mfma_f32_16x16x32_bf16 v[124:127], a[60:63], v[36:39], v[124:127]
    buffer_load_dwordx4 v[24:27], v8, s[8:11], s65 offen sc1
    v_add_u32 v200, s100, v200
    v_mfma_f32_16x16x32_bf16 v[128:131], a[64:67], v[36:39], v[128:131]
    buffer_load_dwordx4 v[28:31], v10, s[8:11], s65 offen sc1
    v_lshrrev_b32 v203, 1, v2
    v_mfma_f32_16x16x32_bf16 v[132:135], a[68:71], v[36:39], v[132:135]
    s_mov_b32 s65, 1148928
    buffer_load_dwordx4 v[32:35], v13, s[8:11], s65 offen sc1
    v_mfma_f32_16x16x32_bf16 v[136:139], a[52:55], v[40:43], v[136:139]
    s_mov_b32 s100, 0x3f803f80
    v_mul_lo_u32 v203, v203, s100
    v_mfma_f32_16x16x32_bf16 v[140:143], a[56:59], v[40:43], v[140:143]
    v_lshl_add_u32 v204, v3, 4, s21
    s_xor_b32 s100, s56, 1
    v_mfma_f32_16x16x32_bf16 v[144:147], a[60:63], v[40:43], v[144:147]
    s_mul_i32 s100, s100, 15360
    v_lshl_add_u32 v5, v3, 4, s100
    v_mfma_f32_16x16x32_bf16 v[148:151], a[64:67], v[40:43], v[148:151]
    s_waitcnt vmcnt(22)
    v_min3_f32 v9, |v48|, |v52|, |v56|
    v_mfma_f32_16x16x32_bf16 v[152:155], a[68:71], v[40:43], v[152:155]
    v_min_f32_e64 v9, v9, |v60|
    v_cmp_gt_f32 vcc, 0x24800000, v9
    v_mfma_f32_16x16x32_bf16 v[156:159], a[52:55], v[44:47], v[156:159]
    s_xor_b32 s100, s56, 2
    s_mul_i32 s100, s100, 15360
    v_mfma_f32_16x16x32_bf16 v[160:163], a[56:59], v[44:47], v[160:163]
    s_cbranch_vccnz m2_q3_again
m2_q3_ok:
    v_mfma_f32_16x16x32_bf16 v[164:167], a[60:63], v[44:47], v[164:167]
    s_add_u32 s100, s100, 5120
    v_lshl_add_u32 v6, v3, 4, s100
    v_mfma_f32_16x16x32_bf16 v[168:171], a[64:67], v[44:47], v[168:171]
    s_xor_b32 s100, s56, 3
    s_mul_i32 s100, s100, 15360
    v_mfma_f32_16x16x32_bf16 v[172:175], a[68:71], v[44:47], v[172:175]
    s_add_u32 s100, s100, 10240
    v_lshl_add_u32 v7, v3, 4, s100
    v_mfma_f32_16x16x32_bf16 v[96:99], a[72:75], v[48:51], v[96:99]
    s_bfe_u32 s100, s61, 0x10004
    s_lshl_b32 s100, s100, 3
    v_mfma_f32_16x16x32_bf16 v[100:103], a[76:79], v[48:51], v[100:103]
    s_lshr_b32 s101, s61, 9
    s_lshl4_add_u32 s100, s101, s100
    v_mfma_f32_16x16x32_bf16 v[104:107], a[80:83], v[48:51], v[104:107]
    s_bfe_u32 s101, s61, 0x20005
    s_lshl_b32 s101, s101, 8
    v_mfma_f32_16x16x32_bf16 v[108:111], a[84:87], v[48:51], v[108:111]
    s_add_u32 s100, s100, s101
    s_and_b32 s101, s61, 128
    v_mfma_f32_16x16x32_bf16 v[112:115], a[88:91], v[48:51], v[112:115]
    s_add_u32 s100, s100, s101
    s_and_b32 s101, s61, 256
    v_mfma_f32_16x16x32_bf16 v[116:119], a[72:75], v[52:55], v[116:119]
    s_lshl2_add_u32 s100, s101, s100
    v_and_b32 v202, 1, v1
    v_mfma_f32_16x16x32_bf16 v[120:123], a[76:79], v[52:55], v[120:123]
    v_lshlrev_b32 v202, 6, v202
    v_lshrrev_b32 v201, 1, v1
    v_mfma_f32_16x16x32_bf16 v[124:127], a[80:83], v[52:55], v[124:127]
    v_add3_u32 v202, v202, v201, s100
    v_mul_u32_u24 v202, 1280, v202
    v_mfma_f32_16x16x32_bf16 v[128:131], a[84:87], v[52:55], v[128:131]
    s_mul_i32 s100, s16, 160
    v_lshl_add_u32 v202, v2, 3, v202
    v_mfma_f32_16x16x32_bf16 v[132:135], a[88:91], v[52:55], v[132:135]
    v_add_u32 v202, s100, v202
    v_mfma_f32_16x16x32_bf16 v[136:139], a[72:75], v[56:59], v[136:139]
    v_mfma_f32_16x16x32_bf16 v[140:143], a[76:79], v[56:59], v[140:143]
    v_mfma_f32_16x16x32_bf16 v[144:147], a[80:83], v[56:59], v[144:147]
    v_mfma_f32_16x16x32_bf16 v[148:151], a[84:87], v[56:59], v[148:151]
    s_waitcnt vmcnt(18)
    v_min3_f32 v9, |v64|, |v68|, |v72|
    v_mfma_f32_16x16x32_bf16 v[152:155], a[88:91], v[56:59], v[152:155]
    v_min_f32_e64 v9, v9, |v76|
    v_cmp_gt_f32 vcc, 0x24800000, v9
    v_mfma_f32_16x16x32_bf16 v[156:159], a[72:75], v[60:63], v[156:159]
    s_mov_b32 s63, 409600
    buffer_load_dwordx4 a[52:55], v15, s[52:55], s63 offen offset:0
    v_mfma_f32_16x16x32_bf16 v[160:163], a[76:79], v[60:63], v[160:163]
    s_cbranch_vccnz m2_q4_again
m2_q4_ok:
    v_mfma_f32_16x16x32_bf16 v[164:167], a[80:83], v[60:63], v[164:167]
    v_mfma_f32_16x16x32_bf16 v[168:171], a[84:87], v[60:63], v[168:171]
    v_mfma_f32_16x16x32_bf16 v[172:175], a[88:91], v[60:63], v[172:175]
    v_mfma_f32_16x16x32_bf16 v[96:99], a[92:95], v[64:67], v[96:99]
    s_waitcnt vmcnt(10)
    s_mov_b32 s62, 0
    v_mfma_f32_16x16x32_bf16 v[100:103], a[96:99], v[64:67], v[100:103]
    buffer_store_dword v6, v248, s[12:15], s62 offen sc1
    buffer_load_dwordx4 a[56:59], v15, s[52:55], s63 offen offset:256
    v_mfma_f32_16x16x32_bf16 v[104:107], a[100:103], v[64:67], v[104:107]
    v_mfma_f32_16x16x32_bf16 v[108:111], a[104:107], v[64:67], v[108:111]
    v_mfma_f32_16x16x32_bf16 v[112:115], a[108:111], v[64:67], v[112:115]
    v_mfma_f32_16x16x32_bf16 v[116:119], a[92:95], v[68:71], v[116:119]
    buffer_load_dwordx4 a[60:63], v15, s[52:55], s63 offen offset:512
    v_mfma_f32_16x16x32_bf16 v[120:123], a[96:99], v[68:71], v[120:123]
    v_mfma_f32_16x16x32_bf16 v[124:127], a[100:103], v[68:71], v[124:127]
    v_mfma_f32_16x16x32_bf16 v[128:131], a[104:107], v[68:71], v[128:131]
    v_mfma_f32_16x16x32_bf16 v[132:135], a[108:111], v[68:71], v[132:135]
    buffer_load_dwordx4 a[64:67], v15, s[52:55], s63 offen offset:768
    v_mfma_f32_16x16x32_bf16 v[136:139], a[92:95], v[72:75], v[136:139]
    v_mfma_f32_16x16x32_bf16 v[140:143], a[96:99], v[72:75], v[140:143]
    v_mfma_f32_16x16x32_bf16 v[144:147], a[100:103], v[72:75], v[144:147]
    v_mfma_f32_16x16x32_bf16 v[148:151], a[104:107], v[72:75], v[148:151]
    v_min3_f32 v9, |v80|, |v84|, |v88|
    v_mfma_f32_16x16x32_bf16 v[152:155], a[108:111], v[72:75], v[152:155]
    v_min_f32_e64 v9, v9, |v92|
    v_cmp_gt_f32 vcc, 0x24800000, v9
    v_mfma_f32_16x16x32_bf16 v[156:159], a[92:95], v[76:79], v[156:159]
    buffer_load_dwordx4 a[68:71], v15, s[52:55], s63 offen offset:1024
    v_mfma_f32_16x16x32_bf16 v[160:163], a[96:99], v[76:79], v[160:163]
    s_cbranch_vccnz m2_q5_again
m2_q5_ok:
    v_mfma_f32_16x16x32_bf16 v[164:167], a[100:103], v[76:79], v[164:167]
    v_mfma_f32_16x16x32_bf16 v[168:171], a[104:107], v[76:79], v[168:171]
    buffer_load_dwordx4 v[36:39], v4, s[8:11], s65 offen sc1
    v_mfma_f32_16x16x32_bf16 v[172:175], a[108:111], v[76:79], v[172:175]
    v_mfma_f32_16x16x32_bf16 v[96:99], a[112:115], v[80:83], v[96:99]
    v_mfma_f32_16x16x32_bf16 v[100:103], a[116:119], v[80:83], v[100:103]
    v_mfma_f32_16x16x32_bf16 v[104:107], a[120:123], v[80:83], v[104:107]
    buffer_load_dwordx4 v[40:43], v8, s[8:11], s65 offen sc1
    v_mfma_f32_16x16x32_bf16 v[108:111], a[124:127], v[80:83], v[108:111]
    v_mfma_f32_16x16x32_bf16 v[112:115], a[128:131], v[80:83], v[112:115]
    v_mfma_f32_16x16x32_bf16 v[116:119], a[112:115], v[84:87], v[116:119]
    v_mfma_f32_16x16x32_bf16 v[120:123], a[116:119], v[84:87], v[120:123]
    v_mfma_f32_16x16x32_bf16 v[124:127], a[120:123], v[84:87], v[124:127]
    buffer_load_dwordx4 v[44:47], v10, s[8:11], s65 offen sc1
    v_mfma_f32_16x16x32_bf16 v[128:131], a[124:127], v[84:87], v[128:131]
    v_mfma_f32_16x16x32_bf16 v[132:135], a[128:131], v[84:87], v[132:135]
    v_mfma_f32_16x16x32_bf16 v[136:139], a[112:115], v[88:91], v[136:139]
    v_mfma_f32_16x16x32_bf16 v[140:143], a[116:119], v[88:91], v[140:143]
    s_mov_b32 s65, 270336
    buffer_load_dwordx4 v[48:51], v13, s[8:11], s65 offen sc1
    v_mfma_f32_16x16x32_bf16 v[144:147], a[120:123], v[88:91], v[144:147]
    v_mfma_f32_16x16x32_bf16 v[148:151], a[124:127], v[88:91], v[148:151]
    s_waitcnt vmcnt(15)
    v_min3_f32 v9, |v176|, |v180|, |v184|
    v_mfma_f32_16x16x32_bf16 v[152:155], a[128:131], v[88:91], v[152:155]
    v_min_f32_e64 v9, v9, |v188|
    v_cmp_gt_f32 vcc, 0x24800000, v9
    v_mfma_f32_16x16x32_bf16 v[156:159], a[112:115], v[92:95], v[156:159]
    v_mfma_f32_16x16x32_bf16 v[160:163], a[116:119], v[92:95], v[160:163]
    s_cbranch_vccnz m2_q6_again
m2_q6_ok:
    v_mfma_f32_16x16x32_bf16 v[164:167], a[120:123], v[92:95], v[164:167]
    buffer_load_dwordx4 v[52:55], v4, s[8:11], s65 offen sc1
    v_mfma_f32_16x16x32_bf16 v[168:171], a[124:127], v[92:95], v[168:171]
    v_mfma_f32_16x16x32_bf16 v[172:175], a[128:131], v[92:95], v[172:175]
    v_mfma_f32_16x16x32_bf16 v[96:99], a[132:135], v[176:179], v[96:99]
    s_waitcnt lgkmcnt(0)
    s_barrier
    v_mfma_f32_16x16x32_bf16 v[100:103], a[136:139], v[176:179], v[100:103]
    buffer_load_dwordx4 v[56:59], v8, s[8:11], s65 offen sc1
    v_mfma_f32_16x16x32_bf16 v[104:107], a[140:143], v[176:179], v[104:107]
    v_mfma_f32_16x16x32_bf16 v[108:111], a[144:147], v[176:179], v[108:111]
    v_mfma_f32_16x16x32_bf16 v[112:115], a[148:151], v[176:179], v[112:115]
    buffer_load_dwordx4 v[60:63], v10, s[8:11], s65 offen sc1
    v_mfma_f32_16x16x32_bf16 v[116:119], a[132:135], v[180:183], v[116:119]
    v_mfma_f32_16x16x32_bf16 v[120:123], a[136:139], v[180:183], v[120:123]
    v_mfma_f32_16x16x32_bf16 v[124:127], a[140:143], v[180:183], v[124:127]
    v_mfma_f32_16x16x32_bf16 v[128:131], a[144:147], v[180:183], v[128:131]
    s_mov_b32 s65, 1216512
    buffer_load_dwordx4 v[64:67], v13, s[8:11], s65 offen sc1
    v_mfma_f32_16x16x32_bf16 v[132:135], a[148:151], v[180:183], v[132:135]
    v_mfma_f32_16x16x32_bf16 v[136:139], a[132:135], v[184:187], v[136:139]
    v_mfma_f32_16x16x32_bf16 v[140:143], a[136:139], v[184:187], v[140:143]
    v_mfma_f32_16x16x32_bf16 v[144:147], a[140:143], v[184:187], v[144:147]
    buffer_load_dwordx4 v[68:71], v4, s[8:11], s65 offen sc1
    v_mfma_f32_16x16x32_bf16 v[148:151], a[144:147], v[184:187], v[148:151]
    s_waitcnt vmcnt(16)
    v_min3_f32 v9, |v16|, |v20|, |v24|
    v_mfma_f32_16x16x32_bf16 v[152:155], a[148:151], v[184:187], v[152:155]
    v_min_f32_e64 v9, v9, |v28|
    v_cmp_gt_f32 vcc, 0x24800000, v9
    v_mfma_f32_16x16x32_bf16 v[156:159], a[132:135], v[188:191], v[156:159]
    v_mfma_f32_16x16x32_bf16 v[160:163], a[136:139], v[188:191], v[160:163]
    s_cbranch_vccnz m2_q7_again
m2_q7_ok:
    v_mfma_f32_16x16x32_bf16 v[164:167], a[140:143], v[188:191], v[164:167]
    buffer_load_dwordx4 v[72:75], v8, s[8:11], s65 offen sc1
    v_mfma_f32_16x16x32_bf16 v[168:171], a[144:147], v[188:191], v[168:171]
    v_mfma_f32_16x16x32_bf16 v[172:175], a[148:151], v[188:191], v[172:175]
    v_mfma_f32_16x16x32_bf16 v[96:99], a[152:155], v[16:19], v[96:99]
    buffer_load_dword v249, v14, s[12:15], s62 offen sc1
    v_mfma_f32_16x16x32_bf16 v[100:103], a[156:159], v[16:19], v[100:103]
    v_mfma_f32_16x16x32_bf16 v[104:107], a[160:163], v[16:19], v[104:107]
    v_mfma_f32_16x16x32_bf16 v[108:111], a[164:167], v[16:19], v[108:111]
    v_mfma_f32_16x16x32_bf16 v[112:115], a[168:171], v[16:19], v[112:115]
    v_mfma_f32_16x16x32_bf16 v[116:119], a[152:155], v[20:23], v[116:119]
    buffer_load_dwordx4 v[76:79], v10, s[8:11], s65 offen sc1
    v_mfma_f32_16x16x32_bf16 v[120:123], a[156:159], v[20:23], v[120:123]
    v_mfma_f32_16x16x32_bf16 v[124:127], a[160:163], v[20:23], v[124:127]
    v_mfma_f32_16x16x32_bf16 v[128:131], a[164:167], v[20:23], v[128:131]
    v_mfma_f32_16x16x32_bf16 v[132:135], a[168:171], v[20:23], v[132:135]
    v_mfma_f32_16x16x32_bf16 v[136:139], a[152:155], v[24:27], v[136:139]
    s_mov_b32 s65, 337920
    buffer_load_dwordx4 v[80:83], v13, s[8:11], s65 offen sc1
    v_mfma_f32_16x16x32_bf16 v[140:143], a[156:159], v[24:27], v[140:143]
    v_mfma_f32_16x16x32_bf16 v[144:147], a[160:163], v[24:27], v[144:147]
    v_mfma_f32_16x16x32_bf16 v[148:151], a[164:167], v[24:27], v[148:151]
    s_waitcnt vmcnt(10)
    v_min3_f32 v9, |v32|, |v36|, |v40|
    v_mfma_f32_16x16x32_bf16 v[152:155], a[168:171], v[24:27], v[152:155]
    v_min_f32_e64 v9, v9, |v44|
    v_cmp_gt_f32 vcc, 0x24800000, v9
    v_mfma_f32_16x16x32_bf16 v[156:159], a[152:155], v[28:31], v[156:159]
    buffer_load_dwordx4 v[84:87], v4, s[8:11], s65 offen sc1
    v_mfma_f32_16x16x32_bf16 v[160:163], a[156:159], v[28:31], v[160:163]
    s_cbranch_vccnz m2_q8_again
m2_q8_ok:
    v_mfma_f32_16x16x32_bf16 v[164:167], a[160:163], v[28:31], v[164:167]
    buffer_load_dwordx4 v[88:91], v8, s[8:11], s65 offen sc1
    v_mfma_f32_16x16x32_bf16 v[168:171], a[164:167], v[28:31], v[168:171]
    buffer_load_dwordx4 v[92:95], v10, s[8:11], s65 offen sc1
    v_mfma_f32_16x16x32_bf16 v[172:175], a[168:171], v[28:31], v[172:175]
    v_mfma_f32_16x16x32_bf16 v[96:99], a[172:175], v[32:35], v[96:99]
    v_mfma_f32_16x16x32_bf16 v[100:103], a[176:179], v[32:35], v[100:103]
    v_mfma_f32_16x16x32_bf16 v[104:107], a[180:183], v[32:35], v[104:107]
    s_mov_b32 s65, 1284096
    buffer_load_dwordx4 v[180:183], v4, s[8:11], s65 offen sc1
    v_mfma_f32_16x16x32_bf16 v[108:111], a[184:187], v[32:35], v[108:111]
    v_mfma_f32_16x16x32_bf16 v[112:115], a[188:191], v[32:35], v[112:115]
    v_mfma_f32_16x16x32_bf16 v[116:119], a[172:175], v[36:39], v[116:119]
    v_mfma_f32_16x16x32_bf16 v[120:123], a[176:179], v[36:39], v[120:123]
    v_mfma_f32_16x16x32_bf16 v[124:127], a[180:183], v[36:39], v[124:127]
    s_mov_b32 s65, 405504
    buffer_load_dwordx4 v[20:23], v4, s[8:11], s65 offen sc1
    v_mfma_f32_16x16x32_bf16 v[128:131], a[184:187], v[36:39], v[128:131]
    v_mfma_f32_16x16x32_bf16 v[132:135], a[188:191], v[36:39], v[132:135]
    v_mfma_f32_16x16x32_bf16 v[136:139], a[172:175], v[40:43], v[136:139]
    v_mfma_f32_16x16x32_bf16 v[140:143], a[176:179], v[40:43], v[140:143]
    s_mov_b32 s65, 1351680
    buffer_load_dwordx4 v[36:39], v4, s[8:11], s65 offen sc1
    v_mfma_f32_16x16x32_bf16 v[144:147], a[180:183], v[40:43], v[144:147]
    v_mfma_f32_16x16x32_bf16 v[148:151], a[184:187], v[40:43], v[148:151]
    s_waitcnt vmcnt(12)
    v_min3_f32 v9, |v48|, |v52|, |v56|
    v_mfma_f32_16x16x32_bf16 v[152:155], a[188:191], v[40:43], v[152:155]
    v_min_f32_e64 v9, v9, |v60|
    v_cmp_gt_f32 vcc, 0x24800000, v9
    v_mfma_f32_16x16x32_bf16 v[156:159], a[172:175], v[44:47], v[156:159]
    s_mov_b32 s65, 1284096
    buffer_load_dwordx4 v[184:187], v8, s[8:11], s65 offen sc1
    v_mfma_f32_16x16x32_bf16 v[160:163], a[176:179], v[44:47], v[160:163]
    s_cbranch_vccnz m2_q9_again
m2_q9_ok:
    v_mfma_f32_16x16x32_bf16 v[164:167], a[180:183], v[44:47], v[164:167]
    v_mfma_f32_16x16x32_bf16 v[168:171], a[184:187], v[44:47], v[168:171]
    v_mfma_f32_16x16x32_bf16 v[172:175], a[188:191], v[44:47], v[172:175]
    v_mfma_f32_16x16x32_bf16 v[96:99], a[192:195], v[48:51], v[96:99]
    s_waitcnt vmcnt(9)
    v_cmp_eq_u32 vcc, 0, v249
    v_mfma_f32_16x16x32_bf16 v[100:103], a[196:199], v[48:51], v[100:103]
    s_mov_b32 s65, 405504
    buffer_load_dwordx4 v[24:27], v8, s[8:11], s65 offen sc1
    v_mfma_f32_16x16x32_bf16 v[104:107], a[200:203], v[48:51], v[104:107]
    s_cbranch_vccnz m2_rgo_spin
m2_rgo_ok:
    v_mfma_f32_16x16x32_bf16 v[108:111], a[204:207], v[48:51], v[108:111]
    s_mov_b32 s65, 1351680
    buffer_load_dwordx4 v[40:43], v8, s[8:11], s65 offen sc1
    v_mfma_f32_16x16x32_bf16 v[112:115], a[208:211], v[48:51], v[112:115]
    s_mov_b32 s64, 0
    buffer_load_dwordx2 v[208:209], v200, s[40:43], s64 offen sc1
    v_mfma_f32_16x16x32_bf16 v[116:119], a[192:195], v[52:55], v[116:119]
    s_mov_b32 s64, 66560
    buffer_load_dwordx2 v[210:211], v200, s[40:43], s64 offen sc1
    v_mfma_f32_16x16x32_bf16 v[120:123], a[196:199], v[52:55], v[120:123]
    v_mfma_f32_16x16x32_bf16 v[124:127], a[200:203], v[52:55], v[124:127]
    v_mfma_f32_16x16x32_bf16 v[128:131], a[204:207], v[52:55], v[128:131]
    v_mfma_f32_16x16x32_bf16 v[132:135], a[208:211], v[52:55], v[132:135]
    s_mov_b32 s64, 133120
    buffer_load_dwordx2 v[212:213], v200, s[40:43], s64 offen sc1
    v_mfma_f32_16x16x32_bf16 v[136:139], a[192:195], v[56:59], v[136:139]
    v_mfma_f32_16x16x32_bf16 v[140:143], a[196:199], v[56:59], v[140:143]
    v_mfma_f32_16x16x32_bf16 v[144:147], a[200:203], v[56:59], v[144:147]
    v_mfma_f32_16x16x32_bf16 v[148:151], a[204:207], v[56:59], v[148:151]
    s_waitcnt vmcnt(13)
    v_min3_f32 v9, |v64|, |v68|, |v72|
    v_mfma_f32_16x16x32_bf16 v[152:155], a[208:211], v[56:59], v[152:155]
    v_min_f32_e64 v9, v9, |v76|
    v_cmp_gt_f32 vcc, 0x24800000, v9
    v_mfma_f32_16x16x32_bf16 v[156:159], a[192:195], v[60:63], v[156:159]
    v_mfma_f32_16x16x32_bf16 v[160:163], a[196:199], v[60:63], v[160:163]
    s_cbranch_vccnz m2_q10_again
m2_q10_ok:
    v_mfma_f32_16x16x32_bf16 v[164:167], a[200:203], v[60:63], v[164:167]
    v_mfma_f32_16x16x32_bf16 v[168:171], a[204:207], v[60:63], v[168:171]
    s_mov_b32 s64, 199680
    buffer_load_dwordx2 v[214:215], v200, s[40:43], s64 offen sc1
    v_mfma_f32_16x16x32_bf16 v[172:175], a[208:211], v[60:63], v[172:175]
    v_mfma_f32_16x16x32_bf16 v[96:99], a[212:215], v[64:67], v[96:99]
    v_mfma_f32_16x16x32_bf16 v[100:103], a[216:219], v[64:67], v[100:103]
    v_mfma_f32_16x16x32_bf16 v[104:107], a[220:223], v[64:67], v[104:107]
    s_mov_b32 s64, 266240
    buffer_load_dwordx2 v[216:217], v200, s[40:43], s64 offen sc1
    v_mfma_f32_16x16x32_bf16 v[108:111], a[224:227], v[64:67], v[108:111]
    v_mfma_f32_16x16x32_bf16 v[112:115], a[228:231], v[64:67], v[112:115]
    v_mfma_f32_16x16x32_bf16 v[116:119], a[212:215], v[68:71], v[116:119]
    v_mfma_f32_16x16x32_bf16 v[120:123], a[216:219], v[68:71], v[120:123]
    s_mov_b32 s65, 1284096
    buffer_load_dwordx4 v[188:191], v10, s[8:11], s65 offen sc1
    v_mfma_f32_16x16x32_bf16 v[124:127], a[220:223], v[68:71], v[124:127]
    v_mfma_f32_16x16x32_bf16 v[128:131], a[224:227], v[68:71], v[128:131]
    v_mfma_f32_16x16x32_bf16 v[132:135], a[228:231], v[68:71], v[132:135]
    v_mfma_f32_16x16x32_bf16 v[136:139], a[212:215], v[72:75], v[136:139]
    v_mfma_f32_16x16x32_bf16 v[140:143], a[216:219], v[72:75], v[140:143]
    s_mov_b32 s65, 405504
    buffer_load_dwordx4 v[28:31], v10, s[8:11], s65 offen sc1
    v_mfma_f32_16x16x32_bf16 v[144:147], a[220:223], v[72:75], v[144:147]
    v_mfma_f32_16x16x32_bf16 v[148:151], a[224:227], v[72:75], v[148:151]
    s_waitcnt vmcnt(13)
    v_min3_f32 v9, |v80|, |v84|, |v88|
    v_mfma_f32_16x16x32_bf16 v[152:155], a[228:231], v[72:75], v[152:155]
    v_min_f32_e64 v9, v9, |v92|
    v_cmp_gt_f32 vcc, 0x24800000, v9
    v_mfma_f32_16x16x32_bf16 v[156:159], a[212:215], v[76:79], v[156:159]
    s_mov_b32 s65, 1351680
    buffer_load_dwordx4 v[44:47], v10, s[8:11], s65 offen sc1
    v_mfma_f32_16x16x32_bf16 v[160:163], a[216:219], v[76:79], v[160:163]
    s_cbranch_vccnz m2_q11_again
m2_q11_ok:
    v_mfma_f32_16x16x32_bf16 v[164:167], a[220:223], v[76:79], v[164:167]
    v_mfma_f32_16x16x32_bf16 v[168:171], a[224:227], v[76:79], v[168:171]
    v_mfma_f32_16x16x32_bf16 v[172:175], a[228:231], v[76:79], v[172:175]
    s_mov_b32 s65, 1284096
    buffer_load_dwordx4 v[176:179], v13, s[8:11], s65 offen sc1
    v_mfma_f32_16x16x32_bf16 v[96:99], a[232:235], v[80:83], v[96:99]
    v_mfma_f32_16x16x32_bf16 v[100:103], a[236:239], v[80:83], v[100:103]
    v_mfma_f32_16x16x32_bf16 v[104:107], a[240:243], v[80:83], v[104:107]
    v_mfma_f32_16x16x32_bf16 v[108:111], a[244:247], v[80:83], v[108:111]
    v_mfma_f32_16x16x32_bf16 v[112:115], a[248:251], v[80:83], v[112:115]
    s_mov_b32 s65, 405504
    buffer_load_dwordx4 v[16:19], v13, s[8:11], s65 offen sc1
    v_mfma_f32_16x16x32_bf16 v[116:119], a[232:235], v[84:87], v[116:119]
    v_mfma_f32_16x16x32_bf16 v[120:123], a[236:239], v[84:87], v[120:123]
    v_mfma_f32_16x16x32_bf16 v[124:127], a[240:243], v[84:87], v[124:127]
    v_mfma_f32_16x16x32_bf16 v[128:131], a[244:247], v[84:87], v[128:131]
    s_mov_b32 s65, 1351680
    buffer_load_dwordx4 v[32:35], v13, s[8:11], s65 offen sc1
    v_mfma_f32_16x16x32_bf16 v[132:135], a[248:251], v[84:87], v[132:135]
    v_mfma_f32_16x16x32_bf16 v[136:139], a[232:235], v[88:91], v[136:139]
    v_mfma_f32_16x16x32_bf16 v[140:143], a[236:239], v[88:91], v[140:143]
    v_mfma_f32_16x16x32_bf16 v[144:147], a[240:243], v[88:91], v[144:147]
    v_mfma_f32_16x16x32_bf16 v[148:151], a[244:247], v[88:91], v[148:151]
    s_waitcnt vmcnt(14)
    v_or_b32 v36, v36, v203
    v_mfma_f32_16x16x32_bf16 v[152:155], a[248:251], v[88:91], v[152:155]
    v_min3_f32 v9, |v180|, |v20|, |v36|
    v_cmp_gt_f32 vcc, 0x24800000, v9
    v_mfma_f32_16x16x32_bf16 v[156:159], a[232:235], v[92:95], v[156:159]
    v_mfma_f32_16x16x32_bf16 v[160:163], a[236:239], v[92:95], v[160:163]
    s_cbranch_vccnz m2_q12_again
m2_q12_ok:
    v_mfma_f32_16x16x32_bf16 v[164:167], a[240:243], v[92:95], v[164:167]
    v_mfma_f32_16x16x32_bf16 v[168:171], a[244:247], v[92:95], v[168:171]
    v_mfma_f32_16x16x32_bf16 v[172:175], a[248:251], v[92:95], v[172:175]
    v_mfma_f32_16x16x32_bf16 v[116:119], a[0:3], v[180:183], v[116:119]
    v_mfma_f32_16x16x32_bf16 v[120:123], a[4:7], v[180:183], v[120:123]
    v_mfma_f32_16x16x32_bf16 v[124:127], a[8:11], v[180:183], v[124:127]
    v_mfma_f32_16x16x32_bf16 v[128:131], a[12:15], v[180:183], v[128:131]
    v_mfma_f32_16x16x32_bf16 v[132:135], a[16:19], v[180:183], v[132:135]
    v_mfma_f32_16x16x32_bf16 v[116:119], a[32:35], v[20:23], v[116:119]
    v_mfma_f32_16x16x32_bf16 v[120:123], a[36:39], v[20:23], v[120:123]
    v_mfma_f32_16x16x32_bf16 v[124:127], a[40:43], v[20:23], v[124:127]
    v_mfma_f32_16x16x32_bf16 v[128:131], a[44:47], v[20:23], v[128:131]
    s_waitcnt vmcnt(11)
    v_or_b32 v40, v40, v203
    v_mfma_f32_16x16x32_bf16 v[132:135], a[48:51], v[20:23], v[132:135]
    v_min3_f32 v9, |v184|, |v24|, |v40|
    v_cmp_gt_f32 vcc, 0x24800000, v9
    v_mfma_f32_16x16x32_bf16 v[116:119], a[52:55], v[36:39], v[116:119]
    s_waitcnt vmcnt(6)
    v_lshlrev_b32 v218, 16, v208
    v_mfma_f32_16x16x32_bf16 v[120:123], a[56:59], v[36:39], v[120:123]
    s_cbranch_vccnz m2_q13_again
m2_q13_ok:
    v_mfma_f32_16x16x32_bf16 v[124:127], a[60:63], v[36:39], v[124:127]
    v_and_b32 v219, s69, v208
    v_fmac_f32 v96, s68, v218
    v_mfma_f32_16x16x32_bf16 v[128:131], a[64:67], v[36:39], v[128:131]
    v_fmac_f32 v97, s68, v219
    v_lshlrev_b32 v220, 16, v209
    v_mfma_f32_16x16x32_bf16 v[132:135], a[68:71], v[36:39], v[132:135]
    v_and_b32 v221, s69, v209
    v_fmac_f32 v98, s68, v220
    v_mfma_f32_16x16x32_bf16 v[136:139], a[0:3], v[184:187], v[136:139]
    ds_write_b128 v5, v[116:119] offset:0
    v_fmac_f32 v99, s68, v221
    v_mfma_f32_16x16x32_bf16 v[140:143], a[4:7], v[184:187], v[140:143]
    v_lshlrev_b32 v218, 16, v210
    v_and_b32 v219, s69, v210
    v_mfma_f32_16x16x32_bf16 v[144:147], a[8:11], v[184:187], v[144:147]
    ds_write_b128 v5, v[120:123] offset:1024
    v_fmac_f32 v100, s68, v218
    v_mfma_f32_16x16x32_bf16 v[148:151], a[12:15], v[184:187], v[148:151]
    v_fmac_f32 v101, s68, v219
    v_lshlrev_b32 v220, 16, v211
    v_mfma_f32_16x16x32_bf16 v[152:155], a[16:19], v[184:187], v[152:155]
    v_and_b32 v221, s69, v211
    v_fmac_f32 v102, s68, v220
    v_mfma_f32_16x16x32_bf16 v[136:139], a[32:35], v[24:27], v[136:139]
    ds_write_b128 v5, v[124:127] offset:2048
    v_fmac_f32 v103, s68, v221
    v_mfma_f32_16x16x32_bf16 v[140:143], a[36:39], v[24:27], v[140:143]
    v_lshlrev_b32 v218, 16, v212
    v_and_b32 v219, s69, v212
    v_mfma_f32_16x16x32_bf16 v[144:147], a[40:43], v[24:27], v[144:147]
    v_fmac_f32 v104, s68, v218
    v_fmac_f32 v105, s68, v219
    v_mfma_f32_16x16x32_bf16 v[148:151], a[44:47], v[24:27], v[148:151]
    s_waitcnt vmcnt(3)
    v_or_b32 v44, v44, v203
    v_mfma_f32_16x16x32_bf16 v[152:155], a[48:51], v[24:27], v[152:155]
    v_min3_f32 v9, |v188|, |v28|, |v44|
    v_cmp_gt_f32 vcc, 0x24800000, v9
    v_mfma_f32_16x16x32_bf16 v[136:139], a[52:55], v[40:43], v[136:139]
    ds_write_b128 v5, v[128:131] offset:3072
    v_lshlrev_b32 v220, 16, v213
    v_mfma_f32_16x16x32_bf16 v[140:143], a[56:59], v[40:43], v[140:143]
    s_cbranch_vccnz m2_q14_again
m2_q14_ok:
    v_mfma_f32_16x16x32_bf16 v[144:147], a[60:63], v[40:43], v[144:147]
    ds_write_b128 v5, v[132:135] offset:4096
    v_and_b32 v221, s69, v213
    v_mfma_f32_16x16x32_bf16 v[148:151], a[64:67], v[40:43], v[148:151]
    v_fmac_f32 v106, s68, v220
    v_fmac_f32 v107, s68, v221
    v_mfma_f32_16x16x32_bf16 v[152:155], a[68:71], v[40:43], v[152:155]
    v_lshlrev_b32 v218, 16, v214
    v_and_b32 v219, s69, v214
    v_mfma_f32_16x16x32_bf16 v[156:159], a[0:3], v[188:191], v[156:159]
    ds_write_b128 v6, v[136:139] offset:0
    v_fmac_f32 v108, s68, v218
    v_mfma_f32_16x16x32_bf16 v[160:163], a[4:7], v[188:191], v[160:163]
    v_fmac_f32 v109, s68, v219
    v_lshlrev_b32 v220, 16, v215
    v_mfma_f32_16x16x32_bf16 v[164:167], a[8:11], v[188:191], v[164:167]
    ds_write_b128 v6, v[140:143] offset:1024
    v_and_b32 v221, s69, v215
    v_mfma_f32_16x16x32_bf16 v[168:171], a[12:15], v[188:191], v[168:171]
    v_fmac_f32 v110, s68, v220
    v_fmac_f32 v111, s68, v221
    v_mfma_f32_16x16x32_bf16 v[172:175], a[16:19], v[188:191], v[172:175]
    v_lshlrev_b32 v218, 16, v216
    v_and_b32 v219, s69, v216
    v_mfma_f32_16x16x32_bf16 v[156:159], a[32:35], v[28:31], v[156:159]
    ds_write_b128 v6, v[144:147] offset:2048
    v_fmac_f32 v112, s68, v218
    v_mfma_f32_16x16x32_bf16 v[160:163], a[36:39], v[28:31], v[160:163]
    v_fmac_f32 v113, s68, v219
    v_lshlrev_b32 v220, 16, v217
    v_mfma_f32_16x16x32_bf16 v[164:167], a[40:43], v[28:31], v[164:167]
    v_and_b32 v221, s69, v217
    v_fmac_f32 v114, s68, v220
    v_mfma_f32_16x16x32_bf16 v[168:171], a[44:47], v[28:31], v[168:171]
    s_waitcnt vmcnt(0)
    v_or_b32 v32, v32, v203
    v_mfma_f32_16x16x32_bf16 v[172:175], a[48:51], v[28:31], v[172:175]
    v_min3_f32 v9, |v176|, |v16|, |v32|
    v_cmp_gt_f32 vcc, 0x24800000, v9
    v_mfma_f32_16x16x32_bf16 v[156:159], a[52:55], v[44:47], v[156:159]
    ds_write_b128 v6, v[148:151] offset:3072
    v_fmac_f32 v115, s68, v221
    v_mfma_f32_16x16x32_bf16 v[160:163], a[56:59], v[44:47], v[160:163]
    s_cbranch_vccnz m2_q15_again
m2_q15_ok:
    v_mfma_f32_16x16x32_bf16 v[164:167], a[60:63], v[44:47], v[164:167]
    ds_write_b128 v6, v[152:155] offset:4096
    v_mfma_f32_16x16x32_bf16 v[168:171], a[64:67], v[44:47], v[168:171]
    v_mfma_f32_16x16x32_bf16 v[172:175], a[68:71], v[44:47], v[172:175]
    s_waitcnt lgkmcnt(0)
    s_barrier
    v_mfma_f32_16x16x32_bf16 v[96:99], a[0:3], v[176:179], v[96:99]
    ds_write_b128 v7, v[156:159] offset:0
    v_mfma_f32_16x16x32_bf16 v[100:103], a[4:7], v[176:179], v[100:103]
    v_mfma_f32_16x16x32_bf16 v[104:107], a[8:11], v[176:179], v[104:107]
    ds_write_b128 v7, v[160:163] offset:1024
    v_mfma_f32_16x16x32_bf16 v[108:111], a[12:15], v[176:179], v[108:111]
    v_mfma_f32_16x16x32_bf16 v[112:115], a[16:19], v[176:179], v[112:115]
    v_mfma_f32_16x16x32_bf16 v[96:99], a[32:35], v[16:19], v[96:99]
    ds_write_b128 v7, v[164:167] offset:2048
    v_mfma_f32_16x16x32_bf16 v[100:103], a[36:39], v[16:19], v[100:103]
    v_mfma_f32_16x16x32_bf16 v[104:107], a[40:43], v[16:19], v[104:107]
    v_mfma_f32_16x16x32_bf16 v[108:111], a[44:47], v[16:19], v[108:111]
    ds_write_b128 v7, v[168:171] offset:3072
    v_mfma_f32_16x16x32_bf16 v[112:115], a[48:51], v[16:19], v[112:115]
    v_mfma_f32_16x16x32_bf16 v[96:99], a[52:55], v[32:35], v[96:99]
    v_mfma_f32_16x16x32_bf16 v[100:103], a[56:59], v[32:35], v[100:103]
    ds_write_b128 v7, v[172:175] offset:4096
    ds_read_b128 v[116:119], v204 offset:0
    v_mfma_f32_16x16x32_bf16 v[104:107], a[60:63], v[32:35], v[104:107]
    ds_read_b128 v[120:123], v204 offset:1024
    ds_read_b128 v[124:127], v204 offset:2048
    v_mfma_f32_16x16x32_bf16 v[108:111], a[64:67], v[32:35], v[108:111]
    ds_read_b128 v[128:131], v204 offset:3072
    ds_read_b128 v[132:135], v204 offset:4096
    v_mfma_f32_16x16x32_bf16 v[112:115], a[68:71], v[32:35], v[112:115]
    ds_read_b128 v[136:139], v204 offset:5120
    ds_read_b128 v[140:143], v204 offset:6144
    ds_read_b128 v[144:147], v204 offset:7168
    ds_read_b128 v[148:151], v204 offset:8192
    ds_read_b128 v[152:155], v204 offset:9216
    s_waitcnt lgkmcnt(0)
    s_barrier
    ds_read_b128 v[156:159], v204 offset:10240
    ds_read_b128 v[160:163], v204 offset:11264
    ds_read_b128 v[164:167], v204 offset:12288
    ds_read_b128 v[168:171], v204 offset:13312
    ds_read_b128 v[172:175], v204 offset:14336
    v_pk_add_f32 v[116:117], v[116:117], v[136:137]
    v_pk_add_f32 v[118:119], v[118:119], v[138:139]
    v_pk_add_f32 v[120:121], v[120:121], v[140:141]
    v_pk_add_f32 v[122:123], v[122:123], v[142:143]
    v_pk_add_f32 v[124:125], v[124:125], v[144:145]
    v_pk_add_f32 v[126:127], v[126:127], v[146:147]
    v_pk_add_f32 v[128:129], v[128:129], v[148:149]
    v_pk_add_f32 v[130:131], v[130:131], v[150:151]
    v_pk_add_f32 v[132:133], v[132:133], v[152:153]
    v_pk_add_f32 v[134:135], v[134:135], v[154:155]
    v_pk_add_f32 v[96:97], v[96:97], v[116:117]
    v_pk_add_f32 v[98:99], v[98:99], v[118:119]
    v_pk_add_f32 v[100:101], v[100:101], v[120:121]
    v_pk_add_f32 v[102:103], v[102:103], v[122:123]
    v_pk_add_f32 v[104:105], v[104:105], v[124:125]
    v_pk_add_f32 v[106:107], v[106:107], v[126:127]
    v_pk_add_f32 v[108:109], v[108:109], v[128:129]
    v_pk_add_f32 v[110:111], v[110:111], v[130:131]
    v_pk_add_f32 v[112:113], v[112:113], v[132:133]
    v_pk_add_f32 v[114:115], v[114:115], v[134:135]
    s_waitcnt lgkmcnt(4)
    v_pk_add_f32 v[96:97], v[96:97], v[156:157]
    v_pk_add_f32 v[98:99], v[98:99], v[158:159]
    v_cvt_pk_bf16_f32 v96, v96, v97
    v_cvt_pk_bf16_f32 v97, v98, v99
    buffer_store_dwordx2 v[96:97], v202, s[36:39], 0 offen offset:0
    s_waitcnt lgkmcnt(3)
    v_pk_add_f32 v[100:101], v[100:101], v[160:161]
    v_pk_add_f32 v[102:103], v[102:103], v[162:163]
    v_cvt_pk_bf16_f32 v100, v100, v101
    v_cvt_pk_bf16_f32 v101, v102, v103
    buffer_store_dwordx2 v[100:101], v202, s[36:39], 0 offen offset:32
    s_waitcnt lgkmcnt(2)
    v_pk_add_f32 v[104:105], v[104:105], v[164:165]
    v_pk_add_f32 v[106:107], v[106:107], v[166:167]
    v_cvt_pk_bf16_f32 v104, v104, v105
    v_cvt_pk_bf16_f32 v105, v106, v107
    buffer_store_dwordx2 v[104:105], v202, s[36:39], 0 offen offset:64
    s_waitcnt lgkmcnt(1)
    v_pk_add_f32 v[108:109], v[108:109], v[168:169]
    v_pk_add_f32 v[110:111], v[110:111], v[170:171]
    v_cvt_pk_bf16_f32 v108, v108, v109
    v_cvt_pk_bf16_f32 v109, v110, v111
    buffer_store_dwordx2 v[108:109], v202, s[36:39], 0 offen offset:96
    s_waitcnt lgkmcnt(0)
    v_pk_add_f32 v[112:113], v[112:113], v[172:173]
    v_pk_add_f32 v[114:115], v[114:115], v[174:175]
    v_cvt_pk_bf16_f32 v112, v112, v113
    v_cvt_pk_bf16_f32 v113, v114, v115
    buffer_store_dwordx2 v[112:113], v202, s[36:39], 0 offen offset:128
    s_endpgm
idle0:
    s_add_u32 s32, s28, 6979584
    s_addc_u32 s33, s29, 0
    s_and_b32 s33, s33, 0xffff
    s_mov_b32 s34, 2662400
    s_mov_b32 s35, 0x20000
    v_and_b32 v16, 31, v3
    v_bfe_u32 v17, v3, 5, 1
    v_lshl_add_u32 v16, v17, 7, v16
    v_lshl_add_u32 v16, s56, 5, v16
    v_lshlrev_b32 v16, 7, v16
    v_add_u32 v16, 294912, v16
    buffer_load_dword v17, v16, s[12:15], 0 offen sc1
    s_getreg_b32 s59, hwreg(HW_REG_XCC_ID, 0, 3)
    s_add_u32 s59, s59, 8
    s_lshl_b32 s58, s3, 7
    s_add_u32 s58, s58, 294912
    v_lshrrev_b32 v22, 1, v0
    v_lshl_add_u32 v22, v22, 20, s58
    v_and_b32 v20, 1, v0
    v_lshlrev_b32 v21, 15, v20
    v_sub_u32 v22, v22, v21
    s_waitcnt vmcnt(1)
    v_accvgpr_read_b32 v21, a255
    v_and_b32 v21, -8, v21
    v_add_u32 v21, s59, v21
    v_or_b32 v21, v20, v21
    s_barrier
    buffer_store_dword v21, v22, s[12:15], 0 offen sc1
    s_getreg_b32 s59, hwreg(HW_REG_XCC_ID, 0, 3)
    s_add_u32 s59, s59, 16
    s_lshl_b32 s58, s3, 7
    s_add_u32 s58, s58, 294912
    v_lshl_add_u32 v26, v0, 20, s58
    v_accvgpr_read_b32 v25, a255
    v_and_b32 v25, -8, v25
    v_add_u32 v25, s59, v25
    v_accvgpr_read_b32 v18, a254
    s_waitcnt vmcnt(1)
    s_nop 2
    s_branch n1_fwt
n1_fw:
    buffer_load_dword v17, v16, s[12:15], 0 offen sc1
    s_add_u32 s99, s99, 1
    s_cmp_ge_u32 s99, 16384
    s_cbranch_scc1 n1_fwok
    s_waitcnt vmcnt(0)
n1_fwt:
    v_cmp_eq_u32 vcc, v18, v17
    s_nop 3
    s_cbranch_vccz n1_fwok
    s_mov_b64 exec, vcc
    s_branch n1_fw
n1_fwok:
    s_mov_b64 exec, -1
    s_getreg_b32 s59, hwreg(HW_REG_XCC_ID, 0, 3)
    s_lshl_b32 s59, s59, 20
    s_lshl_b32 s58, s3, 7
    s_add_u32 s58, s58, s59
    s_add_u32 s58, s58, 294912
    v_and_b32 v17, 7, v17
    v_lshl_add_u32 v17, v17, 20, v16
    v_cmp_gt_u32 vcc, s58, v17
    s_lshl_b32 s59, s56, 2
    v_mov_b32 v16, s59
    s_bcnt1_i32_b64 s58, vcc
    v_mov_b32 v17, s58
    ds_write_b32 v16, v17 offset:16384
    v_mov_b32 v16, 0
    s_waitcnt lgkmcnt(0)
    s_barrier
    buffer_store_dword v25, v26, s[12:15], 0 offen sc1
    ds_read_b128 v[16:19], v16 offset:16384
    s_waitcnt lgkmcnt(0)
    v_add_u32 v16, v16, v17
    v_add3_u32 v16, v16, v18, v19
    s_nop 0
    v_readfirstlane_b32 s100, v16
    s_nop 0
    s_and_b32 s58, s100, 31
    s_bfe_u32 s100, s100, 0x30005
    s_lshl3_add_u32 s100, s58, s100
    s_and_b32 s58, s100, 7
    s_lshr_b32 s59, s58, 1
    s_lshl_b32 s59, s59, 2
    s_bfe_u32 s96, s100, 0x20006
    s_add_u32 s96, s96, s59
    s_and_b32 s58, s58, 1
    s_lshl_b32 s58, s58, 3
    s_bfe_u32 s97, s100, 0x30003
    s_add_u32 s97, s97, s58
    s_lshl_b32 s98, s96, 7
    s_and_b32 s58, s97, 3
    s_cmp_eq_u32 s58, 3
    s_cselect_b32 s26, 0x40000000, 0
    s_lshr_b32 s59, s97, 3
    s_lshl2_add_u32 s16, s59, s58
    s_mul_i32 s19, s97, 7
    s_lshr_b32 s59, s97, 2
    s_sub_u32 s19, s19, s59
    s_mul_i32 s20, s56, 5120
    s_mul_i32 s21, s56, 15360
    s_mul_i32 s62, s56, 35840
    s_add_u32 m0, s62, 20480
    v_lshlrev_b32 v10, 4, v3
    s_mul_i32 s58, s19, 20480
    s_add_u32 s58, s58, 12288
    s_add_u32 s48, s28, s58
    s_addc_u32 s49, s29, 0
    s_and_b32 s49, s49, 0xffff
    s_mov_b32 s50, 163840
    s_cmp_lg_u32 s26, 0
    s_cselect_b32 s50, 143360, s50
    s_mov_b32 s51, 0x20000
    v_lshrrev_b32 v11, 1, v2
    v_and_b32 v12, 1, v2
    v_mad_u32_u24 v15, v11, 14, v12
    v_mul_u32_u24 v15, 10240, v15
    v_lshl_add_u32 v15, v1, 4, v15
    s_mul_i32 s58, s16, 1280
    s_mul_i32 s59, s56, 552960
    s_add_u32 s58, s58, s59
    v_add_u32 v15, s58, v15
    v_mul_u32_u24 v11, 33792, v11
    v_lshl_add_u32 v11, v1, 5, v11
    v_lshl_add_u32 v11, v12, 4, v11
    s_mul_i32 s58, s19, 67584
    s_lshl4_add_u32 s58, s98, s58
    s_lshl_b32 s59, s56, 9
    s_add_u32 s58, s58, s59
    v_add_u32 v11, s58, v11
    v_add_u32 v12, s26, v11
    s_add_u32 s52, s28, 2330624
    s_addc_u32 s53, s29, 0
    s_and_b32 s53, s53, 0xffff
    s_mov_b32 s54, 2232320
    s_mov_b32 s55, 0x20000
    s_add_u32 s58, s56, 1
    s_mul_i32 s58, s58, 552960
    s_cmp_eq_u32 s56, 3
    s_cselect_b32 s54, s54, s58
    buffer_load_dwordx4 v10, s[48:51], m0 offen offset:0 lds
    buffer_load_dwordx4 v10, s[48:51], m0 offen offset:1024 lds
    buffer_load_dwordx4 v10, s[48:51], m0 offen offset:2048 lds
    buffer_load_dwordx4 v10, s[48:51], m0 offen offset:3072 lds
    s_add_u32 m0, m0, 4096
    s_nop 0
    buffer_load_dwordx4 v10, s[48:51], m0 offen offset:0 lds
    s_mov_b32 s65, 0
    buffer_store_dwordx4 a[0:3], v11, s[8:11], s65 offen sc1
    buffer_load_dwordx4 v10, s[48:51], m0 offen offset:1024 lds
    buffer_load_dwordx4 v10, s[48:51], m0 offen offset:2048 lds
    buffer_load_dwordx4 v10, s[48:51], m0 offen offset:3072 lds
    s_add_u32 m0, m0, 4096
    s_nop 0
    buffer_load_dwordx4 v10, s[48:51], m0 offen offset:0 lds
    buffer_load_dwordx4 v10, s[48:51], m0 offen offset:1024 lds
    s_mov_b32 s65, 67584
    buffer_store_dwordx4 a[0:3], v11, s[8:11], s65 offen sc1
    buffer_load_dwordx4 v10, s[48:51], m0 offen offset:2048 lds
    buffer_load_dwordx4 v10, s[48:51], m0 offen offset:3072 lds
    s_add_u32 m0, m0, 4096
    s_nop 0
    buffer_load_dwordx4 v10, s[48:51], m0 offen offset:0 lds
    buffer_load_dwordx4 v10, s[48:51], m0 offen offset:1024 lds
    buffer_load_dwordx4 v10, s[48:51], m0 offen offset:2048 lds
    s_mov_b32 s65, 135168
    buffer_store_dwordx4 a[0:3], v11, s[8:11], s65 offen sc1
    buffer_load_dwordx4 v10, s[48:51], m0 offen offset:3072 lds
    s_add_u32 m0, m0, 4096
    s_nop 0
    buffer_load_dwordx4 v10, s[48:51], m0 offen offset:0 lds
    buffer_load_dwordx4 v10, s[48:51], m0 offen offset:1024 lds
    buffer_load_dwordx4 v10, s[48:51], m0 offen offset:2048 lds
    buffer_load_dwordx4 v10, s[48:51], m0 offen offset:3072 lds
    s_add_u32 m0, m0, 4096
    s_mov_b32 s65, 202752
    buffer_store_dwordx4 a[0:3], v11, s[8:11], s65 offen sc1
    buffer_load_dwordx4 v10, s[48:51], m0 offen offset:0 lds
    buffer_load_dwordx4 v10, s[48:51], m0 offen offset:1024 lds
    buffer_load_dwordx4 v10, s[48:51], m0 offen offset:2048 lds
    buffer_load_dwordx4 v10, s[48:51], m0 offen offset:3072 lds
    s_add_u32 m0, m0, 4096
    s_nop 0
    buffer_load_dwordx4 v10, s[48:51], m0 offen offset:0 lds
    s_mov_b32 s65, 270336
    buffer_store_dwordx4 a[0:3], v11, s[8:11], s65 offen sc1
    buffer_load_dwordx4 v10, s[48:51], m0 offen offset:1024 lds
    buffer_load_dwordx4 v10, s[48:51], m0 offen offset:2048 lds
    buffer_load_dwordx4 v10, s[48:51], m0 offen offset:3072 lds
    s_add_u32 m0, m0, 4096
    s_nop 0
    buffer_load_dwordx4 v10, s[48:51], m0 offen offset:0 lds
    buffer_load_dwordx4 v10, s[48:51], m0 offen offset:1024 lds
    s_mov_b32 s65, 337920
    buffer_store_dwordx4 a[0:3], v11, s[8:11], s65 offen sc1
    s_mul_i32 s64, s56, 27
    v_min_u32 v14, 27, v3
    v_add_u32 v14, s64, v14
    v_sub_u32 v14, 252, v14
    v_lshlrev_b32 v14, 7, v14
    s_mov_b32 s64, 262144
    buffer_load_dword v14, v14, s[12:15], s64 offen sc1
    buffer_load_dwordx4 v10, s[48:51], m0 offen offset:2048 lds
    buffer_load_dwordx4 v10, s[48:51], m0 offen offset:3072 lds
    s_add_u32 m0, m0, 4096
    s_nop 0
    buffer_load_dwordx4 v10, s[48:51], m0 offen offset:0 lds
    buffer_load_dwordx4 v10, s[48:51], m0 offen offset:1024 lds
    s_mov_b32 s65, 405504
    buffer_store_dwordx4 a[0:3], v12, s[8:11], s65 offen sc1
    buffer_load_dwordx4 v10, s[48:51], m0 offen offset:2048 lds
    s_waitcnt vmcnt(6)
    v_cmp_eq_u32 vcc, 0, v14
    s_nop 3
    s_cbranch_vccnz n1_w2
n1_w2ok:
    s_mov_b32 s64, 0
    buffer_load_dwordx4 a[32:35], v15, s[52:55], s64 offen offset:0
    buffer_load_dwordx4 a[36:39], v15, s[52:55], s64 offen offset:256
    buffer_load_dwordx4 a[40:43], v15, s[52:55], s64 offen offset:512
    buffer_load_dwordx4 a[44:47], v15, s[52:55], s64 offen offset:768
    buffer_load_dwordx4 a[48:51], v15, s[52:55], s64 offen offset:1024
    s_mov_b32 s64, 286720
    buffer_load_dwordx4 a[52:55], v15, s[52:55], s64 offen offset:0
    buffer_load_dwordx4 a[56:59], v15, s[52:55], s64 offen offset:256
    buffer_load_dwordx4 a[60:63], v15, s[52:55], s64 offen offset:512
    buffer_load_dwordx4 a[64:67], v15, s[52:55], s64 offen offset:768
    buffer_load_dwordx4 a[68:71], v15, s[52:55], s64 offen offset:1024
    s_mov_b32 s64, 20480
    buffer_load_dwordx4 a[72:75], v15, s[52:55], s64 offen offset:0
    buffer_load_dwordx4 a[76:79], v15, s[52:55], s64 offen offset:256
    buffer_load_dwordx4 a[80:83], v15, s[52:55], s64 offen offset:512
    buffer_load_dwordx4 a[84:87], v15, s[52:55], s64 offen offset:768
    buffer_load_dwordx4 a[88:91], v15, s[52:55], s64 offen offset:1024
    s_mov_b32 s64, 307200
    buffer_load_dwordx4 a[92:95], v15, s[52:55], s64 offen offset:0
    buffer_load_dwordx4 a[96:99], v15, s[52:55], s64 offen offset:256
    buffer_load_dwordx4 a[100:103], v15, s[52:55], s64 offen offset:512
    buffer_load_dwordx4 a[104:107], v15, s[52:55], s64 offen offset:768
    buffer_load_dwordx4 a[108:111], v15, s[52:55], s64 offen offset:1024
    s_mov_b32 s64, 40960
    buffer_load_dwordx4 a[112:115], v15, s[52:55], s64 offen offset:0
    buffer_load_dwordx4 a[116:119], v15, s[52:55], s64 offen offset:256
    buffer_load_dwordx4 a[120:123], v15, s[52:55], s64 offen offset:512
    buffer_load_dwordx4 a[124:127], v15, s[52:55], s64 offen offset:768
    buffer_load_dwordx4 a[128:131], v15, s[52:55], s64 offen offset:1024
    s_mov_b32 s64, 327680
    buffer_load_dwordx4 a[132:135], v15, s[52:55], s64 offen offset:0
    buffer_load_dwordx4 a[136:139], v15, s[52:55], s64 offen offset:256
    buffer_load_dwordx4 a[140:143], v15, s[52:55], s64 offen offset:512
    s_mul_i32 s65, s56, 5120
    s_add_u32 s65, s65, 196608
    v_min_u32 v13, 39, v3
    v_lshlrev_b32 v13, 7, v13
    buffer_load_dword v12, v13, s[12:15], s65 offen sc1
    buffer_load_dwordx4 a[144:147], v15, s[52:55], s64 offen offset:768
    buffer_load_dwordx4 a[148:151], v15, s[52:55], s64 offen offset:1024
    s_mov_b32 s64, 61440
    buffer_load_dwordx4 a[152:155], v15, s[52:55], s64 offen offset:0
    buffer_load_dwordx4 a[156:159], v15, s[52:55], s64 offen offset:256
    buffer_load_dwordx4 a[160:163], v15, s[52:55], s64 offen offset:512
    buffer_load_dwordx4 a[164:167], v15, s[52:55], s64 offen offset:768
    buffer_load_dwordx4 a[168:171], v15, s[52:55], s64 offen offset:1024
    s_mov_b32 s64, 348160
    buffer_load_dwordx4 a[172:175], v15, s[52:55], s64 offen offset:0
    buffer_load_dwordx4 a[176:179], v15, s[52:55], s64 offen offset:256
    buffer_load_dwordx4 a[180:183], v15, s[52:55], s64 offen offset:512
    buffer_load_dwordx4 a[184:187], v15, s[52:55], s64 offen offset:768
    buffer_load_dwordx4 a[188:191], v15, s[52:55], s64 offen offset:1024
    s_waitcnt vmcnt(12)
    v_cmp_eq_u32 vcc, 0, v12
    s_nop 3
    s_cbranch_vccz n1_ok
n1_spin:
    buffer_load_dword v12, v13, s[12:15], s65 offen sc1
    s_add_u32 s99, s99, 1
    s_cmp_ge_u32 s99, 16384
    s_cbranch_scc1 n1_ok
    s_waitcnt vmcnt(0)
    v_cmp_eq_u32 vcc, 0, v12
    s_nop 3
    s_cbranch_vccnz n1_spin
n1_ok:
    s_barrier
    s_branch join0
c1_w2:
    s_mul_i32 s64, s56, 27
    v_min_u32 v14, 27, v3
    v_add_u32 v14, s64, v14
    v_sub_u32 v14, 252, v14
    v_lshlrev_b32 v14, 7, v14
    s_mov_b32 s64, 262144
    buffer_load_dword v14, v14, s[12:15], s64 offen sc1
    s_add_u32 s99, s99, 1
    s_cmp_ge_u32 s99, 16384
    s_cbranch_scc1 c1_w2out
    s_waitcnt vmcnt(0)
    v_cmp_eq_u32 vcc, 0, v14
    s_nop 3
    s_cbranch_vccnz c1_w2
c1_w2out:
    s_waitcnt vmcnt(0)
    s_branch c1_w2ok
m1_x0_again:
    s_nop 7
    s_add_u32 s99, s99, 1
    s_cmp_ge_u32 s99, 16384
    s_cbranch_scc1 m1_x0_out
    s_waitcnt vmcnt(52)
    s_mov_b32 s17, 2529280
    buffer_load_dwordx4 v[16:19], v4, s[32:35], s17 offen sc1
    buffer_load_dwordx4 v[20:23], v8, s[32:35], s17 offen sc1
    s_mov_b32 s17, 2396160
    buffer_load_dwordx4 v[24:27], v4, s[32:35], s17 offen sc1
    buffer_load_dwordx4 v[28:31], v8, s[32:35], s17 offen sc1
    s_mov_b32 s17, 2263040
    buffer_load_dwordx4 v[32:35], v4, s[32:35], s17 offen sc1
    buffer_load_dwordx4 v[36:39], v8, s[32:35], s17 offen sc1
    s_mov_b32 s17, 2129920
    buffer_load_dwordx4 v[40:43], v4, s[32:35], s17 offen sc1
    buffer_load_dwordx4 v[44:47], v8, s[32:35], s17 offen sc1
    s_mov_b32 s17, 1996800
    buffer_load_dwordx4 v[48:51], v4, s[32:35], s17 offen sc1
    buffer_load_dwordx4 v[52:55], v8, s[32:35], s17 offen sc1
    s_waitcnt vmcnt(8)
    v_min_f32_e64 v9, |v16|, |v20|
    v_cmp_gt_f32 vcc, 0x24800000, v9
    s_nop 3
    s_cbranch_vccnz m1_x0_again
m1_x0_out:
    s_branch m1_x0_ok
m1_x1_again:
    s_nop 7
    s_add_u32 s99, s99, 1
    s_cmp_ge_u32 s99, 16384
    s_cbranch_scc1 m1_x1_out
    s_waitcnt vmcnt(51)
    s_mov_b32 s17, 2396160
    buffer_load_dwordx4 v[24:27], v4, s[32:35], s17 offen sc1
    buffer_load_dwordx4 v[28:31], v8, s[32:35], s17 offen sc1
    s_mov_b32 s17, 2263040
    buffer_load_dwordx4 v[32:35], v4, s[32:35], s17 offen sc1
    buffer_load_dwordx4 v[36:39], v8, s[32:35], s17 offen sc1
    s_mov_b32 s17, 2129920
    buffer_load_dwordx4 v[40:43], v4, s[32:35], s17 offen sc1
    buffer_load_dwordx4 v[44:47], v8, s[32:35], s17 offen sc1
    s_mov_b32 s17, 1996800
    buffer_load_dwordx4 v[48:51], v4, s[32:35], s17 offen sc1
    buffer_load_dwordx4 v[52:55], v8, s[32:35], s17 offen sc1
    buffer_load_dword a253, off, s[52:55], 0
    s_mov_b32 s17, 1863680
    buffer_load_dwordx4 v[56:59], v4, s[32:35], s17 offen sc1
    buffer_load_dwordx4 v[60:63], v8, s[32:35], s17 offen sc1
    s_waitcnt vmcnt(9)
    v_min_f32_e64 v9, |v24|, |v28|
    v_cmp_gt_f32 vcc, 0x24800000, v9
    s_nop 3
    s_cbranch_vccnz m1_x1_again
m1_x1_out:
    s_branch m1_x1_ok
m1_x2_again:
    s_nop 7
    s_add_u32 s99, s99, 1
    s_cmp_ge_u32 s99, 16384
    s_cbranch_scc1 m1_x2_out
    s_waitcnt vmcnt(49)
    s_mov_b32 s17, 2263040
    buffer_load_dwordx4 v[32:35], v4, s[32:35], s17 offen sc1
    buffer_load_dwordx4 v[36:39], v8, s[32:35], s17 offen sc1
    s_mov_b32 s17, 2129920
    buffer_load_dwordx4 v[40:43], v4, s[32:35], s17 offen sc1
    buffer_load_dwordx4 v[44:47], v8, s[32:35], s17 offen sc1
    s_mov_b32 s17, 1996800
    buffer_load_dwordx4 v[48:51], v4, s[32:35], s17 offen sc1
    buffer_load_dwordx4 v[52:55], v8, s[32:35], s17 offen sc1
    buffer_load_dword a253, off, s[52:55], 0
    s_mov_b32 s17, 1863680
    buffer_load_dwordx4 v[56:59], v4, s[32:35], s17 offen sc1
    buffer_load_dwordx4 v[60:63], v8, s[32:35], s17 offen sc1
    s_mov_b32 s17, 1730560
    buffer_load_dwordx4 v[64:67], v4, s[32:35], s17 offen sc1
    buffer_load_dwordx4 v[68:71], v8, s[32:35], s17 offen sc1
    s_mov_b32 s17, 1597440
    buffer_load_dwordx4 v[72:75], v4, s[32:35], s17 offen sc1
    buffer_load_dwordx4 v[76:79], v8, s[32:35], s17 offen sc1
    s_waitcnt vmcnt(11)
    v_min_f32_e64 v9, |v32|, |v36|
    v_cmp_gt_f32 vcc, 0x24800000, v9
    s_nop 3
    s_cbranch_vccnz m1_x2_again
m1_x2_out:
    s_branch m1_x2_ok
m1_x3_again:
    s_nop 7
    s_add_u32 s99, s99, 1
    s_cmp_ge_u32 s99, 16384
    s_cbranch_scc1 m1_x3_out
    s_waitcnt vmcnt(47)
    s_mov_b32 s17, 2129920
    buffer_load_dwordx4 v[40:43], v4, s[32:35], s17 offen sc1
    buffer_load_dwordx4 v[44:47], v8, s[32:35], s17 offen sc1
    s_mov_b32 s17, 1996800
    buffer_load_dwordx4 v[48:51], v4, s[32:35], s17 offen sc1
    buffer_load_dwordx4 v[52:55], v8, s[32:35], s17 offen sc1
    buffer_load_dword a253, off, s[52:55], 0
    s_mov_b32 s17, 1863680
    buffer_load_dwordx4 v[56:59], v4, s[32:35], s17 offen sc1
    buffer_load_dwordx4 v[60:63], v8, s[32:35], s17 offen sc1
    s_mov_b32 s17, 1730560
    buffer_load_dwordx4 v[64:67], v4, s[32:35], s17 offen sc1
    buffer_load_dwordx4 v[68:71], v8, s[32:35], s17 offen sc1
    s_mov_b32 s17, 1597440
    buffer_load_dwordx4 v[72:75], v4, s[32:35], s17 offen sc1
    buffer_load_dwordx4 v[76:79], v8, s[32:35], s17 offen sc1
    s_mov_b32 s17, 1464320
    buffer_load_dwordx4 v[80:83], v4, s[32:35], s17 offen sc1
    buffer_load_dwordx4 v[84:87], v8, s[32:35], s17 offen sc1
    s_mov_b32 s17, 1331200
    buffer_load_dwordx4 v[88:91], v4, s[32:35], s17 offen sc1
    buffer_load_dwordx4 v[92:95], v8, s[32:35], s17 offen sc1
    s_waitcnt vmcnt(13)
    v_min_f32_e64 v9, |v40|, |v44|
    v_cmp_gt_f32 vcc, 0x24800000, v9
    s_nop 3
    s_cbranch_vccnz m1_x3_again
m1_x3_out:
    s_branch m1_x3_ok
m1_x4_again:
    s_nop 7
    s_add_u32 s99, s99, 1
    s_cmp_ge_u32 s99, 16384
    s_cbranch_scc1 m1_x4_out
    s_waitcnt vmcnt(48)
    s_mov_b32 s17, 1996800
    buffer_load_dwordx4 v[48:51], v4, s[32:35], s17 offen sc1
    buffer_load_dwordx4 v[52:55], v8, s[32:35], s17 offen sc1
    buffer_load_dword a253, off, s[52:55], 0
    s_mov_b32 s17, 1863680
    buffer_load_dwordx4 v[56:59], v4, s[32:35], s17 offen sc1
    buffer_load_dwordx4 v[60:63], v8, s[32:35], s17 offen sc1
    s_mov_b32 s17, 1730560
    buffer_load_dwordx4 v[64:67], v4, s[32:35], s17 offen sc1
    buffer_load_dwordx4 v[68:71], v8, s[32:35], s17 offen sc1
    s_mov_b32 s17, 1597440
    buffer_load_dwordx4 v[72:75], v4, s[32:35], s17 offen sc1
    buffer_load_dwordx4 v[76:79], v8, s[32:35], s17 offen sc1
    s_mov_b32 s17, 1464320
    buffer_load_dwordx4 v[80:83], v4, s[32:35], s17 offen sc1
    buffer_load_dwordx4 v[84:87], v8, s[32:35], s17 offen sc1
    s_mov_b32 s17, 1331200
    buffer_load_dwordx4 v[88:91], v4, s[32:35], s17 offen sc1
    buffer_load_dwordx4 v[92:95], v8, s[32:35], s17 offen sc1
    s_mov_b32 s17, 1198080
    buffer_load_dwordx4 v[96:99], v4, s[32:35], s17 offen sc1
    s_waitcnt vmcnt(12)
    v_min_f32_e64 v9, |v48|, |v52|
    v_cmp_gt_f32 vcc, 0x24800000, v9
    s_nop 3
    s_cbranch_vccnz m1_x4_again
m1_x4_out:
    s_branch m1_x4_ok
m1_x5_again:
    s_nop 7
    s_add_u32 s99, s99, 1
    s_cmp_ge_u32 s99, 16384
    s_cbranch_scc1 m1_x5_out
    s_waitcnt vmcnt(50)
    s_mov_b32 s17, 1863680
    buffer_load_dwordx4 v[56:59], v4, s[32:35], s17 offen sc1
    buffer_load_dwordx4 v[60:63], v8, s[32:35], s17 offen sc1
    s_mov_b32 s17, 1730560
    buffer_load_dwordx4 v[64:67], v4, s[32:35], s17 offen sc1
    buffer_load_dwordx4 v[68:71], v8, s[32:35], s17 offen sc1
    s_mov_b32 s17, 1597440
    buffer_load_dwordx4 v[72:75], v4, s[32:35], s17 offen sc1
    buffer_load_dwordx4 v[76:79], v8, s[32:35], s17 offen sc1
    s_mov_b32 s17, 1464320
    buffer_load_dwordx4 v[80:83], v4, s[32:35], s17 offen sc1
    buffer_load_dwordx4 v[84:87], v8, s[32:35], s17 offen sc1
    s_mov_b32 s17, 1331200
    buffer_load_dwordx4 v[88:91], v4, s[32:35], s17 offen sc1
    buffer_load_dwordx4 v[92:95], v8, s[32:35], s17 offen sc1
    s_mov_b32 s17, 1198080
    buffer_load_dwordx4 v[96:99], v4, s[32:35], s17 offen sc1
    buffer_load_dwordx4 v[100:103], v8, s[32:35], s17 offen sc1
    s_waitcnt vmcnt(10)
    v_min_f32_e64 v9, |v56|, |v60|
    v_cmp_gt_f32 vcc, 0x24800000, v9
    s_nop 3
    s_cbranch_vccnz m1_x5_again
m1_x5_out:
    s_branch m1_x5_ok
m1_x6_again:
    s_nop 7
    s_add_u32 s99, s99, 1
    s_cmp_ge_u32 s99, 16384
    s_cbranch_scc1 m1_x6_out
    s_waitcnt vmcnt(48)
    s_mov_b32 s17, 1730560
    buffer_load_dwordx4 v[64:67], v4, s[32:35], s17 offen sc1
    buffer_load_dwordx4 v[68:71], v8, s[32:35], s17 offen sc1
    s_mov_b32 s17, 1597440
    buffer_load_dwordx4 v[72:75], v4, s[32:35], s17 offen sc1
    buffer_load_dwordx4 v[76:79], v8, s[32:35], s17 offen sc1
    s_mov_b32 s17, 1464320
    buffer_load_dwordx4 v[80:83], v4, s[32:35], s17 offen sc1
    buffer_load_dwordx4 v[84:87], v8, s[32:35], s17 offen sc1
    s_mov_b32 s17, 1331200
    buffer_load_dwordx4 v[88:91], v4, s[32:35], s17 offen sc1
    buffer_load_dwordx4 v[92:95], v8, s[32:35], s17 offen sc1
    s_mov_b32 s17, 1198080
    buffer_load_dwordx4 v[96:99], v4, s[32:35], s17 offen sc1
    buffer_load_dwordx4 v[100:103], v8, s[32:35], s17 offen sc1
    s_mov_b32 s17, 1064960
    buffer_load_dwordx4 v[104:107], v4, s[32:35], s17 offen sc1
    buffer_load_dwordx4 v[108:111], v8, s[32:35], s17 offen sc1
    s_mov_b32 s17, 931840
    buffer_load_dwordx4 v[112:115], v4, s[32:35], s17 offen sc1
    buffer_load_dwordx4 v[116:119], v8, s[32:35], s17 offen sc1
    s_waitcnt vmcnt(12)
    v_min_f32_e64 v9, |v64|, |v68|
    v_cmp_gt_f32 vcc, 0x24800000, v9
    s_nop 3
    s_cbranch_vccnz m1_x6_again
m1_x6_out:
    s_branch m1_x6_ok
m1_x7_again:
    s_nop 7
    s_add_u32 s99, s99, 1
    s_cmp_ge_u32 s99, 16384
    s_cbranch_scc1 m1_x7_out
    s_waitcnt vmcnt(48)
    s_mov_b32 s17, 1597440
    buffer_load_dwordx4 v[72:75], v4, s[32:35], s17 offen sc1
    buffer_load_dwordx4 v[76:79], v8, s[32:35], s17 offen sc1
    s_mov_b32 s17, 1464320
    buffer_load_dwordx4 v[80:83], v4, s[32:35], s17 offen sc1
    buffer_load_dwordx4 v[84:87], v8, s[32:35], s17 offen sc1
    s_mov_b32 s17, 1331200
    buffer_load_dwordx4 v[88:91], v4, s[32:35], s17 offen sc1
    buffer_load_dwordx4 v[92:95], v8, s[32:35], s17 offen sc1
    s_mov_b32 s17, 1198080
    buffer_load_dwordx4 v[96:99], v4, s[32:35], s17 offen sc1
    buffer_load_dwordx4 v[100:103], v8, s[32:35], s17 offen sc1
    s_mov_b32 s17, 1064960
    buffer_load_dwordx4 v[104:107], v4, s[32:35], s17 offen sc1
    buffer_load_dwordx4 v[108:111], v8, s[32:35], s17 offen sc1
    s_mov_b32 s17, 931840
    buffer_load_dwordx4 v[112:115], v4, s[32:35], s17 offen sc1
    buffer_load_dwordx4 v[116:119], v8, s[32:35], s17 offen sc1
    s_mov_b32 s17, 0
    buffer_load_dwordx4 v[168:171], v4, s[32:35], s17 offen sc1
    buffer_load_dwordx4 v[172:175], v8, s[32:35], s17 offen sc1
    s_waitcnt vmcnt(12)
    v_min_f32_e64 v9, |v72|, |v76|
    v_cmp_gt_f32 vcc, 0x24800000, v9
    s_nop 3
    s_cbranch_vccnz m1_x7_again
m1_x7_out:
    s_branch m1_x7_ok
m1_x8_again:
    s_nop 7
    s_add_u32 s99, s99, 1
    s_cmp_ge_u32 s99, 16384
    s_cbranch_scc1 m1_x8_out
    s_waitcnt vmcnt(48)
    s_mov_b32 s17, 1464320
    buffer_load_dwordx4 v[80:83], v4, s[32:35], s17 offen sc1
    buffer_load_dwordx4 v[84:87], v8, s[32:35], s17 offen sc1
    s_mov_b32 s17, 1331200
    buffer_load_dwordx4 v[88:91], v4, s[32:35], s17 offen sc1
    buffer_load_dwordx4 v[92:95], v8, s[32:35], s17 offen sc1
    s_mov_b32 s17, 1198080
    buffer_load_dwordx4 v[96:99], v4, s[32:35], s17 offen sc1
    buffer_load_dwordx4 v[100:103], v8, s[32:35], s17 offen sc1
    s_mov_b32 s17, 1064960
    buffer_load_dwordx4 v[104:107], v4, s[32:35], s17 offen sc1
    buffer_load_dwordx4 v[108:111], v8, s[32:35], s17 offen sc1
    s_mov_b32 s17, 931840
    buffer_load_dwordx4 v[112:115], v4, s[32:35], s17 offen sc1
    buffer_load_dwordx4 v[116:119], v8, s[32:35], s17 offen sc1
    s_mov_b32 s17, 0
    buffer_load_dwordx4 v[168:171], v4, s[32:35], s17 offen sc1
    buffer_load_dwordx4 v[172:175], v8, s[32:35], s17 offen sc1
    s_mov_b32 s17, 798720
    buffer_load_dwordx4 v[120:123], v4, s[32:35], s17 offen sc1
    buffer_load_dwordx4 v[124:127], v8, s[32:35], s17 offen sc1
    s_waitcnt vmcnt(12)
    v_min_f32_e64 v9, |v80|, |v84|
    v_cmp_gt_f32 vcc, 0x24800000, v9
    s_nop 3
    s_cbranch_vccnz m1_x8_again
m1_x8_out:
    s_branch m1_x8_ok
m1_x9_again:
    s_nop 7
    s_add_u32 s99, s99, 1
    s_cmp_ge_u32 s99, 16384
    s_cbranch_scc1 m1_x9_out
    s_waitcnt vmcnt(48)
    s_mov_b32 s17, 1331200
    buffer_load_dwordx4 v[88:91], v4, s[32:35], s17 offen sc1
    buffer_load_dwordx4 v[92:95], v8, s[32:35], s17 offen sc1
    s_mov_b32 s17, 1198080
    buffer_load_dwordx4 v[96:99], v4, s[32:35], s17 offen sc1
    buffer_load_dwordx4 v[100:103], v8, s[32:35], s17 offen sc1
    s_mov_b32 s17, 1064960
    buffer_load_dwordx4 v[104:107], v4, s[32:35], s17 offen sc1
    buffer_load_dwordx4 v[108:111], v8, s[32:35], s17 offen sc1
    s_mov_b32 s17, 931840
    buffer_load_dwordx4 v[112:115], v4, s[32:35], s17 offen sc1
    buffer_load_dwordx4 v[116:119], v8, s[32:35], s17 offen sc1
    s_mov_b32 s17, 0
    buffer_load_dwordx4 v[168:171], v4, s[32:35], s17 offen sc1
    buffer_load_dwordx4 v[172:175], v8, s[32:35], s17 offen sc1
    s_mov_b32 s17, 798720
    buffer_load_dwordx4 v[120:123], v4, s[32:35], s17 offen sc1
    buffer_load_dwordx4 v[124:127], v8, s[32:35], s17 offen sc1
    s_mov_b32 s17, 665600
    buffer_load_dwordx4 v[128:131], v4, s[32:35], s17 offen sc1
    buffer_load_dwordx4 v[132:135], v8, s[32:35], s17 offen sc1
    s_waitcnt vmcnt(12)
    v_min_f32_e64 v9, |v88|, |v92|
    v_cmp_gt_f32 vcc, 0x24800000, v9
    s_nop 3
    s_cbranch_vccnz m1_x9_again
m1_x9_out:
    s_branch m1_x9_ok
m1_x10_again:
    s_nop 7
    s_add_u32 s99, s99, 1
    s_cmp_ge_u32 s99, 16384
    s_cbranch_scc1 m1_x10_out
    s_waitcnt vmcnt(48)
    s_mov_b32 s17, 1198080
    buffer_load_dwordx4 v[96:99], v4, s[32:35], s17 offen sc1
    buffer_load_dwordx4 v[100:103], v8, s[32:35], s17 offen sc1
    s_mov_b32 s17, 1064960
    buffer_load_dwordx4 v[104:107], v4, s[32:35], s17 offen sc1
    buffer_load_dwordx4 v[108:111], v8, s[32:35], s17 offen sc1
    s_mov_b32 s17, 931840
    buffer_load_dwordx4 v[112:115], v4, s[32:35], s17 offen sc1
    buffer_load_dwordx4 v[116:119], v8, s[32:35], s17 offen sc1
    s_mov_b32 s17, 0
    buffer_load_dwordx4 v[168:171], v4, s[32:35], s17 offen sc1
    buffer_load_dwordx4 v[172:175], v8, s[32:35], s17 offen sc1
    s_mov_b32 s17, 798720
    buffer_load_dwordx4 v[120:123], v4, s[32:35], s17 offen sc1
    buffer_load_dwordx4 v[124:127], v8, s[32:35], s17 offen sc1
    s_mov_b32 s17, 665600
    buffer_load_dwordx4 v[128:131], v4, s[32:35], s17 offen sc1
    buffer_load_dwordx4 v[132:135], v8, s[32:35], s17 offen sc1
    s_mov_b32 s17, 532480
    buffer_load_dwordx4 v[136:139], v4, s[32:35], s17 offen sc1
    buffer_load_dwordx4 v[140:143], v8, s[32:35], s17 offen sc1
    s_waitcnt vmcnt(12)
    v_min_f32_e64 v9, |v96|, |v100|
    v_cmp_gt_f32 vcc, 0x24800000, v9
    s_nop 3
    s_cbranch_vccnz m1_x10_again
m1_x10_out:
    s_branch m1_x10_ok
m1_x11_again:
    s_nop 7
    s_add_u32 s99, s99, 1
    s_cmp_ge_u32 s99, 16384
    s_cbranch_scc1 m1_x11_out
    s_waitcnt vmcnt(48)
    s_mov_b32 s17, 1064960
    buffer_load_dwordx4 v[104:107], v4, s[32:35], s17 offen sc1
    buffer_load_dwordx4 v[108:111], v8, s[32:35], s17 offen sc1
    s_mov_b32 s17, 931840
    buffer_load_dwordx4 v[112:115], v4, s[32:35], s17 offen sc1
    buffer_load_dwordx4 v[116:119], v8, s[32:35], s17 offen sc1
    s_mov_b32 s17, 0
    buffer_load_dwordx4 v[168:171], v4, s[32:35], s17 offen sc1
    buffer_load_dwordx4 v[172:175], v8, s[32:35], s17 offen sc1
    s_mov_b32 s17, 798720
    buffer_load_dwordx4 v[120:123], v4, s[32:35], s17 offen sc1
    buffer_load_dwordx4 v[124:127], v8, s[32:35], s17 offen sc1
    s_mov_b32 s17, 665600
    buffer_load_dwordx4 v[128:131], v4, s[32:35], s17 offen sc1
    buffer_load_dwordx4 v[132:135], v8, s[32:35], s17 offen sc1
    s_mov_b32 s17, 532480
    buffer_load_dwordx4 v[136:139], v4, s[32:35], s17 offen sc1
    buffer_load_dwordx4 v[140:143], v8, s[32:35], s17 offen sc1
    s_mov_b32 s17, 399360
    buffer_load_dwordx4 v[144:147], v4, s[32:35], s17 offen sc1
    buffer_load_dwordx4 v[148:151], v8, s[32:35], s17 offen sc1
    s_waitcnt vmcnt(12)
    v_min_f32_e64 v9, |v104|, |v108|
    v_cmp_gt_f32 vcc, 0x24800000, v9
    s_nop 3
    s_cbranch_vccnz m1_x11_again
m1_x11_out:
    s_branch m1_x11_ok
m1_x12_again:
    s_nop 7
    s_add_u32 s99, s99, 1
    s_cmp_ge_u32 s99, 16384
    s_cbranch_scc1 m1_x12_out
    s_waitcnt vmcnt(48)
    s_mov_b32 s17, 931840
    buffer_load_dwordx4 v[112:115], v4, s[32:35], s17 offen sc1
    buffer_load_dwordx4 v[116:119], v8, s[32:35], s17 offen sc1
    s_mov_b32 s17, 0
    buffer_load_dwordx4 v[168:171], v4, s[32:35], s17 offen sc1
    buffer_load_dwordx4 v[172:175], v8, s[32:35], s17 offen sc1
    s_mov_b32 s17, 798720
    buffer_load_dwordx4 v[120:123], v4, s[32:35], s17 offen sc1
    buffer_load_dwordx4 v[124:127], v8, s[32:35], s17 offen sc1
    s_mov_b32 s17, 665600
    buffer_load_dwordx4 v[128:131], v4, s[32:35], s17 offen sc1
    buffer_load_dwordx4 v[132:135], v8, s[32:35], s17 offen sc1
    s_mov_b32 s17, 532480
    buffer_load_dwordx4 v[136:139], v4, s[32:35], s17 offen sc1
    buffer_load_dwordx4 v[140:143], v8, s[32:35], s17 offen sc1
    s_mov_b32 s17, 399360
    buffer_load_dwordx4 v[144:147], v4, s[32:35], s17 offen sc1
    buffer_load_dwordx4 v[148:151], v8, s[32:35], s17 offen sc1
    s_mov_b32 s17, 266240
    buffer_load_dwordx4 v[152:155], v4, s[32:35], s17 offen sc1
    buffer_load_dwordx4 v[156:159], v8, s[32:35], s17 offen sc1
    s_waitcnt vmcnt(12)
    v_min_f32_e64 v9, |v112|, |v116|
    v_cmp_gt_f32 vcc, 0x24800000, v9
    s_nop 3
    s_cbranch_vccnz m1_x12_again
m1_x12_out:
    s_branch m1_x12_ok
m1_x13_again:
    s_nop 7
    s_add_u32 s99, s99, 1
    s_cmp_ge_u32 s99, 16384
    s_cbranch_scc1 m1_x13_out
    s_waitcnt vmcnt(48)
    s_mov_b32 s17, 0
    buffer_load_dwordx4 v[168:171], v4, s[32:35], s17 offen sc1
    buffer_load_dwordx4 v[172:175], v8, s[32:35], s17 offen sc1
    s_mov_b32 s17, 798720
    buffer_load_dwordx4 v[120:123], v4, s[32:35], s17 offen sc1
    buffer_load_dwordx4 v[124:127], v8, s[32:35], s17 offen sc1
    s_mov_b32 s17, 665600
    buffer_load_dwordx4 v[128:131], v4, s[32:35], s17 offen sc1
    buffer_load_dwordx4 v[132:135], v8, s[32:35], s17 offen sc1
    s_mov_b32 s17, 532480
    buffer_load_dwordx4 v[136:139], v4, s[32:35], s17 offen sc1
    buffer_load_dwordx4 v[140:143], v8, s[32:35], s17 offen sc1
    s_mov_b32 s17, 399360
    buffer_load_dwordx4 v[144:147], v4, s[32:35], s17 offen sc1
    buffer_load_dwordx4 v[148:151], v8, s[32:35], s17 offen sc1
    s_mov_b32 s17, 266240
    buffer_load_dwordx4 v[152:155], v4, s[32:35], s17 offen sc1
    buffer_load_dwordx4 v[156:159], v8, s[32:35], s17 offen sc1
    s_mov_b32 s17, 133120
    buffer_load_dwordx4 v[160:163], v4, s[32:35], s17 offen sc1
    buffer_load_dwordx4 v[164:167], v8, s[32:35], s17 offen sc1
    s_waitcnt vmcnt(10)
    v_min3_f32 v9, |v168|, |v172|, |v120|
    v_min_f32_e64 v9, v9, |v124|
    v_cmp_gt_f32 vcc, 0x24800000, v9
    s_nop 3
    s_cbranch_vccnz m1_x13_again
m1_x13_out:
    s_branch m1_x13_ok
m1_x14_again:
    s_nop 7
    s_add_u32 s99, s99, 1
    s_cmp_ge_u32 s99, 16384
    s_cbranch_scc1 m1_x14_out
    s_waitcnt vmcnt(48)
    s_mov_b32 s17, 665600
    buffer_load_dwordx4 v[128:131], v4, s[32:35], s17 offen sc1
    buffer_load_dwordx4 v[132:135], v8, s[32:35], s17 offen sc1
    s_mov_b32 s17, 532480
    buffer_load_dwordx4 v[136:139], v4, s[32:35], s17 offen sc1
    buffer_load_dwordx4 v[140:143], v8, s[32:35], s17 offen sc1
    s_mov_b32 s17, 399360
    buffer_load_dwordx4 v[144:147], v4, s[32:35], s17 offen sc1
    buffer_load_dwordx4 v[148:151], v8, s[32:35], s17 offen sc1
    s_mov_b32 s17, 266240
    buffer_load_dwordx4 v[152:155], v4, s[32:35], s17 offen sc1
    buffer_load_dwordx4 v[156:159], v8, s[32:35], s17 offen sc1
    s_mov_b32 s17, 133120
    buffer_load_dwordx4 v[160:163], v4, s[32:35], s17 offen sc1
    buffer_load_dwordx4 v[164:167], v8, s[32:35], s17 offen sc1
    buffer_load_dword a253, off, s[52:55], 0
    buffer_load_dword a253, off, s[52:55], 0
    buffer_load_dword a253, off, s[52:55], 0
    buffer_load_dword a253, off, s[52:55], 0
    s_waitcnt vmcnt(12)
    v_min_f32_e64 v9, |v128|, |v132|
    v_cmp_gt_f32 vcc, 0x24800000, v9
    s_nop 3
    s_cbranch_vccnz m1_x14_again
m1_x14_out:
    s_branch m1_x14_ok
m1_x15_again:
    s_nop 7
    s_add_u32 s99, s99, 1
    s_cmp_ge_u32 s99, 16384
    s_cbranch_scc1 m1_x15_out
    s_waitcnt vmcnt(49)
    s_mov_b32 s17, 532480
    buffer_load_dwordx4 v[136:139], v4, s[32:35], s17 offen sc1
    buffer_load_dwordx4 v[140:143], v8, s[32:35], s17 offen sc1
    s_mov_b32 s17, 399360
    buffer_load_dwordx4 v[144:147], v4, s[32:35], s17 offen sc1
    buffer_load_dwordx4 v[148:151], v8, s[32:35], s17 offen sc1
    s_mov_b32 s17, 266240
    buffer_load_dwordx4 v[152:155], v4, s[32:35], s17 offen sc1
    buffer_load_dwordx4 v[156:159], v8, s[32:35], s17 offen sc1
    s_mov_b32 s17, 133120
    buffer_load_dwordx4 v[160:163], v4, s[32:35], s17 offen sc1
    buffer_load_dwordx4 v[164:167], v8, s[32:35], s17 offen sc1
    buffer_load_dword a253, off, s[52:55], 0
    buffer_load_dword a253, off, s[52:55], 0
    buffer_load_dword a253, off, s[52:55], 0
    buffer_load_dword a253, off, s[52:55], 0
    buffer_load_dword a253, off, s[52:55], 0
    s_waitcnt vmcnt(11)
    v_min_f32_e64 v9, |v136|, |v140|
    v_cmp_gt_f32 vcc, 0x24800000, v9
    s_nop 3
    s_cbranch_vccnz m1_x15_again
m1_x15_out:
    s_branch m1_x15_ok
m1_x16_again:
    s_nop 7
    s_add_u32 s99, s99, 1
    s_cmp_ge_u32 s99, 16384
    s_cbranch_scc1 m1_x16_out
    s_waitcnt vmcnt(51)
    s_mov_b32 s17, 399360
    buffer_load_dwordx4 v[144:147], v4, s[32:35], s17 offen sc1
    buffer_load_dwordx4 v[148:151], v8, s[32:35], s17 offen sc1
    s_mov_b32 s17, 266240
    buffer_load_dwordx4 v[152:155], v4, s[32:35], s17 offen sc1
    buffer_load_dwordx4 v[156:159], v8, s[32:35], s17 offen sc1
    s_mov_b32 s17, 133120
    buffer_load_dwordx4 v[160:163], v4, s[32:35], s17 offen sc1
    buffer_load_dwordx4 v[164:167], v8, s[32:35], s17 offen sc1
    buffer_load_dword a253, off, s[52:55], 0
    buffer_load_dword a253, off, s[52:55], 0
    buffer_load_dword a253, off, s[52:55], 0
    buffer_load_dword a253, off, s[52:55], 0
    buffer_load_dword a253, off, s[52:55], 0
    s_waitcnt vmcnt(7)
    v_min3_f32 v9, |v144|, |v148|, |v152|
    v_min_f32_e64 v9, v9, |v156|
    v_cmp_gt_f32 vcc, 0x24800000, v9
    s_nop 3
    s_cbranch_vccnz m1_x16_again
m1_x16_out:
    s_branch m1_x16_ok
m1_x18_again:
    s_nop 7
    s_add_u32 s99, s99, 1
    s_cmp_ge_u32 s99, 16384
    s_cbranch_scc1 m1_x18_out
    s_waitcnt vmcnt(55)
    s_mov_b32 s17, 133120
    buffer_load_dwordx4 v[160:163], v4, s[32:35], s17 offen sc1
    buffer_load_dwordx4 v[164:167], v8, s[32:35], s17 offen sc1
    buffer_load_dword a253, off, s[52:55], 0
    buffer_load_dword a253, off, s[52:55], 0
    buffer_load_dword a253, off, s[52:55], 0
    buffer_load_dword a253, off, s[52:55], 0
    buffer_load_dword a253, off, s[52:55], 0
    s_waitcnt vmcnt(5)
    v_min_f32_e64 v9, |v160|, |v164|
    v_cmp_gt_f32 vcc, 0x24800000, v9
    s_nop 3
    s_cbranch_vccnz m1_x18_again
m1_x18_out:
    s_branch m1_x18_ok
m1_ready_spin:
    s_mov_b32 s17, 131072
    buffer_load_dword v249, v14, s[12:15], s17 offen sc1
    s_waitcnt vmcnt(0)
    s_add_u32 s99, s99, 1
    s_cmp_ge_u32 s99, 16384
    s_cbranch_scc1 m1_ready_ok
    v_cmp_eq_u32 vcc, 0, v249
    s_nop 3
    s_cbranch_vccnz m1_ready_spin
    s_branch m1_ready_ok
m1_q0_again:
    s_nop 7
    s_add_u32 s99, s99, 1
    s_cmp_ge_u32 s99, 16384
    s_cbranch_scc1 m1_q0_out
    s_waitcnt vmcnt(44)
    s_mov_b32 s17, 0
    buffer_load_dwordx4 v[16:19], v13, s[8:11], s17 offen sc1
    buffer_load_dwordx4 v[20:23], v4, s[8:11], s17 offen sc1
    buffer_load_dwordx4 v[24:27], v8, s[8:11], s17 offen sc1
    buffer_load_dwordx4 v[28:31], v10, s[8:11], s17 offen sc1
    s_mov_b32 s17, 946176
    buffer_load_dwordx4 v[32:35], v13, s[8:11], s17 offen sc1
    buffer_load_dword a253, off, s[52:55], 0
    buffer_load_dwordx4 v[36:39], v4, s[8:11], s17 offen sc1
    buffer_load_dwordx4 v[40:43], v8, s[8:11], s17 offen sc1
    buffer_load_dwordx4 v[44:47], v10, s[8:11], s17 offen sc1
    s_mov_b32 s17, 67584
    buffer_load_dwordx4 v[48:51], v13, s[8:11], s17 offen sc1
    buffer_load_dwordx4 v[52:55], v4, s[8:11], s17 offen sc1
    buffer_load_dwordx4 v[56:59], v8, s[8:11], s17 offen sc1
    buffer_load_dwordx4 v[60:63], v10, s[8:11], s17 offen sc1
    s_mov_b32 s17, 1013760
    buffer_load_dwordx4 v[64:67], v13, s[8:11], s17 offen sc1
    buffer_load_dwordx4 v[68:71], v4, s[8:11], s17 offen sc1
    buffer_load_dwordx4 v[72:75], v8, s[8:11], s17 offen sc1
    buffer_load_dwordx4 v[76:79], v10, s[8:11], s17 offen sc1
    buffer_load_dword a253, off, s[52:55], 0
    s_waitcnt vmcnt(16)
    v_cmp_u_f32 vcc, v16, v20
    s_nop 3
    s_cbranch_vccnz m1_q0_again
m1_q0_out:
    s_branch m1_q0_ok
m1_q1_again:
    s_nop 7
    s_add_u32 s99, s99, 1
    s_cmp_ge_u32 s99, 16384
    s_cbranch_scc1 m1_q1_out
    s_waitcnt vmcnt(46)
    s_mov_b32 s17, 0
    buffer_load_dwordx4 v[24:27], v8, s[8:11], s17 offen sc1
    buffer_load_dwordx4 v[28:31], v10, s[8:11], s17 offen sc1
    s_mov_b32 s17, 946176
    buffer_load_dwordx4 v[32:35], v13, s[8:11], s17 offen sc1
    buffer_load_dword a253, off, s[52:55], 0
    buffer_load_dwordx4 v[36:39], v4, s[8:11], s17 offen sc1
    buffer_load_dwordx4 v[40:43], v8, s[8:11], s17 offen sc1
    buffer_load_dwordx4 v[44:47], v10, s[8:11], s17 offen sc1
    s_mov_b32 s17, 67584
    buffer_load_dwordx4 v[48:51], v13, s[8:11], s17 offen sc1
    buffer_load_dwordx4 v[52:55], v4, s[8:11], s17 offen sc1
    buffer_load_dwordx4 v[56:59], v8, s[8:11], s17 offen sc1
    buffer_load_dwordx4 v[60:63], v10, s[8:11], s17 offen sc1
    s_mov_b32 s17, 1013760
    buffer_load_dwordx4 v[64:67], v13, s[8:11], s17 offen sc1
    buffer_load_dwordx4 v[68:71], v4, s[8:11], s17 offen sc1
    buffer_load_dwordx4 v[72:75], v8, s[8:11], s17 offen sc1
    buffer_load_dwordx4 v[76:79], v10, s[8:11], s17 offen sc1
    buffer_load_dword a253, off, s[52:55], 0
    s_waitcnt vmcnt(14)
    v_cmp_u_f32 vcc, v24, v28
    s_nop 3
    s_cbranch_vccnz m1_q1_again
m1_q1_out:
    s_branch m1_q1_ok
m1_q2_again:
    s_nop 7
    s_add_u32 s99, s99, 1
    s_cmp_ge_u32 s99, 16384
    s_cbranch_scc1 m1_q2_out
    s_waitcnt vmcnt(45)
    s_mov_b32 s17, 946176
    buffer_load_dwordx4 v[32:35], v13, s[8:11], s17 offen sc1
    buffer_load_dword a253, off, s[52:55], 0
    buffer_load_dwordx4 v[36:39], v4, s[8:11], s17 offen sc1
    buffer_load_dwordx4 v[40:43], v8, s[8:11], s17 offen sc1
    buffer_load_dwordx4 v[44:47], v10, s[8:11], s17 offen sc1
    s_mov_b32 s17, 67584
    buffer_load_dwordx4 v[48:51], v13, s[8:11], s17 offen sc1
    buffer_load_dwordx4 v[52:55], v4, s[8:11], s17 offen sc1
    buffer_load_dwordx4 v[56:59], v8, s[8:11], s17 offen sc1
    buffer_load_dwordx4 v[60:63], v10, s[8:11], s17 offen sc1
    s_mov_b32 s17, 1013760
    buffer_load_dwordx4 v[64:67], v13, s[8:11], s17 offen sc1
    buffer_load_dwordx4 v[68:71], v4, s[8:11], s17 offen sc1
    buffer_load_dwordx4 v[72:75], v8, s[8:11], s17 offen sc1
    buffer_load_dwordx4 v[76:79], v10, s[8:11], s17 offen sc1
    buffer_load_dword a253, off, s[52:55], 0
    s_mov_b32 s17, 135168
    buffer_load_dwordx4 v[80:83], v13, s[8:11], s17 offen sc1
    buffer_load_dwordx4 v[84:87], v4, s[8:11], s17 offen sc1
    buffer_load_dwordx4 v[88:91], v8, s[8:11], s17 offen sc1
    s_waitcnt vmcnt(12)
    v_max3_u32 v9, v32, v36, v40
    v_cmp_u_f32 vcc, v9, v44
    s_nop 3
    s_cbranch_vccnz m1_q2_again
m1_q2_out:
    s_branch m1_q2_ok
m1_q3_again:
    s_nop 7
    s_add_u32 s99, s99, 1
    s_cmp_ge_u32 s99, 16384
    s_cbranch_scc1 m1_q3_out
    s_waitcnt vmcnt(44)
    s_mov_b32 s17, 67584
    buffer_load_dwordx4 v[48:51], v13, s[8:11], s17 offen sc1
    buffer_load_dwordx4 v[52:55], v4, s[8:11], s17 offen sc1
    buffer_load_dwordx4 v[56:59], v8, s[8:11], s17 offen sc1
    buffer_load_dwordx4 v[60:63], v10, s[8:11], s17 offen sc1
    s_mov_b32 s17, 1013760
    buffer_load_dwordx4 v[64:67], v13, s[8:11], s17 offen sc1
    buffer_load_dwordx4 v[68:71], v4, s[8:11], s17 offen sc1
    buffer_load_dwordx4 v[72:75], v8, s[8:11], s17 offen sc1
    buffer_load_dwordx4 v[76:79], v10, s[8:11], s17 offen sc1
    buffer_load_dword a253, off, s[52:55], 0
    s_mov_b32 s17, 135168
    buffer_load_dwordx4 v[80:83], v13, s[8:11], s17 offen sc1
    buffer_load_dwordx4 v[84:87], v4, s[8:11], s17 offen sc1
    buffer_load_dwordx4 v[88:91], v8, s[8:11], s17 offen sc1
    buffer_load_dwordx4 v[92:95], v10, s[8:11], s17 offen sc1
    s_mov_b32 s17, 1081344
    buffer_load_dwordx4 v[176:179], v13, s[8:11], s17 offen sc1
    buffer_load_dwordx4 v[180:183], v4, s[8:11], s17 offen sc1
    buffer_load_dwordx4 v[184:187], v8, s[8:11], s17 offen sc1
    buffer_load_dword a253, off, s[52:55], 0
    buffer_load_dwordx4 v[188:191], v10, s[8:11], s17 offen sc1
    s_waitcnt vmcnt(14)
    v_max3_u32 v9, v48, v52, v56
    v_cmp_u_f32 vcc, v9, v60
    s_nop 3
    s_cbranch_vccnz m1_q3_again
m1_q3_out:
    s_branch m1_q3_ok
m1_q4_again:
    s_nop 7
    s_add_u32 s99, s99, 1
    s_cmp_ge_u32 s99, 16384
    s_cbranch_scc1 m1_q4_out
    s_waitcnt vmcnt(44)
    s_mov_b32 s17, 1013760
    buffer_load_dwordx4 v[64:67], v13, s[8:11], s17 offen sc1
    buffer_load_dwordx4 v[68:71], v4, s[8:11], s17 offen sc1
    buffer_load_dwordx4 v[72:75], v8, s[8:11], s17 offen sc1
    buffer_load_dwordx4 v[76:79], v10, s[8:11], s17 offen sc1
    buffer_load_dword a253, off, s[52:55], 0
    s_mov_b32 s17, 135168
    buffer_load_dwordx4 v[80:83], v13, s[8:11], s17 offen sc1
    buffer_load_dwordx4 v[84:87], v4, s[8:11], s17 offen sc1
    buffer_load_dwordx4 v[88:91], v8, s[8:11], s17 offen sc1
    buffer_load_dwordx4 v[92:95], v10, s[8:11], s17 offen sc1
    s_mov_b32 s17, 1081344
    buffer_load_dwordx4 v[176:179], v13, s[8:11], s17 offen sc1
    buffer_load_dwordx4 v[180:183], v4, s[8:11], s17 offen sc1
    buffer_load_dwordx4 v[184:187], v8, s[8:11], s17 offen sc1
    buffer_load_dword a253, off, s[52:55], 0
    buffer_load_dwordx4 v[188:191], v10, s[8:11], s17 offen sc1
    s_mov_b32 s17, 202752
    buffer_load_dwordx4 v[16:19], v13, s[8:11], s17 offen sc1
    buffer_load_dwordx4 v[20:23], v4, s[8:11], s17 offen sc1
    buffer_load_dwordx4 v[24:27], v8, s[8:11], s17 offen sc1
    buffer_load_dword a253, off, s[52:55], 0
    s_waitcnt vmcnt(14)
    v_max3_u32 v9, v64, v68, v72
    v_cmp_u_f32 vcc, v9, v76
    s_nop 3
    s_cbranch_vccnz m1_q4_again
m1_q4_out:
    s_branch m1_q4_ok
m1_q5_again:
    s_nop 7
    s_add_u32 s99, s99, 1
    s_cmp_ge_u32 s99, 16384
    s_cbranch_scc1 m1_q5_out
    s_waitcnt vmcnt(44)
    s_mov_b32 s17, 135168
    buffer_load_dwordx4 v[80:83], v13, s[8:11], s17 offen sc1
    buffer_load_dwordx4 v[84:87], v4, s[8:11], s17 offen sc1
    buffer_load_dwordx4 v[88:91], v8, s[8:11], s17 offen sc1
    buffer_load_dwordx4 v[92:95], v10, s[8:11], s17 offen sc1
    s_mov_b32 s17, 1081344
    buffer_load_dwordx4 v[176:179], v13, s[8:11], s17 offen sc1
    buffer_load_dwordx4 v[180:183], v4, s[8:11], s17 offen sc1
    buffer_load_dwordx4 v[184:187], v8, s[8:11], s17 offen sc1
    buffer_load_dword a253, off, s[52:55], 0
    buffer_load_dwordx4 v[188:191], v10, s[8:11], s17 offen sc1
    s_mov_b32 s17, 202752
    buffer_load_dwordx4 v[16:19], v13, s[8:11], s17 offen sc1
    buffer_load_dwordx4 v[20:23], v4, s[8:11], s17 offen sc1
    buffer_load_dwordx4 v[24:27], v8, s[8:11], s17 offen sc1
    buffer_load_dword a253, off, s[52:55], 0
    buffer_load_dwordx4 v[28:31], v10, s[8:11], s17 offen sc1
    s_mov_b32 s17, 1148928
    buffer_load_dwordx4 v[32:35], v13, s[8:11], s17 offen sc1
    buffer_load_dwordx4 v[36:39], v4, s[8:11], s17 offen sc1
    buffer_load_dwordx4 v[40:43], v8, s[8:11], s17 offen sc1
    buffer_load_dwordx4 v[44:47], v10, s[8:11], s17 offen sc1
    s_waitcnt vmcnt(14)
    v_max3_u32 v9, v80, v84, v88
    v_cmp_u_f32 vcc, v9, v92
    s_nop 3
    s_cbranch_vccnz m1_q5_again
m1_q5_out:
    s_branch m1_q5_ok
m1_q6_again:
    s_nop 7
    s_add_u32 s99, s99, 1
    s_cmp_ge_u32 s99, 16384
    s_cbranch_scc1 m1_q6_out
    s_waitcnt vmcnt(43)
    s_mov_b32 s17, 1081344
    buffer_load_dwordx4 v[176:179], v13, s[8:11], s17 offen sc1
    buffer_load_dwordx4 v[180:183], v4, s[8:11], s17 offen sc1
    buffer_load_dwordx4 v[184:187], v8, s[8:11], s17 offen sc1
    buffer_load_dword a253, off, s[52:55], 0
    buffer_load_dwordx4 v[188:191], v10, s[8:11], s17 offen sc1
    s_mov_b32 s17, 202752
    buffer_load_dwordx4 v[16:19], v13, s[8:11], s17 offen sc1
    buffer_load_dwordx4 v[20:23], v4, s[8:11], s17 offen sc1
    buffer_load_dwordx4 v[24:27], v8, s[8:11], s17 offen sc1
    buffer_load_dword a253, off, s[52:55], 0
    buffer_load_dwordx4 v[28:31], v10, s[8:11], s17 offen sc1
    s_mov_b32 s17, 1148928
    buffer_load_dwordx4 v[32:35], v13, s[8:11], s17 offen sc1
    buffer_load_dwordx4 v[36:39], v4, s[8:11], s17 offen sc1
    buffer_load_dwordx4 v[40:43], v8, s[8:11], s17 offen sc1
    buffer_load_dwordx4 v[44:47], v10, s[8:11], s17 offen sc1
    s_mov_b32 s17, 270336
    buffer_load_dwordx4 v[48:51], v13, s[8:11], s17 offen sc1
    buffer_load_dwordx4 v[52:55], v4, s[8:11], s17 offen sc1
    buffer_load_dwordx4 v[56:59], v8, s[8:11], s17 offen sc1
    buffer_load_dwordx4 v[60:63], v10, s[8:11], s17 offen sc1
    s_mov_b32 s17, 1216512
    buffer_load_dwordx4 v[64:67], v13, s[8:11], s17 offen sc1
    s_waitcnt vmcnt(14)
    v_max3_u32 v9, v176, v180, v184
    v_cmp_u_f32 vcc, v9, v188
    s_nop 3
    s_cbranch_vccnz m1_q6_again
m1_q6_out:
    s_branch m1_q6_ok
m1_q7_again:
    s_nop 7
    s_add_u32 s99, s99, 1
    s_cmp_ge_u32 s99, 16384
    s_cbranch_scc1 m1_q7_out
    s_waitcnt vmcnt(45)
    s_mov_b32 s17, 202752
    buffer_load_dwordx4 v[16:19], v13, s[8:11], s17 offen sc1
    buffer_load_dwordx4 v[20:23], v4, s[8:11], s17 offen sc1
    buffer_load_dwordx4 v[24:27], v8, s[8:11], s17 offen sc1
    buffer_load_dword a253, off, s[52:55], 0
    buffer_load_dwordx4 v[28:31], v10, s[8:11], s17 offen sc1
    s_mov_b32 s17, 1148928
    buffer_load_dwordx4 v[32:35], v13, s[8:11], s17 offen sc1
    buffer_load_dwordx4 v[36:39], v4, s[8:11], s17 offen sc1
    buffer_load_dwordx4 v[40:43], v8, s[8:11], s17 offen sc1
    buffer_load_dwordx4 v[44:47], v10, s[8:11], s17 offen sc1
    s_mov_b32 s17, 270336
    buffer_load_dwordx4 v[48:51], v13, s[8:11], s17 offen sc1
    buffer_load_dwordx4 v[52:55], v4, s[8:11], s17 offen sc1
    buffer_load_dwordx4 v[56:59], v8, s[8:11], s17 offen sc1
    buffer_load_dwordx4 v[60:63], v10, s[8:11], s17 offen sc1
    s_mov_b32 s17, 1216512
    buffer_load_dwordx4 v[64:67], v13, s[8:11], s17 offen sc1
    buffer_load_dwordx4 v[68:71], v4, s[8:11], s17 offen sc1
    buffer_load_dword a253, off, s[52:55], 0
    buffer_load_dwordx4 v[72:75], v8, s[8:11], s17 offen sc1
    s_waitcnt vmcnt(12)
    v_max3_u32 v9, v16, v20, v24
    v_cmp_u_f32 vcc, v9, v28
    s_nop 3
    s_cbranch_vccnz m1_q7_again
m1_q7_out:
    s_branch m1_q7_ok
m1_q8_again:
    s_nop 7
    s_add_u32 s99, s99, 1
    s_cmp_ge_u32 s99, 16384
    s_cbranch_scc1 m1_q8_out
    s_waitcnt vmcnt(45)
    s_mov_b32 s17, 1148928
    buffer_load_dwordx4 v[32:35], v13, s[8:11], s17 offen sc1
    buffer_load_dwordx4 v[36:39], v4, s[8:11], s17 offen sc1
    buffer_load_dwordx4 v[40:43], v8, s[8:11], s17 offen sc1
    buffer_load_dwordx4 v[44:47], v10, s[8:11], s17 offen sc1
    s_mov_b32 s17, 270336
    buffer_load_dwordx4 v[48:51], v13, s[8:11], s17 offen sc1
    buffer_load_dwordx4 v[52:55], v4, s[8:11], s17 offen sc1
    buffer_load_dwordx4 v[56:59], v8, s[8:11], s17 offen sc1
    buffer_load_dwordx4 v[60:63], v10, s[8:11], s17 offen sc1
    s_mov_b32 s17, 1216512
    buffer_load_dwordx4 v[64:67], v13, s[8:11], s17 offen sc1
    buffer_load_dwordx4 v[68:71], v4, s[8:11], s17 offen sc1
    buffer_load_dword a253, off, s[52:55], 0
    buffer_load_dwordx4 v[72:75], v8, s[8:11], s17 offen sc1
    buffer_load_dwordx4 v[76:79], v10, s[8:11], s17 offen sc1
    s_mov_b32 s17, 337920
    buffer_load_dwordx4 v[80:83], v13, s[8:11], s17 offen sc1
    buffer_load_dwordx4 v[84:87], v4, s[8:11], s17 offen sc1
    buffer_load_dwordx4 v[88:91], v8, s[8:11], s17 offen sc1
    buffer_load_dwordx4 v[92:95], v10, s[8:11], s17 offen sc1
    s_waitcnt vmcnt(13)
    v_max3_u32 v9, v32, v36, v40
    v_cmp_u_f32 vcc, v9, v44
    s_nop 3
    s_cbranch_vccnz m1_q8_again
m1_q8_out:
    s_branch m1_q8_ok
m1_q9_again:
    s_nop 7
    s_add_u32 s99, s99, 1
    s_cmp_ge_u32 s99, 16384
    s_cbranch_scc1 m1_q9_out
    s_waitcnt vmcnt(44)
    s_mov_b32 s17, 270336
    buffer_load_dwordx4 v[48:51], v13, s[8:11], s17 offen sc1
    buffer_load_dwordx4 v[52:55], v4, s[8:11], s17 offen sc1
    buffer_load_dwordx4 v[56:59], v8, s[8:11], s17 offen sc1
    buffer_load_dwordx4 v[60:63], v10, s[8:11], s17 offen sc1
    s_mov_b32 s17, 1216512
    buffer_load_dwordx4 v[64:67], v13, s[8:11], s17 offen sc1
    buffer_load_dwordx4 v[68:71], v4, s[8:11], s17 offen sc1
    buffer_load_dword a253, off, s[52:55], 0
    buffer_load_dwordx4 v[72:75], v8, s[8:11], s17 offen sc1
    buffer_load_dwordx4 v[76:79], v10, s[8:11], s17 offen sc1
    s_mov_b32 s17, 337920
    buffer_load_dwordx4 v[80:83], v13, s[8:11], s17 offen sc1
    buffer_load_dwordx4 v[84:87], v4, s[8:11], s17 offen sc1
    buffer_load_dwordx4 v[88:91], v8, s[8:11], s17 offen sc1
    buffer_load_dwordx4 v[92:95], v10, s[8:11], s17 offen sc1
    s_mov_b32 s17, 1284096
    buffer_load_dwordx4 v[180:183], v4, s[8:11], s17 offen sc1
    s_mov_b32 s17, 0
    buffer_load_dwordx2 v[208:209], v200, s[32:35], s17 offen sc1
    s_mov_b32 s17, 66560
    buffer_load_dwordx2 v[210:211], v200, s[32:35], s17 offen sc1
    s_mov_b32 s17, 405504
    buffer_load_dwordx4 v[20:23], v4, s[8:11], s17 offen sc1
    s_mov_b32 s17, 1351680
    buffer_load_dwordx4 v[36:39], v4, s[8:11], s17 offen sc1
    s_waitcnt vmcnt(14)
    v_max3_u32 v9, v48, v52, v56
    v_cmp_u_f32 vcc, v9, v60
    s_nop 3
    s_cbranch_vccnz m1_q9_again
m1_q9_out:
    s_branch m1_q9_ok
m1_q10_again:
    s_nop 7
    s_add_u32 s99, s99, 1
    s_cmp_ge_u32 s99, 16384
    s_cbranch_scc1 m1_q10_out
    s_waitcnt vmcnt(43)
    s_mov_b32 s17, 1216512
    buffer_load_dwordx4 v[64:67], v13, s[8:11], s17 offen sc1
    buffer_load_dwordx4 v[68:71], v4, s[8:11], s17 offen sc1
    buffer_load_dword a253, off, s[52:55], 0
    buffer_load_dwordx4 v[72:75], v8, s[8:11], s17 offen sc1
    buffer_load_dwordx4 v[76:79], v10, s[8:11], s17 offen sc1
    s_mov_b32 s17, 337920
    buffer_load_dwordx4 v[80:83], v13, s[8:11], s17 offen sc1
    buffer_load_dwordx4 v[84:87], v4, s[8:11], s17 offen sc1
    buffer_load_dwordx4 v[88:91], v8, s[8:11], s17 offen sc1
    buffer_load_dwordx4 v[92:95], v10, s[8:11], s17 offen sc1
    s_mov_b32 s17, 1284096
    buffer_load_dwordx4 v[180:183], v4, s[8:11], s17 offen sc1
    s_mov_b32 s17, 0
    buffer_load_dwordx2 v[208:209], v200, s[32:35], s17 offen sc1
    s_mov_b32 s17, 66560
    buffer_load_dwordx2 v[210:211], v200, s[32:35], s17 offen sc1
    s_mov_b32 s17, 405504
    buffer_load_dwordx4 v[20:23], v4, s[8:11], s17 offen sc1
    s_mov_b32 s17, 1351680
    buffer_load_dwordx4 v[36:39], v4, s[8:11], s17 offen sc1
    s_mov_b32 s17, 133120
    buffer_load_dwordx2 v[212:213], v200, s[32:35], s17 offen sc1
    s_mov_b32 s17, 199680
    buffer_load_dwordx2 v[214:215], v200, s[32:35], s17 offen sc1
    s_mov_b32 s17, 266240
    buffer_load_dwordx2 v[216:217], v200, s[32:35], s17 offen sc1
    s_mov_b32 s17, 1284096
    buffer_load_dwordx4 v[184:187], v8, s[8:11], s17 offen sc1
    s_mov_b32 s17, 405504
    buffer_load_dwordx4 v[24:27], v8, s[8:11], s17 offen sc1
    s_waitcnt vmcnt(14)
    v_max3_u32 v9, v64, v68, v72
    v_cmp_u_f32 vcc, v9, v76
    s_nop 3
    s_cbranch_vccnz m1_q10_again
m1_q10_out:
    s_branch m1_q10_ok
m1_q11_again:
    s_nop 7
    s_add_u32 s99, s99, 1
    s_cmp_ge_u32 s99, 16384
    s_cbranch_scc1 m1_q11_out
    s_waitcnt vmcnt(43)
    s_mov_b32 s17, 337920
    buffer_load_dwordx4 v[80:83], v13, s[8:11], s17 offen sc1
    buffer_load_dwordx4 v[84:87], v4, s[8:11], s17 offen sc1
    buffer_load_dwordx4 v[88:91], v8, s[8:11], s17 offen sc1
    buffer_load_dwordx4 v[92:95], v10, s[8:11], s17 offen sc1
    s_mov_b32 s17, 1284096
    buffer_load_dwordx4 v[180:183], v4, s[8:11], s17 offen sc1
    s_mov_b32 s17, 0
    buffer_load_dwordx2 v[208:209], v200, s[32:35], s17 offen sc1
    s_mov_b32 s17, 66560
    buffer_load_dwordx2 v[210:211], v200, s[32:35], s17 offen sc1
    s_mov_b32 s17, 405504
    buffer_load_dwordx4 v[20:23], v4, s[8:11], s17 offen sc1
    s_mov_b32 s17, 1351680
    buffer_load_dwordx4 v[36:39], v4, s[8:11], s17 offen sc1
    s_mov_b32 s17, 133120
    buffer_load_dwordx2 v[212:213], v200, s[32:35], s17 offen sc1
    s_mov_b32 s17, 199680
    buffer_load_dwordx2 v[214:215], v200, s[32:35], s17 offen sc1
    s_mov_b32 s17, 266240
    buffer_load_dwordx2 v[216:217], v200, s[32:35], s17 offen sc1
    s_mov_b32 s17, 1284096
    buffer_load_dwordx4 v[184:187], v8, s[8:11], s17 offen sc1
    s_mov_b32 s17, 405504
    buffer_load_dwordx4 v[24:27], v8, s[8:11], s17 offen sc1
    s_mov_b32 s17, 1351680
    buffer_load_dwordx4 v[40:43], v8, s[8:11], s17 offen sc1
    s_mov_b32 s17, 1284096
    buffer_load_dwordx4 v[188:191], v10, s[8:11], s17 offen sc1
    s_mov_b32 s17, 405504
    buffer_load_dwordx4 v[28:31], v10, s[8:11], s17 offen sc1
    s_mov_b32 s17, 1351680
    buffer_load_dwordx4 v[44:47], v10, s[8:11], s17 offen sc1
    s_mov_b32 s17, 1284096
    buffer_load_dwordx4 v[176:179], v13, s[8:11], s17 offen sc1
    s_waitcnt vmcnt(15)
    v_max3_u32 v9, v80, v84, v88
    v_cmp_u_f32 vcc, v9, v92
    s_nop 3
    s_cbranch_vccnz m1_q11_again
m1_q11_out:
    s_branch m1_q11_ok
m1_q12_again:
    s_nop 7
    s_add_u32 s99, s99, 1
    s_cmp_ge_u32 s99, 16384
    s_cbranch_scc1 m1_q12_out
    s_waitcnt vmcnt(45)
    s_mov_b32 s17, 1284096
    buffer_load_dwordx4 v[180:183], v4, s[8:11], s17 offen sc1
    s_mov_b32 s17, 0
    buffer_load_dwordx2 v[208:209], v200, s[32:35], s17 offen sc1
    s_mov_b32 s17, 66560
    buffer_load_dwordx2 v[210:211], v200, s[32:35], s17 offen sc1
    s_mov_b32 s17, 405504
    buffer_load_dwordx4 v[20:23], v4, s[8:11], s17 offen sc1
    s_mov_b32 s17, 1351680
    buffer_load_dwordx4 v[36:39], v4, s[8:11], s17 offen sc1
    s_mov_b32 s17, 133120
    buffer_load_dwordx2 v[212:213], v200, s[32:35], s17 offen sc1
    s_mov_b32 s17, 199680
    buffer_load_dwordx2 v[214:215], v200, s[32:35], s17 offen sc1
    s_mov_b32 s17, 266240
    buffer_load_dwordx2 v[216:217], v200, s[32:35], s17 offen sc1
    s_mov_b32 s17, 1284096
    buffer_load_dwordx4 v[184:187], v8, s[8:11], s17 offen sc1
    s_mov_b32 s17, 405504
    buffer_load_dwordx4 v[24:27], v8, s[8:11], s17 offen sc1
    s_mov_b32 s17, 1351680
    buffer_load_dwordx4 v[40:43], v8, s[8:11], s17 offen sc1
    s_mov_b32 s17, 1284096
    buffer_load_dwordx4 v[188:191], v10, s[8:11], s17 offen sc1
    s_mov_b32 s17, 405504
    buffer_load_dwordx4 v[28:31], v10, s[8:11], s17 offen sc1
    s_mov_b32 s17, 1351680
    buffer_load_dwordx4 v[44:47], v10, s[8:11], s17 offen sc1
    s_mov_b32 s17, 1284096
    buffer_load_dwordx4 v[176:179], v13, s[8:11], s17 offen sc1
    s_mov_b32 s17, 405504
    buffer_load_dwordx4 v[16:19], v13, s[8:11], s17 offen sc1
    s_mov_b32 s17, 1351680
    buffer_load_dwordx4 v[32:35], v13, s[8:11], s17 offen sc1
    s_waitcnt vmcnt(12)
    v_or_b32 v36, v36, v203
    v_max_u32 v9, v180, v20
    v_cmp_u_f32 vcc, v9, v36
    s_nop 3
    s_cbranch_vccnz m1_q12_again
m1_q12_out:
    s_branch m1_q12_ok
m1_q13_again:
    s_nop 7
    s_add_u32 s99, s99, 1
    s_cmp_ge_u32 s99, 16384
    s_cbranch_scc1 m1_q13_out
    s_waitcnt vmcnt(53)
    s_mov_b32 s17, 1284096
    buffer_load_dwordx4 v[184:187], v8, s[8:11], s17 offen sc1
    s_mov_b32 s17, 405504
    buffer_load_dwordx4 v[24:27], v8, s[8:11], s17 offen sc1
    s_mov_b32 s17, 1351680
    buffer_load_dwordx4 v[40:43], v8, s[8:11], s17 offen sc1
    s_mov_b32 s17, 1284096
    buffer_load_dwordx4 v[188:191], v10, s[8:11], s17 offen sc1
    s_mov_b32 s17, 405504
    buffer_load_dwordx4 v[28:31], v10, s[8:11], s17 offen sc1
    s_mov_b32 s17, 1351680
    buffer_load_dwordx4 v[44:47], v10, s[8:11], s17 offen sc1
    s_mov_b32 s17, 1284096
    buffer_load_dwordx4 v[176:179], v13, s[8:11], s17 offen sc1
    s_mov_b32 s17, 405504
    buffer_load_dwordx4 v[16:19], v13, s[8:11], s17 offen sc1
    s_mov_b32 s17, 1351680
    buffer_load_dwordx4 v[32:35], v13, s[8:11], s17 offen sc1
    s_waitcnt vmcnt(6)
    v_or_b32 v40, v40, v203
    v_max_u32 v9, v184, v24
    v_cmp_u_f32 vcc, v9, v40
    s_nop 3
    s_cbranch_vccnz m1_q13_again
m1_q13_out:
    s_branch m1_q13_ok
m1_q14_again:
    s_nop 7
    s_add_u32 s99, s99, 1
    s_cmp_ge_u32 s99, 16384
    s_cbranch_scc1 m1_q14_out
    s_waitcnt vmcnt(56)
    s_mov_b32 s17, 1284096
    buffer_load_dwordx4 v[188:191], v10, s[8:11], s17 offen sc1
    s_mov_b32 s17, 405504
    buffer_load_dwordx4 v[28:31], v10, s[8:11], s17 offen sc1
    s_mov_b32 s17, 1351680
    buffer_load_dwordx4 v[44:47], v10, s[8:11], s17 offen sc1
    s_mov_b32 s17, 1284096
    buffer_load_dwordx4 v[176:179], v13, s[8:11], s17 offen sc1
    s_mov_b32 s17, 405504
    buffer_load_dwordx4 v[16:19], v13, s[8:11], s17 offen sc1
    s_mov_b32 s17, 1351680
    buffer_load_dwordx4 v[32:35], v13, s[8:11], s17 offen sc1
    s_waitcnt vmcnt(3)
    v_or_b32 v44, v44, v203
    v_max_u32 v9, v188, v28
    v_cmp_u_f32 vcc, v9, v44
    s_nop 3
    s_cbranch_vccnz m1_q14_again
m1_q14_out:
    s_branch m1_q14_ok
m1_q15_again:
    s_nop 7
    s_add_u32 s99, s99, 1
    s_cmp_ge_u32 s99, 16384
    s_cbranch_scc1 m1_q15_out
    s_waitcnt vmcnt(59)
    s_mov_b32 s17, 1284096
    buffer_load_dwordx4 v[176:179], v13, s[8:11], s17 offen sc1
    s_mov_b32 s17, 405504
    buffer_load_dwordx4 v[16:19], v13, s[8:11], s17 offen sc1
    s_mov_b32 s17, 1351680
    buffer_load_dwordx4 v[32:35], v13, s[8:11], s17 offen sc1
    s_waitcnt vmcnt(0)
    v_or_b32 v32, v32, v203
    v_max_u32 v9, v176, v16
    v_cmp_u_f32 vcc, v9, v32
    s_nop 3
    s_cbranch_vccnz m1_q15_again
m1_q15_out:
    s_branch m1_q15_ok
idle1:
    s_getpc_b64 s[36:37]
    s_add_u32 s36, s36, ft2@rel32@lo+4
    s_addc_u32 s37, s37, ft2@rel32@hi+12
    s_and_b32 s37, s37, 0xffff
    s_mov_b32 s38, 819200
    s_mov_b32 s39, 0x20000
    s_and_b32 s58, s96, 3
    s_and_b32 s59, s97, 7
    s_lshl3_add_u32 s58, s58, s59
    s_sub_u32 s58, 31, s58
    s_mul_i32 s58, s58, 98304
    v_lshl_add_u32 v13, v0, 7, s58
    s_mov_b32 s64, 0
    buffer_load_dword a253, v13, s[36:39], s64 offen
    s_mov_b32 s64, 32768
    buffer_load_dword a253, v13, s[36:39], s64 offen
    s_mov_b32 s64, 65536
    buffer_load_dword a253, v13, s[36:39], s64 offen
    s_mul_i32 s62, s56, 10240
    s_add_u32 m0, s62, 20480
    v_lshlrev_b32 v10, 4, v3
    s_mul_i32 s58, s19, 20480
    s_add_u32 s58, s58, 12288
    s_add_u32 s48, s28, s58
    s_addc_u32 s49, s29, 0
    s_and_b32 s49, s49, 0xffff
    s_mov_b32 s50, 163840
    s_cmp_lg_u32 s26, 0
    s_cselect_b32 s50, 143360, s50
    s_mov_b32 s51, 0x20000
    v_lshrrev_b32 v11, 1, v2
    v_and_b32 v12, 1, v2
    v_mul_u32_u24 v11, 33792, v11
    v_lshl_add_u32 v11, v1, 5, v11
    v_lshl_add_u32 v11, v12, 4, v11
    s_mul_i32 s58, s19, 67584
    s_lshl4_add_u32 s58, s98, s58
    s_lshl_b32 s59, s56, 9
    s_add_u32 s58, s58, s59
    v_add_u32 v11, s58, v11
    s_add_u32 s52, s52, 2326528
    s_addc_u32 s53, s53, 0
    s_barrier
    s_mul_i32 s64, s56, 27
    v_min_u32 v14, 27, v3
    v_add_u32 v14, s64, v14
    v_sub_u32 v14, 252, v14
    v_lshlrev_b32 v14, 7, v14
    s_mov_b32 s64, 262148
    buffer_load_dword v14, v14, s[12:15], s64 offen sc1
    buffer_load_dwordx4 v10, s[48:51], m0 offen offset:0 lds
    buffer_load_dwordx4 v10, s[48:51], m0 offen offset:1024 lds
    buffer_load_dwordx4 v10, s[48:51], m0 offen offset:2048 lds
    buffer_load_dwordx4 v10, s[48:51], m0 offen offset:3072 lds
    s_add_u32 m0, m0, 4096
    s_nop 0
    buffer_load_dwordx4 v10, s[48:51], m0 offen offset:0 lds
    buffer_load_dwordx4 v10, s[48:51], m0 offen offset:1024 lds
    buffer_load_dwordx4 v10, s[48:51], m0 offen offset:2048 lds
    buffer_load_dwordx4 v10, s[48:51], m0 offen offset:3072 lds
    s_add_u32 m0, m0, 4096
    s_nop 0
    buffer_load_dwordx4 v10, s[48:51], m0 offen offset:0 lds
    buffer_load_dwordx4 v10, s[48:51], m0 offen offset:1024 lds
    s_waitcnt vmcnt(10)
    v_cmp_eq_u32 vcc, 0, v14
    s_nop 3
    s_cbranch_vccnz n2_w2
n2_w2ok:
    s_mov_b32 s64, 0
    buffer_load_dwordx4 a[32:35], v15, s[52:55], s64 offen offset:0
    buffer_load_dwordx4 a[36:39], v15, s[52:55], s64 offen offset:256
    buffer_load_dwordx4 a[40:43], v15, s[52:55], s64 offen offset:512
    buffer_load_dwordx4 a[44:47], v15, s[52:55], s64 offen offset:768
    buffer_load_dwordx4 a[48:51], v15, s[52:55], s64 offen offset:1024
    s_mov_b32 s64, 286720
    buffer_load_dwordx4 a[52:55], v15, s[52:55], s64 offen offset:0
    buffer_load_dwordx4 a[56:59], v15, s[52:55], s64 offen offset:256
    buffer_load_dwordx4 a[60:63], v15, s[52:55], s64 offen offset:512
    buffer_load_dwordx4 a[64:67], v15, s[52:55], s64 offen offset:768
    buffer_load_dwordx4 a[68:71], v15, s[52:55], s64 offen offset:1024
    s_mov_b32 s64, 20480
    buffer_load_dwordx4 a[72:75], v15, s[52:55], s64 offen offset:0
    buffer_load_dwordx4 a[76:79], v15, s[52:55], s64 offen offset:256
    buffer_load_dwordx4 a[80:83], v15, s[52:55], s64 offen offset:512
    buffer_load_dwordx4 a[84:87], v15, s[52:55], s64 offen offset:768
    buffer_load_dwordx4 a[88:91], v15, s[52:55], s64 offen offset:1024
    s_mov_b32 s64, 307200
    buffer_load_dwordx4 a[92:95], v15, s[52:55], s64 offen offset:0
    buffer_load_dwordx4 a[96:99], v15, s[52:55], s64 offen offset:256
    buffer_load_dwordx4 a[100:103], v15, s[52:55], s64 offen offset:512
    buffer_load_dwordx4 a[104:107], v15, s[52:55], s64 offen offset:768
    buffer_load_dwordx4 a[108:111], v15, s[52:55], s64 offen offset:1024
    s_mov_b32 s64, 40960
    buffer_load_dwordx4 a[112:115], v15, s[52:55], s64 offen offset:0
    buffer_load_dwordx4 a[116:119], v15, s[52:55], s64 offen offset:256
    buffer_load_dwordx4 a[120:123], v15, s[52:55], s64 offen offset:512
    buffer_load_dwordx4 a[124:127], v15, s[52:55], s64 offen offset:768
    buffer_load_dwordx4 a[128:131], v15, s[52:55], s64 offen offset:1024
    s_mov_b32 s64, 327680
    buffer_load_dwordx4 a[132:135], v15, s[52:55], s64 offen offset:0
    buffer_load_dwordx4 a[136:139], v15, s[52:55], s64 offen offset:256
    buffer_load_dwordx4 a[140:143], v15, s[52:55], s64 offen offset:512
    buffer_load_dwordx4 a[144:147], v15, s[52:55], s64 offen offset:768
    buffer_load_dwordx4 a[148:151], v15, s[52:55], s64 offen offset:1024
    s_mov_b32 s64, 61440
    buffer_load_dwordx4 a[152:155], v15, s[52:55], s64 offen offset:0
    buffer_load_dwordx4 a[156:159], v15, s[52:55], s64 offen offset:256
    buffer_load_dwordx4 a[160:163], v15, s[52:55], s64 offen offset:512
    buffer_load_dwordx4 a[164:167], v15, s[52:55], s64 offen offset:768
    buffer_load_dwordx4 a[168:171], v15, s[52:55], s64 offen offset:1024
    s_mov_b32 s64, 348160
    buffer_load_dwordx4 a[172:175], v15, s[52:55], s64 offen offset:0
    buffer_load_dwordx4 a[176:179], v15, s[52:55], s64 offen offset:256
    buffer_load_dwordx4 a[180:183], v15, s[52:55], s64 offen offset:512
    buffer_load_dwordx4 a[184:187], v15, s[52:55], s64 offen offset:768
    buffer_load_dwordx4 a[188:191], v15, s[52:55], s64 offen offset:1024
    v_mul_u32_u24 v13, 5, v3
    v_lshrrev_b32 v13, 1, v13
    v_lshlrev_b32 v13, 7, v13
    s_mov_b32 s65, 229376
    s_waitcnt vmcnt(0)
    s_cmp_lg_u32 s56, 0
    s_nop 0
    s_cbranch_scc1 n2_ok
n2_spin:
    buffer_load_dword v12, v13, s[12:15], s65 offen sc1
    s_add_u32 s99, s99, 1
    s_cmp_ge_u32 s99, 16384
    s_cbranch_scc1 n2_ok
    s_waitcnt vmcnt(0)
    v_cmp_eq_u32 vcc, 0, v12
    s_nop 3
    s_cbranch_vccnz n2_spin
n2_ok:
    s_barrier
    s_branch join1
c2_again:
    s_add_u32 s99, s99, 1
    s_cmp_ge_u32 s99, 16384
    s_cbranch_scc1 c2_ok
    buffer_load_dwordx4 v[16:19], v4, s[32:35], s63 offen offset:0 sc1
    buffer_load_dwordx4 v[20:23], v4, s[32:35], s63 offen offset:1024 sc1
    buffer_load_dwordx4 v[24:27], v4, s[32:35], s63 offen offset:2048 sc1
    buffer_load_dwordx4 v[28:31], v4, s[32:35], s63 offen offset:3072 sc1
    buffer_load_dwordx3 v[152:154], v4, s[36:39], 0 offen offset:0 sc1
    buffer_load_dwordx3 v[156:158], v4, s[36:39], 0 offen offset:1024 sc1
    buffer_load_dwordx3 v[160:162], v4, s[36:39], 0 offen offset:2048 sc1
    buffer_load_dwordx3 v[164:166], v4, s[36:39], 0 offen offset:3072 sc1
    s_waitcnt vmcnt(0)
    v_max3_f32 v177, |v16|, |v18|, |v20|
    v_max3_f32 v180, |v22|, |v24|, |v26|
    v_max3_f32 v177, v177, |v28|, |v30|
    v_max_f32 v177, v177, v180
    v_min3_f32 v178, v154, v158, v162
    v_min_f32 v178, v178, v166
    v_fmamk_f32 v178, v177, 0xdc000000, v178
    v_cmp_gt_f32 vcc, 0x40f00000, v178
    v_fma_f32 v32, v152, s58, v179
    v_fma_f32 v33, v153, s58, v179
    v_fma_f32 v34, v156, s58, v179
    v_fma_f32 v35, v157, s58, v179
    v_fma_f32 v36, v160, s58, v179
    v_fma_f32 v37, v161, s58, v179
    v_fma_f32 v38, v164, s58, v179
    v_fma_f32 v39, v165, s58, v179
    s_nop 3
    s_cbranch_vccnz c2_again
    s_branch c2_ok
c2_w2:
    s_mul_i32 s64, s56, 27
    v_min_u32 v14, 27, v3
    v_add_u32 v14, s64, v14
    v_sub_u32 v14, 252, v14
    v_lshlrev_b32 v14, 7, v14
    s_mov_b32 s64, 262148
    buffer_load_dword v14, v14, s[12:15], s64 offen sc1
    s_add_u32 s99, s99, 1
    s_cmp_ge_u32 s99, 16384
    s_cbranch_scc1 c2_w2out
    s_waitcnt vmcnt(0)
    v_cmp_eq_u32 vcc, 0, v14
    s_nop 3
    s_cbranch_vccnz c2_w2
c2_w2out:
    s_waitcnt vmcnt(0)
    s_branch c2_w2ok
m2_x0_again:
    s_nop 7
    s_add_u32 s99, s99, 1
    s_cmp_ge_u32 s99, 16384
    s_cbranch_scc1 m2_x0_out
    s_waitcnt vmcnt(52)
    s_mov_b32 s17, 2529280
    buffer_load_dwordx4 v[16:19], v4, s[32:35], s17 offen sc1
    buffer_load_dwordx4 v[20:23], v8, s[32:35], s17 offen sc1
    s_mov_b32 s17, 2396160
    buffer_load_dwordx4 v[24:27], v4, s[32:35], s17 offen sc1
    buffer_load_dwordx4 v[28:31], v8, s[32:35], s17 offen sc1
    s_mov_b32 s17, 2263040
    buffer_load_dwordx4 v[32:35], v4, s[32:35], s17 offen sc1
    buffer_load_dwordx4 v[36:39], v8, s[32:35], s17 offen sc1
    s_mov_b32 s17, 2129920
    buffer_load_dwordx4 v[40:43], v4, s[32:35], s17 offen sc1
    buffer_load_dwordx4 v[44:47], v8, s[32:35], s17 offen sc1
    s_mov_b32 s17, 1996800
    buffer_load_dwordx4 v[48:51], v4, s[32:35], s17 offen sc1
    buffer_load_dwordx4 v[52:55], v8, s[32:35], s17 offen sc1
    s_waitcnt vmcnt(8)
    v_min_f32_e64 v9, |v16|, |v20|
    v_cmp_gt_f32 vcc, 0x3c800000, v9
    s_nop 3
    s_cbranch_vccnz m2_x0_again
m2_x0_out:
    s_branch m2_x0_ok
m2_x1_again:
    s_nop 7
    s_add_u32 s99, s99, 1
    s_cmp_ge_u32 s99, 16384
    s_cbranch_scc1 m2_x1_out
    s_waitcnt vmcnt(50)
    s_mov_b32 s17, 2396160
    buffer_load_dwordx4 v[24:27], v4, s[32:35], s17 offen sc1
    buffer_load_dwordx4 v[28:31], v8, s[32:35], s17 offen sc1
    s_mov_b32 s17, 2263040
    buffer_load_dwordx4 v[32:35], v4, s[32:35], s17 offen sc1
    buffer_load_dwordx4 v[36:39], v8, s[32:35], s17 offen sc1
    s_mov_b32 s17, 2129920
    buffer_load_dwordx4 v[40:43], v4, s[32:35], s17 offen sc1
    buffer_load_dwordx4 v[44:47], v8, s[32:35], s17 offen sc1
    s_mov_b32 s17, 1996800
    buffer_load_dwordx4 v[48:51], v4, s[32:35], s17 offen sc1
    buffer_load_dwordx4 v[52:55], v8, s[32:35], s17 offen sc1
    s_mov_b32 s17, 1863680
    buffer_load_dwordx4 v[56:59], v4, s[32:35], s17 offen sc1
    buffer_load_dwordx4 v[60:63], v8, s[32:35], s17 offen sc1
    s_mov_b32 s17, 1730560
    buffer_load_dwordx4 v[64:67], v4, s[32:35], s17 offen sc1
    buffer_load_dwordx4 v[68:71], v8, s[32:35], s17 offen sc1
    s_waitcnt vmcnt(10)
    v_min_f32_e64 v9, |v24|, |v28|
    v_cmp_gt_f32 vcc, 0x3c800000, v9
    s_nop 3
    s_cbranch_vccnz m2_x1_again
m2_x1_out:
    s_branch m2_x1_ok
m2_x2_again:
    s_nop 7
    s_add_u32 s99, s99, 1
    s_cmp_ge_u32 s99, 16384
    s_cbranch_scc1 m2_x2_out
    s_waitcnt vmcnt(48)
    s_mov_b32 s17, 2263040
    buffer_load_dwordx4 v[32:35], v4, s[32:35], s17 offen sc1
    buffer_load_dwordx4 v[36:39], v8, s[32:35], s17 offen sc1
    s_mov_b32 s17, 2129920
    buffer_load_dwordx4 v[40:43], v4, s[32:35], s17 offen sc1
    buffer_load_dwordx4 v[44:47], v8, s[32:35], s17 offen sc1
    s_mov_b32 s17, 1996800
    buffer_load_dwordx4 v[48:51], v4, s[32:35], s17 offen sc1
    buffer_load_dwordx4 v[52:55], v8, s[32:35], s17 offen sc1
    s_mov_b32 s17, 1863680
    buffer_load_dwordx4 v[56:59], v4, s[32:35], s17 offen sc1
    buffer_load_dwordx4 v[60:63], v8, s[32:35], s17 offen sc1
    s_mov_b32 s17, 1730560
    buffer_load_dwordx4 v[64:67], v4, s[32:35], s17 offen sc1
    buffer_load_dwordx4 v[68:71], v8, s[32:35], s17 offen sc1
    s_mov_b32 s17, 1597440
    buffer_load_dwordx4 v[72:75], v4, s[32:35], s17 offen sc1
    buffer_load_dwordx4 v[76:79], v8, s[32:35], s17 offen sc1
    s_mov_b32 s17, 1464320
    buffer_load_dwordx4 v[80:83], v4, s[32:35], s17 offen sc1
    buffer_load_dwordx4 v[84:87], v8, s[32:35], s17 offen sc1
    s_waitcnt vmcnt(12)
    v_min_f32_e64 v9, |v32|, |v36|
    v_cmp_gt_f32 vcc, 0x3c800000, v9
    s_nop 3
    s_cbranch_vccnz m2_x2_again
m2_x2_out:
    s_branch m2_x2_ok
m2_x3_again:
    s_nop 7
    s_add_u32 s99, s99, 1
    s_cmp_ge_u32 s99, 16384
    s_cbranch_scc1 m2_x3_out
    s_waitcnt vmcnt(48)
    s_mov_b32 s17, 2129920
    buffer_load_dwordx4 v[40:43], v4, s[32:35], s17 offen sc1
    buffer_load_dwordx4 v[44:47], v8, s[32:35], s17 offen sc1
    s_mov_b32 s17, 1996800
    buffer_load_dwordx4 v[48:51], v4, s[32:35], s17 offen sc1
    buffer_load_dwordx4 v[52:55], v8, s[32:35], s17 offen sc1
    s_mov_b32 s17, 1863680
    buffer_load_dwordx4 v[56:59], v4, s[32:35], s17 offen sc1
    buffer_load_dwordx4 v[60:63], v8, s[32:35], s17 offen sc1
    s_mov_b32 s17, 1730560
    buffer_load_dwordx4 v[64:67], v4, s[32:35], s17 offen sc1
    buffer_load_dwordx4 v[68:71], v8, s[32:35], s17 offen sc1
    s_mov_b32 s17, 1597440
    buffer_load_dwordx4 v[72:75], v4, s[32:35], s17 offen sc1
    buffer_load_dwordx4 v[76:79], v8, s[32:35], s17 offen sc1
    s_mov_b32 s17, 1464320
    buffer_load_dwordx4 v[80:83], v4, s[32:35], s17 offen sc1
    buffer_load_dwordx4 v[84:87], v8, s[32:35], s17 offen sc1
    s_mov_b32 s17, 1331200
    buffer_load_dwordx4 v[88:91], v4, s[32:35], s17 offen sc1
    buffer_load_dwordx4 v[92:95], v8, s[32:35], s17 offen sc1
    s_waitcnt vmcnt(12)
    v_min_f32_e64 v9, |v40|, |v44|
    v_cmp_gt_f32 vcc, 0x3c800000, v9
    s_nop 3
    s_cbranch_vccnz m2_x3_again
m2_x3_out:
    s_branch m2_x3_ok
m2_x4_again:
    s_nop 7
    s_add_u32 s99, s99, 1
    s_cmp_ge_u32 s99, 16384
    s_cbranch_scc1 m2_x4_out
    s_waitcnt vmcnt(48)
    s_mov_b32 s17, 1996800
    buffer_load_dwordx4 v[48:51], v4, s[32:35], s17 offen sc1
    buffer_load_dwordx4 v[52:55], v8, s[32:35], s17 offen sc1
    s_mov_b32 s17, 1863680
    buffer_load_dwordx4 v[56:59], v4, s[32:35], s17 offen sc1
    buffer_load_dwordx4 v[60:63], v8, s[32:35], s17 offen sc1
    s_mov_b32 s17, 1730560
    buffer_load_dwordx4 v[64:67], v4, s[32:35], s17 offen sc1
    buffer_load_dwordx4 v[68:71], v8, s[32:35], s17 offen sc1
    s_mov_b32 s17, 1597440
    buffer_load_dwordx4 v[72:75], v4, s[32:35], s17 offen sc1
    buffer_load_dwordx4 v[76:79], v8, s[32:35], s17 offen sc1
    s_mov_b32 s17, 1464320
    buffer_load_dwordx4 v[80:83], v4, s[32:35], s17 offen sc1
    buffer_load_dwordx4 v[84:87], v8, s[32:35], s17 offen sc1
    s_mov_b32 s17, 1331200
    buffer_load_dwordx4 v[88:91], v4, s[32:35], s17 offen sc1
    buffer_load_dwordx4 v[92:95], v8, s[32:35], s17 offen sc1
    s_mov_b32 s17, 1198080
    buffer_load_dwordx4 v[96:99], v4, s[32:35], s17 offen sc1
    buffer_load_dwordx4 v[100:103], v8, s[32:35], s17 offen sc1
    s_waitcnt vmcnt(12)
    v_min_f32_e64 v9, |v48|, |v52|
    v_cmp_gt_f32 vcc, 0x3c800000, v9
    s_nop 3
    s_cbranch_vccnz m2_x4_again
m2_x4_out:
    s_branch m2_x4_ok
m2_x5_again:
    s_nop 7
    s_add_u32 s99, s99, 1
    s_cmp_ge_u32 s99, 16384
    s_cbranch_scc1 m2_x5_out
    s_waitcnt vmcnt(50)
    s_mov_b32 s17, 1863680
    buffer_load_dwordx4 v[56:59], v4, s[32:35], s17 offen sc1
    buffer_load_dwordx4 v[60:63], v8, s[32:35], s17 offen sc1
    s_mov_b32 s17, 1730560
    buffer_load_dwordx4 v[64:67], v4, s[32:35], s17 offen sc1
    buffer_load_dwordx4 v[68:71], v8, s[32:35], s17 offen sc1
    s_mov_b32 s17, 1597440
    buffer_load_dwordx4 v[72:75], v4, s[32:35], s17 offen sc1
    buffer_load_dwordx4 v[76:79], v8, s[32:35], s17 offen sc1
    s_mov_b32 s17, 1464320
    buffer_load_dwordx4 v[80:83], v4, s[32:35], s17 offen sc1
    buffer_load_dwordx4 v[84:87], v8, s[32:35], s17 offen sc1
    s_mov_b32 s17, 1331200
    buffer_load_dwordx4 v[88:91], v4, s[32:35], s17 offen sc1
    buffer_load_dwordx4 v[92:95], v8, s[32:35], s17 offen sc1
    s_mov_b32 s17, 1198080
    buffer_load_dwordx4 v[96:99], v4, s[32:35], s17 offen sc1
    buffer_load_dwordx4 v[100:103], v8, s[32:35], s17 offen sc1
    s_waitcnt vmcnt(10)
    v_min_f32_e64 v9, |v56|, |v60|
    v_cmp_gt_f32 vcc, 0x3c800000, v9
    s_nop 3
    s_cbranch_vccnz m2_x5_again
m2_x5_out:
    s_branch m2_x5_ok
m2_x6_again:
    s_nop 7
    s_add_u32 s99, s99, 1
    s_cmp_ge_u32 s99, 16384
    s_cbranch_scc1 m2_x6_out
    s_waitcnt vmcnt(48)
    s_mov_b32 s17, 1730560
    buffer_load_dwordx4 v[64:67], v4, s[32:35], s17 offen sc1
    buffer_load_dwordx4 v[68:71], v8, s[32:35], s17 offen sc1
    s_mov_b32 s17, 1597440
    buffer_load_dwordx4 v[72:75], v4, s[32:35], s17 offen sc1
    buffer_load_dwordx4 v[76:79], v8, s[32:35], s17 offen sc1
    s_mov_b32 s17, 1464320
    buffer_load_dwordx4 v[80:83], v4, s[32:35], s17 offen sc1
    buffer_load_dwordx4 v[84:87], v8, s[32:35], s17 offen sc1
    s_mov_b32 s17, 1331200
    buffer_load_dwordx4 v[88:91], v4, s[32:35], s17 offen sc1
    buffer_load_dwordx4 v[92:95], v8, s[32:35], s17 offen sc1
    s_mov_b32 s17, 1198080
    buffer_load_dwordx4 v[96:99], v4, s[32:35], s17 offen sc1
    buffer_load_dwordx4 v[100:103], v8, s[32:35], s17 offen sc1
    s_mov_b32 s17, 1064960
    buffer_load_dwordx4 v[104:107], v4, s[32:35], s17 offen sc1
    buffer_load_dwordx4 v[108:111], v8, s[32:35], s17 offen sc1
    s_mov_b32 s17, 931840
    buffer_load_dwordx4 v[112:115], v4, s[32:35], s17 offen sc1
    buffer_load_dwordx4 v[116:119], v8, s[32:35], s17 offen sc1
    s_waitcnt vmcnt(12)
    v_min_f32_e64 v9, |v64|, |v68|
    v_cmp_gt_f32 vcc, 0x3c800000, v9
    s_nop 3
    s_cbranch_vccnz m2_x6_again
m2_x6_out:
    s_branch m2_x6_ok
m2_x7_again:
    s_nop 7
    s_add_u32 s99, s99, 1
    s_cmp_ge_u32 s99, 16384
    s_cbranch_scc1 m2_x7_out
    s_waitcnt vmcnt(48)
    s_mov_b32 s17, 1597440
    buffer_load_dwordx4 v[72:75], v4, s[32:35], s17 offen sc1
    buffer_load_dwordx4 v[76:79], v8, s[32:35], s17 offen sc1
    s_mov_b32 s17, 1464320
    buffer_load_dwordx4 v[80:83], v4, s[32:35], s17 offen sc1
    buffer_load_dwordx4 v[84:87], v8, s[32:35], s17 offen sc1
    s_mov_b32 s17, 1331200
    buffer_load_dwordx4 v[88:91], v4, s[32:35], s17 offen sc1
    buffer_load_dwordx4 v[92:95], v8, s[32:35], s17 offen sc1
    s_mov_b32 s17, 1198080
    buffer_load_dwordx4 v[96:99], v4, s[32:35], s17 offen sc1
    buffer_load_dwordx4 v[100:103], v8, s[32:35], s17 offen sc1
    s_mov_b32 s17, 1064960
    buffer_load_dwordx4 v[104:107], v4, s[32:35], s17 offen sc1
    buffer_load_dwordx4 v[108:111], v8, s[32:35], s17 offen sc1
    s_mov_b32 s17, 931840
    buffer_load_dwordx4 v[112:115], v4, s[32:35], s17 offen sc1
    buffer_load_dwordx4 v[116:119], v8, s[32:35], s17 offen sc1
    s_mov_b32 s17, 0
    buffer_load_dwordx4 v[168:171], v4, s[32:35], s17 offen sc1
    buffer_load_dwordx4 v[172:175], v8, s[32:35], s17 offen sc1
    s_waitcnt vmcnt(12)
    v_min_f32_e64 v9, |v72|, |v76|
    v_cmp_gt_f32 vcc, 0x3c800000, v9
    s_nop 3
    s_cbranch_vccnz m2_x7_again
m2_x7_out:
    s_branch m2_x7_ok
m2_x8_again:
    s_nop 7
    s_add_u32 s99, s99, 1
    s_cmp_ge_u32 s99, 16384
    s_cbranch_scc1 m2_x8_out
    s_waitcnt vmcnt(48)
    s_mov_b32 s17, 1464320
    buffer_load_dwordx4 v[80:83], v4, s[32:35], s17 offen sc1
    buffer_load_dwordx4 v[84:87], v8, s[32:35], s17 offen sc1
    s_mov_b32 s17, 1331200
    buffer_load_dwordx4 v[88:91], v4, s[32:35], s17 offen sc1
    buffer_load_dwordx4 v[92:95], v8, s[32:35], s17 offen sc1
    s_mov_b32 s17, 1198080
    buffer_load_dwordx4 v[96:99], v4, s[32:35], s17 offen sc1
    buffer_load_dwordx4 v[100:103], v8, s[32:35], s17 offen sc1
    s_mov_b32 s17, 1064960
    buffer_load_dwordx4 v[104:107], v4, s[32:35], s17 offen sc1
    buffer_load_dwordx4 v[108:111], v8, s[32:35], s17 offen sc1
    s_mov_b32 s17, 931840
    buffer_load_dwordx4 v[112:115], v4, s[32:35], s17 offen sc1
    buffer_load_dwordx4 v[116:119], v8, s[32:35], s17 offen sc1
    s_mov_b32 s17, 0
    buffer_load_dwordx4 v[168:171], v4, s[32:35], s17 offen sc1
    buffer_load_dwordx4 v[172:175], v8, s[32:35], s17 offen sc1
    s_mov_b32 s17, 798720
    buffer_load_dwordx4 v[120:123], v4, s[32:35], s17 offen sc1
    buffer_load_dwordx4 v[124:127], v8, s[32:35], s17 offen sc1
    s_waitcnt vmcnt(12)
    v_min_f32_e64 v9, |v80|, |v84|
    v_cmp_gt_f32 vcc, 0x3c800000, v9
    s_nop 3
    s_cbranch_vccnz m2_x8_again
m2_x8_out:
    s_branch m2_x8_ok
m2_x9_again:
    s_nop 7
    s_add_u32 s99, s99, 1
    s_cmp_ge_u32 s99, 16384
    s_cbranch_scc1 m2_x9_out
    s_waitcnt vmcnt(48)
    s_mov_b32 s17, 1331200
    buffer_load_dwordx4 v[88:91], v4, s[32:35], s17 offen sc1
    buffer_load_dwordx4 v[92:95], v8, s[32:35], s17 offen sc1
    s_mov_b32 s17, 1198080
    buffer_load_dwordx4 v[96:99], v4, s[32:35], s17 offen sc1
    buffer_load_dwordx4 v[100:103], v8, s[32:35], s17 offen sc1
    s_mov_b32 s17, 1064960
    buffer_load_dwordx4 v[104:107], v4, s[32:35], s17 offen sc1
    buffer_load_dwordx4 v[108:111], v8, s[32:35], s17 offen sc1
    s_mov_b32 s17, 931840
    buffer_load_dwordx4 v[112:115], v4, s[32:35], s17 offen sc1
    buffer_load_dwordx4 v[116:119], v8, s[32:35], s17 offen sc1
    s_mov_b32 s17, 0
    buffer_load_dwordx4 v[168:171], v4, s[32:35], s17 offen sc1
    buffer_load_dwordx4 v[172:175], v8, s[32:35], s17 offen sc1
    s_mov_b32 s17, 798720
    buffer_load_dwordx4 v[120:123], v4, s[32:35], s17 offen sc1
    buffer_load_dwordx4 v[124:127], v8, s[32:35], s17 offen sc1
    s_mov_b32 s17, 665600
    buffer_load_dwordx4 v[128:131], v4, s[32:35], s17 offen sc1
    buffer_load_dwordx4 v[132:135], v8, s[32:35], s17 offen sc1
    s_waitcnt vmcnt(12)
    v_min_f32_e64 v9, |v88|, |v92|
    v_cmp_gt_f32 vcc, 0x3c800000, v9
    s_nop 3
    s_cbranch_vccnz m2_x9_again
m2_x9_out:
    s_branch m2_x9_ok
m2_x10_again:
    s_nop 7
    s_add_u32 s99, s99, 1
    s_cmp_ge_u32 s99, 16384
    s_cbranch_scc1 m2_x10_out
    s_waitcnt vmcnt(48)
    s_mov_b32 s17, 1198080
    buffer_load_dwordx4 v[96:99], v4, s[32:35], s17 offen sc1
    buffer_load_dwordx4 v[100:103], v8, s[32:35], s17 offen sc1
    s_mov_b32 s17, 1064960
    buffer_load_dwordx4 v[104:107], v4, s[32:35], s17 offen sc1
    buffer_load_dwordx4 v[108:111], v8, s[32:35], s17 offen sc1
    s_mov_b32 s17, 931840
    buffer_load_dwordx4 v[112:115], v4, s[32:35], s17 offen sc1
    buffer_load_dwordx4 v[116:119], v8, s[32:35], s17 offen sc1
    s_mov_b32 s17, 0
    buffer_load_dwordx4 v[168:171], v4, s[32:35], s17 offen sc1
    buffer_load_dwordx4 v[172:175], v8, s[32:35], s17 offen sc1
    s_mov_b32 s17, 798720
    buffer_load_dwordx4 v[120:123], v4, s[32:35], s17 offen sc1
    buffer_load_dwordx4 v[124:127], v8, s[32:35], s17 offen sc1
    s_mov_b32 s17, 665600
    buffer_load_dwordx4 v[128:131], v4, s[32:35], s17 offen sc1
    buffer_load_dwordx4 v[132:135], v8, s[32:35], s17 offen sc1
    s_mov_b32 s17, 532480
    buffer_load_dwordx4 v[136:139], v4, s[32:35], s17 offen sc1
    buffer_load_dwordx4 v[140:143], v8, s[32:35], s17 offen sc1
    s_waitcnt vmcnt(12)
    v_min_f32_e64 v9, |v96|, |v100|
    v_cmp_gt_f32 vcc, 0x3c800000, v9
    s_nop 3
    s_cbranch_vccnz m2_x10_again
m2_x10_out:
    s_branch m2_x10_ok
m2_x11_again:
    s_nop 7
    s_add_u32 s99, s99, 1
    s_cmp_ge_u32 s99, 16384
    s_cbranch_scc1 m2_x11_out
    s_waitcnt vmcnt(48)
    s_mov_b32 s17, 1064960
    buffer_load_dwordx4 v[104:107], v4, s[32:35], s17 offen sc1
    buffer_load_dwordx4 v[108:111], v8, s[32:35], s17 offen sc1
    s_mov_b32 s17, 931840
    buffer_load_dwordx4 v[112:115], v4, s[32:35], s17 offen sc1
    buffer_load_dwordx4 v[116:119], v8, s[32:35], s17 offen sc1
    s_mov_b32 s17, 0
    buffer_load_dwordx4 v[168:171], v4, s[32:35], s17 offen sc1
    buffer_load_dwordx4 v[172:175], v8, s[32:35], s17 offen sc1
    s_mov_b32 s17, 798720
    buffer_load_dwordx4 v[120:123], v4, s[32:35], s17 offen sc1
    buffer_load_dwordx4 v[124:127], v8, s[32:35], s17 offen sc1
    s_mov_b32 s17, 665600
    buffer_load_dwordx4 v[128:131], v4, s[32:35], s17 offen sc1
    buffer_load_dwordx4 v[132:135], v8, s[32:35], s17 offen sc1
    s_mov_b32 s17, 532480
    buffer_load_dwordx4 v[136:139], v4, s[32:35], s17 offen sc1
    buffer_load_dwordx4 v[140:143], v8, s[32:35], s17 offen sc1
    s_mov_b32 s17, 399360
    buffer_load_dwordx4 v[144:147], v4, s[32:35], s17 offen sc1
    buffer_load_dwordx4 v[148:151], v8, s[32:35], s17 offen sc1
    s_waitcnt vmcnt(12)
    v_min_f32_e64 v9, |v104|, |v108|
    v_cmp_gt_f32 vcc, 0x3c800000, v9
    s_nop 3
    s_cbranch_vccnz m2_x11_again
m2_x11_out:
    s_branch m2_x11_ok
m2_x12_again:
    s_nop 7
    s_add_u32 s99, s99, 1
    s_cmp_ge_u32 s99, 16384
    s_cbranch_scc1 m2_x12_out
    s_waitcnt vmcnt(48)
    s_mov_b32 s17, 931840
    buffer_load_dwordx4 v[112:115], v4, s[32:35], s17 offen sc1
    buffer_load_dwordx4 v[116:119], v8, s[32:35], s17 offen sc1
    s_mov_b32 s17, 0
    buffer_load_dwordx4 v[168:171], v4, s[32:35], s17 offen sc1
    buffer_load_dwordx4 v[172:175], v8, s[32:35], s17 offen sc1
    s_mov_b32 s17, 798720
    buffer_load_dwordx4 v[120:123], v4, s[32:35], s17 offen sc1
    buffer_load_dwordx4 v[124:127], v8, s[32:35], s17 offen sc1
    s_mov_b32 s17, 665600
    buffer_load_dwordx4 v[128:131], v4, s[32:35], s17 offen sc1
    buffer_load_dwordx4 v[132:135], v8, s[32:35], s17 offen sc1
    s_mov_b32 s17, 532480
    buffer_load_dwordx4 v[136:139], v4, s[32:35], s17 offen sc1
    buffer_load_dwordx4 v[140:143], v8, s[32:35], s17 offen sc1
    s_mov_b32 s17, 399360
    buffer_load_dwordx4 v[144:147], v4, s[32:35], s17 offen sc1
    buffer_load_dwordx4 v[148:151], v8, s[32:35], s17 offen sc1
    s_mov_b32 s17, 266240
    buffer_load_dwordx4 v[152:155], v4, s[32:35], s17 offen sc1
    buffer_load_dwordx4 v[156:159], v8, s[32:35], s17 offen sc1
    s_waitcnt vmcnt(12)
    v_min_f32_e64 v9, |v112|, |v116|
    v_cmp_gt_f32 vcc, 0x3c800000, v9
    s_nop 3
    s_cbranch_vccnz m2_x12_again
m2_x12_out:
    s_branch m2_x12_ok
m2_x13_again:
    s_nop 7
    s_add_u32 s99, s99, 1
    s_cmp_ge_u32 s99, 16384
    s_cbranch_scc1 m2_x13_out
    s_waitcnt vmcnt(48)
    s_mov_b32 s17, 0
    buffer_load_dwordx4 v[168:171], v4, s[32:35], s17 offen sc1
    buffer_load_dwordx4 v[172:175], v8, s[32:35], s17 offen sc1
    s_mov_b32 s17, 798720
    buffer_load_dwordx4 v[120:123], v4, s[32:35], s17 offen sc1
    buffer_load_dwordx4 v[124:127], v8, s[32:35], s17 offen sc1
    s_mov_b32 s17, 665600
    buffer_load_dwordx4 v[128:131], v4, s[32:35], s17 offen sc1
    buffer_load_dwordx4 v[132:135], v8, s[32:35], s17 offen sc1
    s_mov_b32 s17, 532480
    buffer_load_dwordx4 v[136:139], v4, s[32:35], s17 offen sc1
    buffer_load_dwordx4 v[140:143], v8, s[32:35], s17 offen sc1
    s_mov_b32 s17, 399360
    buffer_load_dwordx4 v[144:147], v4, s[32:35], s17 offen sc1
    buffer_load_dwordx4 v[148:151], v8, s[32:35], s17 offen sc1
    s_mov_b32 s17, 266240
    buffer_load_dwordx4 v[152:155], v4, s[32:35], s17 offen sc1
    buffer_load_dwordx4 v[156:159], v8, s[32:35], s17 offen sc1
    s_mov_b32 s17, 133120
    buffer_load_dwordx4 v[160:163], v4, s[32:35], s17 offen sc1
    buffer_load_dwordx4 v[164:167], v8, s[32:35], s17 offen sc1
    s_waitcnt vmcnt(10)
    v_min3_f32 v9, |v168|, |v172|, |v120|
    v_min_f32_e64 v9, v9, |v124|
    v_cmp_gt_f32 vcc, 0x3c800000, v9
    s_nop 3
    s_cbranch_vccnz m2_x13_again
m2_x13_out:
    s_branch m2_x13_ok
m2_x14_again:
    s_nop 7
    s_add_u32 s99, s99, 1
    s_cmp_ge_u32 s99, 16384
    s_cbranch_scc1 m2_x14_out
    s_waitcnt vmcnt(52)
    s_mov_b32 s17, 665600
    buffer_load_dwordx4 v[128:131], v4, s[32:35], s17 offen sc1
    buffer_load_dwordx4 v[132:135], v8, s[32:35], s17 offen sc1
    s_mov_b32 s17, 532480
    buffer_load_dwordx4 v[136:139], v4, s[32:35], s17 offen sc1
    buffer_load_dwordx4 v[140:143], v8, s[32:35], s17 offen sc1
    s_mov_b32 s17, 399360
    buffer_load_dwordx4 v[144:147], v4, s[32:35], s17 offen sc1
    buffer_load_dwordx4 v[148:151], v8, s[32:35], s17 offen sc1
    s_mov_b32 s17, 266240
    buffer_load_dwordx4 v[152:155], v4, s[32:35], s17 offen sc1
    buffer_load_dwordx4 v[156:159], v8, s[32:35], s17 offen sc1
    s_mov_b32 s17, 133120
    buffer_load_dwordx4 v[160:163], v4, s[32:35], s17 offen sc1
    buffer_load_dwordx4 v[164:167], v8, s[32:35], s17 offen sc1
    s_waitcnt vmcnt(8)
    v_min_f32_e64 v9, |v128|, |v132|
    v_cmp_gt_f32 vcc, 0x3c800000, v9
    s_nop 3
    s_cbranch_vccnz m2_x14_again
m2_x14_out:
    s_branch m2_x14_ok
m2_x15_again:
    s_nop 7
    s_add_u32 s99, s99, 1
    s_cmp_ge_u32 s99, 16384
    s_cbranch_scc1 m2_x15_out
    s_waitcnt vmcnt(54)
    s_mov_b32 s17, 532480
    buffer_load_dwordx4 v[136:139], v4, s[32:35], s17 offen sc1
    buffer_load_dwordx4 v[140:143], v8, s[32:35], s17 offen sc1
    s_mov_b32 s17, 399360
    buffer_load_dwordx4 v[144:147], v4, s[32:35], s17 offen sc1
    buffer_load_dwordx4 v[148:151], v8, s[32:35], s17 offen sc1
    s_mov_b32 s17, 266240
    buffer_load_dwordx4 v[152:155], v4, s[32:35], s17 offen sc1
    buffer_load_dwordx4 v[156:159], v8, s[32:35], s17 offen sc1
    s_mov_b32 s17, 133120
    buffer_load_dwordx4 v[160:163], v4, s[32:35], s17 offen sc1
    buffer_load_dwordx4 v[164:167], v8, s[32:35], s17 offen sc1
    s_waitcnt vmcnt(6)
    v_min_f32_e64 v9, |v136|, |v140|
    v_cmp_gt_f32 vcc, 0x3c800000, v9
    s_nop 3
    s_cbranch_vccnz m2_x15_again
m2_x15_out:
    s_branch m2_x15_ok
m2_x16_again:
    s_nop 7
    s_add_u32 s99, s99, 1
    s_cmp_ge_u32 s99, 16384
    s_cbranch_scc1 m2_x16_out
    s_waitcnt vmcnt(56)
    s_mov_b32 s17, 399360
    buffer_load_dwordx4 v[144:147], v4, s[32:35], s17 offen sc1
    buffer_load_dwordx4 v[148:151], v8, s[32:35], s17 offen sc1
    s_mov_b32 s17, 266240
    buffer_load_dwordx4 v[152:155], v4, s[32:35], s17 offen sc1
    buffer_load_dwordx4 v[156:159], v8, s[32:35], s17 offen sc1
    s_mov_b32 s17, 133120
    buffer_load_dwordx4 v[160:163], v4, s[32:35], s17 offen sc1
    buffer_load_dwordx4 v[164:167], v8, s[32:35], s17 offen sc1
    s_waitcnt vmcnt(2)
    v_min3_f32 v9, |v144|, |v148|, |v152|
    v_min_f32_e64 v9, v9, |v156|
    v_cmp_gt_f32 vcc, 0x3c800000, v9
    s_nop 3
    s_cbranch_vccnz m2_x16_again
m2_x16_out:
    s_branch m2_x16_ok
m2_x18_again:
    s_nop 7
    s_add_u32 s99, s99, 1
    s_cmp_ge_u32 s99, 16384
    s_cbranch_scc1 m2_x18_out
    s_waitcnt vmcnt(60)
    s_mov_b32 s17, 133120
    buffer_load_dwordx4 v[160:163], v4, s[32:35], s17 offen sc1
    buffer_load_dwordx4 v[164:167], v8, s[32:35], s17 offen sc1
    s_waitcnt vmcnt(0)
    v_min_f32_e64 v9, |v160|, |v164|
    v_cmp_gt_f32 vcc, 0x3c800000, v9
    s_nop 3
    s_cbranch_vccnz m2_x18_again
m2_x18_out:
    s_branch m2_x18_ok
m2_q0_again:
    s_nop 7
    s_add_u32 s99, s99, 1
    s_cmp_ge_u32 s99, 16384
    s_cbranch_scc1 m2_q0_out
    s_waitcnt vmcnt(39)
    s_mov_b32 s17, 0
    buffer_load_dwordx4 v[16:19], v13, s[8:11], s17 offen sc1
    buffer_load_dwordx4 v[20:23], v4, s[8:11], s17 offen sc1
    buffer_load_dwordx4 v[24:27], v8, s[8:11], s17 offen sc1
    buffer_load_dwordx4 v[28:31], v10, s[8:11], s17 offen sc1
    s_mov_b32 s17, 946176
    buffer_load_dwordx4 v[32:35], v13, s[8:11], s17 offen sc1
    buffer_load_dwordx4 v[36:39], v4, s[8:11], s17 offen sc1
    buffer_load_dwordx4 v[40:43], v8, s[8:11], s17 offen sc1
    buffer_load_dwordx4 v[44:47], v10, s[8:11], s17 offen sc1
    s_mov_b32 s17, 67584
    buffer_load_dwordx4 v[48:51], v13, s[8:11], s17 offen sc1
    buffer_load_dwordx4 v[52:55], v4, s[8:11], s17 offen sc1
    buffer_load_dword a253, off, s[52:55], 0
    buffer_load_dwordx4 v[56:59], v8, s[8:11], s17 offen sc1
    buffer_load_dwordx4 v[60:63], v10, s[8:11], s17 offen sc1
    s_mov_b32 s17, 1013760
    buffer_load_dwordx4 v[64:67], v13, s[8:11], s17 offen sc1
    buffer_load_dwordx4 v[68:71], v4, s[8:11], s17 offen sc1
    buffer_load_dwordx4 v[72:75], v8, s[8:11], s17 offen sc1
    buffer_load_dwordx4 v[76:79], v10, s[8:11], s17 offen sc1
    s_mov_b32 s17, 135168
    buffer_load_dwordx4 v[80:83], v13, s[8:11], s17 offen sc1
    buffer_load_dwordx4 v[84:87], v4, s[8:11], s17 offen sc1
    buffer_load_dword a253, off, s[52:55], 0
    buffer_load_dwordx4 v[88:91], v8, s[8:11], s17 offen sc1
    buffer_load_dwordx4 v[92:95], v10, s[8:11], s17 offen sc1
    buffer_load_dword a253, off, s[52:55], 0
    s_waitcnt vmcnt(21)
    v_min_f32_e64 v9, |v16|, |v20|
    v_cmp_gt_f32 vcc, 0x24800000, v9
    s_nop 3
    s_cbranch_vccnz m2_q0_again
m2_q0_out:
    s_branch m2_q0_ok
m2_q1_again:
    s_nop 7
    s_add_u32 s99, s99, 1
    s_cmp_ge_u32 s99, 16384
    s_cbranch_scc1 m2_q1_out
    s_waitcnt vmcnt(41)
    s_mov_b32 s17, 0
    buffer_load_dwordx4 v[24:27], v8, s[8:11], s17 offen sc1
    buffer_load_dwordx4 v[28:31], v10, s[8:11], s17 offen sc1
    s_mov_b32 s17, 946176
    buffer_load_dwordx4 v[32:35], v13, s[8:11], s17 offen sc1
    buffer_load_dwordx4 v[36:39], v4, s[8:11], s17 offen sc1
    buffer_load_dwordx4 v[40:43], v8, s[8:11], s17 offen sc1
    buffer_load_dwordx4 v[44:47], v10, s[8:11], s17 offen sc1
    s_mov_b32 s17, 67584
    buffer_load_dwordx4 v[48:51], v13, s[8:11], s17 offen sc1
    buffer_load_dwordx4 v[52:55], v4, s[8:11], s17 offen sc1
    buffer_load_dword a253, off, s[52:55], 0
    buffer_load_dwordx4 v[56:59], v8, s[8:11], s17 offen sc1
    buffer_load_dwordx4 v[60:63], v10, s[8:11], s17 offen sc1
    s_mov_b32 s17, 1013760
    buffer_load_dwordx4 v[64:67], v13, s[8:11], s17 offen sc1
    buffer_load_dwordx4 v[68:71], v4, s[8:11], s17 offen sc1
    buffer_load_dwordx4 v[72:75], v8, s[8:11], s17 offen sc1
    buffer_load_dwordx4 v[76:79], v10, s[8:11], s17 offen sc1
    s_mov_b32 s17, 135168
    buffer_load_dwordx4 v[80:83], v13, s[8:11], s17 offen sc1
    buffer_load_dwordx4 v[84:87], v4, s[8:11], s17 offen sc1
    buffer_load_dword a253, off, s[52:55], 0
    buffer_load_dwordx4 v[88:91], v8, s[8:11], s17 offen sc1
    buffer_load_dwordx4 v[92:95], v10, s[8:11], s17 offen sc1
    buffer_load_dword a253, off, s[52:55], 0
    s_waitcnt vmcnt(19)
    v_min_f32_e64 v9, |v24|, |v28|
    v_cmp_gt_f32 vcc, 0x24800000, v9
    s_nop 3
    s_cbranch_vccnz m2_q1_again
m2_q1_out:
    s_branch m2_q1_ok
m2_q2_again:
    s_nop 7
    s_add_u32 s99, s99, 1
    s_cmp_ge_u32 s99, 16384
    s_cbranch_scc1 m2_q2_out
    s_waitcnt vmcnt(40)
    s_mov_b32 s17, 946176
    buffer_load_dwordx4 v[32:35], v13, s[8:11], s17 offen sc1
    buffer_load_dwordx4 v[36:39], v4, s[8:11], s17 offen sc1
    buffer_load_dwordx4 v[40:43], v8, s[8:11], s17 offen sc1
    buffer_load_dwordx4 v[44:47], v10, s[8:11], s17 offen sc1
    s_mov_b32 s17, 67584
    buffer_load_dwordx4 v[48:51], v13, s[8:11], s17 offen sc1
    buffer_load_dwordx4 v[52:55], v4, s[8:11], s17 offen sc1
    buffer_load_dword a253, off, s[52:55], 0
    buffer_load_dwordx4 v[56:59], v8, s[8:11], s17 offen sc1
    buffer_load_dwordx4 v[60:63], v10, s[8:11], s17 offen sc1
    s_mov_b32 s17, 1013760
    buffer_load_dwordx4 v[64:67], v13, s[8:11], s17 offen sc1
    buffer_load_dwordx4 v[68:71], v4, s[8:11], s17 offen sc1
    buffer_load_dwordx4 v[72:75], v8, s[8:11], s17 offen sc1
    buffer_load_dwordx4 v[76:79], v10, s[8:11], s17 offen sc1
    s_mov_b32 s17, 135168
    buffer_load_dwordx4 v[80:83], v13, s[8:11], s17 offen sc1
    buffer_load_dwordx4 v[84:87], v4, s[8:11], s17 offen sc1
    buffer_load_dword a253, off, s[52:55], 0
    buffer_load_dwordx4 v[88:91], v8, s[8:11], s17 offen sc1
    buffer_load_dwordx4 v[92:95], v10, s[8:11], s17 offen sc1
    buffer_load_dword a253, off, s[52:55], 0
    buffer_load_dword a253, off, s[52:55], 0
    buffer_load_dword a253, off, s[52:55], 0
    buffer_load_dword a253, off, s[52:55], 0
    s_waitcnt vmcnt(18)
    v_min3_f32 v9, |v32|, |v36|, |v40|
    v_min_f32_e64 v9, v9, |v44|
    v_cmp_gt_f32 vcc, 0x24800000, v9
    s_nop 3
    s_cbranch_vccnz m2_q2_again
m2_q2_out:
    s_branch m2_q2_ok
m2_q3_again:
    s_nop 7
    s_add_u32 s99, s99, 1
    s_cmp_ge_u32 s99, 16384
    s_cbranch_scc1 m2_q3_out
    s_waitcnt vmcnt(35)
    s_mov_b32 s17, 67584
    buffer_load_dwordx4 v[48:51], v13, s[8:11], s17 offen sc1
    buffer_load_dwordx4 v[52:55], v4, s[8:11], s17 offen sc1
    buffer_load_dword a253, off, s[52:55], 0
    buffer_load_dwordx4 v[56:59], v8, s[8:11], s17 offen sc1
    buffer_load_dwordx4 v[60:63], v10, s[8:11], s17 offen sc1
    s_mov_b32 s17, 1013760
    buffer_load_dwordx4 v[64:67], v13, s[8:11], s17 offen sc1
    buffer_load_dwordx4 v[68:71], v4, s[8:11], s17 offen sc1
    buffer_load_dwordx4 v[72:75], v8, s[8:11], s17 offen sc1
    buffer_load_dwordx4 v[76:79], v10, s[8:11], s17 offen sc1
    s_mov_b32 s17, 135168
    buffer_load_dwordx4 v[80:83], v13, s[8:11], s17 offen sc1
    buffer_load_dwordx4 v[84:87], v4, s[8:11], s17 offen sc1
    buffer_load_dword a253, off, s[52:55], 0
    buffer_load_dwordx4 v[88:91], v8, s[8:11], s17 offen sc1
    buffer_load_dwordx4 v[92:95], v10, s[8:11], s17 offen sc1
    buffer_load_dword a253, off, s[52:55], 0
    buffer_load_dword a253, off, s[52:55], 0
    buffer_load_dword a253, off, s[52:55], 0
    buffer_load_dword a253, off, s[52:55], 0
    s_mov_b32 s17, 1081344
    buffer_load_dwordx4 v[176:179], v13, s[8:11], s17 offen sc1
    buffer_load_dwordx4 v[180:183], v4, s[8:11], s17 offen sc1
    buffer_load_dwordx4 v[184:187], v8, s[8:11], s17 offen sc1
    buffer_load_dwordx4 v[188:191], v10, s[8:11], s17 offen sc1
    s_mov_b32 s17, 202752
    buffer_load_dwordx4 v[16:19], v13, s[8:11], s17 offen sc1
    buffer_load_dwordx4 v[20:23], v4, s[8:11], s17 offen sc1
    buffer_load_dwordx4 v[24:27], v8, s[8:11], s17 offen sc1
    buffer_load_dwordx4 v[28:31], v10, s[8:11], s17 offen sc1
    s_mov_b32 s17, 1148928
    buffer_load_dwordx4 v[32:35], v13, s[8:11], s17 offen sc1
    s_waitcnt vmcnt(22)
    v_min3_f32 v9, |v48|, |v52|, |v56|
    v_min_f32_e64 v9, v9, |v60|
    v_cmp_gt_f32 vcc, 0x24800000, v9
    s_nop 3
    s_cbranch_vccnz m2_q3_again
m2_q3_out:
    s_branch m2_q3_ok
m2_q4_again:
    s_nop 7
    s_add_u32 s99, s99, 1
    s_cmp_ge_u32 s99, 16384
    s_cbranch_scc1 m2_q4_out
    s_waitcnt vmcnt(39)
    s_mov_b32 s17, 1013760
    buffer_load_dwordx4 v[64:67], v13, s[8:11], s17 offen sc1
    buffer_load_dwordx4 v[68:71], v4, s[8:11], s17 offen sc1
    buffer_load_dwordx4 v[72:75], v8, s[8:11], s17 offen sc1
    buffer_load_dwordx4 v[76:79], v10, s[8:11], s17 offen sc1
    s_mov_b32 s17, 135168
    buffer_load_dwordx4 v[80:83], v13, s[8:11], s17 offen sc1
    buffer_load_dwordx4 v[84:87], v4, s[8:11], s17 offen sc1
    buffer_load_dword a253, off, s[52:55], 0
    buffer_load_dwordx4 v[88:91], v8, s[8:11], s17 offen sc1
    buffer_load_dwordx4 v[92:95], v10, s[8:11], s17 offen sc1
    buffer_load_dword a253, off, s[52:55], 0
    buffer_load_dword a253, off, s[52:55], 0
    buffer_load_dword a253, off, s[52:55], 0
    buffer_load_dword a253, off, s[52:55], 0
    s_mov_b32 s17, 1081344
    buffer_load_dwordx4 v[176:179], v13, s[8:11], s17 offen sc1
    buffer_load_dwordx4 v[180:183], v4, s[8:11], s17 offen sc1
    buffer_load_dwordx4 v[184:187], v8, s[8:11], s17 offen sc1
    buffer_load_dwordx4 v[188:191], v10, s[8:11], s17 offen sc1
    s_mov_b32 s17, 202752
    buffer_load_dwordx4 v[16:19], v13, s[8:11], s17 offen sc1
    buffer_load_dwordx4 v[20:23], v4, s[8:11], s17 offen sc1
    buffer_load_dwordx4 v[24:27], v8, s[8:11], s17 offen sc1
    buffer_load_dwordx4 v[28:31], v10, s[8:11], s17 offen sc1
    s_mov_b32 s17, 1148928
    buffer_load_dwordx4 v[32:35], v13, s[8:11], s17 offen sc1
    s_mov_b32 s17, 409600
    buffer_load_dwordx4 a[52:55], v15, s[52:55], s17 offen offset:0
    s_waitcnt vmcnt(19)
    v_min3_f32 v9, |v64|, |v68|, |v72|
    v_min_f32_e64 v9, v9, |v76|
    v_cmp_gt_f32 vcc, 0x24800000, v9
    s_nop 3
    s_cbranch_vccnz m2_q4_again
m2_q4_out:
    s_branch m2_q4_ok
m2_q5_again:
    s_nop 7
    s_add_u32 s99, s99, 1
    s_cmp_ge_u32 s99, 16384
    s_cbranch_scc1 m2_q5_out
    s_waitcnt vmcnt(38)
    s_mov_b32 s17, 135168
    buffer_load_dwordx4 v[80:83], v13, s[8:11], s17 offen sc1
    buffer_load_dwordx4 v[84:87], v4, s[8:11], s17 offen sc1
    buffer_load_dword a253, off, s[52:55], 0
    buffer_load_dwordx4 v[88:91], v8, s[8:11], s17 offen sc1
    buffer_load_dwordx4 v[92:95], v10, s[8:11], s17 offen sc1
    buffer_load_dword a253, off, s[52:55], 0
    buffer_load_dword a253, off, s[52:55], 0
    buffer_load_dword a253, off, s[52:55], 0
    buffer_load_dword a253, off, s[52:55], 0
    s_mov_b32 s17, 1081344
    buffer_load_dwordx4 v[176:179], v13, s[8:11], s17 offen sc1
    buffer_load_dwordx4 v[180:183], v4, s[8:11], s17 offen sc1
    buffer_load_dwordx4 v[184:187], v8, s[8:11], s17 offen sc1
    buffer_load_dwordx4 v[188:191], v10, s[8:11], s17 offen sc1
    s_mov_b32 s17, 202752
    buffer_load_dwordx4 v[16:19], v13, s[8:11], s17 offen sc1
    buffer_load_dwordx4 v[20:23], v4, s[8:11], s17 offen sc1
    buffer_load_dwordx4 v[24:27], v8, s[8:11], s17 offen sc1
    buffer_load_dwordx4 v[28:31], v10, s[8:11], s17 offen sc1
    s_mov_b32 s17, 1148928
    buffer_load_dwordx4 v[32:35], v13, s[8:11], s17 offen sc1
    s_mov_b32 s17, 409600
    buffer_load_dwordx4 a[52:55], v15, s[52:55], s17 offen offset:0
    buffer_load_dword a253, off, s[52:55], 0
    buffer_load_dwordx4 a[56:59], v15, s[52:55], s17 offen offset:256
    buffer_load_dwordx4 a[60:63], v15, s[52:55], s17 offen offset:512
    buffer_load_dwordx4 a[64:67], v15, s[52:55], s17 offen offset:768
    buffer_load_dwordx4 a[68:71], v15, s[52:55], s17 offen offset:1024
    s_waitcnt vmcnt(19)
    v_min3_f32 v9, |v80|, |v84|, |v88|
    v_min_f32_e64 v9, v9, |v92|
    v_cmp_gt_f32 vcc, 0x24800000, v9
    s_nop 3
    s_cbranch_vccnz m2_q5_again
m2_q5_out:
    s_branch m2_q5_ok
m2_q6_again:
    s_nop 7
    s_add_u32 s99, s99, 1
    s_cmp_ge_u32 s99, 16384
    s_cbranch_scc1 m2_q6_out
    s_waitcnt vmcnt(43)
    s_mov_b32 s17, 1081344
    buffer_load_dwordx4 v[176:179], v13, s[8:11], s17 offen sc1
    buffer_load_dwordx4 v[180:183], v4, s[8:11], s17 offen sc1
    buffer_load_dwordx4 v[184:187], v8, s[8:11], s17 offen sc1
    buffer_load_dwordx4 v[188:191], v10, s[8:11], s17 offen sc1
    s_mov_b32 s17, 202752
    buffer_load_dwordx4 v[16:19], v13, s[8:11], s17 offen sc1
    buffer_load_dwordx4 v[20:23], v4, s[8:11], s17 offen sc1
    buffer_load_dwordx4 v[24:27], v8, s[8:11], s17 offen sc1
    buffer_load_dwordx4 v[28:31], v10, s[8:11], s17 offen sc1
    s_mov_b32 s17, 1148928
    buffer_load_dwordx4 v[32:35], v13, s[8:11], s17 offen sc1
    s_mov_b32 s17, 409600
    buffer_load_dwordx4 a[52:55], v15, s[52:55], s17 offen offset:0
    buffer_load_dword a253, off, s[52:55], 0
    buffer_load_dwordx4 a[56:59], v15, s[52:55], s17 offen offset:256
    buffer_load_dwordx4 a[60:63], v15, s[52:55], s17 offen offset:512
    buffer_load_dwordx4 a[64:67], v15, s[52:55], s17 offen offset:768
    buffer_load_dwordx4 a[68:71], v15, s[52:55], s17 offen offset:1024
    s_mov_b32 s17, 1148928
    buffer_load_dwordx4 v[36:39], v4, s[8:11], s17 offen sc1
    buffer_load_dwordx4 v[40:43], v8, s[8:11], s17 offen sc1
    buffer_load_dwordx4 v[44:47], v10, s[8:11], s17 offen sc1
    s_mov_b32 s17, 270336
    buffer_load_dwordx4 v[48:51], v13, s[8:11], s17 offen sc1
    s_waitcnt vmcnt(15)
    v_min3_f32 v9, |v176|, |v180|, |v184|
    v_min_f32_e64 v9, v9, |v188|
    v_cmp_gt_f32 vcc, 0x24800000, v9
    s_nop 3
    s_cbranch_vccnz m2_q6_again
m2_q6_out:
    s_branch m2_q6_ok
m2_q7_again:
    s_nop 7
    s_add_u32 s99, s99, 1
    s_cmp_ge_u32 s99, 16384
    s_cbranch_scc1 m2_q7_out
    s_waitcnt vmcnt(42)
    s_mov_b32 s17, 202752
    buffer_load_dwordx4 v[16:19], v13, s[8:11], s17 offen sc1
    buffer_load_dwordx4 v[20:23], v4, s[8:11], s17 offen sc1
    buffer_load_dwordx4 v[24:27], v8, s[8:11], s17 offen sc1
    buffer_load_dwordx4 v[28:31], v10, s[8:11], s17 offen sc1
    s_mov_b32 s17, 1148928
    buffer_load_dwordx4 v[32:35], v13, s[8:11], s17 offen sc1
    s_mov_b32 s17, 409600
    buffer_load_dwordx4 a[52:55], v15, s[52:55], s17 offen offset:0
    buffer_load_dword a253, off, s[52:55], 0
    buffer_load_dwordx4 a[56:59], v15, s[52:55], s17 offen offset:256
    buffer_load_dwordx4 a[60:63], v15, s[52:55], s17 offen offset:512
    buffer_load_dwordx4 a[64:67], v15, s[52:55], s17 offen offset:768
    buffer_load_dwordx4 a[68:71], v15, s[52:55], s17 offen offset:1024
    s_mov_b32 s17, 1148928
    buffer_load_dwordx4 v[36:39], v4, s[8:11], s17 offen sc1
    buffer_load_dwordx4 v[40:43], v8, s[8:11], s17 offen sc1
    buffer_load_dwordx4 v[44:47], v10, s[8:11], s17 offen sc1
    s_mov_b32 s17, 270336
    buffer_load_dwordx4 v[48:51], v13, s[8:11], s17 offen sc1
    buffer_load_dwordx4 v[52:55], v4, s[8:11], s17 offen sc1
    buffer_load_dwordx4 v[56:59], v8, s[8:11], s17 offen sc1
    buffer_load_dwordx4 v[60:63], v10, s[8:11], s17 offen sc1
    s_mov_b32 s17, 1216512
    buffer_load_dwordx4 v[64:67], v13, s[8:11], s17 offen sc1
    buffer_load_dwordx4 v[68:71], v4, s[8:11], s17 offen sc1
    s_waitcnt vmcnt(16)
    v_min3_f32 v9, |v16|, |v20|, |v24|
    v_min_f32_e64 v9, v9, |v28|
    v_cmp_gt_f32 vcc, 0x24800000, v9
    s_nop 3
    s_cbranch_vccnz m2_q7_again
m2_q7_out:
    s_branch m2_q7_ok
m2_q8_again:
    s_nop 7
    s_add_u32 s99, s99, 1
    s_cmp_ge_u32 s99, 16384
    s_cbranch_scc1 m2_q8_out
    s_waitcnt vmcnt(41)
    s_mov_b32 s17, 1148928
    buffer_load_dwordx4 v[32:35], v13, s[8:11], s17 offen sc1
    s_mov_b32 s17, 409600
    buffer_load_dwordx4 a[52:55], v15, s[52:55], s17 offen offset:0
    buffer_load_dword a253, off, s[52:55], 0
    buffer_load_dwordx4 a[56:59], v15, s[52:55], s17 offen offset:256
    buffer_load_dwordx4 a[60:63], v15, s[52:55], s17 offen offset:512
    buffer_load_dwordx4 a[64:67], v15, s[52:55], s17 offen offset:768
    buffer_load_dwordx4 a[68:71], v15, s[52:55], s17 offen offset:1024
    s_mov_b32 s17, 1148928
    buffer_load_dwordx4 v[36:39], v4, s[8:11], s17 offen sc1
    buffer_load_dwordx4 v[40:43], v8, s[8:11], s17 offen sc1
    buffer_load_dwordx4 v[44:47], v10, s[8:11], s17 offen sc1
    s_mov_b32 s17, 270336
    buffer_load_dwordx4 v[48:51], v13, s[8:11], s17 offen sc1
    buffer_load_dwordx4 v[52:55], v4, s[8:11], s17 offen sc1
    buffer_load_dwordx4 v[56:59], v8, s[8:11], s17 offen sc1
    buffer_load_dwordx4 v[60:63], v10, s[8:11], s17 offen sc1
    s_mov_b32 s17, 1216512
    buffer_load_dwordx4 v[64:67], v13, s[8:11], s17 offen sc1
    buffer_load_dwordx4 v[68:71], v4, s[8:11], s17 offen sc1
    buffer_load_dwordx4 v[72:75], v8, s[8:11], s17 offen sc1
    buffer_load_dword a253, off, s[52:55], 0
    buffer_load_dwordx4 v[76:79], v10, s[8:11], s17 offen sc1
    s_mov_b32 s17, 337920
    buffer_load_dwordx4 v[80:83], v13, s[8:11], s17 offen sc1
    buffer_load_dwordx4 v[84:87], v4, s[8:11], s17 offen sc1
    s_waitcnt vmcnt(11)
    v_min3_f32 v9, |v32|, |v36|, |v40|
    v_min_f32_e64 v9, v9, |v44|
    v_cmp_gt_f32 vcc, 0x24800000, v9
    s_nop 3
    s_cbranch_vccnz m2_q8_again
m2_q8_out:
    s_branch m2_q8_ok
m2_q9_again:
    s_nop 7
    s_add_u32 s99, s99, 1
    s_cmp_ge_u32 s99, 16384
    s_cbranch_scc1 m2_q9_out
    s_waitcnt vmcnt(45)
    s_mov_b32 s17, 270336
    buffer_load_dwordx4 v[48:51], v13, s[8:11], s17 offen sc1
    buffer_load_dwordx4 v[52:55], v4, s[8:11], s17 offen sc1
    buffer_load_dwordx4 v[56:59], v8, s[8:11], s17 offen sc1
    buffer_load_dwordx4 v[60:63], v10, s[8:11], s17 offen sc1
    s_mov_b32 s17, 1216512
    buffer_load_dwordx4 v[64:67], v13, s[8:11], s17 offen sc1
    buffer_load_dwordx4 v[68:71], v4, s[8:11], s17 offen sc1
    buffer_load_dwordx4 v[72:75], v8, s[8:11], s17 offen sc1
    buffer_load_dword a253, off, s[52:55], 0
    buffer_load_dwordx4 v[76:79], v10, s[8:11], s17 offen sc1
    s_mov_b32 s17, 337920
    buffer_load_dwordx4 v[80:83], v13, s[8:11], s17 offen sc1
    buffer_load_dwordx4 v[84:87], v4, s[8:11], s17 offen sc1
    buffer_load_dwordx4 v[88:91], v8, s[8:11], s17 offen sc1
    buffer_load_dwordx4 v[92:95], v10, s[8:11], s17 offen sc1
    s_mov_b32 s17, 1284096
    buffer_load_dwordx4 v[180:183], v4, s[8:11], s17 offen sc1
    s_mov_b32 s17, 405504
    buffer_load_dwordx4 v[20:23], v4, s[8:11], s17 offen sc1
    s_mov_b32 s17, 1351680
    buffer_load_dwordx4 v[36:39], v4, s[8:11], s17 offen sc1
    s_mov_b32 s17, 1284096
    buffer_load_dwordx4 v[184:187], v8, s[8:11], s17 offen sc1
    s_waitcnt vmcnt(13)
    v_min3_f32 v9, |v48|, |v52|, |v56|
    v_min_f32_e64 v9, v9, |v60|
    v_cmp_gt_f32 vcc, 0x24800000, v9
    s_nop 3
    s_cbranch_vccnz m2_q9_again
m2_q9_out:
    s_branch m2_q9_ok
m2_rgo_spin:
    s_mov_b32 s17, 0
    buffer_load_dword v249, v14, s[12:15], s17 offen sc1
    s_waitcnt vmcnt(0)
    s_add_u32 s99, s99, 1
    s_cmp_ge_u32 s99, 16384
    s_cbranch_scc1 m2_rgo_ok
    v_cmp_eq_u32 vcc, 0, v249
    s_nop 3
    s_cbranch_vccnz m2_rgo_spin
    s_branch m2_rgo_ok
m2_q10_again:
    s_nop 7
    s_add_u32 s99, s99, 1
    s_cmp_ge_u32 s99, 16384
    s_cbranch_scc1 m2_q10_out
    s_waitcnt vmcnt(44)
    s_mov_b32 s17, 1216512
    buffer_load_dwordx4 v[64:67], v13, s[8:11], s17 offen sc1
    buffer_load_dwordx4 v[68:71], v4, s[8:11], s17 offen sc1
    buffer_load_dwordx4 v[72:75], v8, s[8:11], s17 offen sc1
    buffer_load_dword a253, off, s[52:55], 0
    buffer_load_dwordx4 v[76:79], v10, s[8:11], s17 offen sc1
    s_mov_b32 s17, 337920
    buffer_load_dwordx4 v[80:83], v13, s[8:11], s17 offen sc1
    buffer_load_dwordx4 v[84:87], v4, s[8:11], s17 offen sc1
    buffer_load_dwordx4 v[88:91], v8, s[8:11], s17 offen sc1
    buffer_load_dwordx4 v[92:95], v10, s[8:11], s17 offen sc1
    s_mov_b32 s17, 1284096
    buffer_load_dwordx4 v[180:183], v4, s[8:11], s17 offen sc1
    s_mov_b32 s17, 405504
    buffer_load_dwordx4 v[20:23], v4, s[8:11], s17 offen sc1
    s_mov_b32 s17, 1351680
    buffer_load_dwordx4 v[36:39], v4, s[8:11], s17 offen sc1
    s_mov_b32 s17, 1284096
    buffer_load_dwordx4 v[184:187], v8, s[8:11], s17 offen sc1
    s_mov_b32 s17, 405504
    buffer_load_dwordx4 v[24:27], v8, s[8:11], s17 offen sc1
    s_mov_b32 s17, 1351680
    buffer_load_dwordx4 v[40:43], v8, s[8:11], s17 offen sc1
    s_mov_b32 s17, 0
    buffer_load_dwordx2 v[208:209], v200, s[40:43], s17 offen sc1
    s_mov_b32 s17, 66560
    buffer_load_dwordx2 v[210:211], v200, s[40:43], s17 offen sc1
    s_mov_b32 s17, 133120
    buffer_load_dwordx2 v[212:213], v200, s[40:43], s17 offen sc1
    s_waitcnt vmcnt(13)
    v_min3_f32 v9, |v64|, |v68|, |v72|
    v_min_f32_e64 v9, v9, |v76|
    v_cmp_gt_f32 vcc, 0x24800000, v9
    s_nop 3
    s_cbranch_vccnz m2_q10_again
m2_q10_out:
    s_branch m2_q10_ok
m2_q11_again:
    s_nop 7
    s_add_u32 s99, s99, 1
    s_cmp_ge_u32 s99, 16384
    s_cbranch_scc1 m2_q11_out
    s_waitcnt vmcnt(44)
    s_mov_b32 s17, 337920
    buffer_load_dwordx4 v[80:83], v13, s[8:11], s17 offen sc1
    buffer_load_dwordx4 v[84:87], v4, s[8:11], s17 offen sc1
    buffer_load_dwordx4 v[88:91], v8, s[8:11], s17 offen sc1
    buffer_load_dwordx4 v[92:95], v10, s[8:11], s17 offen sc1
    s_mov_b32 s17, 1284096
    buffer_load_dwordx4 v[180:183], v4, s[8:11], s17 offen sc1
    s_mov_b32 s17, 405504
    buffer_load_dwordx4 v[20:23], v4, s[8:11], s17 offen sc1
    s_mov_b32 s17, 1351680
    buffer_load_dwordx4 v[36:39], v4, s[8:11], s17 offen sc1
    s_mov_b32 s17, 1284096
    buffer_load_dwordx4 v[184:187], v8, s[8:11], s17 offen sc1
    s_mov_b32 s17, 405504
    buffer_load_dwordx4 v[24:27], v8, s[8:11], s17 offen sc1
    s_mov_b32 s17, 1351680
    buffer_load_dwordx4 v[40:43], v8, s[8:11], s17 offen sc1
    s_mov_b32 s17, 0
    buffer_load_dwordx2 v[208:209], v200, s[40:43], s17 offen sc1
    s_mov_b32 s17, 66560
    buffer_load_dwordx2 v[210:211], v200, s[40:43], s17 offen sc1
    s_mov_b32 s17, 133120
    buffer_load_dwordx2 v[212:213], v200, s[40:43], s17 offen sc1
    s_mov_b32 s17, 199680
    buffer_load_dwordx2 v[214:215], v200, s[40:43], s17 offen sc1
    s_mov_b32 s17, 266240
    buffer_load_dwordx2 v[216:217], v200, s[40:43], s17 offen sc1
    s_mov_b32 s17, 1284096
    buffer_load_dwordx4 v[188:191], v10, s[8:11], s17 offen sc1
    s_mov_b32 s17, 405504
    buffer_load_dwordx4 v[28:31], v10, s[8:11], s17 offen sc1
    s_mov_b32 s17, 1351680
    buffer_load_dwordx4 v[44:47], v10, s[8:11], s17 offen sc1
    s_waitcnt vmcnt(14)
    v_min3_f32 v9, |v80|, |v84|, |v88|
    v_min_f32_e64 v9, v9, |v92|
    v_cmp_gt_f32 vcc, 0x24800000, v9
    s_nop 3
    s_cbranch_vccnz m2_q11_again
m2_q11_out:
    s_branch m2_q11_ok
m2_q12_again:
    s_nop 7
    s_add_u32 s99, s99, 1
    s_cmp_ge_u32 s99, 16384
    s_cbranch_scc1 m2_q12_out
    s_waitcnt vmcnt(45)
    s_mov_b32 s17, 1284096
    buffer_load_dwordx4 v[180:183], v4, s[8:11], s17 offen sc1
    s_mov_b32 s17, 405504
    buffer_load_dwordx4 v[20:23], v4, s[8:11], s17 offen sc1
    s_mov_b32 s17, 1351680
    buffer_load_dwordx4 v[36:39], v4, s[8:11], s17 offen sc1
    s_mov_b32 s17, 1284096
    buffer_load_dwordx4 v[184:187], v8, s[8:11], s17 offen sc1
    s_mov_b32 s17, 405504
    buffer_load_dwordx4 v[24:27], v8, s[8:11], s17 offen sc1
    s_mov_b32 s17, 1351680
    buffer_load_dwordx4 v[40:43], v8, s[8:11], s17 offen sc1
    s_mov_b32 s17, 0
    buffer_load_dwordx2 v[208:209], v200, s[40:43], s17 offen sc1
    s_mov_b32 s17, 66560
    buffer_load_dwordx2 v[210:211], v200, s[40:43], s17 offen sc1
    s_mov_b32 s17, 133120
    buffer_load_dwordx2 v[212:213], v200, s[40:43], s17 offen sc1
    s_mov_b32 s17, 199680
    buffer_load_dwordx2 v[214:215], v200, s[40:43], s17 offen sc1
    s_mov_b32 s17, 266240
    buffer_load_dwordx2 v[216:217], v200, s[40:43], s17 offen sc1
    s_mov_b32 s17, 1284096
    buffer_load_dwordx4 v[188:191], v10, s[8:11], s17 offen sc1
    s_mov_b32 s17, 405504
    buffer_load_dwordx4 v[28:31], v10, s[8:11], s17 offen sc1
    s_mov_b32 s17, 1351680
    buffer_load_dwordx4 v[44:47], v10, s[8:11], s17 offen sc1
    s_mov_b32 s17, 1284096
    buffer_load_dwordx4 v[176:179], v13, s[8:11], s17 offen sc1
    s_mov_b32 s17, 405504
    buffer_load_dwordx4 v[16:19], v13, s[8:11], s17 offen sc1
    s_mov_b32 s17, 1351680
    buffer_load_dwordx4 v[32:35], v13, s[8:11], s17 offen sc1
    s_waitcnt vmcnt(14)
    v_or_b32 v36, v36, v203
    v_min3_f32 v9, |v180|, |v20|, |v36|
    v_cmp_gt_f32 vcc, 0x24800000, v9
    s_nop 3
    s_cbranch_vccnz m2_q12_again
m2_q12_out:
    s_branch m2_q12_ok
m2_q13_again:
    s_nop 7
    s_add_u32 s99, s99, 1
    s_cmp_ge_u32 s99, 16384
    s_cbranch_scc1 m2_q13_out
    s_waitcnt vmcnt(48)
    s_mov_b32 s17, 1284096
    buffer_load_dwordx4 v[184:187], v8, s[8:11], s17 offen sc1
    s_mov_b32 s17, 405504
    buffer_load_dwordx4 v[24:27], v8, s[8:11], s17 offen sc1
    s_mov_b32 s17, 1351680
    buffer_load_dwordx4 v[40:43], v8, s[8:11], s17 offen sc1
    s_mov_b32 s17, 0
    buffer_load_dwordx2 v[208:209], v200, s[40:43], s17 offen sc1
    s_mov_b32 s17, 66560
    buffer_load_dwordx2 v[210:211], v200, s[40:43], s17 offen sc1
    s_mov_b32 s17, 133120
    buffer_load_dwordx2 v[212:213], v200, s[40:43], s17 offen sc1
    s_mov_b32 s17, 199680
    buffer_load_dwordx2 v[214:215], v200, s[40:43], s17 offen sc1
    s_mov_b32 s17, 266240
    buffer_load_dwordx2 v[216:217], v200, s[40:43], s17 offen sc1
    s_mov_b32 s17, 1284096
    buffer_load_dwordx4 v[188:191], v10, s[8:11], s17 offen sc1
    s_mov_b32 s17, 405504
    buffer_load_dwordx4 v[28:31], v10, s[8:11], s17 offen sc1
    s_mov_b32 s17, 1351680
    buffer_load_dwordx4 v[44:47], v10, s[8:11], s17 offen sc1
    s_mov_b32 s17, 1284096
    buffer_load_dwordx4 v[176:179], v13, s[8:11], s17 offen sc1
    s_mov_b32 s17, 405504
    buffer_load_dwordx4 v[16:19], v13, s[8:11], s17 offen sc1
    s_mov_b32 s17, 1351680
    buffer_load_dwordx4 v[32:35], v13, s[8:11], s17 offen sc1
    s_waitcnt vmcnt(11)
    v_or_b32 v40, v40, v203
    v_min3_f32 v9, |v184|, |v24|, |v40|
    v_cmp_gt_f32 vcc, 0x24800000, v9
    s_nop 3
    s_cbranch_vccnz m2_q13_again
m2_q13_out:
    s_branch m2_q13_ok
m2_q14_again:
    s_nop 7
    s_add_u32 s99, s99, 1
    s_cmp_ge_u32 s99, 16384
    s_cbranch_scc1 m2_q14_out
    s_waitcnt vmcnt(56)
    s_mov_b32 s17, 1284096
    buffer_load_dwordx4 v[188:191], v10, s[8:11], s17 offen sc1
    s_mov_b32 s17, 405504
    buffer_load_dwordx4 v[28:31], v10, s[8:11], s17 offen sc1
    s_mov_b32 s17, 1351680
    buffer_load_dwordx4 v[44:47], v10, s[8:11], s17 offen sc1
    s_mov_b32 s17, 1284096
    buffer_load_dwordx4 v[176:179], v13, s[8:11], s17 offen sc1
    s_mov_b32 s17, 405504
    buffer_load_dwordx4 v[16:19], v13, s[8:11], s17 offen sc1
    s_mov_b32 s17, 1351680
    buffer_load_dwordx4 v[32:35], v13, s[8:11], s17 offen sc1
    s_waitcnt vmcnt(3)
    v_or_b32 v44, v44, v203
    v_min3_f32 v9, |v188|, |v28|, |v44|
    v_cmp_gt_f32 vcc, 0x24800000, v9
    s_nop 3
    s_cbranch_vccnz m2_q14_again
m2_q14_out:
    s_branch m2_q14_ok
m2_q15_again:
    s_nop 7
    s_add_u32 s99, s99, 1
    s_cmp_ge_u32 s99, 16384
    s_cbranch_scc1 m2_q15_out
    s_waitcnt vmcnt(59)
    s_mov_b32 s17, 1284096
    buffer_load_dwordx4 v[176:179], v13, s[8:11], s17 offen sc1
    s_mov_b32 s17, 405504
    buffer_load_dwordx4 v[16:19], v13, s[8:11], s17 offen sc1
    s_mov_b32 s17, 1351680
    buffer_load_dwordx4 v[32:35], v13, s[8:11], s17 offen sc1
    s_waitcnt vmcnt(0)
    v_or_b32 v32, v32, v203
    v_min3_f32 v9, |v176|, |v16|, |v32|
    v_cmp_gt_f32 vcc, 0x24800000, v9
    s_nop 3
    s_cbranch_vccnz m2_q15_again
m2_q15_out:
    s_branch m2_q15_ok
n1_w2:
    s_mul_i32 s64, s56, 27
    v_min_u32 v14, 27, v3
    v_add_u32 v14, s64, v14
    v_sub_u32 v14, 252, v14
    v_lshlrev_b32 v14, 7, v14
    s_mov_b32 s64, 262144
    buffer_load_dword v14, v14, s[12:15], s64 offen sc1
    s_add_u32 s99, s99, 1
    s_cmp_ge_u32 s99, 16384
    s_cbranch_scc1 n1_w2out
    s_waitcnt vmcnt(0)
    v_cmp_eq_u32 vcc, 0, v14
    s_nop 3
    s_cbranch_vccnz n1_w2
n1_w2out:
    s_waitcnt vmcnt(0)
    s_branch n1_w2ok
n2_w2:
    s_mul_i32 s64, s56, 27
    v_min_u32 v14, 27, v3
    v_add_u32 v14, s64, v14
    v_sub_u32 v14, 252, v14
    v_lshlrev_b32 v14, 7, v14
    s_mov_b32 s64, 262148
    buffer_load_dword v14, v14, s[12:15], s64 offen sc1
    s_add_u32 s99, s99, 1
    s_cmp_ge_u32 s99, 16384
    s_cbranch_scc1 n2_w2out
    s_waitcnt vmcnt(0)
    v_cmp_eq_u32 vcc, 0, v14
    s_nop 3
    s_cbranch_vccnz n2_w2
n2_w2out:
    s_waitcnt vmcnt(0)
    s_branch n2_w2ok
mk_kernel_r1:
    s_endpgm
mk_kernel_cend:
text_last:
.section .rodata,"a"
.p2align 6
.amdhsa_kernel mk_kernel
  .amdhsa_next_free_vgpr 512
  .amdhsa_next_free_sgpr 102
  .amdhsa_accum_offset 256
  .amdhsa_group_segment_fixed_size 0
  .amdhsa_kernarg_size 88
  .amdhsa_user_sgpr_count 2
  .amdhsa_user_sgpr_kernarg_segment_ptr 1
  .amdhsa_system_sgpr_workgroup_id_x 1
.end_amdhsa_kernel
.set cq0, 15717
.set cq1, 15717
.set cq2, 15717
.set cq3, 15717
.set cq4, 15717
.set cq5, 15717
.set cq6, 15717
.set cq7, 15716
.set cq8, 15716
.set cq9, 15716
.set cq10, 15716
.set cq11, 15716
.set cq12, 15715
.set cq13, 15715
.set cq14, 15715
.set cq15, 15714
.set cq16, 15714
.set cq17, 15714
.set cq18, 15713
.set cq19, 15713
.set cq20, 15713
.set cq21, 15712
.set cq22, 15712
.set cq23, 15711
.set cq24, 15711
.set cq25, 15710
.set cq26, 15710
.set cq27, 15709
.set cq28, 15708
.set cq29, 15708
.set cq30, 15707
.set cq31, 15706
.set cq32, 15706
.set cq33, 15705
.set cq34, 15704
.set cq35, 15704
.set cq36, 15703
.set cq37, 15702
.set cq38, 15701
.set cq39, 15700
.set cq40, 15700
.set cq41, 15699
.set cq42, 15698
.set cq43, 15697
.set cq44, 15696
.set cq45, 15695
.set cq46, 15694
.set cq47, 15693
.set cq48, 15692
.set cq49, 15691
.set cq50, 15690
.set cq51, 15689
.set cq52, 15688
.set cq53, 15687
.set cq54, 15686
.set cq55, 15684
.set cq56, 15683
.set cq57, 15682
.set cq58, 15681
.set cq59, 15680
.set cq60, 15678
.set cq61, 15677
.set cq62, 15676
.set cq63, 15675
.set cq64, 15673
.set cq65, 15672
.set cq66, 15671
.set cq67, 15669
.set cq68, 15668
.set cq69, 15666
.set cq70, 15665
.set cq71, 15664
.set cq72, 15662
.set cq73, 15661
.set cq74, 15659
.set cq75, 15658
.set cq76, 15656
.set cq77, 15655
.set cq78, 15653
.set cq79, 15651
.set cq80, 15650
.set cq81, 15648
.set cq82, 15647
.set cq83, 15645
.set cq84, 15643
.set cq85, 15642
.set cq86, 15640
.set cq87, 15638
.set cq88, 15637
.set cq89, 15635
.set cq90, 15633
.set cq91, 15632
.set cq92, 15630
.set cq93, 15628
.set cq94, 15626
.set cq95, 15624
.set cq96, 15623
.set cq97, 15621
.set cq98, 15619
.set cq99, 15617
.set cq100, 15614
.set cq101, 15611
.set cq102, 15607
.set cq103, 15603
.set cq104, 15599
.set cq105, 15595
.set cq106, 15592
.set cq107, 15588
.set cq108, 15584
.set cq109, 15580
.set cq110, 15576
.set cq111, 15572
.set cq112, 15568
.set cq113, 15564
.set cq114, 15560
.set cq115, 15556
.set cq116, 15552
.set cq117, 15548
.set cq118, 15544
.set cq119, 15539
.set cq120, 15535
.set cq121, 15531
.set cq122, 15527
.set cq123, 15523
.set cq124, 15519
.set cq125, 15514
.set cq126, 15510
.set cq127, 15506
.set cq128, 15502
.set cq129, 15497
.set cq130, 15493
.set cq131, 15489
.set cq132, 15481
.set cq133, 15472
.set cq134, 15463
.set cq135, 15455
.set cq136, 15446
.set cq137, 15437
.set cq138, 15428
.set cq139, 15419
.set cq140, 15411
.set cq141, 15402
.set cq142, 15393
.set cq143, 15384
.set cq144, 15375
.set cq145, 15366
.set cq146, 15355
.set cq147, 15337
.set cq148, 15319
.set cq149, 15301
.set cq150, 15284
.set cq151, 15266
.set cq152, 15248
.set cq153, 15228
.set cq154, 15192
.set cq155, 15156
.set cq156, 15120
.set cq157, 15064
.set cq158, 14992
.set cq159, 14864
.set cq160, 0
.set cq161, 47632
.set cq162, 47760
.set cq163, 47832
.set cq164, 47888
.set cq165, 47924
.set cq166, 47960
.set cq167, 47996
.set cq168, 48016
.set cq169, 48034
.set cq170, 48052
.set cq171, 48069
.set cq172, 48087
.set cq173, 48105
.set cq174, 48123
.set cq175, 48134
.set cq176, 48143
.set cq177, 48152
.set cq178, 48161
.set cq179, 48170
.set cq180, 48179
.set cq181, 48187
.set cq182, 48196
.set cq183, 48205
.set cq184, 48214
.set cq185, 48223
.set cq186, 48231
.set cq187, 48240
.set cq188, 48249
.set cq189, 48257
.set cq190, 48261
.set cq191, 48265
.set cq192, 48270
.set cq193, 48274
.set cq194, 48278
.set cq195, 48282
.set cq196, 48287
.set cq197, 48291
.set cq198, 48295
.set cq199, 48299
.set cq200, 48303
.set cq201, 48307
.set cq202, 48312
.set cq203, 48316
.set cq204, 48320
.set cq205, 48324
.set cq206, 48328
.set cq207, 48332
.set cq208, 48336
.set cq209, 48340
.set cq210, 48344
.set cq211, 48348
.set cq212, 48352
.set cq213, 48356
.set cq214, 48360
.set cq215, 48363
.set cq216, 48367
.set cq217, 48371
.set cq218, 48375
.set cq219, 48379
.set cq220, 48382
.set cq221, 48385
.set cq222, 48387
.set cq223, 48389
.set cq224, 48391
.set cq225, 48392
.set cq226, 48394
.set cq227, 48396
.set cq228, 48398
.set cq229, 48400
.set cq230, 48401
.set cq231, 48403
.set cq232, 48405
.set cq233, 48406
.set cq234, 48408
.set cq235, 48410
.set cq236, 48411
.set cq237, 48413
.set cq238, 48415
.set cq239, 48416
.set cq240, 48418
.set cq241, 48419
.set cq242, 48421
.set cq243, 48423
.set cq244, 48424
.set cq245, 48426
.set cq246, 48427
.set cq247, 48429
.set cq248, 48430
.set cq249, 48432
.set cq250, 48433
.set cq251, 48434
.set cq252, 48436
.set cq253, 48437
.set cq254, 48439
.set cq255, 48440
.set cq256, 48441
.set cq257, 48443
.set cq258, 48444
.set cq259, 48445
.set cq260, 48446
.set cq261, 48448
.set cq262, 48449
.set cq263, 48450
.set cq264, 48451
.set cq265, 48452
.set cq266, 48454
.set cq267, 48455
.set cq268, 48456
.set cq269, 48457
.set cq270, 48458
.set cq271, 48459
.set cq272, 48460
.set cq273, 48461
.set cq274, 48462
.set cq275, 48463
.set cq276, 48464
.set cq277, 48465
.set cq278, 48466
.set cq279, 48467
.set cq280, 48468
.set cq281, 48468
.set cq282, 48469
.set cq283, 48470
.set cq284, 48471
.set cq285, 48472
.set cq286, 48472
.set cq287, 48473
.set cq288, 48474
.set cq289, 48474
.set cq290, 48475
.set cq291, 48476
.set cq292, 48476
.set cq293, 48477
.set cq294, 48478
.set cq295, 48478
.set cq296, 48479
.set cq297, 48479
.set cq298, 48480
.set cq299, 48480
.set cq300, 48481
.set cq301, 48481
.set cq302, 48481
.set cq303, 48482
.set cq304, 48482
.set cq305, 48482
.set cq306, 48483
.set cq307, 48483
.set cq308, 48483
.set cq309, 48484
.set cq310, 48484
.set cq311, 48484
.set cq312, 48484
.set cq313, 48484
.set cq314, 48485
.set cq315, 48485
.set cq316, 48485
.set cq317, 48485
.set cq318, 48485
.set cq319, 48485
.set cq320, 48485
.set cq321, 48485
.set cq322, 48485
.set cq323, 48485
.set cq324, 48485
.set cq325, 48485
.set cq326, 48485
.set cq327, 48484
.set cq328, 48484
.set cq329, 48484
.set cq330, 48484
.set cq331, 48484
.set cq332, 48483
.set cq333, 48483
.set cq334, 48483
.set cq335, 48482
.set cq336, 48482
.set cq337, 48482
.set cq338, 48481
.set cq339, 48481
.set cq340, 48481
.set cq341, 48480
.set cq342, 48480
.set cq343, 48479
.set cq344, 48479
.set cq345, 48478
.set cq346, 48478
.set cq347, 48477
.set cq348, 48476
.set cq349, 48476
.set cq350, 48475
.set cq351, 48474
.set cq352, 48474
.set cq353, 48473
.set cq354, 48472
.set cq355, 48472
.set cq356, 48471
.set cq357, 48470
.set cq358, 48469
.set cq359, 48468
.set cq360, 48468
.set cq361, 48467
.set cq362, 48466
.set cq363, 48465
.set cq364, 48464
.set cq365, 48463
.set cq366, 48462
.set cq367, 48461
.set cq368, 48460
.set cq369, 48459
.set cq370, 48458
.set cq371, 48457
.set cq372, 48456
.set cq373, 48455
.set cq374, 48454
.set cq375, 48452
.set cq376, 48451
.set cq377, 48450
.set cq378, 48449
.set cq379, 48448
.set cq380, 48446
.set cq381, 48445
.set cq382, 48444
.set cq383, 48443
.set cq384, 48441
.set cq385, 48440
.set cq386, 48439
.set cq387, 48437
.set cq388, 48436
.set cq389, 48434
.set cq390, 48433
.set cq391, 48432
.set cq392, 48430
.set cq393, 48429
.set cq394, 48427
.set cq395, 48426
.set cq396, 48424
.set cq397, 48423
.set cq398, 48421
.set cq399, 48419
.set cq400, 48418
.set cq401, 48416
.set cq402, 48415
.set cq403, 48413
.set cq404, 48411
.set cq405, 48410
.set cq406, 48408
.set cq407, 48406
.set cq408, 48405
.set cq409, 48403
.set cq410, 48401
.set cq411, 48400
.set cq412, 48398
.set cq413, 48396
.set cq414, 48394
.set cq415, 48392
.set cq416, 48391
.set cq417, 48389
.set cq418, 48387
.set cq419, 48385
.set cq420, 48382
.set cq421, 48379
.set cq422, 48375
.set cq423, 48371
.set cq424, 48367
.set cq425, 48363
.set cq426, 48360
.set cq427, 48356
.set cq428, 48352
.set cq429, 48348
.set cq430, 48344
.set cq431, 48340
.set cq432, 48336
.set cq433, 48332
.set cq434, 48328
.set cq435, 48324
.set cq436, 48320
.set cq437, 48316
.set cq438, 48312
.set cq439, 48307
.set cq440, 48303
.set cq441, 48299
.set cq442, 48295
.set cq443, 48291
.set cq444, 48287
.set cq445, 48282
.set cq446, 48278
.set cq447, 48274
.set cq448, 48270
.set cq449, 48265
.set cq450, 48261
.set cq451, 48257
.set cq452, 48249
.set cq453, 48240
.set cq454, 48231
.set cq455, 48223
.set cq456, 48214
.set cq457, 48205
.set cq458, 48196
.set cq459, 48187
.set cq460, 48179
.set cq461, 48170
.set cq462, 48161
.set cq463, 48152
.set cq464, 48143
.set cq465, 48134
.set cq466, 48123
.set cq467, 48105
.set cq468, 48087
.set cq469, 48069
.set cq470, 48052
.set cq471, 48034
.set cq472, 48016
.set cq473, 47996
.set cq474, 47960
.set cq475, 47924
.set cq476, 47888
.set cq477, 47832
.set cq478, 47760
.set cq479, 47632
.set cq480, 0
.set cq481, 14864
.set cq482, 14992
.set cq483, 15064
.set cq484, 15120
.set cq485, 15156
.set cq486, 15192
.set cq487, 15228
.set cq488, 15248
.set cq489, 15266
.set cq490, 15284
.set cq491, 15301
.set cq492, 15319
.set cq493, 15337
.set cq494, 15355
.set cq495, 15366
.set cq496, 15375
.set cq497, 15384
.set cq498, 15393
.set cq499, 15402
.set cq500, 15411
.set cq501, 15419
.set cq502, 15428
.set cq503, 15437
.set cq504, 15446
.set cq505, 15455
.set cq506, 15463
.set cq507, 15472
.set cq508, 15481
.set cq509, 15489
.set cq510, 15493
.set cq511, 15497
.set cq512, 15502
.set cq513, 15506
.set cq514, 15510
.set cq515, 15514
.set cq516, 15519
.set cq517, 15523
.set cq518, 15527
.set cq519, 15531
.set cq520, 15535
.set cq521, 15539
.set cq522, 15544
.set cq523, 15548
.set cq524, 15552
.set cq525, 15556
.set cq526, 15560
.set cq527, 15564
.set cq528, 15568
.set cq529, 15572
.set cq530, 15576
.set cq531, 15580
.set cq532, 15584
.set cq533, 15588
.set cq534, 15592
.set cq535, 15595
.set cq536, 15599
.set cq537, 15603
.set cq538, 15607
.set cq539, 15611
.set cq540, 15614
.set cq541, 15617
.set cq542, 15619
.set cq543, 15621
.set cq544, 15623
.set cq545, 15624
.set cq546, 15626
.set cq547, 15628
.set cq548, 15630
.set cq549, 15632
.set cq550, 15633
.set cq551, 15635
.set cq552, 15637
.set cq553, 15638
.set cq554, 15640
.set cq555, 15642
.set cq556, 15643
.set cq557, 15645
.set cq558, 15647
.set cq559, 15648
.set cq560, 15650
.set cq561, 15651
.set cq562, 15653
.set cq563, 15655
.set cq564, 15656
.set cq565, 15658
.set cq566, 15659
.set cq567, 15661
.set cq568, 15662
.set cq569, 15664
.set cq570, 15665
.set cq571, 15666
.set cq572, 15668
.set cq573, 15669
.set cq574, 15671
.set cq575, 15672
.set cq576, 15673
.set cq577, 15675
.set cq578, 15676
.set cq579, 15677
.set cq580, 15678
.set cq581, 15680
.set cq582, 15681
.set cq583, 15682
.set cq584, 15683
.set cq585, 15684
.set cq586, 15686
.set cq587, 15687
.set cq588, 15688
.set cq589, 15689
.set cq590, 15690
.set cq591, 15691
.set cq592, 15692
.set cq593, 15693
.set cq594, 15694
.set cq595, 15695
.set cq596, 15696
.set cq597, 15697
.set cq598, 15698
.set cq599, 15699
.set cq600, 15700
.set cq601, 15700
.set cq602, 15701
.set cq603, 15702
.set cq604, 15703
.set cq605, 15704
.set cq606, 15704
.set cq607, 15705
.set cq608, 15706
.set cq609, 15706
.set cq610, 15707
.set cq611, 15708
.set cq612, 15708
.set cq613, 15709
.set cq614, 15710
.set cq615, 15710
.set cq616, 15711
.set cq617, 15711
.set cq618, 15712
.set cq619, 15712
.set cq620, 15713
.set cq621, 15713
.set cq622, 15713
.set cq623, 15714
.set cq624, 15714
.set cq625, 15714
.set cq626, 15715
.set cq627, 15715
.set cq628, 15715
.set cq629, 15716
.set cq630, 15716
.set cq631, 15716
.set cq632, 15716
.set cq633, 15716
.set cq634, 15717
.set cq635, 15717
.set cq636, 15717
.set cq637, 15717
.set cq638, 15717
.set cq639, 15717
.altmacro
.macro e8 a,b,c,d,e,f,g,h
.short cq\a, cq\b, cq\c, cq\d, cq\e, cq\f, cq\g, cq\h
.endm
.macro e6 a,b,c,d,e,f
.short cq\a, cq\b, cq\c, cq\d, cq\e, cq\f
.endm
.p2align 12
ft2:
.set tt, 0
.rept 40
.set td, tt
.rept 16
.short 15650+((td&1)<<15), 15650
e6 %((20*td+0)%640), %((20*td+160)%640), %((160*td+0)%640), %((160*td+160)%640), %((180*td+0)%640), %((180*td+160)%640)
.set td, td+1
.endr
.set td, tt
.rept 16
e8 %((40*td+0)%640), %((40*td+160)%640), %((60*td+0)%640), %((60*td+160)%640), %((200*td+0)%640), %((200*td+160)%640), %((220*td+0)%640), %((220*td+160)%640)
.set td, td+1
.endr
.set td, tt
.rept 16
e8 %((80*td+0)%640), %((80*td+160)%640), %((100*td+0)%640), %((100*td+160)%640), %((240*td+0)%640), %((240*td+160)%640), %((260*td+0)%640), %((260*td+160)%640)
.set td, td+1
.endr
.set td, tt
.rept 16
e8 %((120*td+0)%640), %((120*td+160)%640), %((140*td+0)%640), %((140*td+160)%640), %((280*td+0)%640), %((280*td+160)%640), %((300*td+0)%640), %((300*td+160)%640)
.set td, td+1
.endr
.set td, tt
.rept 16
e8 %((310*td+0)%640), %((310*td+160)%640), %((290*td+0)%640), %((290*td+160)%640), %((150*td+0)%640), %((150*td+160)%640), %((130*td+0)%640), %((130*td+160)%640)
.set td, td+1
.endr
.set td, tt
.rept 16
e8 %((270*td+0)%640), %((270*td+160)%640), %((250*td+0)%640), %((250*td+160)%640), %((110*td+0)%640), %((110*td+160)%640), %((90*td+0)%640), %((90*td+160)%640)
.set td, td+1
.endr
.set td, tt
.rept 16
e8 %((230*td+0)%640), %((230*td+160)%640), %((210*td+0)%640), %((210*td+160)%640), %((70*td+0)%640), %((70*td+160)%640), %((50*td+0)%640), %((50*td+160)%640)
.set td, td+1
.endr
.set td, tt
.rept 16
e8 %((190*td+0)%640), %((190*td+160)%640), %((170*td+0)%640), %((170*td+160)%640), %((30*td+0)%640), %((30*td+160)%640), %((10*td+0)%640), %((10*td+160)%640)
.set td, td+1
.endr
.set td, tt
.rept 16
e8 %((1*td+0)%640), %((1*td+160)%640), %((21*td+0)%640), %((21*td+160)%640), %((161*td+0)%640), %((161*td+160)%640), %((181*td+0)%640), %((181*td+160)%640)
.set td, td+1
.endr
.set td, tt
.rept 16
e8 %((41*td+0)%640), %((41*td+160)%640), %((61*td+0)%640), %((61*td+160)%640), %((201*td+0)%640), %((201*td+160)%640), %((221*td+0)%640), %((221*td+160)%640)
.set td, td+1
.endr
.set td, tt
.rept 16
e8 %((81*td+0)%640), %((81*td+160)%640), %((101*td+0)%640), %((101*td+160)%640), %((241*td+0)%640), %((241*td+160)%640), %((261*td+0)%640), %((261*td+160)%640)
.set td, td+1
.endr
.set td, tt
.rept 16
e8 %((121*td+0)%640), %((121*td+160)%640), %((141*td+0)%640), %((141*td+160)%640), %((281*td+0)%640), %((281*td+160)%640), %((301*td+0)%640), %((301*td+160)%640)
.set td, td+1
.endr
.set td, tt
.rept 16
e8 %((319*td+0)%640), %((319*td+160)%640), %((299*td+0)%640), %((299*td+160)%640), %((159*td+0)%640), %((159*td+160)%640), %((139*td+0)%640), %((139*td+160)%640)
.set td, td+1
.endr
.set td, tt
.rept 16
e8 %((279*td+0)%640), %((279*td+160)%640), %((259*td+0)%640), %((259*td+160)%640), %((119*td+0)%640), %((119*td+160)%640), %((99*td+0)%640), %((99*td+160)%640)
.set td, td+1
.endr
.set td, tt
.rept 16
e8 %((239*td+0)%640), %((239*td+160)%640), %((219*td+0)%640), %((219*td+160)%640), %((79*td+0)%640), %((79*td+160)%640), %((59*td+0)%640), %((59*td+160)%640)
.set td, td+1
.endr
.set td, tt
.rept 16
e8 %((199*td+0)%640), %((199*td+160)%640), %((179*td+0)%640), %((179*td+160)%640), %((39*td+0)%640), %((39*td+160)%640), %((19*td+0)%640), %((19*td+160)%640)
.set td, td+1
.endr
.set td, tt
.rept 16
e8 %((2*td+0)%640), %((2*td+160)%640), %((22*td+0)%640), %((22*td+160)%640), %((162*td+0)%640), %((162*td+160)%640), %((182*td+0)%640), %((182*td+160)%640)
.set td, td+1
.endr
.set td, tt
.rept 16
e8 %((42*td+0)%640), %((42*td+160)%640), %((62*td+0)%640), %((62*td+160)%640), %((202*td+0)%640), %((202*td+160)%640), %((222*td+0)%640), %((222*td+160)%640)
.set td, td+1
.endr
.set td, tt
.rept 16
e8 %((82*td+0)%640), %((82*td+160)%640), %((102*td+0)%640), %((102*td+160)%640), %((242*td+0)%640), %((242*td+160)%640), %((262*td+0)%640), %((262*td+160)%640)
.set td, td+1
.endr
.set td, tt
.rept 16
e8 %((122*td+0)%640), %((122*td+160)%640), %((142*td+0)%640), %((142*td+160)%640), %((282*td+0)%640), %((282*td+160)%640), %((302*td+0)%640), %((302*td+160)%640)
.set td, td+1
.endr
.set td, tt
.rept 16
e8 %((318*td+0)%640), %((318*td+160)%640), %((298*td+0)%640), %((298*td+160)%640), %((158*td+0)%640), %((158*td+160)%640), %((138*td+0)%640), %((138*td+160)%640)
.set td, td+1
.endr
.set td, tt
.rept 16
e8 %((278*td+0)%640), %((278*td+160)%640), %((258*td+0)%640), %((258*td+160)%640), %((118*td+0)%640), %((118*td+160)%640), %((98*td+0)%640), %((98*td+160)%640)
.set td, td+1
.endr
.set td, tt
.rept 16
e8 %((238*td+0)%640), %((238*td+160)%640), %((218*td+0)%640), %((218*td+160)%640), %((78*td+0)%640), %((78*td+160)%640), %((58*td+0)%640), %((58*td+160)%640)
.set td, td+1
.endr
.set td, tt
.rept 16
e8 %((198*td+0)%640), %((198*td+160)%640), %((178*td+0)%640), %((178*td+160)%640), %((38*td+0)%640), %((38*td+160)%640), %((18*td+0)%640), %((18*td+160)%640)
.set td, td+1
.endr
.set td, tt
.rept 16
e8 %((3*td+0)%640), %((3*td+160)%640), %((23*td+0)%640), %((23*td+160)%640), %((163*td+0)%640), %((163*td+160)%640), %((183*td+0)%640), %((183*td+160)%640)
.set td, td+1
.endr
.set td, tt
.rept 16
e8 %((43*td+0)%640), %((43*td+160)%640), %((63*td+0)%640), %((63*td+160)%640), %((203*td+0)%640), %((203*td+160)%640), %((223*td+0)%640), %((223*td+160)%640)
.set td, td+1
.endr
.set td, tt
.rept 16
e8 %((83*td+0)%640), %((83*td+160)%640), %((103*td+0)%640), %((103*td+160)%640), %((243*td+0)%640), %((243*td+160)%640), %((263*td+0)%640), %((263*td+160)%640)
.set td, td+1
.endr
.set td, tt
.rept 16
e8 %((123*td+0)%640), %((123*td+160)%640), %((143*td+0)%640), %((143*td+160)%640), %((283*td+0)%640), %((283*td+160)%640), %((303*td+0)%640), %((303*td+160)%640)
.set td, td+1
.endr
.set td, tt
.rept 16
e8 %((317*td+0)%640), %((317*td+160)%640), %((297*td+0)%640), %((297*td+160)%640), %((157*td+0)%640), %((157*td+160)%640), %((137*td+0)%640), %((137*td+160)%640)
.set td, td+1
.endr
.set td, tt
.rept 16
e8 %((277*td+0)%640), %((277*td+160)%640), %((257*td+0)%640), %((257*td+160)%640), %((117*td+0)%640), %((117*td+160)%640), %((97*td+0)%640), %((97*td+160)%640)
.set td, td+1
.endr
.set td, tt
.rept 16
e8 %((237*td+0)%640), %((237*td+160)%640), %((217*td+0)%640), %((217*td+160)%640), %((77*td+0)%640), %((77*td+160)%640), %((57*td+0)%640), %((57*td+160)%640)
.set td, td+1
.endr
.set td, tt
.rept 16
e8 %((197*td+0)%640), %((197*td+160)%640), %((177*td+0)%640), %((177*td+160)%640), %((37*td+0)%640), %((37*td+160)%640), %((17*td+0)%640), %((17*td+160)%640)
.set td, td+1
.endr
.set td, tt
.rept 16
e8 %((4*td+0)%640), %((4*td+160)%640), %((24*td+0)%640), %((24*td+160)%640), %((164*td+0)%640), %((164*td+160)%640), %((184*td+0)%640), %((184*td+160)%640)
.set td, td+1
.endr
.set td, tt
.rept 16
e8 %((44*td+0)%640), %((44*td+160)%640), %((64*td+0)%640), %((64*td+160)%640), %((204*td+0)%640), %((204*td+160)%640), %((224*td+0)%640), %((224*td+160)%640)
.set td, td+1
.endr
.set td, tt
.rept 16
e8 %((84*td+0)%640), %((84*td+160)%640), %((104*td+0)%640), %((104*td+160)%640), %((244*td+0)%640), %((244*td+160)%640), %((264*td+0)%640), %((264*td+160)%640)
.set td, td+1
.endr
.set td, tt
.rept 16
e8 %((124*td+0)%640), %((124*td+160)%640), %((144*td+0)%640), %((144*td+160)%640), %((284*td+0)%640), %((284*td+160)%640), %((304*td+0)%640), %((304*td+160)%640)
.set td, td+1
.endr
.set td, tt
.rept 16
e8 %((316*td+0)%640), %((316*td+160)%640), %((296*td+0)%640), %((296*td+160)%640), %((156*td+0)%640), %((156*td+160)%640), %((136*td+0)%640), %((136*td+160)%640)
.set td, td+1
.endr
.set td, tt
.rept 16
e8 %((276*td+0)%640), %((276*td+160)%640), %((256*td+0)%640), %((256*td+160)%640), %((116*td+0)%640), %((116*td+160)%640), %((96*td+0)%640), %((96*td+160)%640)
.set td, td+1
.endr
.set td, tt
.rept 16
e8 %((236*td+0)%640), %((236*td+160)%640), %((216*td+0)%640), %((216*td+160)%640), %((76*td+0)%640), %((76*td+160)%640), %((56*td+0)%640), %((56*td+160)%640)
.set td, td+1
.endr
.set td, tt
.rept 16
e8 %((196*td+0)%640), %((196*td+160)%640), %((176*td+0)%640), %((176*td+160)%640), %((36*td+0)%640), %((36*td+160)%640), %((16*td+0)%640), %((16*td+160)%640)
.set td, td+1
.endr
.set td, tt
.rept 16
e8 %((5*td+0)%640), %((5*td+160)%640), %((25*td+0)%640), %((25*td+160)%640), %((165*td+0)%640), %((165*td+160)%640), %((185*td+0)%640), %((185*td+160)%640)
.set td, td+1
.endr
.set td, tt
.rept 16
e8 %((45*td+0)%640), %((45*td+160)%640), %((65*td+0)%640), %((65*td+160)%640), %((205*td+0)%640), %((205*td+160)%640), %((225*td+0)%640), %((225*td+160)%640)
.set td, td+1
.endr
.set td, tt
.rept 16
e8 %((85*td+0)%640), %((85*td+160)%640), %((105*td+0)%640), %((105*td+160)%640), %((245*td+0)%640), %((245*td+160)%640), %((265*td+0)%640), %((265*td+160)%640)
.set td, td+1
.endr
.set td, tt
.rept 16
e8 %((125*td+0)%640), %((125*td+160)%640), %((145*td+0)%640), %((145*td+160)%640), %((285*td+0)%640), %((285*td+160)%640), %((305*td+0)%640), %((305*td+160)%640)
.set td, td+1
.endr
.set td, tt
.rept 16
e8 %((315*td+0)%640), %((315*td+160)%640), %((295*td+0)%640), %((295*td+160)%640), %((155*td+0)%640), %((155*td+160)%640), %((135*td+0)%640), %((135*td+160)%640)
.set td, td+1
.endr
.set td, tt
.rept 16
e8 %((275*td+0)%640), %((275*td+160)%640), %((255*td+0)%640), %((255*td+160)%640), %((115*td+0)%640), %((115*td+160)%640), %((95*td+0)%640), %((95*td+160)%640)
.set td, td+1
.endr
.set td, tt
.rept 16
e8 %((235*td+0)%640), %((235*td+160)%640), %((215*td+0)%640), %((215*td+160)%640), %((75*td+0)%640), %((75*td+160)%640), %((55*td+0)%640), %((55*td+160)%640)
.set td, td+1
.endr
.set td, tt
.rept 16
e8 %((195*td+0)%640), %((195*td+160)%640), %((175*td+0)%640), %((175*td+160)%640), %((35*td+0)%640), %((35*td+160)%640), %((15*td+0)%640), %((15*td+160)%640)
.set td, td+1
.endr
.set td, tt
.rept 16
e8 %((6*td+0)%640), %((6*td+160)%640), %((26*td+0)%640), %((26*td+160)%640), %((166*td+0)%640), %((166*td+160)%640), %((186*td+0)%640), %((186*td+160)%640)
.set td, td+1
.endr
.set td, tt
.rept 16
e8 %((46*td+0)%640), %((46*td+160)%640), %((66*td+0)%640), %((66*td+160)%640), %((206*td+0)%640), %((206*td+160)%640), %((226*td+0)%640), %((226*td+160)%640)
.set td, td+1
.endr
.set td, tt
.rept 16
e8 %((86*td+0)%640), %((86*td+160)%640), %((106*td+0)%640), %((106*td+160)%640), %((246*td+0)%640), %((246*td+160)%640), %((266*td+0)%640), %((266*td+160)%640)
.set td, td+1
.endr
.set td, tt
.rept 16
e8 %((126*td+0)%640), %((126*td+160)%640), %((146*td+0)%640), %((146*td+160)%640), %((286*td+0)%640), %((286*td+160)%640), %((306*td+0)%640), %((306*td+160)%640)
.set td, td+1
.endr
.set td, tt
.rept 16
e8 %((314*td+0)%640), %((314*td+160)%640), %((294*td+0)%640), %((294*td+160)%640), %((154*td+0)%640), %((154*td+160)%640), %((134*td+0)%640), %((134*td+160)%640)
.set td, td+1
.endr
.set td, tt
.rept 16
e8 %((274*td+0)%640), %((274*td+160)%640), %((254*td+0)%640), %((254*td+160)%640), %((114*td+0)%640), %((114*td+160)%640), %((94*td+0)%640), %((94*td+160)%640)
.set td, td+1
.endr
.set td, tt
.rept 16
e8 %((234*td+0)%640), %((234*td+160)%640), %((214*td+0)%640), %((214*td+160)%640), %((74*td+0)%640), %((74*td+160)%640), %((54*td+0)%640), %((54*td+160)%640)
.set td, td+1
.endr
.set td, tt
.rept 16
e8 %((194*td+0)%640), %((194*td+160)%640), %((174*td+0)%640), %((174*td+160)%640), %((34*td+0)%640), %((34*td+160)%640), %((14*td+0)%640), %((14*td+160)%640)
.set td, td+1
.endr
.set td, tt
.rept 16
e8 %((7*td+0)%640), %((7*td+160)%640), %((27*td+0)%640), %((27*td+160)%640), %((167*td+0)%640), %((167*td+160)%640), %((187*td+0)%640), %((187*td+160)%640)
.set td, td+1
.endr
.set td, tt
.rept 16
e8 %((47*td+0)%640), %((47*td+160)%640), %((67*td+0)%640), %((67*td+160)%640), %((207*td+0)%640), %((207*td+160)%640), %((227*td+0)%640), %((227*td+160)%640)
.set td, td+1
.endr
.set td, tt
.rept 16
e8 %((87*td+0)%640), %((87*td+160)%640), %((107*td+0)%640), %((107*td+160)%640), %((247*td+0)%640), %((247*td+160)%640), %((267*td+0)%640), %((267*td+160)%640)
.set td, td+1
.endr
.set td, tt
.rept 16
e8 %((127*td+0)%640), %((127*td+160)%640), %((147*td+0)%640), %((147*td+160)%640), %((287*td+0)%640), %((287*td+160)%640), %((307*td+0)%640), %((307*td+160)%640)
.set td, td+1
.endr
.set td, tt
.rept 16
e8 %((313*td+0)%640), %((313*td+160)%640), %((293*td+0)%640), %((293*td+160)%640), %((153*td+0)%640), %((153*td+160)%640), %((133*td+0)%640), %((133*td+160)%640)
.set td, td+1
.endr
.set td, tt
.rept 16
e8 %((273*td+0)%640), %((273*td+160)%640), %((253*td+0)%640), %((253*td+160)%640), %((113*td+0)%640), %((113*td+160)%640), %((93*td+0)%640), %((93*td+160)%640)
.set td, td+1
.endr
.set td, tt
.rept 16
e8 %((233*td+0)%640), %((233*td+160)%640), %((213*td+0)%640), %((213*td+160)%640), %((73*td+0)%640), %((73*td+160)%640), %((53*td+0)%640), %((53*td+160)%640)
.set td, td+1
.endr
.set td, tt
.rept 16
e8 %((193*td+0)%640), %((193*td+160)%640), %((173*td+0)%640), %((173*td+160)%640), %((33*td+0)%640), %((33*td+160)%640), %((13*td+0)%640), %((13*td+160)%640)
.set td, td+1
.endr
.set td, tt
.rept 16
e8 %((8*td+0)%640), %((8*td+160)%640), %((28*td+0)%640), %((28*td+160)%640), %((168*td+0)%640), %((168*td+160)%640), %((188*td+0)%640), %((188*td+160)%640)
.set td, td+1
.endr
.set td, tt
.rept 16
e8 %((48*td+0)%640), %((48*td+160)%640), %((68*td+0)%640), %((68*td+160)%640), %((208*td+0)%640), %((208*td+160)%640), %((228*td+0)%640), %((228*td+160)%640)
.set td, td+1
.endr
.set td, tt
.rept 16
e8 %((88*td+0)%640), %((88*td+160)%640), %((108*td+0)%640), %((108*td+160)%640), %((248*td+0)%640), %((248*td+160)%640), %((268*td+0)%640), %((268*td+160)%640)
.set td, td+1
.endr
.set td, tt
.rept 16
e8 %((128*td+0)%640), %((128*td+160)%640), %((148*td+0)%640), %((148*td+160)%640), %((288*td+0)%640), %((288*td+160)%640), %((308*td+0)%640), %((308*td+160)%640)
.set td, td+1
.endr
.set td, tt
.rept 16
e8 %((312*td+0)%640), %((312*td+160)%640), %((292*td+0)%640), %((292*td+160)%640), %((152*td+0)%640), %((152*td+160)%640), %((132*td+0)%640), %((132*td+160)%640)
.set td, td+1
.endr
.set td, tt
.rept 16
e8 %((272*td+0)%640), %((272*td+160)%640), %((252*td+0)%640), %((252*td+160)%640), %((112*td+0)%640), %((112*td+160)%640), %((92*td+0)%640), %((92*td+160)%640)
.set td, td+1
.endr
.set td, tt
.rept 16
e8 %((232*td+0)%640), %((232*td+160)%640), %((212*td+0)%640), %((212*td+160)%640), %((72*td+0)%640), %((72*td+160)%640), %((52*td+0)%640), %((52*td+160)%640)
.set td, td+1
.endr
.set td, tt
.rept 16
e8 %((192*td+0)%640), %((192*td+160)%640), %((172*td+0)%640), %((172*td+160)%640), %((32*td+0)%640), %((32*td+160)%640), %((12*td+0)%640), %((12*td+160)%640)
.set td, td+1
.endr
.set td, tt
.rept 16
e8 %((9*td+0)%640), %((9*td+160)%640), %((29*td+0)%640), %((29*td+160)%640), %((169*td+0)%640), %((169*td+160)%640), %((189*td+0)%640), %((189*td+160)%640)
.set td, td+1
.endr
.set td, tt
.rept 16
e8 %((49*td+0)%640), %((49*td+160)%640), %((69*td+0)%640), %((69*td+160)%640), %((209*td+0)%640), %((209*td+160)%640), %((229*td+0)%640), %((229*td+160)%640)
.set td, td+1
.endr
.set td, tt
.rept 16
e8 %((89*td+0)%640), %((89*td+160)%640), %((109*td+0)%640), %((109*td+160)%640), %((249*td+0)%640), %((249*td+160)%640), %((269*td+0)%640), %((269*td+160)%640)
.set td, td+1
.endr
.set td, tt
.rept 16
e8 %((129*td+0)%640), %((129*td+160)%640), %((149*td+0)%640), %((149*td+160)%640), %((289*td+0)%640), %((289*td+160)%640), %((309*td+0)%640), %((309*td+160)%640)
.set td, td+1
.endr
.set td, tt
.rept 16
e8 %((311*td+0)%640), %((311*td+160)%640), %((291*td+0)%640), %((291*td+160)%640), %((151*td+0)%640), %((151*td+160)%640), %((131*td+0)%640), %((131*td+160)%640)
.set td, td+1
.endr
.set td, tt
.rept 16
e8 %((271*td+0)%640), %((271*td+160)%640), %((251*td+0)%640), %((251*td+160)%640), %((111*td+0)%640), %((111*td+160)%640), %((91*td+0)%640), %((91*td+160)%640)
.set td, td+1
.endr
.set td, tt
.rept 16
e8 %((231*td+0)%640), %((231*td+160)%640), %((211*td+0)%640), %((211*td+160)%640), %((71*td+0)%640), %((71*td+160)%640), %((51*td+0)%640), %((51*td+160)%640)
.set td, td+1
.endr
.set td, tt
.rept 16
e8 %((191*td+0)%640), %((191*td+160)%640), %((171*td+0)%640), %((171*td+160)%640), %((31*td+0)%640), %((31*td+160)%640), %((11*td+0)%640), %((11*td+160)%640)
.set td, td+1
.endr
.set tt, tt+16
.endr
.noaltmacro
```
